```python
import torch

def _softmax(x, axis=-1):
    return torch.softmax(x, dim=axis)

def _gelu(x):
    return torch.nn.functional.gelu(x, approximate='tanh')

def _silu(x):
    return torch.nn.functional.silu(x)

def _sigmoid(x):
    return torch.sigmoid(x)

def _layernorm(x, axis=-1, eps=1e-05):
    m = x.mean(dim=axis, keepdim=True)
    v = x.var(dim=axis, keepdim=True, unbiased=False)
    return (x - m) / torch.sqrt(v + eps)

def _scatter_add(tgt, idx, src, axis=0):
    return tgt.clone().index_add_(axis, idx, src)

def _segment_sum(src, seg, n):
    out = torch.zeros((n,) + src.shape[1:], dtype=src.dtype)
    return out.index_add_(0, seg, src)

def _pad(x, pw):
    flat = tuple((v for pair in reversed(pw) for v in pair))
    return torch.nn.functional.pad(x, flat)
kernel_name = 'adaLN_cond__sliding_local_dilated__dense_activation_relu__prompt'

def setup_inputs():

    _w = lambda a: (lambda t: t.to(torch.bfloat16) if t.is_floating_point() else t)(torch.as_tensor(a))

    def _A_setup():
        B, S, D = (1, 2048, 576)
        return {'x': _w((lambda *s: torch.randn(*s, dtype=torch.bfloat16) * 0.05)(B, S, D)), 'wqkv': _w((lambda *s: torch.randn(*s, dtype=torch.bfloat16) * 0.05)(D, 3 * D)), 'wo': _w((lambda *s: torch.randn(*s, dtype=torch.bfloat16) * 0.05)(D, D))}
    _A_in = _A_setup()

    def _B_setup():
        B, S, D, Dff = (1, 2048, 576, 4608)
        return {'x': _w((lambda *s: torch.randn(*s, dtype=torch.bfloat16) * 0.05)(B, S, D)), 'w1': _w((lambda *s: torch.randn(*s, dtype=torch.bfloat16) * 0.05)(D, Dff)), 'w2': _w((lambda *s: torch.randn(*s, dtype=torch.bfloat16) * 0.05)(Dff, D))}
    _B_in = _B_setup()
    return {'A_x': _A_in['x'], 'A_wqkv': _A_in['wqkv'], 'A_wo': _A_in['wo'], 'B_x': _B_in['x'], 'B_w1': _B_in['w1'], 'B_w2': _B_in['w2'], 'c': _w((lambda *s: torch.randn(*s, dtype=torch.bfloat16) * 0.1)(1, 576) * 8.0), 'w_mod': _w((lambda *s: torch.randn(*s, dtype=torch.bfloat16) * 0.1)(576, 6 * 576) * 576 ** (-0.5) * 8.0)}

def reference(A_x, A_wqkv, A_wo, B_x, B_w1, B_w2, c, w_mod):

    def _A_ref(x, wqkv, wo):
        B, S, D = x.shape
        H = 32
        Dh = D // H
        W, dil = (8, 2)
        qkv = (lambda x, *d: x.permute(*d))((x @ wqkv).reshape(B, S, 3, H, Dh), 2, 0, 3, 1, 4)
        q, k, v = (qkv[0], qkv[1], qkv[2])
        scale = Dh ** (-0.5)
        pos = torch.arange(S)
        off = torch.arange(W) * dil
        idx = pos[:, None] - off[None, :]
        mask = idx >= 0
        idx_c = torch.where(mask, idx, 0).reshape(-1)
        kg = k[:, :, idx_c, :].reshape(B, H, S, W, Dh)
        vg = v[:, :, idx_c, :].reshape(B, H, S, W, Dh)
        logits = torch.einsum('bhsd,bhswd->bhsw', q, kg) * scale
        logits = torch.where(mask[None, None, :, :], logits, -1000000000.0)
        attn = _softmax(logits, axis=-1)
        o = torch.einsum('bhsw,bhswd->bhsd', attn, vg)
        return (lambda x, *d: x.permute(*d))(o, 0, 2, 1, 3).reshape(B, S, D) @ wo

    def _B_ref(x, w1, w2):
        h = torch.einsum('bsd,df->bsf', x, w1)
        zero = torch.zeros_like(h)
        h = torch.maximum(h, zero)
        return torch.einsum('bsf,fd->bsd', h, w2)
    x = A_x
    mod = (_silu(c) @ w_mod).reshape(c.shape[0], 6, 1, -1)
    sa, ca, ga, sb, cb, gb = (mod[:, 0].clone(), mod[:, 1].clone(), mod[:, 2].clone(), mod[:, 3].clone(), mod[:, 4].clone(), mod[:, 5].clone())
    h = _layernorm(x, axis=-1) * (1 + ca) + sa
    x = x + ga * _A_ref(h, A_wqkv, A_wo)
    h = _layernorm(x, axis=-1) * (1 + cb) + sb
    x = x + gb * _B_ref(h, B_w1, B_w2)
    return x
```

```asm
; @launch kernel=k0_kernel grid=(496,1,1) block=(256,1,1) lds=24576
; @launch kernel=kf_kernel grid=(256,1,1) block=(256,1,1) lds=163840
.amdgcn_target "amdgcn-amd-amdhsa--gfx950"
.text
.globl k0_kernel
.p2align 8
.type k0_kernel,@function
k0_kernel:
  s_cmp_ge_u32 s2, 496
  s_cbranch_scc1 L_end_k0_kernel
  s_load_dwordx2 s[12:13], s[0:1], 80
  s_mov_b32 s14, 52715520
  s_mov_b32 s15, 0x20000
  s_cmp_ge_u32 s2, 352
  s_cbranch_scc1 L_relay
  s_cmp_ge_u32 s2, 224
  s_cbranch_scc1 L_ln
  s_getpc_b64 s[28:29]
L_pc:
  s_add_u32 s28, s28, kf_kernel-L_pc
  s_addc_u32 s29, s29, 0
  s_lshr_b32 s30, s2, 3
  s_lshl_b32 s30, s30, 12
  v_lshl_add_u32 v60, v0, 4, s30
  v_min_u32 v60, L_kf_last-kf_kernel-16, v60
  v_mov_b32 v61, s29
  v_add_co_u32 v60, vcc, s28, v60
  s_nop 1
  v_addc_co_u32 v61, vcc, 0, v61, vcc
  global_load_dwordx4 v[64:67], v[60:61], off
  s_load_dwordx2 s[4:5], s[0:1], 48
  s_mov_b32 s6, 1152
  s_mov_b32 s7, 0x20000
  s_load_dwordx2 s[8:9], s[0:1], 56
  s_mov_b32 s10, 3981312
  s_mov_b32 s11, 0x20000
  s_and_b32 s20, s2, 7
  s_lshr_b32 s21, s2, 3
  s_mul_i32 s20, s20, 7
  s_lshr_b32 s22, s21, 2
  s_add_u32 s20, s20, s22
  s_cmp_ge_u32 s20, 54
  s_cbranch_scc1 L_end_k0_kernel
  s_and_b32 s21, s21, 3
  s_lshl_b32 s20, s20, 2
  s_add_u32 s20, s20, s21
  s_lshl_b32 s23, s20, 5
  v_lshrrev_b32 v1, 1, v0
  v_and_b32 v2, 1, v0
  v_lshlrev_b32 v2, 4, v2
  v_mul_u32_u24 v3, 6912, v1
  v_add_u32 v3, v3, v2
  v_lshlrev_b32 v4, 1, v1
  s_waitcnt lgkmcnt(0)
  buffer_load_ushort v10, v4, s[4:7], 0 offen offset:0
  buffer_load_ushort v11, v4, s[4:7], 0 offen offset:256
  buffer_load_ushort v12, v4, s[4:7], 0 offen offset:512
  buffer_load_ushort v13, v4, s[4:7], 0 offen offset:768
  buffer_load_ushort v14, v4, s[4:7], 0 offen offset:1024
  buffer_load_dwordx4 v[16:19], v3, s[8:11], s23 offen
  s_add_u32 s23, s23, 884736
  buffer_load_dwordx4 v[20:23], v3, s[8:11], s23 offen
  s_add_u32 s23, s23, 884736
  buffer_load_dwordx4 v[24:27], v3, s[8:11], s23 offen
  s_add_u32 s23, s23, 884736
  buffer_load_dwordx4 v[28:31], v3, s[8:11], s23 offen
  s_add_u32 s23, s23, 884736
  buffer_load_dwordx4 v[32:35], v3, s[8:11], s23 offen
  s_waitcnt vmcnt(9)
  v_lshlrev_b32 v10, 16, v10
  v_mul_f32 v40, 0xbfb8aa3b, v10
  s_waitcnt vmcnt(8)
  v_lshlrev_b32 v11, 16, v11
  v_mul_f32 v41, 0xbfb8aa3b, v11
  s_waitcnt vmcnt(7)
  v_lshlrev_b32 v12, 16, v12
  v_mul_f32 v42, 0xbfb8aa3b, v12
  s_waitcnt vmcnt(6)
  v_lshlrev_b32 v13, 16, v13
  v_mul_f32 v43, 0xbfb8aa3b, v13
  s_waitcnt vmcnt(5)
  v_lshlrev_b32 v14, 16, v14
  v_mul_f32 v44, 0xbfb8aa3b, v14
  v_exp_f32 v40, v40
  v_exp_f32 v41, v41
  v_exp_f32 v42, v42
  v_exp_f32 v43, v43
  v_exp_f32 v44, v44
  v_add_f32 v40, 1.0, v40
  v_add_f32 v41, 1.0, v41
  v_add_f32 v42, 1.0, v42
  v_add_f32 v43, 1.0, v43
  v_add_f32 v44, 1.0, v44
  v_rcp_f32 v40, v40
  v_rcp_f32 v41, v41
  v_rcp_f32 v42, v42
  v_rcp_f32 v43, v43
  v_rcp_f32 v44, v44
  v_mul_f32 v10, v10, v40
  v_mul_f32 v11, v11, v41
  v_mul_f32 v12, v12, v42
  v_mul_f32 v13, v13, v43
  v_mul_f32 v14, v14, v44
  v_cvt_pk_bf16_f32 v10, v10, v10
  v_cvt_pk_bf16_f32 v11, v11, v11
  v_cvt_pk_bf16_f32 v12, v12, v12
  v_cvt_pk_bf16_f32 v13, v13, v13
  v_cvt_pk_bf16_f32 v14, v14, v14
  v_lshlrev_b32 v10, 16, v10
  v_lshlrev_b32 v11, 16, v11
  v_lshlrev_b32 v12, 16, v12
  v_lshlrev_b32 v13, 16, v13
  v_lshlrev_b32 v14, 16, v14
  s_waitcnt vmcnt(4)
  v_lshlrev_b32 v46, 16, v16
  v_and_b32 v47, 0xffff0000, v16
  v_mul_f32 v48, v46, v10
  v_mul_f32 v49, v47, v10
  v_lshlrev_b32 v46, 16, v17
  v_and_b32 v47, 0xffff0000, v17
  v_mul_f32 v50, v46, v10
  v_mul_f32 v51, v47, v10
  v_lshlrev_b32 v46, 16, v18
  v_and_b32 v47, 0xffff0000, v18
  v_mul_f32 v52, v46, v10
  v_mul_f32 v53, v47, v10
  v_lshlrev_b32 v46, 16, v19
  v_and_b32 v47, 0xffff0000, v19
  v_mul_f32 v54, v46, v10
  v_mul_f32 v55, v47, v10
  s_waitcnt vmcnt(3)
  v_lshlrev_b32 v46, 16, v20
  v_and_b32 v47, 0xffff0000, v20
  v_fmac_f32 v48, v46, v11
  v_fmac_f32 v49, v47, v11
  v_lshlrev_b32 v46, 16, v21
  v_and_b32 v47, 0xffff0000, v21
  v_fmac_f32 v50, v46, v11
  v_fmac_f32 v51, v47, v11
  v_lshlrev_b32 v46, 16, v22
  v_and_b32 v47, 0xffff0000, v22
  v_fmac_f32 v52, v46, v11
  v_fmac_f32 v53, v47, v11
  v_lshlrev_b32 v46, 16, v23
  v_and_b32 v47, 0xffff0000, v23
  v_fmac_f32 v54, v46, v11
  v_fmac_f32 v55, v47, v11
  s_waitcnt vmcnt(2)
  v_lshlrev_b32 v46, 16, v24
  v_and_b32 v47, 0xffff0000, v24
  v_fmac_f32 v48, v46, v12
  v_fmac_f32 v49, v47, v12
  v_lshlrev_b32 v46, 16, v25
  v_and_b32 v47, 0xffff0000, v25
  v_fmac_f32 v50, v46, v12
  v_fmac_f32 v51, v47, v12
  v_lshlrev_b32 v46, 16, v26
  v_and_b32 v47, 0xffff0000, v26
  v_fmac_f32 v52, v46, v12
  v_fmac_f32 v53, v47, v12
  v_lshlrev_b32 v46, 16, v27
  v_and_b32 v47, 0xffff0000, v27
  v_fmac_f32 v54, v46, v12
  v_fmac_f32 v55, v47, v12
  s_waitcnt vmcnt(1)
  v_lshlrev_b32 v46, 16, v28
  v_and_b32 v47, 0xffff0000, v28
  v_fmac_f32 v48, v46, v13
  v_fmac_f32 v49, v47, v13
  v_lshlrev_b32 v46, 16, v29
  v_and_b32 v47, 0xffff0000, v29
  v_fmac_f32 v50, v46, v13
  v_fmac_f32 v51, v47, v13
  v_lshlrev_b32 v46, 16, v30
  v_and_b32 v47, 0xffff0000, v30
  v_fmac_f32 v52, v46, v13
  v_fmac_f32 v53, v47, v13
  v_lshlrev_b32 v46, 16, v31
  v_and_b32 v47, 0xffff0000, v31
  v_fmac_f32 v54, v46, v13
  v_fmac_f32 v55, v47, v13
  s_waitcnt vmcnt(0)
  v_lshlrev_b32 v46, 16, v32
  v_and_b32 v47, 0xffff0000, v32
  v_fmac_f32 v48, v46, v14
  v_fmac_f32 v49, v47, v14
  v_lshlrev_b32 v46, 16, v33
  v_and_b32 v47, 0xffff0000, v33
  v_fmac_f32 v50, v46, v14
  v_fmac_f32 v51, v47, v14
  v_lshlrev_b32 v46, 16, v34
  v_and_b32 v47, 0xffff0000, v34
  v_fmac_f32 v52, v46, v14
  v_fmac_f32 v53, v47, v14
  v_lshlrev_b32 v46, 16, v35
  v_and_b32 v47, 0xffff0000, v35
  v_fmac_f32 v54, v46, v14
  v_fmac_f32 v55, v47, v14
  v_add_f32 v48, v48, v48 row_ror:2
  v_add_f32 v49, v49, v49 row_ror:2
  v_add_f32 v50, v50, v50 row_ror:2
  v_add_f32 v51, v51, v51 row_ror:2
  v_add_f32 v52, v52, v52 row_ror:2
  v_add_f32 v53, v53, v53 row_ror:2
  v_add_f32 v54, v54, v54 row_ror:2
  v_add_f32 v55, v55, v55 row_ror:2
  v_add_f32 v48, v48, v48 row_ror:4
  v_add_f32 v49, v49, v49 row_ror:4
  v_add_f32 v50, v50, v50 row_ror:4
  v_add_f32 v51, v51, v51 row_ror:4
  v_add_f32 v52, v52, v52 row_ror:4
  v_add_f32 v53, v53, v53 row_ror:4
  v_add_f32 v54, v54, v54 row_ror:4
  v_add_f32 v55, v55, v55 row_ror:4
  v_add_f32 v48, v48, v48 row_ror:8
  v_add_f32 v49, v49, v49 row_ror:8
  v_add_f32 v50, v50, v50 row_ror:8
  v_add_f32 v51, v51, v51 row_ror:8
  v_add_f32 v52, v52, v52 row_ror:8
  v_add_f32 v53, v53, v53 row_ror:8
  v_add_f32 v54, v54, v54 row_ror:8
  v_add_f32 v55, v55, v55 row_ror:8
  v_lshrrev_b32 v5, 4, v0
  v_lshlrev_b32 v5, 6, v5
  v_lshl_add_u32 v5, v2, 1, v5
  v_and_b32 v6, 15, v0
  v_cmp_gt_u32 vcc, 2, v6
  s_nop 0
  s_and_saveexec_b64 s[24:25], vcc
  ds_write_b128 v5, v[48:51]
  ds_write_b128 v5, v[52:55] offset:16
  s_mov_b64 exec, s[24:25]
  s_waitcnt lgkmcnt(0)
  s_barrier
  v_cmp_gt_u32 vcc, 16, v0
  s_nop 0
  s_and_saveexec_b64 s[24:25], vcc
  s_cbranch_execz L_end_k0_kernel
  v_lshlrev_b32 v5, 2, v0
  ds_read_b32 v16, v5 offset:0
  ds_read_b32 v17, v5 offset:64
  ds_read_b32 v18, v5 offset:128
  ds_read_b32 v19, v5 offset:192
  ds_read_b32 v20, v5 offset:256
  ds_read_b32 v21, v5 offset:320
  ds_read_b32 v22, v5 offset:384
  ds_read_b32 v23, v5 offset:448
  ds_read_b32 v24, v5 offset:512
  ds_read_b32 v25, v5 offset:576
  ds_read_b32 v26, v5 offset:640
  ds_read_b32 v27, v5 offset:704
  ds_read_b32 v28, v5 offset:768
  ds_read_b32 v29, v5 offset:832
  ds_read_b32 v30, v5 offset:896
  ds_read_b32 v31, v5 offset:960
  s_waitcnt lgkmcnt(7)
  v_add_f32 v16, v16, v24
  s_waitcnt lgkmcnt(6)
  v_add_f32 v17, v17, v25
  s_waitcnt lgkmcnt(5)
  v_add_f32 v18, v18, v26
  s_waitcnt lgkmcnt(4)
  v_add_f32 v19, v19, v27
  s_waitcnt lgkmcnt(3)
  v_add_f32 v20, v20, v28
  s_waitcnt lgkmcnt(2)
  v_add_f32 v21, v21, v29
  s_waitcnt lgkmcnt(1)
  v_add_f32 v22, v22, v30
  s_waitcnt lgkmcnt(0)
  v_add_f32 v23, v23, v31
  v_add_f32 v16, v16, v20
  v_add_f32 v17, v17, v21
  v_add_f32 v18, v18, v22
  v_add_f32 v19, v19, v23
  v_add_f32 v16, v16, v18
  v_add_f32 v17, v17, v19
  v_add_f32 v16, v16, v17
  v_cvt_pk_bf16_f32 v16, v16, v16
  v_lshlrev_b32 v16, 16, v16
  v_add_f32 v17, 1.0, v16
  v_cvt_pk_bf16_f32 v17, v17, v17
  v_lshlrev_b32 v17, 16, v17
  s_mul_i32 s21, s20, 1821
  s_lshr_b32 s21, s21, 16
  s_cmp_eq_u32 s21, 1
  s_cselect_b64 s[26:27], -1, 0
  s_cmp_eq_u32 s21, 4
  s_cselect_b64 s[26:27], -1, s[26:27]
  v_cndmask_b32 v16, v16, v17, s[26:27]
  s_lshl_b32 s20, s20, 6
  buffer_store_dword v16, v5, s[12:15], s20 offen
  s_endpgm
L_ln:
  s_load_dwordx2 s[4:5], s[0:1], 0
  s_mov_b32 s6, 2359296
  s_mov_b32 s7, 0x20000
  s_sub_u32 s20, s2, 224
  v_lshrrev_b32 v1, 4, v0
  v_and_b32 v2, 15, v0
  s_mul_i32 s21, s20, 18432
  s_mov_b32 s24, 0x00ff00ff
  s_mov_b32 s25, 0x00ff00ff
  v_mul_u32_u24 v3, 1152, v1
  v_lshl_add_u32 v3, v2, 4, v3
  v_mov_b32 v24, 0
  v_mov_b32 v25, 0
  v_mov_b32 v26, 0
  v_mov_b32 v27, 0
  s_waitcnt lgkmcnt(0)
  buffer_load_dwordx4 v[8:11], v3, s[4:7], s21 offen offset:0
  buffer_load_dwordx4 v[12:15], v3, s[4:7], s21 offen offset:256
  buffer_load_dwordx4 v[16:19], v3, s[4:7], s21 offen offset:512
  buffer_load_dwordx4 v[20:23], v3, s[4:7], s21 offen offset:768
  s_mov_b64 exec, s[24:25]
  buffer_load_dwordx4 v[24:27], v3, s[4:7], s21 offen offset:1024
  s_mov_b64 exec, -1
  v_lshlrev_b32 v5, 2, v0
  v_mov_b32 v6, 0
  s_lshl_b32 s23, s20, 10
  s_add_u32 s23, s23, 32768
  s_cmp_lt_u32 s20, 96
  s_cselect_b32 s23, s23, 0x40000000
  buffer_store_dword v6, v5, s[12:15], s23 offen
  v_lshlrev_b32 v4, 4, v1
  v_lshl_add_u32 v4, v2, 8, v4
  s_add_u32 s22, s21, 131072
  s_waitcnt vmcnt(5)
  v_lshlrev_b32 v48, 16, v8
  v_and_b32 v49, 0xffff0000, v8
  v_lshlrev_b32 v50, 16, v9
  v_and_b32 v51, 0xffff0000, v9
  v_lshlrev_b32 v52, 16, v10
  v_and_b32 v53, 0xffff0000, v10
  v_lshlrev_b32 v54, 16, v11
  v_and_b32 v55, 0xffff0000, v11
  s_waitcnt vmcnt(4)
  v_lshlrev_b32 v56, 16, v12
  v_and_b32 v57, 0xffff0000, v12
  v_lshlrev_b32 v58, 16, v13
  v_and_b32 v59, 0xffff0000, v13
  v_lshlrev_b32 v60, 16, v14
  v_and_b32 v61, 0xffff0000, v14
  v_lshlrev_b32 v62, 16, v15
  v_and_b32 v63, 0xffff0000, v15
  s_waitcnt vmcnt(3)
  v_lshlrev_b32 v64, 16, v16
  v_and_b32 v65, 0xffff0000, v16
  v_lshlrev_b32 v66, 16, v17
  v_and_b32 v67, 0xffff0000, v17
  v_lshlrev_b32 v68, 16, v18
  v_and_b32 v69, 0xffff0000, v18
  v_lshlrev_b32 v70, 16, v19
  v_and_b32 v71, 0xffff0000, v19
  s_waitcnt vmcnt(2)
  v_lshlrev_b32 v72, 16, v20
  v_and_b32 v73, 0xffff0000, v20
  v_lshlrev_b32 v74, 16, v21
  v_and_b32 v75, 0xffff0000, v21
  v_lshlrev_b32 v76, 16, v22
  v_and_b32 v77, 0xffff0000, v22
  v_lshlrev_b32 v78, 16, v23
  v_and_b32 v79, 0xffff0000, v23
  s_waitcnt vmcnt(1)
  v_lshlrev_b32 v80, 16, v24
  v_and_b32 v81, 0xffff0000, v24
  v_lshlrev_b32 v82, 16, v25
  v_and_b32 v83, 0xffff0000, v25
  v_lshlrev_b32 v84, 16, v26
  v_and_b32 v85, 0xffff0000, v26
  v_lshlrev_b32 v86, 16, v27
  v_and_b32 v87, 0xffff0000, v27
  v_pk_add_f32 v[6:7], v[48:49], v[50:51]
  v_pk_add_f32 v[6:7], v[6:7], v[52:53]
  v_pk_add_f32 v[6:7], v[6:7], v[54:55]
  v_pk_add_f32 v[6:7], v[6:7], v[56:57]
  v_pk_add_f32 v[6:7], v[6:7], v[58:59]
  v_pk_add_f32 v[6:7], v[6:7], v[60:61]
  v_pk_add_f32 v[6:7], v[6:7], v[62:63]
  v_pk_add_f32 v[6:7], v[6:7], v[64:65]
  v_pk_add_f32 v[6:7], v[6:7], v[66:67]
  v_pk_add_f32 v[6:7], v[6:7], v[68:69]
  v_pk_add_f32 v[6:7], v[6:7], v[70:71]
  v_pk_add_f32 v[6:7], v[6:7], v[72:73]
  v_pk_add_f32 v[6:7], v[6:7], v[74:75]
  v_pk_add_f32 v[6:7], v[6:7], v[76:77]
  v_pk_add_f32 v[6:7], v[6:7], v[78:79]
  v_pk_add_f32 v[6:7], v[6:7], v[80:81]
  v_pk_add_f32 v[6:7], v[6:7], v[82:83]
  v_pk_add_f32 v[6:7], v[6:7], v[84:85]
  v_pk_add_f32 v[6:7], v[6:7], v[86:87]
  v_add_f32 v6, v6, v7
  s_nop 1
  v_add_f32 v6, v6, v6 row_ror:1
  s_nop 1
  v_add_f32 v6, v6, v6 row_ror:2
  s_nop 1
  v_add_f32 v6, v6, v6 row_ror:4
  s_nop 1
  v_add_f32 v6, v6, v6 row_ror:8
  v_mul_f32 v46, 0xbae38e39, v6
  v_pk_add_f32 v[48:49], v[48:49], v[46:47] op_sel_hi:[1,0]
  v_pk_add_f32 v[50:51], v[50:51], v[46:47] op_sel_hi:[1,0]
  v_pk_add_f32 v[52:53], v[52:53], v[46:47] op_sel_hi:[1,0]
  v_pk_add_f32 v[54:55], v[54:55], v[46:47] op_sel_hi:[1,0]
  v_pk_add_f32 v[56:57], v[56:57], v[46:47] op_sel_hi:[1,0]
  v_pk_add_f32 v[58:59], v[58:59], v[46:47] op_sel_hi:[1,0]
  v_pk_add_f32 v[60:61], v[60:61], v[46:47] op_sel_hi:[1,0]
  v_pk_add_f32 v[62:63], v[62:63], v[46:47] op_sel_hi:[1,0]
  v_pk_add_f32 v[64:65], v[64:65], v[46:47] op_sel_hi:[1,0]
  v_pk_add_f32 v[66:67], v[66:67], v[46:47] op_sel_hi:[1,0]
  v_pk_add_f32 v[68:69], v[68:69], v[46:47] op_sel_hi:[1,0]
  v_pk_add_f32 v[70:71], v[70:71], v[46:47] op_sel_hi:[1,0]
  v_pk_add_f32 v[72:73], v[72:73], v[46:47] op_sel_hi:[1,0]
  v_pk_add_f32 v[74:75], v[74:75], v[46:47] op_sel_hi:[1,0]
  v_pk_add_f32 v[76:77], v[76:77], v[46:47] op_sel_hi:[1,0]
  v_pk_add_f32 v[78:79], v[78:79], v[46:47] op_sel_hi:[1,0]
  s_mov_b64 exec, s[24:25]
  v_pk_add_f32 v[80:81], v[80:81], v[46:47] op_sel_hi:[1,0]
  v_pk_add_f32 v[82:83], v[82:83], v[46:47] op_sel_hi:[1,0]
  v_pk_add_f32 v[84:85], v[84:85], v[46:47] op_sel_hi:[1,0]
  v_pk_add_f32 v[86:87], v[86:87], v[46:47] op_sel_hi:[1,0]
  s_mov_b64 exec, -1
  v_pk_mul_f32 v[6:7], v[48:49], v[48:49]
  v_pk_fma_f32 v[6:7], v[50:51], v[50:51], v[6:7]
  v_pk_fma_f32 v[6:7], v[52:53], v[52:53], v[6:7]
  v_pk_fma_f32 v[6:7], v[54:55], v[54:55], v[6:7]
  v_pk_fma_f32 v[6:7], v[56:57], v[56:57], v[6:7]
  v_pk_fma_f32 v[6:7], v[58:59], v[58:59], v[6:7]
  v_pk_fma_f32 v[6:7], v[60:61], v[60:61], v[6:7]
  v_pk_fma_f32 v[6:7], v[62:63], v[62:63], v[6:7]
  v_pk_fma_f32 v[6:7], v[64:65], v[64:65], v[6:7]
  v_pk_fma_f32 v[6:7], v[66:67], v[66:67], v[6:7]
  v_pk_fma_f32 v[6:7], v[68:69], v[68:69], v[6:7]
  v_pk_fma_f32 v[6:7], v[70:71], v[70:71], v[6:7]
  v_pk_fma_f32 v[6:7], v[72:73], v[72:73], v[6:7]
  v_pk_fma_f32 v[6:7], v[74:75], v[74:75], v[6:7]
  v_pk_fma_f32 v[6:7], v[76:77], v[76:77], v[6:7]
  v_pk_fma_f32 v[6:7], v[78:79], v[78:79], v[6:7]
  v_pk_fma_f32 v[6:7], v[80:81], v[80:81], v[6:7]
  v_pk_fma_f32 v[6:7], v[82:83], v[82:83], v[6:7]
  v_pk_fma_f32 v[6:7], v[84:85], v[84:85], v[6:7]
  v_pk_fma_f32 v[6:7], v[86:87], v[86:87], v[6:7]
  v_add_f32 v6, v6, v7
  s_nop 1
  v_add_f32 v6, v6, v6 row_ror:1
  s_nop 1
  v_add_f32 v6, v6, v6 row_ror:2
  s_nop 1
  v_add_f32 v6, v6, v6 row_ror:4
  s_nop 1
  v_add_f32 v6, v6, v6 row_ror:8
  v_mov_b32 v7, 0x3727c5ac
  v_fmac_f32 v7, 0x3ae38e39, v6
  v_rsq_f32 v46, v7
  s_nop 0
  v_pk_mul_f32 v[48:49], v[48:49], v[46:47] op_sel_hi:[1,0]
  v_cvt_pk_f16_f32 v8, v48, v49
  v_pk_mul_f32 v[50:51], v[50:51], v[46:47] op_sel_hi:[1,0]
  v_cvt_pk_f16_f32 v9, v50, v51
  v_pk_mul_f32 v[52:53], v[52:53], v[46:47] op_sel_hi:[1,0]
  v_cvt_pk_f16_f32 v10, v52, v53
  v_pk_mul_f32 v[54:55], v[54:55], v[46:47] op_sel_hi:[1,0]
  v_cvt_pk_f16_f32 v11, v54, v55
  buffer_store_dwordx4 v[8:11], v4, s[12:15], s22 offen
  s_add_u32 s22, s22, 4096
  v_pk_mul_f32 v[56:57], v[56:57], v[46:47] op_sel_hi:[1,0]
  v_cvt_pk_f16_f32 v12, v56, v57
  v_pk_mul_f32 v[58:59], v[58:59], v[46:47] op_sel_hi:[1,0]
  v_cvt_pk_f16_f32 v13, v58, v59
  v_pk_mul_f32 v[60:61], v[60:61], v[46:47] op_sel_hi:[1,0]
  v_cvt_pk_f16_f32 v14, v60, v61
  v_pk_mul_f32 v[62:63], v[62:63], v[46:47] op_sel_hi:[1,0]
  v_cvt_pk_f16_f32 v15, v62, v63
  buffer_store_dwordx4 v[12:15], v4, s[12:15], s22 offen
  s_add_u32 s22, s22, 4096
  v_pk_mul_f32 v[64:65], v[64:65], v[46:47] op_sel_hi:[1,0]
  v_cvt_pk_f16_f32 v16, v64, v65
  v_pk_mul_f32 v[66:67], v[66:67], v[46:47] op_sel_hi:[1,0]
  v_cvt_pk_f16_f32 v17, v66, v67
  v_pk_mul_f32 v[68:69], v[68:69], v[46:47] op_sel_hi:[1,0]
  v_cvt_pk_f16_f32 v18, v68, v69
  v_pk_mul_f32 v[70:71], v[70:71], v[46:47] op_sel_hi:[1,0]
  v_cvt_pk_f16_f32 v19, v70, v71
  buffer_store_dwordx4 v[16:19], v4, s[12:15], s22 offen
  s_add_u32 s22, s22, 4096
  v_pk_mul_f32 v[72:73], v[72:73], v[46:47] op_sel_hi:[1,0]
  v_cvt_pk_f16_f32 v20, v72, v73
  v_pk_mul_f32 v[74:75], v[74:75], v[46:47] op_sel_hi:[1,0]
  v_cvt_pk_f16_f32 v21, v74, v75
  v_pk_mul_f32 v[76:77], v[76:77], v[46:47] op_sel_hi:[1,0]
  v_cvt_pk_f16_f32 v22, v76, v77
  v_pk_mul_f32 v[78:79], v[78:79], v[46:47] op_sel_hi:[1,0]
  v_cvt_pk_f16_f32 v23, v78, v79
  buffer_store_dwordx4 v[20:23], v4, s[12:15], s22 offen
  s_add_u32 s22, s22, 4096
  v_pk_mul_f32 v[80:81], v[80:81], v[46:47] op_sel_hi:[1,0]
  v_cvt_pk_f16_f32 v24, v80, v81
  v_pk_mul_f32 v[82:83], v[82:83], v[46:47] op_sel_hi:[1,0]
  v_cvt_pk_f16_f32 v25, v82, v83
  v_pk_mul_f32 v[84:85], v[84:85], v[46:47] op_sel_hi:[1,0]
  v_cvt_pk_f16_f32 v26, v84, v85
  v_pk_mul_f32 v[86:87], v[86:87], v[46:47] op_sel_hi:[1,0]
  v_cvt_pk_f16_f32 v27, v86, v87
  s_mov_b64 exec, s[24:25]
  buffer_store_dwordx4 v[24:27], v4, s[12:15], s22 offen
  s_add_u32 s22, s22, 4096
  s_endpgm
L_relay:
  s_load_dwordx2 s[4:5], s[0:1], 8
  s_mov_b32 s6, 1990656
  s_mov_b32 s7, 0x20000
  s_load_dwordx2 s[8:9], s[0:1], 16
  s_mov_b32 s10, 663552
  s_mov_b32 s11, 0x20000
  v_lshrrev_b32 v1, 6, v0
  s_nop 0
  v_readfirstlane_b32 s20, v1
  v_and_b32 v0, 63, v0
  s_sub_u32 s21, s2, 352
  s_and_b32 s22, s21, 7
  s_lshr_b32 s23, s21, 3
  s_mul_i32 s22, s22, 18
  s_add_u32 s21, s22, s23
  s_and_b32 s22, s21, 7
  s_lshr_b32 s23, s21, 3
  v_and_b32 v1, 15, v0
  v_lshrrev_b32 v2, 4, v0
  v_lshlrev_b32 v8, 4, v0
  s_waitcnt lgkmcnt(0)
  s_cmp_eq_u32 s20, 3
  s_cselect_b32 s4, s8, s4
  s_cselect_b32 s5, s9, s5
  s_cselect_b32 s6, s10, s6
  s_cselect_b64 s[30:31], -1, 0
  s_mov_b32 s24, 3456
  s_cselect_b32 s24, 1152, s24
  s_cselect_b32 s25, 0, s20
  s_mul_i32 s25, s25, 1152
  s_mul_i32 s26, s22, 144
  s_add_u32 s25, s25, s26
  s_lshl_b32 s26, s23, 5
  s_mul_i32 s26, s26, s24
  s_add_u32 s25, s25, s26
  s_mul_i32 s34, s20, 6144
  v_mov_b32 v11, 0x40000000
  s_add_u32 m0, s34, 0
  v_add_u32 v9, 0, v0
  v_mul_u32_u24 v10, 7282, v9
  v_lshrrev_b32 v10, 16, v10
  v_mul_u32_u24 v12, 9, v10
  v_sub_u32 v12, v9, v12
  v_mul_lo_u32 v10, v10, s24
  v_lshl_add_u32 v10, v12, 4, v10
  buffer_load_dwordx4 v10, s[4:7], s25 offen lds
  s_add_u32 m0, s34, 1024
  v_add_u32 v9, 64, v0
  v_mul_u32_u24 v10, 7282, v9
  v_lshrrev_b32 v10, 16, v10
  v_mul_u32_u24 v12, 9, v10
  v_sub_u32 v12, v9, v12
  v_mul_lo_u32 v10, v10, s24
  v_lshl_add_u32 v10, v12, 4, v10
  buffer_load_dwordx4 v10, s[4:7], s25 offen lds
  s_add_u32 m0, s34, 2048
  v_add_u32 v9, 128, v0
  v_mul_u32_u24 v10, 7282, v9
  v_lshrrev_b32 v10, 16, v10
  v_mul_u32_u24 v12, 9, v10
  v_sub_u32 v12, v9, v12
  v_mul_lo_u32 v10, v10, s24
  v_lshl_add_u32 v10, v12, 4, v10
  buffer_load_dwordx4 v10, s[4:7], s25 offen lds
  s_add_u32 m0, s34, 3072
  v_add_u32 v9, 192, v0
  v_mul_u32_u24 v10, 7282, v9
  v_lshrrev_b32 v10, 16, v10
  v_mul_u32_u24 v12, 9, v10
  v_sub_u32 v12, v9, v12
  v_mul_lo_u32 v10, v10, s24
  v_lshl_add_u32 v10, v12, 4, v10
  buffer_load_dwordx4 v10, s[4:7], s25 offen lds
  s_add_u32 m0, s34, 4096
  v_add_u32 v9, 256, v0
  v_mul_u32_u24 v10, 7282, v9
  v_lshrrev_b32 v10, 16, v10
  v_mul_u32_u24 v12, 9, v10
  v_sub_u32 v12, v9, v12
  v_mul_lo_u32 v10, v10, s24
  v_lshl_add_u32 v10, v12, 4, v10
  v_cmp_gt_u32 vcc, 32, v0
  s_nop 1
  v_cndmask_b32 v10, v11, v10, vcc
  buffer_load_dwordx4 v10, s[4:7], s25 offen lds
  s_add_u32 m0, s34, 5120
  s_nop 0
  buffer_load_dwordx4 v11, s[4:7], s25 offen lds
  v_mul_u32_u24 v2, 1152, v2
  v_add_u32 v2, s34, v2
  s_add_u32 s35, s34, 4608
  v_mov_b32 v12, s35
  v_add_u32 v9, 0, v1
  v_mul_u32_u24 v10, 205, v9
  v_lshrrev_b32 v10, 12, v10
  v_mul_u32_u24 v11, 20, v10
  v_sub_u32 v11, v9, v11
  v_cmp_gt_u32 s[32:33], 18, v11
  v_cmp_gt_u32 vcc, 72, v9
  v_lshlrev_b32 v10, 1, v10
  v_sub_u32 v10, v9, v10
  v_cndmask_b32 v10, v10, v9, s[30:31]
  s_and_b64 vcc, vcc, s[30:31]
  s_andn2_b64 s[32:33], s[32:33], s[30:31]
  s_or_b64 vcc, vcc, s[32:33]
  v_lshl_add_u32 v10, v10, 1, v2
  v_cndmask_b32 v3, v12, v10, vcc
  v_add_u32 v9, 16, v1
  v_mul_u32_u24 v10, 205, v9
  v_lshrrev_b32 v10, 12, v10
  v_mul_u32_u24 v11, 20, v10
  v_sub_u32 v11, v9, v11
  v_cmp_gt_u32 s[32:33], 18, v11
  v_cmp_gt_u32 vcc, 72, v9
  v_lshlrev_b32 v10, 1, v10
  v_sub_u32 v10, v9, v10
  v_cndmask_b32 v10, v10, v9, s[30:31]
  s_and_b64 vcc, vcc, s[30:31]
  s_andn2_b64 s[32:33], s[32:33], s[30:31]
  s_or_b64 vcc, vcc, s[32:33]
  v_lshl_add_u32 v10, v10, 1, v2
  v_cndmask_b32 v4, v12, v10, vcc
  v_add_u32 v9, 32, v1
  v_mul_u32_u24 v10, 205, v9
  v_lshrrev_b32 v10, 12, v10
  v_mul_u32_u24 v11, 20, v10
  v_sub_u32 v11, v9, v11
  v_cmp_gt_u32 s[32:33], 18, v11
  v_cmp_gt_u32 vcc, 72, v9
  v_lshlrev_b32 v10, 1, v10
  v_sub_u32 v10, v9, v10
  v_cndmask_b32 v10, v10, v9, s[30:31]
  s_and_b64 vcc, vcc, s[30:31]
  s_andn2_b64 s[32:33], s[32:33], s[30:31]
  s_or_b64 vcc, vcc, s[32:33]
  v_lshl_add_u32 v10, v10, 1, v2
  v_cndmask_b32 v5, v12, v10, vcc
  v_add_u32 v9, 48, v1
  v_mul_u32_u24 v10, 205, v9
  v_lshrrev_b32 v10, 12, v10
  v_mul_u32_u24 v11, 20, v10
  v_sub_u32 v11, v9, v11
  v_cmp_gt_u32 s[32:33], 18, v11
  v_cmp_gt_u32 vcc, 72, v9
  v_lshlrev_b32 v10, 1, v10
  v_sub_u32 v10, v9, v10
  v_cndmask_b32 v10, v10, v9, s[30:31]
  s_and_b64 vcc, vcc, s[30:31]
  s_andn2_b64 s[32:33], s[32:33], s[30:31]
  s_or_b64 vcc, vcc, s[32:33]
  v_lshl_add_u32 v10, v10, 1, v2
  v_cndmask_b32 v6, v12, v10, vcc
  v_add_u32 v9, 64, v1
  v_mul_u32_u24 v10, 205, v9
  v_lshrrev_b32 v10, 12, v10
  v_mul_u32_u24 v11, 20, v10
  v_sub_u32 v11, v9, v11
  v_cmp_gt_u32 s[32:33], 18, v11
  v_cmp_gt_u32 vcc, 72, v9
  v_lshlrev_b32 v10, 1, v10
  v_sub_u32 v10, v9, v10
  v_cndmask_b32 v10, v10, v9, s[30:31]
  s_and_b64 vcc, vcc, s[30:31]
  s_andn2_b64 s[32:33], s[32:33], s[30:31]
  s_or_b64 vcc, vcc, s[32:33]
  v_lshl_add_u32 v10, v10, 1, v2
  v_cndmask_b32 v7, v12, v10, vcc
  s_mul_i32 s26, s22, 15
  s_mul_i32 s27, s20, 5
  s_add_u32 s26, s26, s27
  s_mul_i32 s26, s26, 18
  s_add_u32 s26, s26, s23
  s_add_u32 s26, s26, 2432
  s_mul_i32 s27, s22, 18
  s_add_u32 s27, s27, s23
  s_mul_i32 s27, s27, 5
  s_add_u32 s27, s27, 4592
  s_cmp_eq_u32 s20, 3
  s_cselect_b32 s26, s27, s26
  s_mov_b32 s28, 18432
  s_cselect_b32 s28, 1024, s28
  s_lshl_b32 s26, s26, 10
  s_waitcnt vmcnt(0)
  ds_read_u16 v16, v3 offset:0
  ds_read_u16 v17, v3 offset:144
  ds_read_u16 v18, v3 offset:288
  ds_read_u16 v19, v3 offset:432
  ds_read_u16 v20, v3 offset:576
  ds_read_u16 v21, v3 offset:720
  ds_read_u16 v22, v3 offset:864
  ds_read_u16 v23, v3 offset:1008
  ds_read_u16 v24, v4 offset:0
  ds_read_u16 v25, v4 offset:144
  ds_read_u16 v26, v4 offset:288
  ds_read_u16 v27, v4 offset:432
  ds_read_u16 v28, v4 offset:576
  ds_read_u16 v29, v4 offset:720
  ds_read_u16 v30, v4 offset:864
  ds_read_u16 v31, v4 offset:1008
  ds_read_u16 v32, v5 offset:0
  ds_read_u16 v33, v5 offset:144
  ds_read_u16 v34, v5 offset:288
  ds_read_u16 v35, v5 offset:432
  ds_read_u16 v36, v5 offset:576
  ds_read_u16 v37, v5 offset:720
  ds_read_u16 v38, v5 offset:864
  ds_read_u16 v39, v5 offset:1008
  ds_read_u16 v40, v6 offset:0
  ds_read_u16 v41, v6 offset:144
  ds_read_u16 v42, v6 offset:288
  ds_read_u16 v43, v6 offset:432
  ds_read_u16 v44, v6 offset:576
  ds_read_u16 v45, v6 offset:720
  ds_read_u16 v46, v6 offset:864
  ds_read_u16 v47, v6 offset:1008
  ds_read_u16 v48, v7 offset:0
  ds_read_u16 v49, v7 offset:144
  ds_read_u16 v50, v7 offset:288
  ds_read_u16 v51, v7 offset:432
  ds_read_u16 v52, v7 offset:576
  ds_read_u16 v53, v7 offset:720
  ds_read_u16 v54, v7 offset:864
  ds_read_u16 v55, v7 offset:1008
  s_waitcnt lgkmcnt(14)
  v_lshl_or_b32 v60, v17, 16, v16
  v_lshl_or_b32 v61, v19, 16, v18
  v_lshl_or_b32 v62, v21, 16, v20
  v_lshl_or_b32 v63, v23, 16, v22
  buffer_store_dwordx4 v[60:63], v8, s[12:15], s26 offen
  s_add_u32 s26, s26, s28
  v_lshl_or_b32 v64, v25, 16, v24
  v_lshl_or_b32 v65, v27, 16, v26
  v_lshl_or_b32 v66, v29, 16, v28
  v_lshl_or_b32 v67, v31, 16, v30
  buffer_store_dwordx4 v[64:67], v8, s[12:15], s26 offen
  s_add_u32 s26, s26, s28
  v_lshl_or_b32 v68, v33, 16, v32
  v_lshl_or_b32 v69, v35, 16, v34
  v_lshl_or_b32 v70, v37, 16, v36
  v_lshl_or_b32 v71, v39, 16, v38
  buffer_store_dwordx4 v[68:71], v8, s[12:15], s26 offen
  s_add_u32 s26, s26, s28
  v_lshl_or_b32 v72, v41, 16, v40
  s_waitcnt lgkmcnt(12)
  v_lshl_or_b32 v73, v43, 16, v42
  s_waitcnt lgkmcnt(10)
  v_lshl_or_b32 v74, v45, 16, v44
  s_waitcnt lgkmcnt(8)
  v_lshl_or_b32 v75, v47, 16, v46
  buffer_store_dwordx4 v[72:75], v8, s[12:15], s26 offen
  s_add_u32 s26, s26, s28
  s_waitcnt lgkmcnt(6)
  v_lshl_or_b32 v76, v49, 16, v48
  s_waitcnt lgkmcnt(4)
  v_lshl_or_b32 v77, v51, 16, v50
  s_waitcnt lgkmcnt(2)
  v_lshl_or_b32 v78, v53, 16, v52
  s_waitcnt lgkmcnt(0)
  v_lshl_or_b32 v79, v55, 16, v54
  buffer_store_dwordx4 v[76:79], v8, s[12:15], s26 offen
  s_add_u32 s26, s26, s28
  s_endpgm
L_end_k0_kernel:
  s_endpgm
.globl kf_kernel
.p2align 8
.type kf_kernel,@function
kf_kernel:
  s_cmp_ge_u32 s2, 256
  s_cbranch_scc1 L_end_kf_kernel
  s_load_dwordx2 s[12:13], s[0:1], 80
  s_mov_b32 s14, 52715520
  s_mov_b32 s15, 0x20000
  s_load_dwordx2 s[4:5], s[0:1], 32
  s_mov_b32 s6, 5308416
  s_mov_b32 s7, 0x20000
  s_load_dwordx2 s[8:9], s[0:1], 40
  s_mov_b32 s10, 5308416
  s_mov_b32 s11, 0x20000
  s_load_dwordx2 s[48:49], s[0:1], 32
  s_mov_b32 s50, 5308416
  s_mov_b32 s51, 0x20000
  s_load_dwordx2 s[64:65], s[0:1], 0
  s_mov_b32 s66, 2359296
  s_mov_b32 s67, 0x20000
  s_load_dwordx2 s[68:69], s[0:1], 64
  s_mov_b32 s70, 2359296
  s_mov_b32 s71, 0x20000
  s_and_b32 s30, s2, 7
  s_lshr_b32 s31, s2, 3
  s_and_b32 s32, s30, 0
  s_lshl_b32 s32, s32, 3
  s_and_b32 s33, s31, 7
  s_add_u32 s17, s32, s33
  s_lshr_b32 s32, s30, 0
  s_lshl_b32 s32, s32, 2
  s_lshr_b32 s33, s31, 3
  s_add_u32 s16, s32, s33
  v_lshrrev_b32 v1, 6, v0
  s_nop 0
  v_readfirstlane_b32 s20, v1
  v_and_b32 v0, 63, v0
  s_bfe_u32 s3, s31, 0x10000
  s_and_b32 s32, s31, 0
  s_lshr_b32 s31, s31, 1
  s_lshl_b32 s31, s31, 0
  s_or_b32 s31, s31, s32
  s_and_b32 s32, s30, 3
  s_lshl_b32 s32, s32, 1
  s_and_b32 s33, s31, 1
  s_add_u32 s19, s32, s33
  s_lshr_b32 s32, s30, 2
  s_lshl_b32 s32, s32, 3
  s_lshr_b32 s33, s31, 1
  s_add_u32 s18, s32, s33
  v_lshlrev_b32 v2, 4, v0
  v_and_b32 v3, 15, v0
  v_lshrrev_b32 v4, 4, v0
  s_and_b32 s21, s16, 3
  s_mul_i32 s21, s21, 5
  s_mul_i32 s22, s17, 2
  s_add_u32 s21, s21, s22
  s_sub_u32 s22, s21, 18
  s_cmp_ge_u32 s21, 18
  s_cselect_b32 s21, s22, s21
  s_mov_b32 s21, 0
  s_add_u32 s24, s20, 0
  s_add_u32 s24, s24, s21
  s_sub_u32 s23, s24, 18
  s_cmp_ge_u32 s24, 18
  s_cselect_b32 s24, s23, s24
  s_add_u32 s25, s20, 4
  s_add_u32 s25, s25, s21
  s_sub_u32 s23, s25, 18
  s_cmp_ge_u32 s25, 18
  s_cselect_b32 s25, s23, s25
  s_add_u32 s26, s20, 8
  s_add_u32 s26, s26, s21
  s_sub_u32 s23, s26, 18
  s_cmp_ge_u32 s26, 18
  s_cselect_b32 s26, s23, s26
  s_add_u32 s27, s20, 12
  s_add_u32 s27, s27, s21
  s_sub_u32 s23, s27, 18
  s_cmp_ge_u32 s27, 18
  s_cselect_b32 s27, s23, s27
  s_and_b32 s28, s20, 1
  s_add_u32 s28, s28, 16
  s_lshl_b32 s29, s28, 10
  s_add_u32 s28, s28, s21
  s_sub_u32 s23, s28, 18
  s_cmp_ge_u32 s28, 18
  s_cselect_b32 s28, s23, s28
  s_lshl_b32 s35, s16, 2
  s_sub_u32 s34, s35, 1
  s_max_i32 s34, s34, 0
  s_mul_i32 s34, s34, 18432
  s_mul_i32 s35, s35, 18432
  s_add_u32 s34, s34, 131072
  s_add_u32 s35, s35, 131072
  s_add_u32 s36, s35, 18432
  s_add_u32 s37, s36, 18432
  s_add_u32 s38, s37, 18432
  v_lshl_add_u32 v156, s24, 10, v2
  v_lshl_add_u32 v157, s25, 10, v2
  v_lshl_add_u32 v158, s26, 10, v2
  v_lshl_add_u32 v159, s27, 10, v2
  v_lshl_add_u32 v160, s28, 10, v2
  s_lshl_b32 s22, s20, 12
  s_add_u32 m0, s22, 147456
  s_waitcnt lgkmcnt(0)
  buffer_load_dwordx4 v2, s[12:15], s22 offen offset:0 lds
  buffer_load_dwordx4 v2, s[12:15], s22 offen offset:1024 lds
  s_cmp_eq_u32 s20, 3
  s_cselect_b32 s23, 2048, 0
  s_sub_u32 m0, m0, s23
  s_sub_u32 s22, s22, s23
  buffer_load_dwordx4 v2, s[12:15], s22 offen offset:2048 lds
  buffer_load_dwordx4 v2, s[12:15], s22 offen offset:3072 lds
  buffer_load_dwordx4 v[16:19], v156, s[12:15], s34 offen
  buffer_load_dwordx4 v[20:23], v156, s[12:15], s35 offen
  buffer_load_dwordx4 v[24:27], v156, s[12:15], s36 offen
  buffer_load_dwordx4 v[28:31], v156, s[12:15], s37 offen
  buffer_load_dwordx4 v[32:35], v156, s[12:15], s38 offen
  buffer_load_dwordx4 v[36:39], v157, s[12:15], s34 offen
  buffer_load_dwordx4 v[40:43], v157, s[12:15], s35 offen
  buffer_load_dwordx4 v[44:47], v157, s[12:15], s36 offen
  s_lshl_b32 s22, s20, 4
  s_mov_b32 s30, 0x32b610a5
  s_mov_b32 s31, 0x4ed94c87
  s_lshr_b64 s[30:31], s[30:31], s22
  s_mul_i32 s23, s17, 15
  v_lshlrev_b32 v6, 2, v4
  s_bfe_u32 s32, s30, 0x40000
  s_add_u32 s33, s32, s23
  s_mul_i32 s33, s33, 18432
  s_add_u32 s33, s33, 2490368
  v_add_u32 v8, s33, v2
  s_mul_i32 s33, s32, 52
  s_lshr_b32 s33, s33, 8
  s_mul_i32 s39, s33, 5
  s_sub_u32 s39, s32, s39
  s_lshl_b32 s39, s39, 4
  s_cmp_eq_u32 s33, 2
  s_cselect_b32 s40, 80, 48
  s_cselect_b32 s41, 2, 1
  s_mov_b32 s42, 3800
  s_cselect_b32 s42, 6320, s42
  s_mul_i32 s33, s33, 15360
  v_add_u32 v5, s39, v6
  v_mul_u32_u24 v1, 205, v5
  v_lshrrev_b32 v1, 12, v1
  v_mul_u32_u24 v1, s42, v1
  v_lshl_add_u32 v5, v5, s41, v1
  v_mul_u32_u24 v7, s40, v3
  v_add3_u32 v12, v5, v7, s33
  s_bfe_u32 s32, s30, 0x40004
  s_add_u32 s33, s32, s23
  s_mul_i32 s33, s33, 18432
  s_add_u32 s33, s33, 2490368
  v_add_u32 v9, s33, v2
  s_mul_i32 s33, s32, 52
  s_lshr_b32 s33, s33, 8
  s_mul_i32 s39, s33, 5
  s_sub_u32 s39, s32, s39
  s_lshl_b32 s39, s39, 4
  s_cmp_eq_u32 s33, 2
  s_cselect_b32 s40, 80, 48
  s_cselect_b32 s41, 2, 1
  s_mov_b32 s42, 3800
  s_cselect_b32 s42, 6320, s42
  s_mul_i32 s33, s33, 15360
  v_add_u32 v5, s39, v6
  v_mul_u32_u24 v1, 205, v5
  v_lshrrev_b32 v1, 12, v1
  v_mul_u32_u24 v1, s42, v1
  v_lshl_add_u32 v5, v5, s41, v1
  v_mul_u32_u24 v7, s40, v3
  v_add3_u32 v13, v5, v7, s33
  s_bfe_u32 s32, s30, 0x40008
  s_add_u32 s33, s32, s23
  s_mul_i32 s33, s33, 18432
  s_add_u32 s33, s33, 2490368
  v_add_u32 v10, s33, v2
  s_mul_i32 s33, s32, 52
  s_lshr_b32 s33, s33, 8
  s_mul_i32 s39, s33, 5
  s_sub_u32 s39, s32, s39
  s_lshl_b32 s39, s39, 4
  s_cmp_eq_u32 s33, 2
  s_cselect_b32 s40, 80, 48
  s_cselect_b32 s41, 2, 1
  s_mov_b32 s42, 3800
  s_cselect_b32 s42, 6320, s42
  s_mul_i32 s33, s33, 15360
  v_add_u32 v5, s39, v6
  v_mul_u32_u24 v1, 205, v5
  v_lshrrev_b32 v1, 12, v1
  v_mul_u32_u24 v1, s42, v1
  v_lshl_add_u32 v5, v5, s41, v1
  v_mul_u32_u24 v7, s40, v3
  v_add3_u32 v14, v5, v7, s33
  s_bfe_u32 s32, s30, 0x4000c
  s_add_u32 s33, s32, s23
  s_mul_i32 s33, s33, 18432
  s_add_u32 s33, s33, 2490368
  v_add_u32 v11, s33, v2
  s_mul_i32 s33, s32, 52
  s_lshr_b32 s33, s33, 8
  s_mul_i32 s39, s33, 5
  s_sub_u32 s39, s32, s39
  s_lshl_b32 s39, s39, 4
  s_cmp_eq_u32 s33, 2
  s_cselect_b32 s40, 80, 48
  s_cselect_b32 s41, 2, 1
  s_mov_b32 s42, 3800
  s_cselect_b32 s42, 6320, s42
  s_mul_i32 s33, s33, 15360
  v_add_u32 v5, s39, v6
  v_mul_u32_u24 v1, 205, v5
  v_lshrrev_b32 v1, 12, v1
  v_mul_u32_u24 v1, s42, v1
  v_lshl_add_u32 v5, v5, s41, v1
  v_mul_u32_u24 v7, s40, v3
  v_add3_u32 v15, v5, v7, s33
  s_lshl_b32 s39, s21, 10
  v_lshlrev_b32 v1, 5, v4
  v_add_u32 v1, 147456, v1
  s_lshl_b32 s22, s20, 10
  v_add_u32 v149, s22, v2
  v_add_u32 v150, 0xd800, v149
  s_lshr_b32 s22, s20, 1
  s_mul_i32 s22, s22, 36864
  s_add_u32 s22, s22, s29
  v_add_u32 v151, s22, v2
  s_lshl_b32 s22, s16, 1
  s_add_u32 s22, s22, s20
  s_sub_u32 s22, s22, 2
  s_cmp_lt_u32 s20, 2
  s_cselect_b32 s22, 60, s22
  s_mul_i32 s44, s17, 54
  s_add_u32 s23, s22, s44
  s_max_u32 s44, s20, 1
  s_mul_i32 s44, s44, 12288
  s_add_u32 s44, s44, 98304
  s_mul_i32 s47, s22, 43
  s_lshr_b32 s47, s47, 8
  s_mul_i32 s46, s47, 6
  s_sub_u32 s46, s22, s46
  s_mul_i32 s45, s17, 6
  s_add_u32 s45, s45, s46
  s_mul_i32 s45, s45, 4608
  s_lshl_b32 s47, s47, 8
  s_add_u32 s45, s45, s47
  s_add_u32 s45, s45, 52494336
  s_cmp_lt_u32 s22, 54
  s_cselect_b32 s45, s45, 0x40000000
  s_cselect_b32 s46, s46, 0
  s_mul_i32 s46, s46, 384
  s_mul_i32 s56, s23, 10923
  s_lshr_b32 s56, s56, 16
  s_mul_i32 s57, s56, 6
  s_sub_u32 s57, s23, s57
  s_mul_i32 s58, s56, 7282
  s_lshr_b32 s58, s58, 16
  s_mul_i32 s59, s58, 9
  s_sub_u32 s59, s56, s59
  s_mul_i32 s60, s58, 648
  s_mul_i32 s61, s59, 18
  s_add_u32 s60, s60, s61
  s_mul_i32 s61, s57, 3
  s_add_u32 s60, s60, s61
  s_lshl_b32 s60, s60, 10
  s_add_u32 s60, s60, 29032448
  s_cmp_ge_u32 s58, 8
  s_cselect_b32 s48, s48, s48
  s_cselect_b32 s49, s49, s49
  s_mov_b32 s61, 9216
  s_cselect_b32 s61, 1152, s61
  s_cselect_b32 s56, s59, s56
  s_cselect_b32 s58, s58, 8
  s_sub_u32 s58, s58, 8
  s_mul_i32 s58, s58, 576
  s_mul_i32 s57, s57, 96
  s_add_u32 s57, s57, s58
  s_mul_i32 s57, s57, s61
  s_lshl_b32 s56, s56, 7
  s_add_u32 s57, s57, s56
  s_lshl_b32 s62, s61, 3
  s_sub_u32 s63, s62, 1024
  s_add_u32 s62, s62, 3072
  v_lshrrev_b32 v220, 3, v0
  v_mul_lo_u32 v222, v220, s61
  v_and_b32 v220, 2, v220
  v_and_b32 v221, 7, v0
  v_xor_b32 v220, v220, v221
  v_lshl_add_u32 v222, v220, 4, v222
  v_xor_b32 v223, 64, v222
  v_bfe_u32 v220, v0, 3, 2
  v_lshlrev_b32 v220, 5, v220
  v_and_b32 v221, 3, v0
  v_lshl_add_u32 v220, v221, 3, v220
  v_bfe_u32 v221, v0, 2, 2
  v_lshl_add_u32 v220, v221, 7, v220
  v_lshrrev_b32 v221, 4, v0
  v_lshl_add_u32 v220, v221, 10, v220
  v_add_u32 v220, s44, v220
  s_mov_b32 s42, 0x00030003
  s_mov_b32 s43, 0x00030003
  s_cmp_ge_u32 s22, 54
  s_cselect_b32 s50, 0, s50
  s_lshl_b32 s29, s16, 2
  s_add_u32 s29, s29, s20
  s_mul_i32 s29, s29, 18432
  s_mul_i32 s47, s17, 144
  s_add_u32 s47, s47, s29
  v_mul_u32_u24 v161, 1152, v3
  v_lshl_add_u32 v161, v4, 3, v161
  v_cmp_eq_u32 vcc, 0, v3
  v_mov_b32 v172, 154368
  v_mov_b32 v6, 156672
  v_cndmask_b32 v172, v172, v6, vcc
  v_lshl_add_u32 v172, v4, 5, v172
  v_add_u32 v172, s46, v172
  v_mul_u32_u24 v173, 2304, v3
  v_lshl_add_u32 v173, v4, 4, v173
  s_waitcnt vmcnt(8)
  s_barrier
  v_lshl_add_u32 v148, s24, 7, v1
  ds_read_b128 v[108:111], v148 offset:0
  ds_read_b128 v[112:115], v148 offset:16
  ds_read_b128 v[116:119], v148 offset:2304
  ds_read_b128 v[120:123], v148 offset:2320
  s_waitcnt vmcnt(7) lgkmcnt(1)
  v_fma_mix_f32 v140, v16, v116, v108 op_sel_hi:[1,0,0]
  v_fma_mix_f32 v141, v16, v117, v109 op_sel:[1,0,0] op_sel_hi:[1,0,0]
  buffer_load_dwordx4 v[48:51], v157, s[12:15], s37 offen
  v_fma_mix_f32 v142, v17, v118, v110 op_sel_hi:[1,0,0]
  v_fma_mix_f32 v143, v17, v119, v111 op_sel:[1,0,0] op_sel_hi:[1,0,0]
  v_lshl_add_u32 v148, s25, 7, v1
  s_waitcnt lgkmcnt(0)
  v_fma_mix_f32 v144, v18, v120, v112 op_sel_hi:[1,0,0]
  v_fma_mix_f32 v145, v18, v121, v113 op_sel:[1,0,0] op_sel_hi:[1,0,0]
  v_fma_mix_f32 v146, v19, v122, v114 op_sel_hi:[1,0,0]
  v_fma_mix_f32 v147, v19, v123, v115 op_sel:[1,0,0] op_sel_hi:[1,0,0]
  v_cvt_pk_bf16_f32 v16, v140, v141
  v_cvt_pk_bf16_f32 v17, v142, v143
  v_cvt_pk_bf16_f32 v18, v144, v145
  ds_read_b128 v[124:127], v148 offset:0
  v_cvt_pk_bf16_f32 v19, v146, v147
  ds_write_b128 v149, v[16:19] offset:0
  s_waitcnt vmcnt(7)
  v_fma_mix_f32 v140, v20, v116, v108 op_sel_hi:[1,0,0]
  v_fma_mix_f32 v141, v20, v117, v109 op_sel:[1,0,0] op_sel_hi:[1,0,0]
  buffer_load_dwordx4 v[52:55], v157, s[12:15], s38 offen
  v_fma_mix_f32 v142, v21, v118, v110 op_sel_hi:[1,0,0]
  v_fma_mix_f32 v143, v21, v119, v111 op_sel:[1,0,0] op_sel_hi:[1,0,0]
  ds_read_b128 v[128:131], v148 offset:16
  v_fma_mix_f32 v144, v22, v120, v112 op_sel_hi:[1,0,0]
  v_fma_mix_f32 v145, v22, v121, v113 op_sel:[1,0,0] op_sel_hi:[1,0,0]
  v_fma_mix_f32 v146, v23, v122, v114 op_sel_hi:[1,0,0]
  v_fma_mix_f32 v147, v23, v123, v115 op_sel:[1,0,0] op_sel_hi:[1,0,0]
  v_cvt_pk_bf16_f32 v20, v140, v141
  v_cvt_pk_bf16_f32 v21, v142, v143
  v_cvt_pk_bf16_f32 v22, v144, v145
  ds_read_b128 v[132:135], v148 offset:2304
  v_cvt_pk_bf16_f32 v23, v146, v147
  ds_write_b128 v149, v[20:23] offset:18432
  s_waitcnt vmcnt(7)
  v_fma_mix_f32 v140, v24, v116, v108 op_sel_hi:[1,0,0]
  v_fma_mix_f32 v141, v24, v117, v109 op_sel:[1,0,0] op_sel_hi:[1,0,0]
  buffer_load_dwordx4 v[56:59], v158, s[12:15], s34 offen
  v_fma_mix_f32 v142, v25, v118, v110 op_sel_hi:[1,0,0]
  v_fma_mix_f32 v143, v25, v119, v111 op_sel:[1,0,0] op_sel_hi:[1,0,0]
  ds_read_b128 v[136:139], v148 offset:2320
  v_fma_mix_f32 v144, v26, v120, v112 op_sel_hi:[1,0,0]
  v_fma_mix_f32 v145, v26, v121, v113 op_sel:[1,0,0] op_sel_hi:[1,0,0]
  v_fma_mix_f32 v146, v27, v122, v114 op_sel_hi:[1,0,0]
  v_fma_mix_f32 v147, v27, v123, v115 op_sel:[1,0,0] op_sel_hi:[1,0,0]
  v_cvt_pk_bf16_f32 v24, v140, v141
  v_cvt_pk_bf16_f32 v25, v142, v143
  v_cvt_pk_bf16_f32 v26, v144, v145
  v_cvt_pk_bf16_f32 v27, v146, v147
  ds_write_b128 v149, v[24:27] offset:36864
  s_waitcnt vmcnt(7)
  v_fma_mix_f32 v140, v28, v116, v108 op_sel_hi:[1,0,0]
  v_fma_mix_f32 v141, v28, v117, v109 op_sel:[1,0,0] op_sel_hi:[1,0,0]
  buffer_load_dwordx4 v[60:63], v158, s[12:15], s35 offen
  v_fma_mix_f32 v142, v29, v118, v110 op_sel_hi:[1,0,0]
  v_fma_mix_f32 v143, v29, v119, v111 op_sel:[1,0,0] op_sel_hi:[1,0,0]
  v_fma_mix_f32 v144, v30, v120, v112 op_sel_hi:[1,0,0]
  v_fma_mix_f32 v145, v30, v121, v113 op_sel:[1,0,0] op_sel_hi:[1,0,0]
  v_fma_mix_f32 v146, v31, v122, v114 op_sel_hi:[1,0,0]
  v_fma_mix_f32 v147, v31, v123, v115 op_sel:[1,0,0] op_sel_hi:[1,0,0]
  v_cvt_pk_bf16_f32 v28, v140, v141
  v_cvt_pk_bf16_f32 v29, v142, v143
  v_cvt_pk_bf16_f32 v30, v144, v145
  v_cvt_pk_bf16_f32 v31, v146, v147
  ds_write_b128 v150, v[28:31] offset:0
  s_waitcnt vmcnt(7)
  v_fma_mix_f32 v140, v32, v116, v108 op_sel_hi:[1,0,0]
  v_fma_mix_f32 v141, v32, v117, v109 op_sel:[1,0,0] op_sel_hi:[1,0,0]
  buffer_load_dwordx4 v[64:67], v158, s[12:15], s36 offen
  v_fma_mix_f32 v142, v33, v118, v110 op_sel_hi:[1,0,0]
  v_fma_mix_f32 v143, v33, v119, v111 op_sel:[1,0,0] op_sel_hi:[1,0,0]
  v_fma_mix_f32 v144, v34, v120, v112 op_sel_hi:[1,0,0]
  v_fma_mix_f32 v145, v34, v121, v113 op_sel:[1,0,0] op_sel_hi:[1,0,0]
  v_fma_mix_f32 v146, v35, v122, v114 op_sel_hi:[1,0,0]
  v_fma_mix_f32 v147, v35, v123, v115 op_sel:[1,0,0] op_sel_hi:[1,0,0]
  v_cvt_pk_bf16_f32 v32, v140, v141
  v_cvt_pk_bf16_f32 v33, v142, v143
  v_cvt_pk_bf16_f32 v34, v144, v145
  v_cvt_pk_bf16_f32 v35, v146, v147
  ds_write_b128 v150, v[32:35] offset:18432
  s_waitcnt vmcnt(7) lgkmcnt(5)
  v_fma_mix_f32 v140, v36, v132, v124 op_sel_hi:[1,0,0]
  v_fma_mix_f32 v141, v36, v133, v125 op_sel:[1,0,0] op_sel_hi:[1,0,0]
  buffer_load_dwordx4 v[68:71], v158, s[12:15], s37 offen
  v_fma_mix_f32 v142, v37, v134, v126 op_sel_hi:[1,0,0]
  v_fma_mix_f32 v143, v37, v135, v127 op_sel:[1,0,0] op_sel_hi:[1,0,0]
  v_lshl_add_u32 v148, s26, 7, v1
  s_waitcnt lgkmcnt(3)
  v_fma_mix_f32 v144, v38, v136, v128 op_sel_hi:[1,0,0]
  v_fma_mix_f32 v145, v38, v137, v129 op_sel:[1,0,0] op_sel_hi:[1,0,0]
  v_fma_mix_f32 v146, v39, v138, v130 op_sel_hi:[1,0,0]
  v_fma_mix_f32 v147, v39, v139, v131 op_sel:[1,0,0] op_sel_hi:[1,0,0]
  v_cvt_pk_bf16_f32 v36, v140, v141
  v_cvt_pk_bf16_f32 v37, v142, v143
  v_cvt_pk_bf16_f32 v38, v144, v145
  ds_read_b128 v[108:111], v148 offset:0
  v_cvt_pk_bf16_f32 v39, v146, v147
  ds_write_b128 v149, v[36:39] offset:4096
  s_waitcnt vmcnt(7)
  v_fma_mix_f32 v140, v40, v132, v124 op_sel_hi:[1,0,0]
  v_fma_mix_f32 v141, v40, v133, v125 op_sel:[1,0,0] op_sel_hi:[1,0,0]
  buffer_load_dwordx4 v[72:75], v158, s[12:15], s38 offen
  v_fma_mix_f32 v142, v41, v134, v126 op_sel_hi:[1,0,0]
  v_fma_mix_f32 v143, v41, v135, v127 op_sel:[1,0,0] op_sel_hi:[1,0,0]
  ds_read_b128 v[112:115], v148 offset:16
  v_fma_mix_f32 v144, v42, v136, v128 op_sel_hi:[1,0,0]
  v_fma_mix_f32 v145, v42, v137, v129 op_sel:[1,0,0] op_sel_hi:[1,0,0]
  v_fma_mix_f32 v146, v43, v138, v130 op_sel_hi:[1,0,0]
  v_fma_mix_f32 v147, v43, v139, v131 op_sel:[1,0,0] op_sel_hi:[1,0,0]
  v_cvt_pk_bf16_f32 v40, v140, v141
  v_cvt_pk_bf16_f32 v41, v142, v143
  v_cvt_pk_bf16_f32 v42, v144, v145
  ds_read_b128 v[116:119], v148 offset:2304
  v_cvt_pk_bf16_f32 v43, v146, v147
  ds_write_b128 v149, v[40:43] offset:22528
  s_waitcnt vmcnt(7)
  v_fma_mix_f32 v140, v44, v132, v124 op_sel_hi:[1,0,0]
  v_fma_mix_f32 v141, v44, v133, v125 op_sel:[1,0,0] op_sel_hi:[1,0,0]
  buffer_load_dwordx4 v[76:79], v159, s[12:15], s34 offen
  v_fma_mix_f32 v142, v45, v134, v126 op_sel_hi:[1,0,0]
  v_fma_mix_f32 v143, v45, v135, v127 op_sel:[1,0,0] op_sel_hi:[1,0,0]
  ds_read_b128 v[120:123], v148 offset:2320
  v_fma_mix_f32 v144, v46, v136, v128 op_sel_hi:[1,0,0]
  v_fma_mix_f32 v145, v46, v137, v129 op_sel:[1,0,0] op_sel_hi:[1,0,0]
  v_fma_mix_f32 v146, v47, v138, v130 op_sel_hi:[1,0,0]
  v_fma_mix_f32 v147, v47, v139, v131 op_sel:[1,0,0] op_sel_hi:[1,0,0]
  v_cvt_pk_bf16_f32 v44, v140, v141
  v_cvt_pk_bf16_f32 v45, v142, v143
  v_cvt_pk_bf16_f32 v46, v144, v145
  v_cvt_pk_bf16_f32 v47, v146, v147
  ds_write_b128 v149, v[44:47] offset:40960
  s_waitcnt vmcnt(7)
  v_fma_mix_f32 v140, v48, v132, v124 op_sel_hi:[1,0,0]
  v_fma_mix_f32 v141, v48, v133, v125 op_sel:[1,0,0] op_sel_hi:[1,0,0]
  buffer_load_dwordx4 v[80:83], v159, s[12:15], s35 offen
  v_fma_mix_f32 v142, v49, v134, v126 op_sel_hi:[1,0,0]
  v_fma_mix_f32 v143, v49, v135, v127 op_sel:[1,0,0] op_sel_hi:[1,0,0]
  v_fma_mix_f32 v144, v50, v136, v128 op_sel_hi:[1,0,0]
  v_fma_mix_f32 v145, v50, v137, v129 op_sel:[1,0,0] op_sel_hi:[1,0,0]
  v_fma_mix_f32 v146, v51, v138, v130 op_sel_hi:[1,0,0]
  v_fma_mix_f32 v147, v51, v139, v131 op_sel:[1,0,0] op_sel_hi:[1,0,0]
  v_cvt_pk_bf16_f32 v48, v140, v141
  v_cvt_pk_bf16_f32 v49, v142, v143
  v_cvt_pk_bf16_f32 v50, v144, v145
  v_cvt_pk_bf16_f32 v51, v146, v147
  ds_write_b128 v150, v[48:51] offset:4096
  s_waitcnt vmcnt(7)
  v_fma_mix_f32 v140, v52, v132, v124 op_sel_hi:[1,0,0]
  v_fma_mix_f32 v141, v52, v133, v125 op_sel:[1,0,0] op_sel_hi:[1,0,0]
  buffer_load_dwordx4 v[84:87], v159, s[12:15], s36 offen
  v_fma_mix_f32 v142, v53, v134, v126 op_sel_hi:[1,0,0]
  v_fma_mix_f32 v143, v53, v135, v127 op_sel:[1,0,0] op_sel_hi:[1,0,0]
  v_fma_mix_f32 v144, v54, v136, v128 op_sel_hi:[1,0,0]
  v_fma_mix_f32 v145, v54, v137, v129 op_sel:[1,0,0] op_sel_hi:[1,0,0]
  v_fma_mix_f32 v146, v55, v138, v130 op_sel_hi:[1,0,0]
  v_fma_mix_f32 v147, v55, v139, v131 op_sel:[1,0,0] op_sel_hi:[1,0,0]
  v_cvt_pk_bf16_f32 v52, v140, v141
  v_cvt_pk_bf16_f32 v53, v142, v143
  v_cvt_pk_bf16_f32 v54, v144, v145
  v_cvt_pk_bf16_f32 v55, v146, v147
  ds_write_b128 v150, v[52:55] offset:22528
  s_waitcnt vmcnt(7) lgkmcnt(5)
  v_fma_mix_f32 v140, v56, v116, v108 op_sel_hi:[1,0,0]
  v_fma_mix_f32 v141, v56, v117, v109 op_sel:[1,0,0] op_sel_hi:[1,0,0]
  buffer_load_dwordx4 v[88:91], v159, s[12:15], s37 offen
  v_fma_mix_f32 v142, v57, v118, v110 op_sel_hi:[1,0,0]
  v_fma_mix_f32 v143, v57, v119, v111 op_sel:[1,0,0] op_sel_hi:[1,0,0]
  v_lshl_add_u32 v148, s27, 7, v1
  s_waitcnt lgkmcnt(3)
  v_fma_mix_f32 v144, v58, v120, v112 op_sel_hi:[1,0,0]
  v_fma_mix_f32 v145, v58, v121, v113 op_sel:[1,0,0] op_sel_hi:[1,0,0]
  v_fma_mix_f32 v146, v59, v122, v114 op_sel_hi:[1,0,0]
  v_fma_mix_f32 v147, v59, v123, v115 op_sel:[1,0,0] op_sel_hi:[1,0,0]
  v_cvt_pk_bf16_f32 v56, v140, v141
  v_cvt_pk_bf16_f32 v57, v142, v143
  v_cvt_pk_bf16_f32 v58, v144, v145
  ds_read_b128 v[124:127], v148 offset:0
  v_cvt_pk_bf16_f32 v59, v146, v147
  ds_write_b128 v149, v[56:59] offset:8192
  s_waitcnt vmcnt(7)
  v_fma_mix_f32 v140, v60, v116, v108 op_sel_hi:[1,0,0]
  v_fma_mix_f32 v141, v60, v117, v109 op_sel:[1,0,0] op_sel_hi:[1,0,0]
  buffer_load_dwordx4 v[92:95], v159, s[12:15], s38 offen
  v_fma_mix_f32 v142, v61, v118, v110 op_sel_hi:[1,0,0]
  v_fma_mix_f32 v143, v61, v119, v111 op_sel:[1,0,0] op_sel_hi:[1,0,0]
  ds_read_b128 v[128:131], v148 offset:16
  v_fma_mix_f32 v144, v62, v120, v112 op_sel_hi:[1,0,0]
  v_fma_mix_f32 v145, v62, v121, v113 op_sel:[1,0,0] op_sel_hi:[1,0,0]
  v_fma_mix_f32 v146, v63, v122, v114 op_sel_hi:[1,0,0]
  v_fma_mix_f32 v147, v63, v123, v115 op_sel:[1,0,0] op_sel_hi:[1,0,0]
  v_cvt_pk_bf16_f32 v60, v140, v141
  v_cvt_pk_bf16_f32 v61, v142, v143
  v_cvt_pk_bf16_f32 v62, v144, v145
  ds_read_b128 v[132:135], v148 offset:2304
  v_cvt_pk_bf16_f32 v63, v146, v147
  ds_write_b128 v149, v[60:63] offset:26624
  s_waitcnt vmcnt(7)
  v_fma_mix_f32 v140, v64, v116, v108 op_sel_hi:[1,0,0]
  v_fma_mix_f32 v141, v64, v117, v109 op_sel:[1,0,0] op_sel_hi:[1,0,0]
  s_cmp_ge_u32 s20, 2
  s_cselect_b32 s34, s36, s34
  s_cselect_b32 s35, s37, s35
  s_cselect_b32 s36, s38, s36
  buffer_load_dwordx4 v[96:99], v160, s[12:15], s34 offen
  v_fma_mix_f32 v142, v65, v118, v110 op_sel_hi:[1,0,0]
  v_fma_mix_f32 v143, v65, v119, v111 op_sel:[1,0,0] op_sel_hi:[1,0,0]
  ds_read_b128 v[136:139], v148 offset:2320
  v_fma_mix_f32 v144, v66, v120, v112 op_sel_hi:[1,0,0]
  v_fma_mix_f32 v145, v66, v121, v113 op_sel:[1,0,0] op_sel_hi:[1,0,0]
  v_fma_mix_f32 v146, v67, v122, v114 op_sel_hi:[1,0,0]
  v_fma_mix_f32 v147, v67, v123, v115 op_sel:[1,0,0] op_sel_hi:[1,0,0]
  v_cvt_pk_bf16_f32 v64, v140, v141
  v_cvt_pk_bf16_f32 v65, v142, v143
  v_cvt_pk_bf16_f32 v66, v144, v145
  v_cvt_pk_bf16_f32 v67, v146, v147
  ds_write_b128 v149, v[64:67] offset:45056
  s_waitcnt vmcnt(7)
  v_fma_mix_f32 v140, v68, v116, v108 op_sel_hi:[1,0,0]
  v_fma_mix_f32 v141, v68, v117, v109 op_sel:[1,0,0] op_sel_hi:[1,0,0]
  buffer_load_dwordx4 v[100:103], v160, s[12:15], s35 offen
  v_fma_mix_f32 v142, v69, v118, v110 op_sel_hi:[1,0,0]
  v_fma_mix_f32 v143, v69, v119, v111 op_sel:[1,0,0] op_sel_hi:[1,0,0]
  v_fma_mix_f32 v144, v70, v120, v112 op_sel_hi:[1,0,0]
  v_fma_mix_f32 v145, v70, v121, v113 op_sel:[1,0,0] op_sel_hi:[1,0,0]
  v_fma_mix_f32 v146, v71, v122, v114 op_sel_hi:[1,0,0]
  v_fma_mix_f32 v147, v71, v123, v115 op_sel:[1,0,0] op_sel_hi:[1,0,0]
  v_cvt_pk_bf16_f32 v68, v140, v141
  v_cvt_pk_bf16_f32 v69, v142, v143
  v_cvt_pk_bf16_f32 v70, v144, v145
  v_cvt_pk_bf16_f32 v71, v146, v147
  ds_write_b128 v150, v[68:71] offset:8192
  s_waitcnt vmcnt(7)
  v_fma_mix_f32 v140, v72, v116, v108 op_sel_hi:[1,0,0]
  v_fma_mix_f32 v141, v72, v117, v109 op_sel:[1,0,0] op_sel_hi:[1,0,0]
  buffer_load_dwordx4 v[104:107], v160, s[12:15], s36 offen
  v_fma_mix_f32 v142, v73, v118, v110 op_sel_hi:[1,0,0]
  v_fma_mix_f32 v143, v73, v119, v111 op_sel:[1,0,0] op_sel_hi:[1,0,0]
  v_fma_mix_f32 v144, v74, v120, v112 op_sel_hi:[1,0,0]
  v_fma_mix_f32 v145, v74, v121, v113 op_sel:[1,0,0] op_sel_hi:[1,0,0]
  v_fma_mix_f32 v146, v75, v122, v114 op_sel_hi:[1,0,0]
  v_fma_mix_f32 v147, v75, v123, v115 op_sel:[1,0,0] op_sel_hi:[1,0,0]
  v_cvt_pk_bf16_f32 v72, v140, v141
  v_cvt_pk_bf16_f32 v73, v142, v143
  v_cvt_pk_bf16_f32 v74, v144, v145
  v_cvt_pk_bf16_f32 v75, v146, v147
  ds_write_b128 v150, v[72:75] offset:26624
  s_waitcnt vmcnt(7) lgkmcnt(5)
  v_fma_mix_f32 v140, v76, v132, v124 op_sel_hi:[1,0,0]
  v_fma_mix_f32 v141, v76, v133, v125 op_sel:[1,0,0] op_sel_hi:[1,0,0]
  buffer_load_dwordx4 a[0:3], v8, s[12:15], s39 offen
  v_fma_mix_f32 v142, v77, v134, v126 op_sel_hi:[1,0,0]
  v_fma_mix_f32 v143, v77, v135, v127 op_sel:[1,0,0] op_sel_hi:[1,0,0]
  v_lshl_add_u32 v148, s28, 7, v1
  s_waitcnt lgkmcnt(3)
  v_fma_mix_f32 v144, v78, v136, v128 op_sel_hi:[1,0,0]
  v_fma_mix_f32 v145, v78, v137, v129 op_sel:[1,0,0] op_sel_hi:[1,0,0]
  v_fma_mix_f32 v146, v79, v138, v130 op_sel_hi:[1,0,0]
  v_fma_mix_f32 v147, v79, v139, v131 op_sel:[1,0,0] op_sel_hi:[1,0,0]
  v_cvt_pk_bf16_f32 v76, v140, v141
  v_cvt_pk_bf16_f32 v77, v142, v143
  v_cvt_pk_bf16_f32 v78, v144, v145
  ds_read_b128 v[108:111], v148 offset:0
  v_cvt_pk_bf16_f32 v79, v146, v147
  ds_write_b128 v149, v[76:79] offset:12288
  s_waitcnt vmcnt(7)
  v_fma_mix_f32 v140, v80, v132, v124 op_sel_hi:[1,0,0]
  v_fma_mix_f32 v141, v80, v133, v125 op_sel:[1,0,0] op_sel_hi:[1,0,0]
  buffer_load_dwordx4 a[4:7], v9, s[12:15], s39 offen
  v_fma_mix_f32 v142, v81, v134, v126 op_sel_hi:[1,0,0]
  v_fma_mix_f32 v143, v81, v135, v127 op_sel:[1,0,0] op_sel_hi:[1,0,0]
  ds_read_b128 v[112:115], v148 offset:16
  v_fma_mix_f32 v144, v82, v136, v128 op_sel_hi:[1,0,0]
  v_fma_mix_f32 v145, v82, v137, v129 op_sel:[1,0,0] op_sel_hi:[1,0,0]
  v_fma_mix_f32 v146, v83, v138, v130 op_sel_hi:[1,0,0]
  v_fma_mix_f32 v147, v83, v139, v131 op_sel:[1,0,0] op_sel_hi:[1,0,0]
  v_cvt_pk_bf16_f32 v80, v140, v141
  v_cvt_pk_bf16_f32 v81, v142, v143
  v_cvt_pk_bf16_f32 v82, v144, v145
  ds_read_b128 v[116:119], v148 offset:2304
  v_cvt_pk_bf16_f32 v83, v146, v147
  ds_write_b128 v149, v[80:83] offset:30720
  s_waitcnt vmcnt(7)
  v_fma_mix_f32 v140, v84, v132, v124 op_sel_hi:[1,0,0]
  v_fma_mix_f32 v141, v84, v133, v125 op_sel:[1,0,0] op_sel_hi:[1,0,0]
  buffer_load_dwordx4 a[8:11], v10, s[12:15], s39 offen
  v_fma_mix_f32 v142, v85, v134, v126 op_sel_hi:[1,0,0]
  v_fma_mix_f32 v143, v85, v135, v127 op_sel:[1,0,0] op_sel_hi:[1,0,0]
  ds_read_b128 v[120:123], v148 offset:2320
  v_fma_mix_f32 v144, v86, v136, v128 op_sel_hi:[1,0,0]
  v_fma_mix_f32 v145, v86, v137, v129 op_sel:[1,0,0] op_sel_hi:[1,0,0]
  v_fma_mix_f32 v146, v87, v138, v130 op_sel_hi:[1,0,0]
  v_fma_mix_f32 v147, v87, v139, v131 op_sel:[1,0,0] op_sel_hi:[1,0,0]
  v_cvt_pk_bf16_f32 v84, v140, v141
  v_cvt_pk_bf16_f32 v85, v142, v143
  v_cvt_pk_bf16_f32 v86, v144, v145
  v_cvt_pk_bf16_f32 v87, v146, v147
  ds_write_b128 v149, v[84:87] offset:49152
  s_waitcnt vmcnt(7)
  v_fma_mix_f32 v140, v88, v132, v124 op_sel_hi:[1,0,0]
  v_fma_mix_f32 v141, v88, v133, v125 op_sel:[1,0,0] op_sel_hi:[1,0,0]
  buffer_load_dwordx4 a[12:15], v11, s[12:15], s39 offen
  s_add_u32 s39, s39, 1024
  v_fma_mix_f32 v142, v89, v134, v126 op_sel_hi:[1,0,0]
  v_fma_mix_f32 v143, v89, v135, v127 op_sel:[1,0,0] op_sel_hi:[1,0,0]
  v_fma_mix_f32 v144, v90, v136, v128 op_sel_hi:[1,0,0]
  v_fma_mix_f32 v145, v90, v137, v129 op_sel:[1,0,0] op_sel_hi:[1,0,0]
  v_fma_mix_f32 v146, v91, v138, v130 op_sel_hi:[1,0,0]
  v_fma_mix_f32 v147, v91, v139, v131 op_sel:[1,0,0] op_sel_hi:[1,0,0]
  v_cvt_pk_bf16_f32 v88, v140, v141
  v_cvt_pk_bf16_f32 v89, v142, v143
  v_cvt_pk_bf16_f32 v90, v144, v145
  v_cvt_pk_bf16_f32 v91, v146, v147
  ds_write_b128 v150, v[88:91] offset:12288
  s_waitcnt vmcnt(7)
  v_fma_mix_f32 v140, v92, v132, v124 op_sel_hi:[1,0,0]
  v_fma_mix_f32 v141, v92, v133, v125 op_sel:[1,0,0] op_sel_hi:[1,0,0]
  buffer_load_dwordx4 a[16:19], v8, s[12:15], s39 offen
  v_fma_mix_f32 v142, v93, v134, v126 op_sel_hi:[1,0,0]
  v_fma_mix_f32 v143, v93, v135, v127 op_sel:[1,0,0] op_sel_hi:[1,0,0]
  v_fma_mix_f32 v144, v94, v136, v128 op_sel_hi:[1,0,0]
  v_fma_mix_f32 v145, v94, v137, v129 op_sel:[1,0,0] op_sel_hi:[1,0,0]
  v_fma_mix_f32 v146, v95, v138, v130 op_sel_hi:[1,0,0]
  v_fma_mix_f32 v147, v95, v139, v131 op_sel:[1,0,0] op_sel_hi:[1,0,0]
  v_cvt_pk_bf16_f32 v92, v140, v141
  v_cvt_pk_bf16_f32 v93, v142, v143
  v_cvt_pk_bf16_f32 v94, v144, v145
  v_cvt_pk_bf16_f32 v95, v146, v147
  ds_write_b128 v150, v[92:95] offset:30720
  s_waitcnt vmcnt(7) lgkmcnt(5)
  v_fma_mix_f32 v140, v96, v116, v108 op_sel_hi:[1,0,0]
  v_fma_mix_f32 v141, v96, v117, v109 op_sel:[1,0,0] op_sel_hi:[1,0,0]
  buffer_load_dwordx4 a[20:23], v9, s[12:15], s39 offen
  v_fma_mix_f32 v142, v97, v118, v110 op_sel_hi:[1,0,0]
  v_fma_mix_f32 v143, v97, v119, v111 op_sel:[1,0,0] op_sel_hi:[1,0,0]
  s_waitcnt lgkmcnt(3)
  v_fma_mix_f32 v144, v98, v120, v112 op_sel_hi:[1,0,0]
  v_fma_mix_f32 v145, v98, v121, v113 op_sel:[1,0,0] op_sel_hi:[1,0,0]
  v_fma_mix_f32 v146, v99, v122, v114 op_sel_hi:[1,0,0]
  v_fma_mix_f32 v147, v99, v123, v115 op_sel:[1,0,0] op_sel_hi:[1,0,0]
  v_cvt_pk_bf16_f32 v96, v140, v141
  v_cvt_pk_bf16_f32 v97, v142, v143
  v_cvt_pk_bf16_f32 v98, v144, v145
  v_cvt_pk_bf16_f32 v99, v146, v147
  ds_write_b128 v151, v[96:99] offset:0
  s_waitcnt vmcnt(7)
  v_fma_mix_f32 v140, v100, v116, v108 op_sel_hi:[1,0,0]
  v_fma_mix_f32 v141, v100, v117, v109 op_sel:[1,0,0] op_sel_hi:[1,0,0]
  buffer_load_dwordx4 a[24:27], v10, s[12:15], s39 offen
  v_fma_mix_f32 v142, v101, v118, v110 op_sel_hi:[1,0,0]
  v_fma_mix_f32 v143, v101, v119, v111 op_sel:[1,0,0] op_sel_hi:[1,0,0]
  v_fma_mix_f32 v144, v102, v120, v112 op_sel_hi:[1,0,0]
  v_fma_mix_f32 v145, v102, v121, v113 op_sel:[1,0,0] op_sel_hi:[1,0,0]
  v_fma_mix_f32 v146, v103, v122, v114 op_sel_hi:[1,0,0]
  v_fma_mix_f32 v147, v103, v123, v115 op_sel:[1,0,0] op_sel_hi:[1,0,0]
  v_cvt_pk_bf16_f32 v100, v140, v141
  v_cvt_pk_bf16_f32 v101, v142, v143
  v_cvt_pk_bf16_f32 v102, v144, v145
  v_cvt_pk_bf16_f32 v103, v146, v147
  ds_write_b128 v151, v[100:103] offset:18432
  s_waitcnt vmcnt(7)
  v_fma_mix_f32 v140, v104, v116, v108 op_sel_hi:[1,0,0]
  v_fma_mix_f32 v141, v104, v117, v109 op_sel:[1,0,0] op_sel_hi:[1,0,0]
  buffer_load_dwordx4 a[28:31], v11, s[12:15], s39 offen
  s_add_u32 s39, s39, 1024
  v_fma_mix_f32 v142, v105, v118, v110 op_sel_hi:[1,0,0]
  v_fma_mix_f32 v143, v105, v119, v111 op_sel:[1,0,0] op_sel_hi:[1,0,0]
  v_fma_mix_f32 v144, v106, v120, v112 op_sel_hi:[1,0,0]
  v_fma_mix_f32 v145, v106, v121, v113 op_sel:[1,0,0] op_sel_hi:[1,0,0]
  v_fma_mix_f32 v146, v107, v122, v114 op_sel_hi:[1,0,0]
  v_fma_mix_f32 v147, v107, v123, v115 op_sel:[1,0,0] op_sel_hi:[1,0,0]
  v_cvt_pk_bf16_f32 v104, v140, v141
  v_cvt_pk_bf16_f32 v105, v142, v143
  v_cvt_pk_bf16_f32 v106, v144, v145
  v_cvt_pk_bf16_f32 v107, v146, v147
  ds_write_b128 v151, v[104:107] offset:36864
  buffer_load_dwordx4 a[32:35], v8, s[12:15], s39 offen
  buffer_load_dwordx4 a[36:39], v9, s[12:15], s39 offen
  buffer_load_dwordx4 a[40:43], v10, s[12:15], s39 offen
  buffer_load_dwordx4 a[44:47], v11, s[12:15], s39 offen
  s_add_u32 s39, s39, 1024
  v_add_u32 v1, 0xd800, v2
  s_waitcnt lgkmcnt(0)
  s_barrier
  s_cmp_eq_u32 s20, 2
  s_cbranch_scc1 L_a_c1
  s_cmp_eq_u32 s20, 3
  s_cbranch_scc1 L_a_c2
  ds_read_b128 v[88:91], v2 offset:0
  ds_read_b128 v[92:95], v2 offset:18432
  ds_read_b128 v[96:99], v2 offset:36864
  ds_read_b128 v[100:103], v1 offset:0
  ds_read_b128 v[104:107], v1 offset:18432
  s_waitcnt vmcnt(11) lgkmcnt(4)
  v_mfma_f32_16x16x32_bf16 v[16:19], a[0:3], v[88:91], 0
  ds_read_b128 v[108:111], v2 offset:1024
  s_waitcnt vmcnt(10)
  v_mfma_f32_16x16x32_bf16 v[36:39], a[4:7], v[88:91], 0
  s_waitcnt lgkmcnt(4)
  v_mfma_f32_16x16x32_bf16 v[20:23], a[0:3], v[92:95], 0
  buffer_load_dwordx4 a[48:51], v8, s[12:15], s39 offen
  v_mfma_f32_16x16x32_bf16 v[40:43], a[4:7], v[92:95], 0
  s_waitcnt vmcnt(10)
  v_mfma_f32_16x16x32_bf16 v[56:59], a[8:11], v[92:95], 0
  ds_read_b128 v[112:115], v2 offset:19456
  s_waitcnt vmcnt(9)
  v_mfma_f32_16x16x32_bf16 v[72:75], a[12:15], v[92:95], 0
  s_waitcnt lgkmcnt(4)
  v_mfma_f32_16x16x32_bf16 v[24:27], a[0:3], v[96:99], 0
  buffer_load_dwordx4 a[52:55], v9, s[12:15], s39 offen
  v_mfma_f32_16x16x32_bf16 v[44:47], a[4:7], v[96:99], 0
  v_mfma_f32_16x16x32_bf16 v[60:63], a[8:11], v[96:99], 0
  ds_read_b128 v[116:119], v2 offset:37888
  v_mfma_f32_16x16x32_bf16 v[76:79], a[12:15], v[96:99], 0
  s_waitcnt lgkmcnt(4)
  v_mfma_f32_16x16x32_bf16 v[28:31], a[0:3], v[100:103], 0
  buffer_load_dwordx4 a[56:59], v10, s[12:15], s39 offen
  v_mfma_f32_16x16x32_bf16 v[48:51], a[4:7], v[100:103], 0
  v_mfma_f32_16x16x32_bf16 v[64:67], a[8:11], v[100:103], 0
  ds_read_b128 v[120:123], v1 offset:1024
  v_mfma_f32_16x16x32_bf16 v[80:83], a[12:15], v[100:103], 0
  s_waitcnt lgkmcnt(4)
  v_mfma_f32_16x16x32_bf16 v[32:35], a[0:3], v[104:107], 0
  buffer_load_dwordx4 a[60:63], v11, s[12:15], s39 offen
  s_add_u32 s39, s39, 1024
  v_mfma_f32_16x16x32_bf16 v[52:55], a[4:7], v[104:107], 0
  v_mfma_f32_16x16x32_bf16 v[68:71], a[8:11], v[104:107], 0
  ds_read_b128 v[124:127], v1 offset:19456
  v_mfma_f32_16x16x32_bf16 v[84:87], a[12:15], v[104:107], 0
  s_waitcnt vmcnt(11) lgkmcnt(4)
  v_mfma_f32_16x16x32_bf16 v[16:19], a[16:19], v[108:111], v[16:19]
  ds_read_b128 v[88:91], v2 offset:2048
  s_waitcnt vmcnt(10)
  v_mfma_f32_16x16x32_bf16 v[36:39], a[20:23], v[108:111], v[36:39]
  s_waitcnt lgkmcnt(4)
  v_mfma_f32_16x16x32_bf16 v[20:23], a[16:19], v[112:115], v[20:23]
  buffer_load_dwordx4 a[64:67], v8, s[12:15], s39 offen
  v_mfma_f32_16x16x32_bf16 v[40:43], a[20:23], v[112:115], v[40:43]
  s_waitcnt vmcnt(10)
  v_mfma_f32_16x16x32_bf16 v[56:59], a[24:27], v[112:115], v[56:59]
  ds_read_b128 v[92:95], v2 offset:20480
  s_waitcnt vmcnt(9)
  v_mfma_f32_16x16x32_bf16 v[72:75], a[28:31], v[112:115], v[72:75]
  s_waitcnt lgkmcnt(4)
  v_mfma_f32_16x16x32_bf16 v[24:27], a[16:19], v[116:119], v[24:27]
  buffer_load_dwordx4 a[68:71], v9, s[12:15], s39 offen
  v_mfma_f32_16x16x32_bf16 v[44:47], a[20:23], v[116:119], v[44:47]
  v_mfma_f32_16x16x32_bf16 v[60:63], a[24:27], v[116:119], v[60:63]
  ds_read_b128 v[96:99], v2 offset:38912
  v_mfma_f32_16x16x32_bf16 v[76:79], a[28:31], v[116:119], v[76:79]
  s_waitcnt lgkmcnt(4)
  v_mfma_f32_16x16x32_bf16 v[28:31], a[16:19], v[120:123], v[28:31]
  buffer_load_dwordx4 a[72:75], v10, s[12:15], s39 offen
  v_mfma_f32_16x16x32_bf16 v[48:51], a[20:23], v[120:123], v[48:51]
  v_mfma_f32_16x16x32_bf16 v[64:67], a[24:27], v[120:123], v[64:67]
  ds_read_b128 v[100:103], v1 offset:2048
  v_mfma_f32_16x16x32_bf16 v[80:83], a[28:31], v[120:123], v[80:83]
  s_waitcnt lgkmcnt(4)
  v_mfma_f32_16x16x32_bf16 v[32:35], a[16:19], v[124:127], v[32:35]
  buffer_load_dwordx4 a[76:79], v11, s[12:15], s39 offen
  s_add_u32 s39, s39, 1024
  v_mfma_f32_16x16x32_bf16 v[52:55], a[20:23], v[124:127], v[52:55]
  v_mfma_f32_16x16x32_bf16 v[68:71], a[24:27], v[124:127], v[68:71]
  ds_read_b128 v[104:107], v1 offset:20480
  v_mfma_f32_16x16x32_bf16 v[84:87], a[28:31], v[124:127], v[84:87]
  s_waitcnt vmcnt(11) lgkmcnt(4)
  v_mfma_f32_16x16x32_bf16 v[16:19], a[32:35], v[88:91], v[16:19]
  ds_read_b128 v[108:111], v2 offset:3072
  s_waitcnt vmcnt(10)
  v_mfma_f32_16x16x32_bf16 v[36:39], a[36:39], v[88:91], v[36:39]
  s_waitcnt lgkmcnt(4)
  v_mfma_f32_16x16x32_bf16 v[20:23], a[32:35], v[92:95], v[20:23]
  buffer_load_dwordx4 a[80:83], v8, s[12:15], s39 offen
  v_mfma_f32_16x16x32_bf16 v[40:43], a[36:39], v[92:95], v[40:43]
  s_waitcnt vmcnt(10)
  v_mfma_f32_16x16x32_bf16 v[56:59], a[40:43], v[92:95], v[56:59]
  ds_read_b128 v[112:115], v2 offset:21504
  s_waitcnt vmcnt(9)
  v_mfma_f32_16x16x32_bf16 v[72:75], a[44:47], v[92:95], v[72:75]
  s_waitcnt lgkmcnt(4)
  v_mfma_f32_16x16x32_bf16 v[24:27], a[32:35], v[96:99], v[24:27]
  buffer_load_dwordx4 a[84:87], v9, s[12:15], s39 offen
  v_mfma_f32_16x16x32_bf16 v[44:47], a[36:39], v[96:99], v[44:47]
  v_mfma_f32_16x16x32_bf16 v[60:63], a[40:43], v[96:99], v[60:63]
  ds_read_b128 v[116:119], v2 offset:39936
  v_mfma_f32_16x16x32_bf16 v[76:79], a[44:47], v[96:99], v[76:79]
  s_waitcnt lgkmcnt(4)
  v_mfma_f32_16x16x32_bf16 v[28:31], a[32:35], v[100:103], v[28:31]
  buffer_load_dwordx4 a[88:91], v10, s[12:15], s39 offen
  v_mfma_f32_16x16x32_bf16 v[48:51], a[36:39], v[100:103], v[48:51]
  v_mfma_f32_16x16x32_bf16 v[64:67], a[40:43], v[100:103], v[64:67]
  ds_read_b128 v[120:123], v1 offset:3072
  v_mfma_f32_16x16x32_bf16 v[80:83], a[44:47], v[100:103], v[80:83]
  s_waitcnt lgkmcnt(4)
  v_mfma_f32_16x16x32_bf16 v[32:35], a[32:35], v[104:107], v[32:35]
  buffer_load_dwordx4 a[92:95], v11, s[12:15], s39 offen
  s_add_u32 s39, s39, 1024
  v_mfma_f32_16x16x32_bf16 v[52:55], a[36:39], v[104:107], v[52:55]
  v_mfma_f32_16x16x32_bf16 v[68:71], a[40:43], v[104:107], v[68:71]
  ds_read_b128 v[124:127], v1 offset:21504
  v_mfma_f32_16x16x32_bf16 v[84:87], a[44:47], v[104:107], v[84:87]
  s_waitcnt vmcnt(11) lgkmcnt(4)
  v_mfma_f32_16x16x32_bf16 v[16:19], a[48:51], v[108:111], v[16:19]
  ds_read_b128 v[88:91], v2 offset:4096
  s_waitcnt vmcnt(10)
  v_mfma_f32_16x16x32_bf16 v[36:39], a[52:55], v[108:111], v[36:39]
  s_waitcnt lgkmcnt(4)
  v_mfma_f32_16x16x32_bf16 v[20:23], a[48:51], v[112:115], v[20:23]
  buffer_load_dwordx4 a[96:99], v8, s[12:15], s39 offen
  v_mfma_f32_16x16x32_bf16 v[40:43], a[52:55], v[112:115], v[40:43]
  s_waitcnt vmcnt(10)
  v_mfma_f32_16x16x32_bf16 v[56:59], a[56:59], v[112:115], v[56:59]
  ds_read_b128 v[92:95], v2 offset:22528
  s_waitcnt vmcnt(9)
  v_mfma_f32_16x16x32_bf16 v[72:75], a[60:63], v[112:115], v[72:75]
  s_waitcnt lgkmcnt(4)
  v_mfma_f32_16x16x32_bf16 v[24:27], a[48:51], v[116:119], v[24:27]
  buffer_load_dwordx4 a[100:103], v9, s[12:15], s39 offen
  v_mfma_f32_16x16x32_bf16 v[44:47], a[52:55], v[116:119], v[44:47]
  v_mfma_f32_16x16x32_bf16 v[60:63], a[56:59], v[116:119], v[60:63]
  ds_read_b128 v[96:99], v2 offset:40960
  v_mfma_f32_16x16x32_bf16 v[76:79], a[60:63], v[116:119], v[76:79]
  s_waitcnt lgkmcnt(4)
  v_mfma_f32_16x16x32_bf16 v[28:31], a[48:51], v[120:123], v[28:31]
  buffer_load_dwordx4 a[104:107], v10, s[12:15], s39 offen
  v_mfma_f32_16x16x32_bf16 v[48:51], a[52:55], v[120:123], v[48:51]
  v_mfma_f32_16x16x32_bf16 v[64:67], a[56:59], v[120:123], v[64:67]
  ds_read_b128 v[100:103], v1 offset:4096
  v_mfma_f32_16x16x32_bf16 v[80:83], a[60:63], v[120:123], v[80:83]
  s_waitcnt lgkmcnt(4)
  v_mfma_f32_16x16x32_bf16 v[32:35], a[48:51], v[124:127], v[32:35]
  buffer_load_dwordx4 a[108:111], v11, s[12:15], s39 offen
  s_add_u32 s39, s39, 1024
  v_mfma_f32_16x16x32_bf16 v[52:55], a[52:55], v[124:127], v[52:55]
  v_mfma_f32_16x16x32_bf16 v[68:71], a[56:59], v[124:127], v[68:71]
  ds_read_b128 v[104:107], v1 offset:22528
  v_mfma_f32_16x16x32_bf16 v[84:87], a[60:63], v[124:127], v[84:87]
  s_waitcnt vmcnt(11) lgkmcnt(4)
  v_mfma_f32_16x16x32_bf16 v[16:19], a[64:67], v[88:91], v[16:19]
  ds_read_b128 v[108:111], v2 offset:5120
  s_waitcnt vmcnt(10)
  v_mfma_f32_16x16x32_bf16 v[36:39], a[68:71], v[88:91], v[36:39]
  s_waitcnt lgkmcnt(4)
  v_mfma_f32_16x16x32_bf16 v[20:23], a[64:67], v[92:95], v[20:23]
  buffer_load_dwordx4 a[112:115], v8, s[12:15], s39 offen
  v_mfma_f32_16x16x32_bf16 v[40:43], a[68:71], v[92:95], v[40:43]
  s_waitcnt vmcnt(10)
  v_mfma_f32_16x16x32_bf16 v[56:59], a[72:75], v[92:95], v[56:59]
  ds_read_b128 v[112:115], v2 offset:23552
  s_waitcnt vmcnt(9)
  v_mfma_f32_16x16x32_bf16 v[72:75], a[76:79], v[92:95], v[72:75]
  s_waitcnt lgkmcnt(4)
  v_mfma_f32_16x16x32_bf16 v[24:27], a[64:67], v[96:99], v[24:27]
  buffer_load_dwordx4 a[116:119], v9, s[12:15], s39 offen
  v_mfma_f32_16x16x32_bf16 v[44:47], a[68:71], v[96:99], v[44:47]
  v_mfma_f32_16x16x32_bf16 v[60:63], a[72:75], v[96:99], v[60:63]
  ds_read_b128 v[116:119], v2 offset:41984
  v_mfma_f32_16x16x32_bf16 v[76:79], a[76:79], v[96:99], v[76:79]
  s_waitcnt lgkmcnt(4)
  v_mfma_f32_16x16x32_bf16 v[28:31], a[64:67], v[100:103], v[28:31]
  buffer_load_dwordx4 a[120:123], v10, s[12:15], s39 offen
  v_mfma_f32_16x16x32_bf16 v[48:51], a[68:71], v[100:103], v[48:51]
  v_mfma_f32_16x16x32_bf16 v[64:67], a[72:75], v[100:103], v[64:67]
  ds_read_b128 v[120:123], v1 offset:5120
  v_mfma_f32_16x16x32_bf16 v[80:83], a[76:79], v[100:103], v[80:83]
  s_waitcnt lgkmcnt(4)
  v_mfma_f32_16x16x32_bf16 v[32:35], a[64:67], v[104:107], v[32:35]
  buffer_load_dwordx4 a[124:127], v11, s[12:15], s39 offen
  s_add_u32 s39, s39, 1024
  v_mfma_f32_16x16x32_bf16 v[52:55], a[68:71], v[104:107], v[52:55]
  v_mfma_f32_16x16x32_bf16 v[68:71], a[72:75], v[104:107], v[68:71]
  ds_read_b128 v[124:127], v1 offset:23552
  v_mfma_f32_16x16x32_bf16 v[84:87], a[76:79], v[104:107], v[84:87]
  s_waitcnt vmcnt(11) lgkmcnt(4)
  v_mfma_f32_16x16x32_bf16 v[16:19], a[80:83], v[108:111], v[16:19]
  ds_read_b128 v[88:91], v2 offset:6144
  s_waitcnt vmcnt(10)
  v_mfma_f32_16x16x32_bf16 v[36:39], a[84:87], v[108:111], v[36:39]
  s_waitcnt lgkmcnt(4)
  v_mfma_f32_16x16x32_bf16 v[20:23], a[80:83], v[112:115], v[20:23]
  buffer_load_dwordx4 a[128:131], v8, s[12:15], s39 offen
  v_mfma_f32_16x16x32_bf16 v[40:43], a[84:87], v[112:115], v[40:43]
  s_waitcnt vmcnt(10)
  v_mfma_f32_16x16x32_bf16 v[56:59], a[88:91], v[112:115], v[56:59]
  ds_read_b128 v[92:95], v2 offset:24576
  s_waitcnt vmcnt(9)
  v_mfma_f32_16x16x32_bf16 v[72:75], a[92:95], v[112:115], v[72:75]
  s_waitcnt lgkmcnt(4)
  v_mfma_f32_16x16x32_bf16 v[24:27], a[80:83], v[116:119], v[24:27]
  buffer_load_dwordx4 a[132:135], v9, s[12:15], s39 offen
  v_mfma_f32_16x16x32_bf16 v[44:47], a[84:87], v[116:119], v[44:47]
  v_mfma_f32_16x16x32_bf16 v[60:63], a[88:91], v[116:119], v[60:63]
  ds_read_b128 v[96:99], v2 offset:43008
  v_mfma_f32_16x16x32_bf16 v[76:79], a[92:95], v[116:119], v[76:79]
  s_waitcnt lgkmcnt(4)
  v_mfma_f32_16x16x32_bf16 v[28:31], a[80:83], v[120:123], v[28:31]
  buffer_load_dwordx4 a[136:139], v10, s[12:15], s39 offen
  v_mfma_f32_16x16x32_bf16 v[48:51], a[84:87], v[120:123], v[48:51]
  v_mfma_f32_16x16x32_bf16 v[64:67], a[88:91], v[120:123], v[64:67]
  ds_read_b128 v[100:103], v1 offset:6144
  v_mfma_f32_16x16x32_bf16 v[80:83], a[92:95], v[120:123], v[80:83]
  s_waitcnt lgkmcnt(4)
  v_mfma_f32_16x16x32_bf16 v[32:35], a[80:83], v[124:127], v[32:35]
  buffer_load_dwordx4 a[140:143], v11, s[12:15], s39 offen
  s_add_u32 s39, s39, 1024
  v_mfma_f32_16x16x32_bf16 v[52:55], a[84:87], v[124:127], v[52:55]
  v_mfma_f32_16x16x32_bf16 v[68:71], a[88:91], v[124:127], v[68:71]
  ds_read_b128 v[104:107], v1 offset:24576
  v_mfma_f32_16x16x32_bf16 v[84:87], a[92:95], v[124:127], v[84:87]
  s_waitcnt vmcnt(11) lgkmcnt(4)
  v_mfma_f32_16x16x32_bf16 v[16:19], a[96:99], v[88:91], v[16:19]
  ds_read_b128 v[108:111], v2 offset:7168
  s_waitcnt vmcnt(10)
  v_mfma_f32_16x16x32_bf16 v[36:39], a[100:103], v[88:91], v[36:39]
  s_waitcnt lgkmcnt(4)
  v_mfma_f32_16x16x32_bf16 v[20:23], a[96:99], v[92:95], v[20:23]
  buffer_load_dwordx4 a[144:147], v8, s[12:15], s39 offen
  v_mfma_f32_16x16x32_bf16 v[40:43], a[100:103], v[92:95], v[40:43]
  s_waitcnt vmcnt(10)
  v_mfma_f32_16x16x32_bf16 v[56:59], a[104:107], v[92:95], v[56:59]
  ds_read_b128 v[112:115], v2 offset:25600
  s_waitcnt vmcnt(9)
  v_mfma_f32_16x16x32_bf16 v[72:75], a[108:111], v[92:95], v[72:75]
  s_waitcnt lgkmcnt(4)
  v_mfma_f32_16x16x32_bf16 v[24:27], a[96:99], v[96:99], v[24:27]
  buffer_load_dwordx4 a[148:151], v9, s[12:15], s39 offen
  v_mfma_f32_16x16x32_bf16 v[44:47], a[100:103], v[96:99], v[44:47]
  v_mfma_f32_16x16x32_bf16 v[60:63], a[104:107], v[96:99], v[60:63]
  ds_read_b128 v[116:119], v2 offset:44032
  v_mfma_f32_16x16x32_bf16 v[76:79], a[108:111], v[96:99], v[76:79]
  s_waitcnt lgkmcnt(4)
  v_mfma_f32_16x16x32_bf16 v[28:31], a[96:99], v[100:103], v[28:31]
  buffer_load_dwordx4 a[152:155], v10, s[12:15], s39 offen
  v_mfma_f32_16x16x32_bf16 v[48:51], a[100:103], v[100:103], v[48:51]
  v_mfma_f32_16x16x32_bf16 v[64:67], a[104:107], v[100:103], v[64:67]
  ds_read_b128 v[120:123], v1 offset:7168
  v_mfma_f32_16x16x32_bf16 v[80:83], a[108:111], v[100:103], v[80:83]
  s_waitcnt lgkmcnt(4)
  v_mfma_f32_16x16x32_bf16 v[32:35], a[96:99], v[104:107], v[32:35]
  buffer_load_dwordx4 a[156:159], v11, s[12:15], s39 offen
  s_add_u32 s39, s39, 1024
  v_mfma_f32_16x16x32_bf16 v[52:55], a[100:103], v[104:107], v[52:55]
  v_mfma_f32_16x16x32_bf16 v[68:71], a[104:107], v[104:107], v[68:71]
  ds_read_b128 v[124:127], v1 offset:25600
  v_mfma_f32_16x16x32_bf16 v[84:87], a[108:111], v[104:107], v[84:87]
  s_waitcnt vmcnt(11) lgkmcnt(4)
  v_mfma_f32_16x16x32_bf16 v[16:19], a[112:115], v[108:111], v[16:19]
  ds_read_b128 v[88:91], v2 offset:8192
  s_waitcnt vmcnt(10)
  v_mfma_f32_16x16x32_bf16 v[36:39], a[116:119], v[108:111], v[36:39]
  s_waitcnt lgkmcnt(4)
  v_mfma_f32_16x16x32_bf16 v[20:23], a[112:115], v[112:115], v[20:23]
  buffer_load_dwordx4 a[160:163], v8, s[12:15], s39 offen
  v_mfma_f32_16x16x32_bf16 v[40:43], a[116:119], v[112:115], v[40:43]
  s_waitcnt vmcnt(10)
  v_mfma_f32_16x16x32_bf16 v[56:59], a[120:123], v[112:115], v[56:59]
  ds_read_b128 v[92:95], v2 offset:26624
  s_waitcnt vmcnt(9)
  v_mfma_f32_16x16x32_bf16 v[72:75], a[124:127], v[112:115], v[72:75]
  s_waitcnt lgkmcnt(4)
  v_mfma_f32_16x16x32_bf16 v[24:27], a[112:115], v[116:119], v[24:27]
  buffer_load_dwordx4 a[164:167], v9, s[12:15], s39 offen
  v_mfma_f32_16x16x32_bf16 v[44:47], a[116:119], v[116:119], v[44:47]
  v_mfma_f32_16x16x32_bf16 v[60:63], a[120:123], v[116:119], v[60:63]
  ds_read_b128 v[96:99], v2 offset:45056
  v_mfma_f32_16x16x32_bf16 v[76:79], a[124:127], v[116:119], v[76:79]
  s_waitcnt lgkmcnt(4)
  v_mfma_f32_16x16x32_bf16 v[28:31], a[112:115], v[120:123], v[28:31]
  buffer_load_dwordx4 a[168:171], v10, s[12:15], s39 offen
  v_mfma_f32_16x16x32_bf16 v[48:51], a[116:119], v[120:123], v[48:51]
  v_mfma_f32_16x16x32_bf16 v[64:67], a[120:123], v[120:123], v[64:67]
  ds_read_b128 v[100:103], v1 offset:8192
  v_mfma_f32_16x16x32_bf16 v[80:83], a[124:127], v[120:123], v[80:83]
  s_waitcnt lgkmcnt(4)
  v_mfma_f32_16x16x32_bf16 v[32:35], a[112:115], v[124:127], v[32:35]
  buffer_load_dwordx4 a[172:175], v11, s[12:15], s39 offen
  s_add_u32 s39, s39, 1024
  v_mfma_f32_16x16x32_bf16 v[52:55], a[116:119], v[124:127], v[52:55]
  v_mfma_f32_16x16x32_bf16 v[68:71], a[120:123], v[124:127], v[68:71]
  ds_read_b128 v[104:107], v1 offset:26624
  v_mfma_f32_16x16x32_bf16 v[84:87], a[124:127], v[124:127], v[84:87]
  s_waitcnt vmcnt(11) lgkmcnt(4)
  v_mfma_f32_16x16x32_bf16 v[16:19], a[128:131], v[88:91], v[16:19]
  ds_read_b128 v[108:111], v2 offset:9216
  s_waitcnt vmcnt(10)
  v_mfma_f32_16x16x32_bf16 v[36:39], a[132:135], v[88:91], v[36:39]
  s_waitcnt lgkmcnt(4)
  v_mfma_f32_16x16x32_bf16 v[20:23], a[128:131], v[92:95], v[20:23]
  buffer_load_dwordx4 a[176:179], v8, s[12:15], s39 offen
  v_mfma_f32_16x16x32_bf16 v[40:43], a[132:135], v[92:95], v[40:43]
  s_waitcnt vmcnt(10)
  v_mfma_f32_16x16x32_bf16 v[56:59], a[136:139], v[92:95], v[56:59]
  ds_read_b128 v[112:115], v2 offset:27648
  s_waitcnt vmcnt(9)
  v_mfma_f32_16x16x32_bf16 v[72:75], a[140:143], v[92:95], v[72:75]
  s_waitcnt lgkmcnt(4)
  v_mfma_f32_16x16x32_bf16 v[24:27], a[128:131], v[96:99], v[24:27]
  buffer_load_dwordx4 a[180:183], v9, s[12:15], s39 offen
  v_mfma_f32_16x16x32_bf16 v[44:47], a[132:135], v[96:99], v[44:47]
  v_mfma_f32_16x16x32_bf16 v[60:63], a[136:139], v[96:99], v[60:63]
  ds_read_b128 v[116:119], v2 offset:46080
  v_mfma_f32_16x16x32_bf16 v[76:79], a[140:143], v[96:99], v[76:79]
  s_waitcnt lgkmcnt(4)
  v_mfma_f32_16x16x32_bf16 v[28:31], a[128:131], v[100:103], v[28:31]
  buffer_load_dwordx4 a[184:187], v10, s[12:15], s39 offen
  v_mfma_f32_16x16x32_bf16 v[48:51], a[132:135], v[100:103], v[48:51]
  v_mfma_f32_16x16x32_bf16 v[64:67], a[136:139], v[100:103], v[64:67]
  ds_read_b128 v[120:123], v1 offset:9216
  v_mfma_f32_16x16x32_bf16 v[80:83], a[140:143], v[100:103], v[80:83]
  s_waitcnt lgkmcnt(4)
  v_mfma_f32_16x16x32_bf16 v[32:35], a[128:131], v[104:107], v[32:35]
  buffer_load_dwordx4 a[188:191], v11, s[12:15], s39 offen
  s_add_u32 s39, s39, 1024
  v_mfma_f32_16x16x32_bf16 v[52:55], a[132:135], v[104:107], v[52:55]
  v_mfma_f32_16x16x32_bf16 v[68:71], a[136:139], v[104:107], v[68:71]
  ds_read_b128 v[124:127], v1 offset:27648
  v_mfma_f32_16x16x32_bf16 v[84:87], a[140:143], v[104:107], v[84:87]
  s_waitcnt vmcnt(11) lgkmcnt(4)
  v_mfma_f32_16x16x32_bf16 v[16:19], a[144:147], v[108:111], v[16:19]
  ds_read_b128 v[88:91], v2 offset:10240
  s_waitcnt vmcnt(10)
  v_mfma_f32_16x16x32_bf16 v[36:39], a[148:151], v[108:111], v[36:39]
  s_waitcnt lgkmcnt(4)
  v_mfma_f32_16x16x32_bf16 v[20:23], a[144:147], v[112:115], v[20:23]
  buffer_load_dwordx4 a[192:195], v8, s[12:15], s39 offen
  v_mfma_f32_16x16x32_bf16 v[40:43], a[148:151], v[112:115], v[40:43]
  s_waitcnt vmcnt(10)
  v_mfma_f32_16x16x32_bf16 v[56:59], a[152:155], v[112:115], v[56:59]
  ds_read_b128 v[92:95], v2 offset:28672
  s_waitcnt vmcnt(9)
  v_mfma_f32_16x16x32_bf16 v[72:75], a[156:159], v[112:115], v[72:75]
  s_waitcnt lgkmcnt(4)
  v_mfma_f32_16x16x32_bf16 v[24:27], a[144:147], v[116:119], v[24:27]
  buffer_load_dwordx4 a[196:199], v9, s[12:15], s39 offen
  v_mfma_f32_16x16x32_bf16 v[44:47], a[148:151], v[116:119], v[44:47]
  v_mfma_f32_16x16x32_bf16 v[60:63], a[152:155], v[116:119], v[60:63]
  ds_read_b128 v[96:99], v2 offset:47104
  v_mfma_f32_16x16x32_bf16 v[76:79], a[156:159], v[116:119], v[76:79]
  s_waitcnt lgkmcnt(4)
  v_mfma_f32_16x16x32_bf16 v[28:31], a[144:147], v[120:123], v[28:31]
  buffer_load_dwordx4 a[200:203], v10, s[12:15], s39 offen
  v_mfma_f32_16x16x32_bf16 v[48:51], a[148:151], v[120:123], v[48:51]
  v_mfma_f32_16x16x32_bf16 v[64:67], a[152:155], v[120:123], v[64:67]
  ds_read_b128 v[100:103], v1 offset:10240
  v_mfma_f32_16x16x32_bf16 v[80:83], a[156:159], v[120:123], v[80:83]
  s_waitcnt lgkmcnt(4)
  v_mfma_f32_16x16x32_bf16 v[32:35], a[144:147], v[124:127], v[32:35]
  buffer_load_dwordx4 a[204:207], v11, s[12:15], s39 offen
  s_add_u32 s39, s39, 1024
  v_mfma_f32_16x16x32_bf16 v[52:55], a[148:151], v[124:127], v[52:55]
  v_mfma_f32_16x16x32_bf16 v[68:71], a[152:155], v[124:127], v[68:71]
  ds_read_b128 v[104:107], v1 offset:28672
  v_mfma_f32_16x16x32_bf16 v[84:87], a[156:159], v[124:127], v[84:87]
  s_waitcnt vmcnt(11) lgkmcnt(4)
  v_mfma_f32_16x16x32_bf16 v[16:19], a[160:163], v[88:91], v[16:19]
  ds_read_b128 v[108:111], v2 offset:11264
  s_waitcnt vmcnt(10)
  v_mfma_f32_16x16x32_bf16 v[36:39], a[164:167], v[88:91], v[36:39]
  s_waitcnt lgkmcnt(4)
  v_mfma_f32_16x16x32_bf16 v[20:23], a[160:163], v[92:95], v[20:23]
  buffer_load_dwordx4 a[208:211], v8, s[12:15], s39 offen
  v_mfma_f32_16x16x32_bf16 v[40:43], a[164:167], v[92:95], v[40:43]
  s_waitcnt vmcnt(10)
  v_mfma_f32_16x16x32_bf16 v[56:59], a[168:171], v[92:95], v[56:59]
  ds_read_b128 v[112:115], v2 offset:29696
  s_waitcnt vmcnt(9)
  v_mfma_f32_16x16x32_bf16 v[72:75], a[172:175], v[92:95], v[72:75]
  s_waitcnt lgkmcnt(4)
  v_mfma_f32_16x16x32_bf16 v[24:27], a[160:163], v[96:99], v[24:27]
  buffer_load_dwordx4 a[212:215], v9, s[12:15], s39 offen
  v_mfma_f32_16x16x32_bf16 v[44:47], a[164:167], v[96:99], v[44:47]
  v_mfma_f32_16x16x32_bf16 v[60:63], a[168:171], v[96:99], v[60:63]
  ds_read_b128 v[116:119], v2 offset:48128
  v_mfma_f32_16x16x32_bf16 v[76:79], a[172:175], v[96:99], v[76:79]
  s_waitcnt lgkmcnt(4)
  v_mfma_f32_16x16x32_bf16 v[28:31], a[160:163], v[100:103], v[28:31]
  buffer_load_dwordx4 a[216:219], v10, s[12:15], s39 offen
  v_mfma_f32_16x16x32_bf16 v[48:51], a[164:167], v[100:103], v[48:51]
  v_mfma_f32_16x16x32_bf16 v[64:67], a[168:171], v[100:103], v[64:67]
  ds_read_b128 v[120:123], v1 offset:11264
  v_mfma_f32_16x16x32_bf16 v[80:83], a[172:175], v[100:103], v[80:83]
  s_waitcnt lgkmcnt(4)
  v_mfma_f32_16x16x32_bf16 v[32:35], a[160:163], v[104:107], v[32:35]
  buffer_load_dwordx4 a[220:223], v11, s[12:15], s39 offen
  s_add_u32 s39, s39, 1024
  v_mfma_f32_16x16x32_bf16 v[52:55], a[164:167], v[104:107], v[52:55]
  v_mfma_f32_16x16x32_bf16 v[68:71], a[168:171], v[104:107], v[68:71]
  ds_read_b128 v[124:127], v1 offset:29696
  v_mfma_f32_16x16x32_bf16 v[84:87], a[172:175], v[104:107], v[84:87]
  s_waitcnt vmcnt(11) lgkmcnt(4)
  v_mfma_f32_16x16x32_bf16 v[16:19], a[176:179], v[108:111], v[16:19]
  ds_read_b128 v[88:91], v2 offset:12288
  s_waitcnt vmcnt(10)
  v_mfma_f32_16x16x32_bf16 v[36:39], a[180:183], v[108:111], v[36:39]
  s_waitcnt lgkmcnt(4)
  v_mfma_f32_16x16x32_bf16 v[20:23], a[176:179], v[112:115], v[20:23]
  buffer_load_dwordx4 a[224:227], v8, s[12:15], s39 offen
  v_mfma_f32_16x16x32_bf16 v[40:43], a[180:183], v[112:115], v[40:43]
  s_waitcnt vmcnt(10)
  v_mfma_f32_16x16x32_bf16 v[56:59], a[184:187], v[112:115], v[56:59]
  ds_read_b128 v[92:95], v2 offset:30720
  s_waitcnt vmcnt(9)
  v_mfma_f32_16x16x32_bf16 v[72:75], a[188:191], v[112:115], v[72:75]
  s_waitcnt lgkmcnt(4)
  v_mfma_f32_16x16x32_bf16 v[24:27], a[176:179], v[116:119], v[24:27]
  buffer_load_dwordx4 a[228:231], v9, s[12:15], s39 offen
  v_mfma_f32_16x16x32_bf16 v[44:47], a[180:183], v[116:119], v[44:47]
  v_mfma_f32_16x16x32_bf16 v[60:63], a[184:187], v[116:119], v[60:63]
  ds_read_b128 v[96:99], v2 offset:49152
  v_mfma_f32_16x16x32_bf16 v[76:79], a[188:191], v[116:119], v[76:79]
  s_waitcnt lgkmcnt(4)
  v_mfma_f32_16x16x32_bf16 v[28:31], a[176:179], v[120:123], v[28:31]
  buffer_load_dwordx4 a[232:235], v10, s[12:15], s39 offen
  v_mfma_f32_16x16x32_bf16 v[48:51], a[180:183], v[120:123], v[48:51]
  v_mfma_f32_16x16x32_bf16 v[64:67], a[184:187], v[120:123], v[64:67]
  ds_read_b128 v[100:103], v1 offset:12288
  v_mfma_f32_16x16x32_bf16 v[80:83], a[188:191], v[120:123], v[80:83]
  s_waitcnt lgkmcnt(4)
  v_mfma_f32_16x16x32_bf16 v[32:35], a[176:179], v[124:127], v[32:35]
  buffer_load_dwordx4 a[236:239], v11, s[12:15], s39 offen
  s_add_u32 s39, s39, 1024
  v_mfma_f32_16x16x32_bf16 v[52:55], a[180:183], v[124:127], v[52:55]
  v_mfma_f32_16x16x32_bf16 v[68:71], a[184:187], v[124:127], v[68:71]
  ds_read_b128 v[104:107], v1 offset:30720
  v_mfma_f32_16x16x32_bf16 v[84:87], a[188:191], v[124:127], v[84:87]
  s_waitcnt vmcnt(11) lgkmcnt(4)
  v_mfma_f32_16x16x32_bf16 v[16:19], a[192:195], v[88:91], v[16:19]
  ds_read_b128 v[108:111], v2 offset:13312
  s_waitcnt vmcnt(10)
  v_mfma_f32_16x16x32_bf16 v[36:39], a[196:199], v[88:91], v[36:39]
  s_waitcnt lgkmcnt(4)
  v_mfma_f32_16x16x32_bf16 v[20:23], a[192:195], v[92:95], v[20:23]
  buffer_load_dwordx4 a[240:243], v8, s[12:15], s39 offen
  v_mfma_f32_16x16x32_bf16 v[40:43], a[196:199], v[92:95], v[40:43]
  s_waitcnt vmcnt(10)
  v_mfma_f32_16x16x32_bf16 v[56:59], a[200:203], v[92:95], v[56:59]
  ds_read_b128 v[112:115], v2 offset:31744
  s_waitcnt vmcnt(9)
  v_mfma_f32_16x16x32_bf16 v[72:75], a[204:207], v[92:95], v[72:75]
  s_waitcnt lgkmcnt(4)
  v_mfma_f32_16x16x32_bf16 v[24:27], a[192:195], v[96:99], v[24:27]
  buffer_load_dwordx4 a[244:247], v9, s[12:15], s39 offen
  v_mfma_f32_16x16x32_bf16 v[44:47], a[196:199], v[96:99], v[44:47]
  v_mfma_f32_16x16x32_bf16 v[60:63], a[200:203], v[96:99], v[60:63]
  ds_read_b128 v[116:119], v2 offset:50176
  v_mfma_f32_16x16x32_bf16 v[76:79], a[204:207], v[96:99], v[76:79]
  s_waitcnt lgkmcnt(4)
  v_mfma_f32_16x16x32_bf16 v[28:31], a[192:195], v[100:103], v[28:31]
  buffer_load_dwordx4 a[248:251], v10, s[12:15], s39 offen
  v_mfma_f32_16x16x32_bf16 v[48:51], a[196:199], v[100:103], v[48:51]
  v_mfma_f32_16x16x32_bf16 v[64:67], a[200:203], v[100:103], v[64:67]
  ds_read_b128 v[120:123], v1 offset:13312
  v_mfma_f32_16x16x32_bf16 v[80:83], a[204:207], v[100:103], v[80:83]
  s_waitcnt lgkmcnt(4)
  v_mfma_f32_16x16x32_bf16 v[32:35], a[192:195], v[104:107], v[32:35]
  buffer_load_dwordx4 a[252:255], v11, s[12:15], s39 offen
  s_add_u32 s39, s39, 1024
  v_mfma_f32_16x16x32_bf16 v[52:55], a[196:199], v[104:107], v[52:55]
  v_mfma_f32_16x16x32_bf16 v[68:71], a[200:203], v[104:107], v[68:71]
  ds_read_b128 v[124:127], v1 offset:31744
  v_mfma_f32_16x16x32_bf16 v[84:87], a[204:207], v[104:107], v[84:87]
  s_waitcnt vmcnt(11) lgkmcnt(4)
  v_mfma_f32_16x16x32_bf16 v[16:19], a[208:211], v[108:111], v[16:19]
  ds_read_b128 v[88:91], v2 offset:14336
  s_waitcnt vmcnt(10)
  v_mfma_f32_16x16x32_bf16 v[36:39], a[212:215], v[108:111], v[36:39]
  s_waitcnt lgkmcnt(4)
  v_mfma_f32_16x16x32_bf16 v[20:23], a[208:211], v[112:115], v[20:23]
  buffer_load_dwordx4 v[224:227], v8, s[12:15], s39 offen
  v_mfma_f32_16x16x32_bf16 v[40:43], a[212:215], v[112:115], v[40:43]
  s_waitcnt vmcnt(10)
  v_mfma_f32_16x16x32_bf16 v[56:59], a[216:219], v[112:115], v[56:59]
  ds_read_b128 v[92:95], v2 offset:32768
  s_waitcnt vmcnt(9)
  v_mfma_f32_16x16x32_bf16 v[72:75], a[220:223], v[112:115], v[72:75]
  s_waitcnt lgkmcnt(4)
  v_mfma_f32_16x16x32_bf16 v[24:27], a[208:211], v[116:119], v[24:27]
  buffer_load_dwordx4 v[228:231], v9, s[12:15], s39 offen
  v_mfma_f32_16x16x32_bf16 v[44:47], a[212:215], v[116:119], v[44:47]
  v_mfma_f32_16x16x32_bf16 v[60:63], a[216:219], v[116:119], v[60:63]
  ds_read_b128 v[96:99], v2 offset:51200
  v_mfma_f32_16x16x32_bf16 v[76:79], a[220:223], v[116:119], v[76:79]
  s_waitcnt lgkmcnt(4)
  v_mfma_f32_16x16x32_bf16 v[28:31], a[208:211], v[120:123], v[28:31]
  buffer_load_dwordx4 v[232:235], v10, s[12:15], s39 offen
  v_mfma_f32_16x16x32_bf16 v[48:51], a[212:215], v[120:123], v[48:51]
  v_mfma_f32_16x16x32_bf16 v[64:67], a[216:219], v[120:123], v[64:67]
  ds_read_b128 v[100:103], v1 offset:14336
  v_mfma_f32_16x16x32_bf16 v[80:83], a[220:223], v[120:123], v[80:83]
  s_waitcnt lgkmcnt(4)
  v_mfma_f32_16x16x32_bf16 v[32:35], a[208:211], v[124:127], v[32:35]
  buffer_load_dwordx4 v[236:239], v11, s[12:15], s39 offen
  s_add_u32 s39, s39, 1024
  v_mfma_f32_16x16x32_bf16 v[52:55], a[212:215], v[124:127], v[52:55]
  v_mfma_f32_16x16x32_bf16 v[68:71], a[216:219], v[124:127], v[68:71]
  ds_read_b128 v[104:107], v1 offset:32768
  v_mfma_f32_16x16x32_bf16 v[84:87], a[220:223], v[124:127], v[84:87]
  s_waitcnt vmcnt(11) lgkmcnt(4)
  v_mfma_f32_16x16x32_bf16 v[16:19], a[224:227], v[88:91], v[16:19]
  ds_read_b128 v[108:111], v2 offset:15360
  s_waitcnt vmcnt(10)
  v_mfma_f32_16x16x32_bf16 v[36:39], a[228:231], v[88:91], v[36:39]
  s_waitcnt lgkmcnt(4)
  v_mfma_f32_16x16x32_bf16 v[20:23], a[224:227], v[92:95], v[20:23]
  buffer_load_dwordx4 v[240:243], v8, s[12:15], s39 offen
  v_mfma_f32_16x16x32_bf16 v[40:43], a[228:231], v[92:95], v[40:43]
  s_waitcnt vmcnt(10)
  v_mfma_f32_16x16x32_bf16 v[56:59], a[232:235], v[92:95], v[56:59]
  ds_read_b128 v[112:115], v2 offset:33792
  s_waitcnt vmcnt(9)
  v_mfma_f32_16x16x32_bf16 v[72:75], a[236:239], v[92:95], v[72:75]
  s_waitcnt lgkmcnt(4)
  v_mfma_f32_16x16x32_bf16 v[24:27], a[224:227], v[96:99], v[24:27]
  buffer_load_dwordx4 v[244:247], v9, s[12:15], s39 offen
  v_mfma_f32_16x16x32_bf16 v[44:47], a[228:231], v[96:99], v[44:47]
  v_mfma_f32_16x16x32_bf16 v[60:63], a[232:235], v[96:99], v[60:63]
  ds_read_b128 v[116:119], v2 offset:52224
  v_mfma_f32_16x16x32_bf16 v[76:79], a[236:239], v[96:99], v[76:79]
  s_waitcnt lgkmcnt(4)
  v_mfma_f32_16x16x32_bf16 v[28:31], a[224:227], v[100:103], v[28:31]
  buffer_load_dwordx4 v[248:251], v10, s[12:15], s39 offen
  v_mfma_f32_16x16x32_bf16 v[48:51], a[228:231], v[100:103], v[48:51]
  v_mfma_f32_16x16x32_bf16 v[64:67], a[232:235], v[100:103], v[64:67]
  ds_read_b128 v[120:123], v1 offset:15360
  v_mfma_f32_16x16x32_bf16 v[80:83], a[236:239], v[100:103], v[80:83]
  s_waitcnt lgkmcnt(4)
  v_mfma_f32_16x16x32_bf16 v[32:35], a[224:227], v[104:107], v[32:35]
  buffer_load_dwordx4 v[252:255], v11, s[12:15], s39 offen
  v_mfma_f32_16x16x32_bf16 v[52:55], a[228:231], v[104:107], v[52:55]
  v_mfma_f32_16x16x32_bf16 v[68:71], a[232:235], v[104:107], v[68:71]
  ds_read_b128 v[124:127], v1 offset:33792
  v_mfma_f32_16x16x32_bf16 v[84:87], a[236:239], v[104:107], v[84:87]
  s_waitcnt vmcnt(11) lgkmcnt(4)
  v_mfma_f32_16x16x32_bf16 v[16:19], a[240:243], v[108:111], v[16:19]
  ds_read_b128 v[88:91], v2 offset:16384
  s_waitcnt vmcnt(10)
  v_mfma_f32_16x16x32_bf16 v[36:39], a[244:247], v[108:111], v[36:39]
  s_waitcnt lgkmcnt(4)
  v_mfma_f32_16x16x32_bf16 v[20:23], a[240:243], v[112:115], v[20:23]
  buffer_load_dwordx2 v[174:175], v161, s[64:67], s47 offen offset:0
  v_mfma_f32_16x16x32_bf16 v[40:43], a[244:247], v[112:115], v[40:43]
  s_waitcnt vmcnt(10)
  v_mfma_f32_16x16x32_bf16 v[56:59], a[248:251], v[112:115], v[56:59]
  ds_read_b128 v[92:95], v2 offset:34816
  s_waitcnt vmcnt(9)
  v_mfma_f32_16x16x32_bf16 v[72:75], a[252:255], v[112:115], v[72:75]
  s_waitcnt lgkmcnt(4)
  v_mfma_f32_16x16x32_bf16 v[24:27], a[240:243], v[116:119], v[24:27]
  buffer_load_dwordx2 v[176:177], v161, s[64:67], s47 offen offset:32
  v_mfma_f32_16x16x32_bf16 v[44:47], a[244:247], v[116:119], v[44:47]
  v_mfma_f32_16x16x32_bf16 v[60:63], a[248:251], v[116:119], v[60:63]
  ds_read_b128 v[96:99], v2 offset:53248
  v_mfma_f32_16x16x32_bf16 v[76:79], a[252:255], v[116:119], v[76:79]
  s_waitcnt lgkmcnt(4)
  v_mfma_f32_16x16x32_bf16 v[28:31], a[240:243], v[120:123], v[28:31]
  buffer_load_dwordx2 v[178:179], v161, s[64:67], s47 offen offset:64
  v_mfma_f32_16x16x32_bf16 v[48:51], a[244:247], v[120:123], v[48:51]
  v_mfma_f32_16x16x32_bf16 v[64:67], a[248:251], v[120:123], v[64:67]
  ds_read_b128 v[100:103], v1 offset:16384
  v_mfma_f32_16x16x32_bf16 v[80:83], a[252:255], v[120:123], v[80:83]
  s_waitcnt lgkmcnt(4)
  v_mfma_f32_16x16x32_bf16 v[32:35], a[240:243], v[124:127], v[32:35]
  buffer_load_dwordx2 v[180:181], v161, s[64:67], s47 offen offset:96
  v_mfma_f32_16x16x32_bf16 v[52:55], a[244:247], v[124:127], v[52:55]
  v_mfma_f32_16x16x32_bf16 v[68:71], a[248:251], v[124:127], v[68:71]
  ds_read_b128 v[104:107], v1 offset:34816
  v_mfma_f32_16x16x32_bf16 v[84:87], a[252:255], v[124:127], v[84:87]
  s_waitcnt vmcnt(11) lgkmcnt(4)
  v_mfma_f32_16x16x32_bf16 v[16:19], v[224:227], v[88:91], v[16:19]
  ds_read_b128 v[108:111], v2 offset:17408
  s_waitcnt vmcnt(10)
  v_mfma_f32_16x16x32_bf16 v[36:39], v[228:231], v[88:91], v[36:39]
  s_waitcnt lgkmcnt(4)
  v_mfma_f32_16x16x32_bf16 v[20:23], v[224:227], v[92:95], v[20:23]
  v_mfma_f32_16x16x32_bf16 v[40:43], v[228:231], v[92:95], v[40:43]
  buffer_load_dwordx2 v[182:183], v161, s[64:67], s47 offen offset:128
  s_waitcnt vmcnt(10)
  v_mfma_f32_16x16x32_bf16 v[56:59], v[232:235], v[92:95], v[56:59]
  s_waitcnt vmcnt(9)
  v_mfma_f32_16x16x32_bf16 v[72:75], v[236:239], v[92:95], v[72:75]
  s_waitcnt lgkmcnt(3)
  v_mfma_f32_16x16x32_bf16 v[24:27], v[224:227], v[96:99], v[24:27]
  ds_read_b128 v[112:115], v2 offset:35840
  v_mfma_f32_16x16x32_bf16 v[44:47], v[228:231], v[96:99], v[44:47]
  v_mfma_f32_16x16x32_bf16 v[60:63], v[232:235], v[96:99], v[60:63]
  v_mfma_f32_16x16x32_bf16 v[76:79], v[236:239], v[96:99], v[76:79]
  ds_read_b128 v[116:119], v2 offset:54272
  s_waitcnt lgkmcnt(4)
  v_mfma_f32_16x16x32_bf16 v[28:31], v[224:227], v[100:103], v[28:31]
  v_mfma_f32_16x16x32_bf16 v[48:51], v[228:231], v[100:103], v[48:51]
  v_mfma_f32_16x16x32_bf16 v[64:67], v[232:235], v[100:103], v[64:67]
  ds_read_b128 v[120:123], v1 offset:17408
  v_mfma_f32_16x16x32_bf16 v[80:83], v[236:239], v[100:103], v[80:83]
  s_waitcnt lgkmcnt(4)
  v_mfma_f32_16x16x32_bf16 v[32:35], v[224:227], v[104:107], v[32:35]
  v_mfma_f32_16x16x32_bf16 v[52:55], v[228:231], v[104:107], v[52:55]
  ds_read_b128 v[124:127], v1 offset:35840
  v_mfma_f32_16x16x32_bf16 v[68:71], v[232:235], v[104:107], v[68:71]
  v_mfma_f32_16x16x32_bf16 v[84:87], v[236:239], v[104:107], v[84:87]
  s_waitcnt vmcnt(8) lgkmcnt(4)
  v_mfma_f32_16x16x32_bf16 v[16:19], v[240:243], v[108:111], v[16:19]
  s_waitcnt vmcnt(7)
  v_mfma_f32_16x16x32_bf16 v[36:39], v[244:247], v[108:111], v[36:39]
  s_waitcnt lgkmcnt(3)
  v_mfma_f32_16x16x32_bf16 v[20:23], v[240:243], v[112:115], v[20:23]
  v_mfma_f32_16x16x32_bf16 v[40:43], v[244:247], v[112:115], v[40:43]
  s_waitcnt vmcnt(6)
  v_mfma_f32_16x16x32_bf16 v[56:59], v[248:251], v[112:115], v[56:59]
  s_waitcnt vmcnt(5)
  v_mfma_f32_16x16x32_bf16 v[72:75], v[252:255], v[112:115], v[72:75]
  s_waitcnt lgkmcnt(2)
  v_mfma_f32_16x16x32_bf16 v[24:27], v[240:243], v[116:119], v[24:27]
  v_mfma_f32_16x16x32_bf16 v[44:47], v[244:247], v[116:119], v[44:47]
  v_mfma_f32_16x16x32_bf16 v[60:63], v[248:251], v[116:119], v[60:63]
  v_mfma_f32_16x16x32_bf16 v[76:79], v[252:255], v[116:119], v[76:79]
  s_waitcnt lgkmcnt(1)
  v_mfma_f32_16x16x32_bf16 v[28:31], v[240:243], v[120:123], v[28:31]
  v_mfma_f32_16x16x32_bf16 v[48:51], v[244:247], v[120:123], v[48:51]
  v_mfma_f32_16x16x32_bf16 v[64:67], v[248:251], v[120:123], v[64:67]
  v_mfma_f32_16x16x32_bf16 v[80:83], v[252:255], v[120:123], v[80:83]
  s_waitcnt lgkmcnt(0)
  v_mfma_f32_16x16x32_bf16 v[32:35], v[240:243], v[124:127], v[32:35]
  v_mfma_f32_16x16x32_bf16 v[52:55], v[244:247], v[124:127], v[52:55]
  v_mfma_f32_16x16x32_bf16 v[68:71], v[248:251], v[124:127], v[68:71]
  v_mfma_f32_16x16x32_bf16 v[84:87], v[252:255], v[124:127], v[84:87]
  s_barrier
  v_cvt_pk_bf16_f32 v16, v16, v17
  v_cvt_pk_bf16_f32 v17, v18, v19
  ds_write_b64 v12, v[16:17] offset:0
  v_cvt_pk_bf16_f32 v20, v20, v21
  v_cvt_pk_bf16_f32 v21, v22, v23
  ds_write_b64 v12, v[20:21] offset:768
  v_cvt_pk_bf16_f32 v24, v24, v25
  v_cvt_pk_bf16_f32 v25, v26, v27
  ds_write_b64 v12, v[24:25] offset:1536
  v_cvt_pk_bf16_f32 v28, v28, v29
  v_cvt_pk_bf16_f32 v29, v30, v31
  ds_write_b64 v12, v[28:29] offset:2304
  v_cvt_pk_bf16_f32 v32, v32, v33
  v_cvt_pk_bf16_f32 v33, v34, v35
  ds_write_b64 v12, v[32:33] offset:3072
  ds_write_b128 v13, v[36:39] offset:0
  ds_write_b128 v13, v[40:43] offset:1280
  ds_write_b128 v13, v[44:47] offset:2560
  ds_write_b128 v13, v[48:51] offset:3840
  ds_write_b128 v13, v[52:55] offset:5120
  v_cvt_pk_bf16_f32 v56, v56, v57
  v_cvt_pk_bf16_f32 v57, v58, v59
  ds_write_b64 v14, v[56:57] offset:768
  v_cvt_pk_bf16_f32 v60, v60, v61
  v_cvt_pk_bf16_f32 v61, v62, v63
  ds_write_b64 v14, v[60:61] offset:1536
  v_cvt_pk_bf16_f32 v64, v64, v65
  v_cvt_pk_bf16_f32 v65, v66, v67
  ds_write_b64 v14, v[64:65] offset:2304
  v_cvt_pk_bf16_f32 v68, v68, v69
  v_cvt_pk_bf16_f32 v69, v70, v71
  ds_write_b64 v14, v[68:69] offset:3072
  v_cvt_pk_bf16_f32 v72, v72, v73
  v_cvt_pk_bf16_f32 v73, v74, v75
  ds_write_b64 v15, v[72:73] offset:768
  v_cvt_pk_bf16_f32 v76, v76, v77
  v_cvt_pk_bf16_f32 v77, v78, v79
  ds_write_b64 v15, v[76:77] offset:1536
  v_cvt_pk_bf16_f32 v80, v80, v81
  v_cvt_pk_bf16_f32 v81, v82, v83
  ds_write_b64 v15, v[80:81] offset:2304
  v_cvt_pk_bf16_f32 v84, v84, v85
  v_cvt_pk_bf16_f32 v85, v86, v87
  ds_write_b64 v15, v[84:85] offset:3072
  s_waitcnt lgkmcnt(0)
L_a_join:
  s_mul_i32 s22, s20, 3840
  s_add_u32 s22, s22, 96
  v_mul_u32_u24 v5, 48, v0
  v_add_u32 v5, s22, v5
  s_mul_i32 s22, s20, 6400
  s_add_u32 s22, s22, 30880
  v_mul_u32_u24 v6, 80, v0
  v_add_u32 v6, s22, v6
  v_mov_b32 v200, 0
  v_mov_b32 v202, 0
  v_mov_b32 v204, 0
  v_mov_b32 v206, 0
  v_mov_b32 v208, 0
  v_mov_b32 v210, 0
  v_mov_b32 v212, 0
  v_mov_b32 v214, 0
  s_barrier
  s_mul_i32 s28, s17, 92160
  s_lshl_b32 s27, s20, 10
  s_add_u32 s28, s28, s27
  s_add_u32 s28, s28, 4702208
  ds_read_b128 v[16:19], v5 offset:672
  ds_read_b128 v[20:23], v5 offset:688
  ds_read_b32 v24, v5 offset:704
  ds_read_b128 v[36:39], v5 offset:16032
  ds_read_b128 v[40:43], v5 offset:16048
  ds_read_b32 v44, v5 offset:16064
  ds_read_b128 v[56:59], v5 offset:15936
  ds_read_b128 v[60:63], v5 offset:15952
  ds_read_b32 v64, v5 offset:15968
  ds_read_b128 v[76:79], v5 offset:15840
  ds_read_b128 v[80:83], v5 offset:15856
  ds_read_b32 v84, v5 offset:15872
  buffer_load_dwordx4 a[64:67], v2, s[12:15], s28 offen
  s_add_u32 s28, s28, 4096
  buffer_load_dwordx4 a[68:71], v2, s[12:15], s28 offen
  s_add_u32 s28, s28, 4096
  buffer_load_dwordx4 a[72:75], v2, s[12:15], s28 offen
  s_add_u32 s28, s28, 4096
  s_waitcnt lgkmcnt(8)
  v_dot2c_f32_bf16 v200, v16, v36
  ds_read_b128 v[96:99], v5 offset:15744
  v_dot2c_f32_bf16 v200, v17, v37
  v_dot2c_f32_bf16 v200, v18, v38
  ds_read_b128 v[100:103], v5 offset:15760
  v_dot2c_f32_bf16 v200, v19, v39
  s_waitcnt lgkmcnt(9)
  v_dot2c_f32_bf16 v200, v20, v40
  ds_read_b32 v104, v5 offset:15776
  v_dot2c_f32_bf16 v200, v21, v41
  v_dot2c_f32_bf16 v200, v22, v42
  buffer_load_dwordx4 a[76:79], v2, s[12:15], s28 offen
  s_add_u32 s28, s28, 4096
  v_dot2c_f32_bf16 v200, v23, v43
  s_waitcnt lgkmcnt(9)
  v_dot2c_f32_bf16 v200, v24, v44
  s_waitcnt lgkmcnt(8)
  v_dot2c_f32_bf16 v202, v16, v56
  ds_read_b128 v[116:119], v5 offset:15648
  v_dot2c_f32_bf16 v202, v17, v57
  v_dot2c_f32_bf16 v202, v18, v58
  ds_read_b128 v[120:123], v5 offset:15664
  v_dot2c_f32_bf16 v202, v19, v59
  s_waitcnt lgkmcnt(9)
  v_dot2c_f32_bf16 v202, v20, v60
  ds_read_b32 v124, v5 offset:15680
  v_dot2c_f32_bf16 v202, v21, v61
  v_dot2c_f32_bf16 v202, v22, v62
  buffer_load_dwordx4 a[80:83], v2, s[12:15], s28 offen
  s_add_u32 s28, s28, 4096
  v_dot2c_f32_bf16 v202, v23, v63
  s_waitcnt lgkmcnt(9)
  v_dot2c_f32_bf16 v202, v24, v64
  s_waitcnt lgkmcnt(8)
  v_dot2c_f32_bf16 v204, v16, v76
  ds_read_b128 v[136:139], v5 offset:15552
  v_dot2c_f32_bf16 v204, v17, v77
  v_dot2c_f32_bf16 v204, v18, v78
  ds_read_b128 v[140:143], v5 offset:15568
  v_dot2c_f32_bf16 v204, v19, v79
  s_waitcnt lgkmcnt(9)
  v_dot2c_f32_bf16 v204, v20, v80
  ds_read_b32 v144, v5 offset:15584
  v_dot2c_f32_bf16 v204, v21, v81
  v_dot2c_f32_bf16 v204, v22, v82
  buffer_load_dwordx4 a[84:87], v2, s[12:15], s28 offen
  s_add_u32 s28, s28, 4096
  v_dot2c_f32_bf16 v204, v23, v83
  s_waitcnt lgkmcnt(9)
  v_dot2c_f32_bf16 v204, v24, v84
  s_waitcnt lgkmcnt(8)
  v_dot2c_f32_bf16 v206, v16, v96
  ds_read_b128 v[36:39], v5 offset:15456
  v_dot2c_f32_bf16 v206, v17, v97
  v_dot2c_f32_bf16 v206, v18, v98
  ds_read_b128 v[40:43], v5 offset:15472
  v_dot2c_f32_bf16 v206, v19, v99
  s_waitcnt lgkmcnt(9)
  v_dot2c_f32_bf16 v206, v20, v100
  ds_read_b32 v44, v5 offset:15488
  v_dot2c_f32_bf16 v206, v21, v101
  v_dot2c_f32_bf16 v206, v22, v102
  buffer_load_dwordx4 a[88:91], v2, s[12:15], s28 offen
  s_add_u32 s28, s28, 4096
  v_dot2c_f32_bf16 v206, v23, v103
  s_waitcnt lgkmcnt(9)
  v_dot2c_f32_bf16 v206, v24, v104
  s_waitcnt lgkmcnt(8)
  v_dot2c_f32_bf16 v208, v16, v116
  ds_read_b128 v[56:59], v5 offset:15360
  v_dot2c_f32_bf16 v208, v17, v117
  v_dot2c_f32_bf16 v208, v18, v118
  ds_read_b128 v[60:63], v5 offset:15376
  v_dot2c_f32_bf16 v208, v19, v119
  s_waitcnt lgkmcnt(9)
  v_dot2c_f32_bf16 v208, v20, v120
  ds_read_b32 v64, v5 offset:15392
  v_dot2c_f32_bf16 v208, v21, v121
  v_dot2c_f32_bf16 v208, v22, v122
  buffer_load_dwordx4 a[92:95], v2, s[12:15], s28 offen
  s_add_u32 s28, s28, 4096
  v_dot2c_f32_bf16 v208, v23, v123
  s_waitcnt lgkmcnt(9)
  v_dot2c_f32_bf16 v208, v24, v124
  s_waitcnt lgkmcnt(8)
  v_dot2c_f32_bf16 v210, v16, v136
  ds_read_b128 v[76:79], v6 offset:1120
  v_dot2c_f32_bf16 v210, v17, v137
  ds_read_b128 v[80:83], v6 offset:1136
  v_dot2c_f32_bf16 v210, v18, v138
  v_dot2c_f32_bf16 v210, v19, v139
  ds_read_b128 v[84:87], v6 offset:1152
  s_waitcnt lgkmcnt(10)
  v_dot2c_f32_bf16 v210, v20, v140
  ds_read_b128 v[88:91], v6 offset:1168
  v_dot2c_f32_bf16 v210, v21, v141
  v_dot2c_f32_bf16 v210, v22, v142
  ds_read_b64 v[92:93], v6 offset:1184
  v_dot2c_f32_bf16 v210, v23, v143
  buffer_load_dwordx4 a[96:99], v2, s[12:15], s28 offen
  s_add_u32 s28, s28, 4096
  s_waitcnt lgkmcnt(11)
  v_dot2c_f32_bf16 v210, v24, v144
  s_waitcnt lgkmcnt(10)
  v_dot2c_f32_bf16 v212, v16, v36
  ds_read_b128 v[96:99], v6 offset:960
  v_dot2c_f32_bf16 v212, v17, v37
  ds_read_b128 v[100:103], v6 offset:976
  v_dot2c_f32_bf16 v212, v18, v38
  v_dot2c_f32_bf16 v212, v19, v39
  ds_read_b128 v[104:107], v6 offset:992
  s_waitcnt lgkmcnt(12)
  v_dot2c_f32_bf16 v212, v20, v40
  ds_read_b128 v[108:111], v6 offset:1008
  v_dot2c_f32_bf16 v212, v21, v41
  v_dot2c_f32_bf16 v212, v22, v42
  ds_read_b64 v[112:113], v6 offset:1024
  v_dot2c_f32_bf16 v212, v23, v43
  buffer_load_dwordx4 a[100:103], v2, s[12:15], s28 offen
  s_add_u32 s28, s28, 4096
  s_waitcnt lgkmcnt(13)
  v_dot2c_f32_bf16 v212, v24, v44
  s_waitcnt lgkmcnt(12)
  v_dot2c_f32_bf16 v214, v16, v56
  ds_read_b128 v[116:119], v6 offset:800
  v_dot2c_f32_bf16 v214, v17, v57
  ds_read_b128 v[120:123], v6 offset:816
  v_dot2c_f32_bf16 v214, v18, v58
  v_dot2c_f32_bf16 v214, v19, v59
  ds_read_b128 v[124:127], v6 offset:832
  s_waitcnt lgkmcnt(14)
  v_dot2c_f32_bf16 v214, v20, v60
  ds_read_b128 v[128:131], v6 offset:848
  v_dot2c_f32_bf16 v214, v21, v61
  v_dot2c_f32_bf16 v214, v22, v62
  ds_read_b64 v[132:133], v6 offset:864
  v_dot2c_f32_bf16 v214, v23, v63
  buffer_load_dwordx4 a[104:107], v2, s[12:15], s28 offen
  s_add_u32 s28, s28, 4096
  s_waitcnt lgkmcnt(14)
  v_dot2c_f32_bf16 v214, v24, v64
  s_nop 1
  s_cmp_lg_u32 s16, 0
  s_cbranch_scc1 L_nomask
  v_mov_b32 v216, 0xcf7ce18f
  v_cmp_le_u32 vcc, 2, v0
  s_nop 1
  v_cndmask_b32 v202, v216, v202, vcc
  v_cmp_le_u32 vcc, 4, v0
  s_nop 1
  v_cndmask_b32 v204, v216, v204, vcc
  v_cmp_le_u32 vcc, 6, v0
  s_nop 1
  v_cndmask_b32 v206, v216, v206, vcc
  v_cmp_le_u32 vcc, 8, v0
  s_nop 1
  v_cndmask_b32 v208, v216, v208, vcc
  v_cmp_le_u32 vcc, 10, v0
  s_nop 1
  v_cndmask_b32 v210, v216, v210, vcc
  v_cmp_le_u32 vcc, 12, v0
  s_nop 1
  v_cndmask_b32 v212, v216, v212, vcc
  v_cmp_le_u32 vcc, 14, v0
  s_nop 1
  v_cndmask_b32 v214, v216, v214, vcc
L_nomask:
  v_max3_f32 v216, v200, v202, v204
  buffer_load_dwordx4 a[108:111], v2, s[12:15], s28 offen
  s_add_u32 s28, s28, 4096
  ds_read_b128 v[136:139], v6 offset:640
  v_max3_f32 v217, v206, v208, v210
  v_max3_f32 v216, v216, v212, v214
  v_max_f32 v216, v216, v217
  ds_read_b128 v[140:143], v6 offset:656
  s_mov_b32 s23, 0x3eae1a93
  v_sub_f32 v200, v200, v216
  v_sub_f32 v202, v202, v216
  ds_read_b128 v[144:147], v6 offset:672
  v_sub_f32 v204, v204, v216
  v_sub_f32 v206, v206, v216
  v_sub_f32 v208, v208, v216
  ds_read_b128 v[148:151], v6 offset:688
  v_sub_f32 v210, v210, v216
  v_sub_f32 v212, v212, v216
  buffer_load_dwordx4 a[112:115], v2, s[12:15], s28 offen
  s_add_u32 s28, s28, 4096
  v_sub_f32 v214, v214, v216
  ds_read_b64 v[152:153], v6 offset:704
  v_mul_f32 v200, s23, v200
  v_mul_f32 v202, s23, v202
  v_mul_f32 v204, s23, v204
  ds_read_b128 v[36:39], v6 offset:480
  v_mul_f32 v206, s23, v206
  v_mul_f32 v208, s23, v208
  v_mul_f32 v210, s23, v210
  ds_read_b128 v[40:43], v6 offset:496
  v_mul_f32 v212, s23, v212
  v_mul_f32 v214, s23, v214
  v_exp_f32 v200, v200
  ds_read_b128 v[44:47], v6 offset:512
  v_exp_f32 v202, v202
  buffer_load_dwordx4 a[116:119], v2, s[12:15], s28 offen
  s_add_u32 s28, s28, 4096
  v_exp_f32 v204, v204
  v_exp_f32 v206, v206
  ds_read_b128 v[48:51], v6 offset:528
  v_exp_f32 v208, v208
  v_exp_f32 v210, v210
  v_exp_f32 v212, v212
  ds_read_b64 v[52:53], v6 offset:544
  v_exp_f32 v214, v214
  v_add_f32 v216, v200, v202
  v_add_f32 v217, v204, v206
  ds_read_b128 v[56:59], v6 offset:320
  v_add_f32 v218, v208, v210
  v_add_f32 v219, v212, v214
  v_add_f32 v216, v216, v217
  ds_read_b128 v[60:63], v6 offset:336
  buffer_load_dwordx4 a[120:123], v2, s[12:15], s28 offen
  s_add_u32 s28, s28, 4096
  v_add_f32 v218, v218, v219
  v_add_f32 v216, v216, v218
  v_rcp_f32 v216, v216
  ds_read_b128 v[64:67], v6 offset:352
  v_mul_f32 v200, v200, v216
  v_mul_f32 v202, v202, v216
  v_mul_f32 v204, v204, v216
  ds_read_b128 v[68:71], v6 offset:368
  v_mul_f32 v206, v206, v216
  v_mul_f32 v208, v208, v216
  v_mul_f32 v210, v210, v216
  ds_read_b64 v[72:73], v6 offset:384
  v_mul_f32 v212, v212, v216
  v_mul_f32 v214, v214, v216
  v_pk_mul_f32 v[16:17], v[76:77], v[200:201] op_sel_hi:[1,0]
  buffer_load_dwordx4 a[124:127], v2, s[12:15], s28 offen
  s_add_u32 s28, s28, 4096
  v_pk_mul_f32 v[18:19], v[78:79], v[200:201] op_sel_hi:[1,0]
  s_waitcnt lgkmcnt(14)
  v_pk_mul_f32 v[20:21], v[80:81], v[200:201] op_sel_hi:[1,0]
  v_pk_mul_f32 v[22:23], v[82:83], v[200:201] op_sel_hi:[1,0]
  v_pk_mul_f32 v[24:25], v[84:85], v[200:201] op_sel_hi:[1,0]
  v_pk_mul_f32 v[26:27], v[86:87], v[200:201] op_sel_hi:[1,0]
  v_pk_mul_f32 v[28:29], v[88:89], v[200:201] op_sel_hi:[1,0]
  v_pk_mul_f32 v[30:31], v[90:91], v[200:201] op_sel_hi:[1,0]
  v_pk_mul_f32 v[32:33], v[92:93], v[200:201] op_sel_hi:[1,0]
  v_pk_fma_f32 v[16:17], v[96:97], v[202:203], v[16:17] op_sel_hi:[1,0,1]
  ds_read_b128 v[76:79], v6 offset:160
  v_pk_fma_f32 v[18:19], v[98:99], v[202:203], v[18:19] op_sel_hi:[1,0,1]
  ds_read_b128 v[80:83], v6 offset:176
  v_pk_fma_f32 v[20:21], v[100:101], v[202:203], v[20:21] op_sel_hi:[1,0,1]
  v_pk_fma_f32 v[22:23], v[102:103], v[202:203], v[22:23] op_sel_hi:[1,0,1]
  ds_read_b128 v[84:87], v6 offset:192
  v_pk_fma_f32 v[24:25], v[104:105], v[202:203], v[24:25] op_sel_hi:[1,0,1]
  ds_read_b128 v[88:91], v6 offset:208
  v_pk_fma_f32 v[26:27], v[106:107], v[202:203], v[26:27] op_sel_hi:[1,0,1]
  v_pk_fma_f32 v[28:29], v[108:109], v[202:203], v[28:29] op_sel_hi:[1,0,1]
  ds_read_b64 v[92:93], v6 offset:224
  v_pk_fma_f32 v[30:31], v[110:111], v[202:203], v[30:31] op_sel_hi:[1,0,1]
  buffer_load_dwordx4 a[128:131], v2, s[12:15], s28 offen
  s_add_u32 s28, s28, 4096
  v_pk_fma_f32 v[32:33], v[112:113], v[202:203], v[32:33] op_sel_hi:[1,0,1]
  v_pk_fma_f32 v[16:17], v[116:117], v[204:205], v[16:17] op_sel_hi:[1,0,1]
  ds_read_b128 v[96:99], v6 offset:0
  v_pk_fma_f32 v[18:19], v[118:119], v[204:205], v[18:19] op_sel_hi:[1,0,1]
  ds_read_b128 v[100:103], v6 offset:16
  v_pk_fma_f32 v[20:21], v[120:121], v[204:205], v[20:21] op_sel_hi:[1,0,1]
  v_pk_fma_f32 v[22:23], v[122:123], v[204:205], v[22:23] op_sel_hi:[1,0,1]
  ds_read_b128 v[104:107], v6 offset:32
  v_pk_fma_f32 v[24:25], v[124:125], v[204:205], v[24:25] op_sel_hi:[1,0,1]
  ds_read_b128 v[108:111], v6 offset:48
  v_pk_fma_f32 v[26:27], v[126:127], v[204:205], v[26:27] op_sel_hi:[1,0,1]
  v_pk_fma_f32 v[28:29], v[128:129], v[204:205], v[28:29] op_sel_hi:[1,0,1]
  ds_read_b64 v[112:113], v6 offset:64
  v_pk_fma_f32 v[30:31], v[130:131], v[204:205], v[30:31] op_sel_hi:[1,0,1]
  buffer_load_dwordx4 a[132:135], v2, s[12:15], s28 offen
  s_add_u32 s28, s28, 4096
  v_pk_fma_f32 v[32:33], v[132:133], v[204:205], v[32:33] op_sel_hi:[1,0,1]
  v_pk_fma_f32 v[16:17], v[136:137], v[206:207], v[16:17] op_sel_hi:[1,0,1]
  buffer_load_dwordx4 a[136:139], v2, s[12:15], s28 offen
  s_add_u32 s28, s28, 4096
  v_pk_fma_f32 v[18:19], v[138:139], v[206:207], v[18:19] op_sel_hi:[1,0,1]
  s_waitcnt lgkmcnt(14)
  v_pk_fma_f32 v[20:21], v[140:141], v[206:207], v[20:21] op_sel_hi:[1,0,1]
  v_pk_fma_f32 v[22:23], v[142:143], v[206:207], v[22:23] op_sel_hi:[1,0,1]
  v_pk_fma_f32 v[24:25], v[144:145], v[206:207], v[24:25] op_sel_hi:[1,0,1]
  v_pk_fma_f32 v[26:27], v[146:147], v[206:207], v[26:27] op_sel_hi:[1,0,1]
  v_pk_fma_f32 v[28:29], v[148:149], v[206:207], v[28:29] op_sel_hi:[1,0,1]
  v_pk_fma_f32 v[30:31], v[150:151], v[206:207], v[30:31] op_sel_hi:[1,0,1]
  v_pk_fma_f32 v[32:33], v[152:153], v[206:207], v[32:33] op_sel_hi:[1,0,1]
  v_pk_fma_f32 v[16:17], v[36:37], v[208:209], v[16:17] op_sel_hi:[1,0,1]
  buffer_load_dwordx4 a[140:143], v2, s[12:15], s28 offen
  s_add_u32 s28, s28, 4096
  v_pk_fma_f32 v[18:19], v[38:39], v[208:209], v[18:19] op_sel_hi:[1,0,1]
  v_pk_fma_f32 v[20:21], v[40:41], v[208:209], v[20:21] op_sel_hi:[1,0,1]
  v_pk_fma_f32 v[22:23], v[42:43], v[208:209], v[22:23] op_sel_hi:[1,0,1]
  v_pk_fma_f32 v[24:25], v[44:45], v[208:209], v[24:25] op_sel_hi:[1,0,1]
  v_pk_fma_f32 v[26:27], v[46:47], v[208:209], v[26:27] op_sel_hi:[1,0,1]
  v_pk_fma_f32 v[28:29], v[48:49], v[208:209], v[28:29] op_sel_hi:[1,0,1]
  v_pk_fma_f32 v[30:31], v[50:51], v[208:209], v[30:31] op_sel_hi:[1,0,1]
  v_pk_fma_f32 v[32:33], v[52:53], v[208:209], v[32:33] op_sel_hi:[1,0,1]
  v_pk_fma_f32 v[16:17], v[56:57], v[210:211], v[16:17] op_sel_hi:[1,0,1]
  buffer_load_dwordx4 a[144:147], v2, s[12:15], s28 offen
  s_add_u32 s28, s28, 4096
  v_pk_fma_f32 v[18:19], v[58:59], v[210:211], v[18:19] op_sel_hi:[1,0,1]
  s_waitcnt lgkmcnt(13)
  v_pk_fma_f32 v[20:21], v[60:61], v[210:211], v[20:21] op_sel_hi:[1,0,1]
  v_pk_fma_f32 v[22:23], v[62:63], v[210:211], v[22:23] op_sel_hi:[1,0,1]
  s_waitcnt lgkmcnt(12)
  v_pk_fma_f32 v[24:25], v[64:65], v[210:211], v[24:25] op_sel_hi:[1,0,1]
  v_pk_fma_f32 v[26:27], v[66:67], v[210:211], v[26:27] op_sel_hi:[1,0,1]
  s_waitcnt lgkmcnt(11)
  v_pk_fma_f32 v[28:29], v[68:69], v[210:211], v[28:29] op_sel_hi:[1,0,1]
  v_pk_fma_f32 v[30:31], v[70:71], v[210:211], v[30:31] op_sel_hi:[1,0,1]
  s_waitcnt lgkmcnt(10)
  v_pk_fma_f32 v[32:33], v[72:73], v[210:211], v[32:33] op_sel_hi:[1,0,1]
  s_waitcnt lgkmcnt(9)
  v_pk_fma_f32 v[16:17], v[76:77], v[212:213], v[16:17] op_sel_hi:[1,0,1]
  buffer_load_dwordx4 a[148:151], v2, s[12:15], s28 offen
  s_add_u32 s28, s28, 4096
  v_pk_fma_f32 v[18:19], v[78:79], v[212:213], v[18:19] op_sel_hi:[1,0,1]
  s_waitcnt lgkmcnt(8)
  v_pk_fma_f32 v[20:21], v[80:81], v[212:213], v[20:21] op_sel_hi:[1,0,1]
  v_pk_fma_f32 v[22:23], v[82:83], v[212:213], v[22:23] op_sel_hi:[1,0,1]
  s_waitcnt lgkmcnt(7)
  v_pk_fma_f32 v[24:25], v[84:85], v[212:213], v[24:25] op_sel_hi:[1,0,1]
  v_pk_fma_f32 v[26:27], v[86:87], v[212:213], v[26:27] op_sel_hi:[1,0,1]
  s_waitcnt lgkmcnt(6)
  v_pk_fma_f32 v[28:29], v[88:89], v[212:213], v[28:29] op_sel_hi:[1,0,1]
  v_pk_fma_f32 v[30:31], v[90:91], v[212:213], v[30:31] op_sel_hi:[1,0,1]
  s_waitcnt lgkmcnt(5)
  v_pk_fma_f32 v[32:33], v[92:93], v[212:213], v[32:33] op_sel_hi:[1,0,1]
  s_waitcnt lgkmcnt(4)
  v_pk_fma_f32 v[16:17], v[96:97], v[214:215], v[16:17] op_sel_hi:[1,0,1]
  buffer_load_dwordx4 a[152:155], v2, s[12:15], s28 offen
  v_pk_fma_f32 v[18:19], v[98:99], v[214:215], v[18:19] op_sel_hi:[1,0,1]
  s_waitcnt lgkmcnt(3)
  v_pk_fma_f32 v[20:21], v[100:101], v[214:215], v[20:21] op_sel_hi:[1,0,1]
  v_pk_fma_f32 v[22:23], v[102:103], v[214:215], v[22:23] op_sel_hi:[1,0,1]
  s_waitcnt lgkmcnt(2)
  v_pk_fma_f32 v[24:25], v[104:105], v[214:215], v[24:25] op_sel_hi:[1,0,1]
  v_pk_fma_f32 v[26:27], v[106:107], v[214:215], v[26:27] op_sel_hi:[1,0,1]
  s_waitcnt lgkmcnt(1)
  v_pk_fma_f32 v[28:29], v[108:109], v[214:215], v[28:29] op_sel_hi:[1,0,1]
  v_pk_fma_f32 v[30:31], v[110:111], v[214:215], v[30:31] op_sel_hi:[1,0,1]
  s_waitcnt lgkmcnt(0)
  v_pk_fma_f32 v[32:33], v[112:113], v[214:215], v[32:33] op_sel_hi:[1,0,1]
  s_mul_i32 s22, s20, 36
  s_add_u32 s22, s22, 98304
  v_mul_u32_u24 v5, 144, v0
  v_add_u32 v5, s22, v5
  v_cvt_pk_bf16_f32 v36, v16, v17
  v_cvt_pk_bf16_f32 v37, v18, v19
  ds_write2_b32 v5, v36, v37 offset0:0 offset1:1
  v_cvt_pk_bf16_f32 v38, v20, v21
  v_cvt_pk_bf16_f32 v39, v22, v23
  ds_write2_b32 v5, v38, v39 offset0:2 offset1:3
  v_cvt_pk_bf16_f32 v40, v24, v25
  v_cvt_pk_bf16_f32 v41, v26, v27
  ds_write2_b32 v5, v40, v41 offset0:4 offset1:5
  v_cvt_pk_bf16_f32 v42, v28, v29
  v_cvt_pk_bf16_f32 v43, v30, v31
  ds_write2_b32 v5, v42, v43 offset0:6 offset1:7
  v_cvt_pk_bf16_f32 v44, v32, v33
  ds_write_b32 v5, v44 offset:32
  s_mul_i32 s22, s20, 2304
  s_add_u32 s22, s22, 98304
  v_mul_u32_u24 v5, 144, v3
  v_lshl_add_u32 v5, v4, 4, v5
  v_add_u32 v5, s22, v5
  s_mul_i32 s22, s17, 2304
  s_add_u32 s22, s22, s29
  s_add_u32 s23, s22, 5439488
  s_waitcnt lgkmcnt(0)
  s_barrier
  ds_read_b128 v[16:19], v5 offset:0
  ds_read_b128 v[20:23], v5 offset:64
  ds_read_b128 v[24:27], v5 offset:128
  s_waitcnt lgkmcnt(2)
  buffer_store_dwordx4 v[16:19], v2, s[12:15], s23 offen offset:0 sc0 sc1
  s_waitcnt lgkmcnt(1)
  buffer_store_dwordx4 v[20:23], v2, s[12:15], s23 offen offset:1024 sc0 sc1
  s_mov_b64 exec, 0xffff
  s_waitcnt lgkmcnt(0)
  buffer_store_dwordx4 v[24:27], v2, s[12:15], s23 offen offset:2048 sc0 sc1
  s_mov_b64 exec, -1
  s_lshl_b32 s24, s16, 2
  s_add_u32 s24, s24, s20
  s_lshl_b32 s24, s24, 7
  s_add_u32 s24, s24, 98304
  s_lshl_b32 s30, s17, 2
  s_add_u32 s30, s30, s24
  s_lshl_b32 s31, s16, 1
  s_add_u32 s31, s31, s20
  s_lshl_b32 s31, s31, 2
  s_lshl_b32 s32, s17, 8
  s_add_u32 s31, s31, s32
  s_add_u32 s31, s31, 122872
  s_cmp_lt_u32 s20, 2
  s_cselect_b32 s31, 0x40000000, s31
  s_lshl_b32 s25, s19, 8
  s_add_u32 s25, s25, 122880
  s_add_u32 s23, s29, 5439488
  v_add_u32 v7, s27, v2
  v_add_u32 v32, 0xc000, v7
  v_mov_b32 v5, 1
  v_mov_b32 v6, 0
  s_waitcnt vmcnt(25)
  ds_write_b128 v7, a[64:67] offset:0
  s_waitcnt vmcnt(24)
  ds_write_b128 v7, a[68:71] offset:4096
  s_waitcnt vmcnt(23)
  ds_write_b128 v7, a[72:75] offset:8192
  s_waitcnt vmcnt(22)
  ds_write_b128 v7, a[76:79] offset:12288
  s_waitcnt vmcnt(21)
  ds_write_b128 v7, a[80:83] offset:16384
  s_waitcnt vmcnt(20)
  ds_write_b128 v7, a[84:87] offset:20480
  s_waitcnt vmcnt(19)
  ds_write_b128 v7, a[88:91] offset:24576
  s_waitcnt vmcnt(18)
  ds_write_b128 v7, a[92:95] offset:28672
  s_waitcnt vmcnt(17)
  ds_write_b128 v7, a[96:99] offset:32768
  s_waitcnt vmcnt(16)
  ds_write_b128 v7, a[100:103] offset:36864
  s_waitcnt vmcnt(15)
  ds_write_b128 v7, a[104:107] offset:40960
  s_waitcnt vmcnt(14)
  ds_write_b128 v7, a[108:111] offset:45056
  s_waitcnt vmcnt(13)
  ds_write_b128 v32, a[112:115] offset:0
  s_waitcnt vmcnt(12)
  ds_write_b128 v32, a[116:119] offset:4096
  s_waitcnt vmcnt(11)
  ds_write_b128 v32, a[120:123] offset:8192
  s_waitcnt vmcnt(10)
  ds_write_b128 v32, a[124:127] offset:12288
  s_waitcnt vmcnt(0)
  s_mov_b64 exec, 1
  buffer_store_dword v5, v6, s[12:15], s30 offen sc0 sc1
  s_mov_b64 exec, -1
  ds_write_b128 v32, a[128:131] offset:16384
  ds_write_b128 v32, a[132:135] offset:20480
  ds_write_b128 v32, a[136:139] offset:24576
  ds_write_b128 v32, a[140:143] offset:28672
  ds_write_b128 v32, a[144:147] offset:32768
  ds_write_b128 v32, a[148:151] offset:36864
  ds_write_b128 v32, a[152:155] offset:40960
  s_mov_b32 s53, s31
  s_cmp_lt_u32 s20, 2
  s_cbranch_scc1 L_nojob
  ds_read_b64_tr_b16 a[0:1], v220 offset:0
  ds_read_b64_tr_b16 a[2:3], v220 offset:512
  ds_read_b64_tr_b16 a[4:5], v220 offset:4096
  ds_read_b64_tr_b16 a[6:7], v220 offset:4608
  ds_read_b64_tr_b16 a[8:9], v220 offset:8192
  ds_read_b64_tr_b16 a[10:11], v220 offset:8704
  v_xor_b32 v221, 32, v220
  ds_read_b64_tr_b16 a[12:13], v221 offset:0
  ds_read_b64_tr_b16 a[14:15], v221 offset:512
  ds_read_b64_tr_b16 a[16:17], v221 offset:4096
  ds_read_b64_tr_b16 a[18:19], v221 offset:4608
  ds_read_b64_tr_b16 a[20:21], v221 offset:8192
  ds_read_b64_tr_b16 a[22:23], v221 offset:8704
  v_xor_b32 v221, 64, v220
  ds_read_b64_tr_b16 a[24:25], v221 offset:0
  ds_read_b64_tr_b16 a[26:27], v221 offset:512
  ds_read_b64_tr_b16 a[28:29], v221 offset:4096
  ds_read_b64_tr_b16 a[30:31], v221 offset:4608
  ds_read_b64_tr_b16 a[32:33], v221 offset:8192
  ds_read_b64_tr_b16 a[34:35], v221 offset:8704
  v_xor_b32 v221, 96, v220
  ds_read_b64_tr_b16 a[36:37], v221 offset:0
  ds_read_b64_tr_b16 a[38:39], v221 offset:512
  ds_read_b64_tr_b16 a[40:41], v221 offset:4096
  ds_read_b64_tr_b16 a[42:43], v221 offset:4608
  ds_read_b64_tr_b16 a[44:45], v221 offset:8192
  ds_read_b64_tr_b16 a[46:47], v221 offset:8704
  s_waitcnt lgkmcnt(14)
  v_mfma_f32_16x16x32_bf16 a[48:51], a[0:3], v[184:187], 0
  v_mfma_f32_16x16x32_bf16 a[48:51], a[4:7], v[188:191], a[48:51]
  v_mfma_f32_16x16x32_bf16 a[48:51], a[8:11], v[192:195], a[48:51]
  v_mfma_f32_16x16x32_bf16 a[52:55], a[12:15], v[184:187], 0
  v_mfma_f32_16x16x32_bf16 a[52:55], a[16:19], v[188:191], a[52:55]
  s_waitcnt lgkmcnt(12)
  v_mfma_f32_16x16x32_bf16 a[52:55], a[20:23], v[192:195], a[52:55]
  s_waitcnt lgkmcnt(10)
  v_mfma_f32_16x16x32_bf16 a[56:59], a[24:27], v[184:187], 0
  s_waitcnt lgkmcnt(8)
  v_mfma_f32_16x16x32_bf16 a[56:59], a[28:31], v[188:191], a[56:59]
  s_waitcnt lgkmcnt(6)
  v_mfma_f32_16x16x32_bf16 a[56:59], a[32:35], v[192:195], a[56:59]
  s_waitcnt lgkmcnt(4)
  v_mfma_f32_16x16x32_bf16 a[60:63], a[36:39], v[184:187], 0
  s_waitcnt lgkmcnt(2)
  v_mfma_f32_16x16x32_bf16 a[60:63], a[40:43], v[188:191], a[60:63]
  s_waitcnt lgkmcnt(0)
  v_mfma_f32_16x16x32_bf16 a[60:63], a[44:47], v[192:195], a[60:63]
  s_mov_b64 exec, s[42:43]
  buffer_store_dwordx4 a[48:51], v173, s[12:15], s45 offen offset:0 sc0 sc1
  s_mov_b64 exec, -1
  s_mov_b64 exec, s[42:43]
  buffer_store_dwordx4 a[52:55], v173, s[12:15], s45 offen offset:64 sc0 sc1
  s_mov_b64 exec, -1
  s_mov_b64 exec, s[42:43]
  buffer_store_dwordx4 a[56:59], v173, s[12:15], s45 offen offset:128 sc0 sc1
  s_mov_b64 exec, -1
  s_mov_b64 exec, s[42:43]
  buffer_store_dwordx4 a[60:63], v173, s[12:15], s45 offen offset:192 sc0 sc1
  s_mov_b64 exec, -1
L_nojob:
  v_and_b32 v39, 7, v0
  v_lshlrev_b32 v39, 2, v39
  s_mul_i32 s28, s18, 52
  s_lshr_b32 s28, s28, 8
  s_mul_i32 s28, s28, 5
  s_sub_u32 s28, s18, s28
  s_and_b32 s29, s18, 3
  s_lshl_b32 s27, s20, 10
  v_lshrrev_b32 v5, 3, v0
  v_and_b32 v6, 1, v4
  s_and_b32 s21, s20, 1
  s_lshl_b32 s21, s21, 1
  v_or_b32 v6, s21, v6
  v_lshlrev_b32 v6, 1, v6
  v_and_b32 v7, 7, v0
  v_xor_b32 v6, v6, v7
  v_lshlrev_b32 v32, 4, v6
  s_lshl_b32 s21, s20, 3
  v_add_u32 v6, s21, v5
  v_mul_u32_u24 v6, 9216, v6
  s_mul_i32 s21, s19, 1152
  v_add3_u32 v20, v6, v32, s21
  v_add_u32 v21, 294912, v20
  v_lshrrev_b32 v6, 2, v5
  v_and_b32 v5, 3, v5
  v_lshl_add_u32 v5, v6, 4, v5
  s_lshl_b32 s21, s20, 2
  v_add_u32 v5, s21, v5
  v_mul_u32_u24 v5, 1152, v5
  s_mul_i32 s21, s19, 663552
  v_add3_u32 v22, v5, v32, s21
  v_add_u32 v23, 36864, v22
  v_bfe_u32 v5, v0, 3, 2
  v_lshlrev_b32 v5, 5, v5
  v_and_b32 v6, 3, v0
  v_lshl_add_u32 v5, v6, 3, v5
  v_bfe_u32 v6, v0, 2, 2
  v_lshl_add_u32 v5, v6, 7, v5
  v_lshl_add_u32 v8, v4, 10, v5
  v_xor_b32 v9, 32, v8
  v_xor_b32 v10, 64, v8
  v_xor_b32 v11, 96, v8
  v_add_u32 v12, 0x10000, v8
  v_add_u32 v13, 0x10000, v9
  v_add_u32 v14, 0x10000, v10
  v_add_u32 v15, 0x10000, v11
  v_add_u32 v16, 0x10000, v12
  v_add_u32 v17, 0x10000, v13
  v_add_u32 v18, 0x10000, v14
  v_add_u32 v19, 0x10000, v15
  v_and_b32 v5, 1, v4
  v_lshrrev_b32 v6, 3, v3
  v_lshl_add_u32 v5, v5, 1, v6
  v_mul_u32_u24 v1, 73728, v5
  v_lshrrev_b32 v5, 1, v4
  v_lshl_add_u32 v1, v5, 7, v1
  v_and_b32 v5, 7, v3
  v_lshl_add_u32 v1, v5, 4, v1
  s_getpc_b64 s[40:41]
L_pc2:
  s_lshr_b32 s42, s2, 3
  s_lshl_b32 s42, s42, 2
  s_add_u32 s42, s42, s20
  s_mul_i32 s42, s42, 768
  v_mul_u32_u24 v32, 12, v0
  v_add_u32 v32, s42, v32
  v_min_u32 v32, L_kf_last-L_pc2-4, v32
  v_mov_b32 v33, s41
  v_add_co_u32 v32, vcc, s40, v32
  s_nop 1
  v_addc_co_u32 v33, vcc, 0, v33, vcc
  global_load_dword v34, v[32:33], off
  v_min_u32 v36, 53, v0
  v_lshlrev_b32 v36, 2, v36
  buffer_load_dword v37, v39, s[12:15], s24 offen sc0 sc1
  s_cmp_eq_u32 s3, 1
  s_cbranch_scc1 L_tb1
  s_add_u32 s34, s28, 0
  s_sub_u32 s21, s34, 5
  s_cmp_ge_u32 s34, 5
  s_cselect_b32 s34, s21, s34
  s_add_u32 s35, s28, 1
  s_sub_u32 s21, s35, 5
  s_cmp_ge_u32 s35, 5
  s_cselect_b32 s35, s21, s35
  s_add_u32 s36, s28, 2
  s_sub_u32 s21, s36, 5
  s_cmp_ge_u32 s36, 5
  s_cselect_b32 s36, s21, s36
  s_add_u32 s37, s28, 3
  s_sub_u32 s21, s37, 5
  s_cmp_ge_u32 s37, 5
  s_cselect_b32 s37, s21, s37
  s_add_u32 s38, s28, 4
  s_sub_u32 s21, s38, 5
  s_cmp_ge_u32 s38, 5
  s_cselect_b32 s38, s21, s38
  s_add_u32 s61, s29, 5
  s_sub_u32 s21, s61, 4
  s_cmp_ge_u32 s61, 9
  s_cselect_b32 s61, s21, s61
  s_mul_i32 s61, s61, 73728
  s_add_u32 s62, s29, 6
  s_sub_u32 s21, s62, 4
  s_cmp_ge_u32 s62, 9
  s_cselect_b32 s62, s21, s62
  s_mul_i32 s62, s62, 73728
  s_add_u32 s63, s29, 7
  s_sub_u32 s21, s63, 4
  s_cmp_ge_u32 s63, 9
  s_cselect_b32 s63, s21, s63
  s_mul_i32 s63, s63, 73728
  s_add_u32 s64, s29, 8
  s_sub_u32 s21, s64, 4
  s_cmp_ge_u32 s64, 9
  s_cselect_b32 s64, s21, s64
  s_mul_i32 s64, s64, 73728
  s_add_u32 s65, s29, 0
  s_sub_u32 s21, s65, 4
  s_cmp_ge_u32 s65, 4
  s_cselect_b32 s65, s21, s65
  s_mul_i32 s65, s65, 128
  s_add_u32 s66, s29, 1
  s_sub_u32 s21, s66, 4
  s_cmp_ge_u32 s66, 4
  s_cselect_b32 s66, s21, s66
  s_mul_i32 s66, s66, 128
  s_add_u32 s67, s29, 2
  s_sub_u32 s21, s67, 4
  s_cmp_ge_u32 s67, 4
  s_cselect_b32 s67, s21, s67
  s_mul_i32 s67, s67, 128
  s_add_u32 s39, s29, 3
  s_sub_u32 s21, s39, 4
  s_cmp_ge_u32 s39, 4
  s_cselect_b32 s39, s21, s39
  s_mul_i32 s39, s39, 128
  s_mul_i32 s56, s34, 73728
  s_mul_i32 s57, s35, 73728
  s_mul_i32 s58, s36, 73728
  s_mul_i32 s59, s37, 73728
  s_mul_i32 s60, s38, 73728
  s_branch L_tb2
L_tb1:
  s_add_u32 s34, s29, 5
  s_sub_u32 s21, s34, 4
  s_cmp_ge_u32 s34, 9
  s_cselect_b32 s34, s21, s34
  s_add_u32 s35, s29, 6
  s_sub_u32 s21, s35, 4
  s_cmp_ge_u32 s35, 9
  s_cselect_b32 s35, s21, s35
  s_add_u32 s36, s29, 7
  s_sub_u32 s21, s36, 4
  s_cmp_ge_u32 s36, 9
  s_cselect_b32 s36, s21, s36
  s_add_u32 s37, s29, 8
  s_sub_u32 s21, s37, 4
  s_cmp_ge_u32 s37, 9
  s_cselect_b32 s37, s21, s37
  s_add_u32 s60, s28, 0
  s_sub_u32 s21, s60, 5
  s_cmp_ge_u32 s60, 5
  s_cselect_b32 s60, s21, s60
  s_mul_i32 s60, s60, 73728
  s_add_u32 s61, s28, 1
  s_sub_u32 s21, s61, 5
  s_cmp_ge_u32 s61, 5
  s_cselect_b32 s61, s21, s61
  s_mul_i32 s61, s61, 73728
  s_add_u32 s62, s28, 2
  s_sub_u32 s21, s62, 5
  s_cmp_ge_u32 s62, 5
  s_cselect_b32 s62, s21, s62
  s_mul_i32 s62, s62, 73728
  s_add_u32 s63, s28, 3
  s_sub_u32 s21, s63, 5
  s_cmp_ge_u32 s63, 5
  s_cselect_b32 s63, s21, s63
  s_mul_i32 s63, s63, 73728
  s_add_u32 s64, s28, 4
  s_sub_u32 s21, s64, 5
  s_cmp_ge_u32 s64, 5
  s_cselect_b32 s64, s21, s64
  s_mul_i32 s64, s64, 73728
  s_add_u32 s65, s28, 4
  s_sub_u32 s21, s65, 5
  s_cmp_ge_u32 s65, 9
  s_cselect_b32 s65, s21, s65
  s_mul_i32 s65, s65, 128
  s_add_u32 s66, s28, 5
  s_sub_u32 s21, s66, 5
  s_cmp_ge_u32 s66, 9
  s_cselect_b32 s66, s21, s66
  s_mul_i32 s66, s66, 128
  s_add_u32 s67, s28, 6
  s_sub_u32 s21, s67, 5
  s_cmp_ge_u32 s67, 9
  s_cselect_b32 s67, s21, s67
  s_mul_i32 s67, s67, 128
  s_add_u32 s39, s28, 7
  s_sub_u32 s21, s39, 5
  s_cmp_ge_u32 s39, 9
  s_cselect_b32 s39, s21, s39
  s_mul_i32 s39, s39, 128
  s_add_u32 s100, s28, 8
  s_sub_u32 s21, s100, 5
  s_cmp_ge_u32 s100, 9
  s_cselect_b32 s100, s21, s100
  s_mul_i32 s100, s100, 128
  s_mul_i32 s56, s34, 73728
  s_mul_i32 s57, s35, 73728
  s_mul_i32 s58, s36, 73728
  s_mul_i32 s59, s37, 73728
L_tb2:
  s_waitcnt vmcnt(0)
  v_cmp_ne_u32 s[40:41], 1, v37
  s_nop 0
  s_cmp_eq_u64 s[40:41], 0
  s_cbranch_scc1 L_vk_o
  s_mov_b32 s42, 0
L_vs_o:
  buffer_load_dword v37, v39, s[12:15], s24 offen sc0 sc1
  s_add_u32 s42, s42, 1
  s_waitcnt vmcnt(0)
  v_cmp_ne_u32 s[40:41], 1, v37
  s_cmp_gt_u32 s42, 0x40000
  s_cbranch_scc1 L_vk_o
  s_cmp_lg_u64 s[40:41], 0
  s_cbranch_scc1 L_vs_o
L_vk_o:
  v_mov_b32 v6, 0
  s_mov_b64 exec, 1
  buffer_store_dword v37, v6, s[12:15], s53 offen sc0 sc1
  s_mov_b64 exec, -1
  buffer_load_dwordx4 v[40:43], v2, s[12:15], s23 offen offset:0 sc1
  buffer_load_dwordx4 v[44:47], v2, s[12:15], s23 offen offset:1024 sc1
  buffer_load_dwordx4 v[48:51], v2, s[12:15], s23 offen offset:2048 sc1
  buffer_load_dwordx4 v[52:55], v2, s[12:15], s23 offen offset:3072 sc1
  s_add_u32 s23, s23, 4096
  buffer_load_dwordx4 v[56:59], v2, s[12:15], s23 offen offset:0 sc1
  buffer_load_dwordx4 v[60:63], v2, s[12:15], s23 offen offset:1024 sc1
  buffer_load_dwordx4 v[64:67], v2, s[12:15], s23 offen offset:2048 sc1
  buffer_load_dwordx4 v[68:71], v2, s[12:15], s23 offen offset:3072 sc1
  s_add_u32 s23, s23, 4096
  buffer_load_dwordx4 v[72:75], v2, s[12:15], s23 offen offset:0 sc1
  buffer_load_dwordx4 v[76:79], v2, s[12:15], s23 offen offset:1024 sc1
  buffer_load_dwordx4 v[80:83], v2, s[12:15], s23 offen offset:2048 sc1
  buffer_load_dwordx4 v[84:87], v2, s[12:15], s23 offen offset:3072 sc1
  s_add_u32 s23, s23, 4096
  buffer_load_dwordx4 v[88:91], v2, s[12:15], s23 offen offset:0 sc1
  buffer_load_dwordx4 v[92:95], v2, s[12:15], s23 offen offset:1024 sc1
  v_add_u32 v38, 0xb400, v2
  s_mul_i32 s21, s17, 288
  s_add_u32 s21, s21, 152064
  v_lshl_add_u32 v6, v4, 4, s21
  ds_read_b128 v[208:211], v6 offset:0
  ds_read_b128 v[212:215], v6 offset:4608
  ds_read_b128 v[216:219], v6 offset:64
  ds_read_b128 v[220:223], v6 offset:4672
  ds_read_b128 v[224:227], v6 offset:128
  ds_read_b128 v[228:231], v6 offset:4736
  ds_read_b128 v[232:235], v6 offset:192
  ds_read_b128 v[236:239], v6 offset:4800
  ds_read_b128 v[240:243], v6 offset:256
  ds_read_b128 v[244:247], v6 offset:4864
  v_lshlrev_b32 v184, 16, v174
  v_and_b32 v185, 0xffff0000, v174
  v_lshlrev_b32 v186, 16, v175
  v_and_b32 v187, 0xffff0000, v175
  v_lshlrev_b32 v188, 16, v176
  v_and_b32 v189, 0xffff0000, v176
  v_lshlrev_b32 v190, 16, v177
  v_and_b32 v191, 0xffff0000, v177
  v_lshlrev_b32 v192, 16, v178
  v_and_b32 v193, 0xffff0000, v178
  v_lshlrev_b32 v194, 16, v179
  v_and_b32 v195, 0xffff0000, v179
  v_lshlrev_b32 v196, 16, v180
  v_and_b32 v197, 0xffff0000, v180
  v_lshlrev_b32 v198, 16, v181
  v_and_b32 v199, 0xffff0000, v181
  v_lshlrev_b32 v200, 16, v182
  v_and_b32 v201, 0xffff0000, v182
  v_lshlrev_b32 v202, 16, v183
  v_and_b32 v203, 0xffff0000, v183
  s_mul_i32 s21, s19, 27648
  s_mul_i32 s26, s3, 1280
  s_add_u32 s21, s21, s26
  s_mul_i32 s26, s20, 320
  s_add_u32 s26, s26, s21
  s_add_u32 s26, s26, 52494336
  v_min_u32 v35, 39, v0
  v_lshlrev_b32 v35, 3, v35
  v_and_b32 v5, 1, v4
  v_mul_u32_u24 v5, 164864, v5
  v_lshrrev_b32 v7, 1, v4
  v_add_u32 v5, v5, v7
  v_lshlrev_b32 v5, 8, v5
  v_lshl_add_u32 v5, v3, 4, v5
  s_add_u32 s55, s22, 7798784
  s_mov_b32 s101, 0x3f803f80
  v_mov_b32 v248, 0
  v_mov_b32 v249, 0
  s_lshl_b32 s54, s16, 2
  s_add_u32 s54, s54, s20
  s_lshl_b32 s54, s54, 3
  s_add_u32 s54, s54, s17
  s_lshl_b32 s54, s54, 7
  s_add_u32 s54, s54, 52363264
  v_lshlrev_b32 v39, 3, v0
  s_lshl_b32 s30, s16, 2
  s_add_u32 s30, s30, s20
  s_lshl_b32 s30, s30, 6
  s_and_b32 s31, s20, 1
  s_lshl_b32 s31, s31, 5
  s_sub_u32 s30, s30, s31
  s_lshl_b32 s31, s17, 2
  s_add_u32 s30, s30, s31
  s_add_u32 s30, s30, 114688
  s_waitcnt lgkmcnt(0)
  s_barrier
  ds_read_b128 v[132:135], v2 offset:0
  ds_read_b128 v[136:139], v2 offset:1024
  ds_read_b128 v[140:143], v2 offset:2048
  ds_read_b128 v[144:147], v2 offset:3072
  ds_read_b128 v[148:151], v2 offset:4096
  s_waitcnt vmcnt(13) lgkmcnt(4)
  v_mfma_f32_16x16x32_bf16 v[112:115], v[132:135], v[40:43], 0
  buffer_load_dwordx4 v[96:99], v2, s[12:15], s23 offen offset:2048 sc1
  ds_read_b128 v[152:155], v2 offset:5120
  s_waitcnt lgkmcnt(4)
  v_mfma_f32_16x16x32_bf16 v[116:119], v[136:139], v[40:43], 0
  ds_read_b128 v[156:159], v2 offset:6144
  s_waitcnt lgkmcnt(4)
  v_mfma_f32_16x16x32_bf16 v[120:123], v[140:143], v[40:43], 0
  ds_read_b128 v[160:163], v2 offset:7168
  s_waitcnt lgkmcnt(4)
  v_mfma_f32_16x16x32_bf16 v[124:127], v[144:147], v[40:43], 0
  ds_read_b128 v[164:167], v2 offset:8192
  s_waitcnt lgkmcnt(4)
  v_mfma_f32_16x16x32_bf16 v[128:131], v[148:151], v[40:43], 0
  ds_read_b128 v[168:171], v2 offset:9216
  s_waitcnt vmcnt(13) lgkmcnt(4)
  v_mfma_f32_16x16x32_bf16 v[112:115], v[152:155], v[44:47], v[112:115]
  buffer_load_dwordx4 v[100:103], v2, s[12:15], s23 offen offset:3072 sc1
  s_add_u32 s23, s23, 4096
  ds_read_b128 v[132:135], v2 offset:10240
  s_waitcnt lgkmcnt(4)
  v_mfma_f32_16x16x32_bf16 v[116:119], v[156:159], v[44:47], v[116:119]
  ds_read_b128 v[136:139], v2 offset:11264
  s_waitcnt lgkmcnt(4)
  v_mfma_f32_16x16x32_bf16 v[120:123], v[160:163], v[44:47], v[120:123]
  ds_read_b128 v[140:143], v2 offset:12288
  s_waitcnt lgkmcnt(4)
  v_mfma_f32_16x16x32_bf16 v[124:127], v[164:167], v[44:47], v[124:127]
  ds_read_b128 v[144:147], v2 offset:13312
  s_waitcnt lgkmcnt(4)
  v_mfma_f32_16x16x32_bf16 v[128:131], v[168:171], v[44:47], v[128:131]
  ds_read_b128 v[148:151], v2 offset:14336
  s_waitcnt vmcnt(13) lgkmcnt(4)
  v_mfma_f32_16x16x32_bf16 v[112:115], v[132:135], v[48:51], v[112:115]
  buffer_load_dwordx4 v[104:107], v2, s[12:15], s23 offen offset:0 sc1
  ds_read_b128 v[152:155], v2 offset:15360
  s_waitcnt lgkmcnt(4)
  v_mfma_f32_16x16x32_bf16 v[116:119], v[136:139], v[48:51], v[116:119]
  ds_read_b128 v[156:159], v2 offset:16384
  s_waitcnt lgkmcnt(4)
  v_mfma_f32_16x16x32_bf16 v[120:123], v[140:143], v[48:51], v[120:123]
  ds_read_b128 v[160:163], v2 offset:17408
  s_waitcnt lgkmcnt(4)
  v_mfma_f32_16x16x32_bf16 v[124:127], v[144:147], v[48:51], v[124:127]
  ds_read_b128 v[164:167], v2 offset:18432
  s_waitcnt lgkmcnt(4)
  v_mfma_f32_16x16x32_bf16 v[128:131], v[148:151], v[48:51], v[128:131]
  ds_read_b128 v[168:171], v2 offset:19456
  s_waitcnt vmcnt(13) lgkmcnt(4)
  v_mfma_f32_16x16x32_bf16 v[112:115], v[152:155], v[52:55], v[112:115]
  buffer_load_dwordx4 v[108:111], v2, s[12:15], s23 offen offset:1024 sc1
  ds_read_b128 v[132:135], v2 offset:20480
  s_waitcnt lgkmcnt(4)
  v_mfma_f32_16x16x32_bf16 v[116:119], v[156:159], v[52:55], v[116:119]
  ds_read_b128 v[136:139], v2 offset:21504
  s_waitcnt lgkmcnt(4)
  v_mfma_f32_16x16x32_bf16 v[120:123], v[160:163], v[52:55], v[120:123]
  ds_read_b128 v[140:143], v2 offset:22528
  s_waitcnt lgkmcnt(4)
  v_mfma_f32_16x16x32_bf16 v[124:127], v[164:167], v[52:55], v[124:127]
  ds_read_b128 v[144:147], v2 offset:23552
  s_waitcnt lgkmcnt(4)
  v_mfma_f32_16x16x32_bf16 v[128:131], v[168:171], v[52:55], v[128:131]
  ds_read_b128 v[148:151], v2 offset:24576
  s_waitcnt vmcnt(13) lgkmcnt(4)
  v_mfma_f32_16x16x32_bf16 v[112:115], v[132:135], v[56:59], v[112:115]
  s_add_u32 m0, s27, 98304
  s_lshl_b32 s24, s34, 7
  buffer_load_dwordx4 v20, s[4:7], s24 offen lds
  ds_read_b128 v[152:155], v2 offset:25600
  s_waitcnt lgkmcnt(4)
  v_mfma_f32_16x16x32_bf16 v[116:119], v[136:139], v[56:59], v[116:119]
  ds_read_b128 v[156:159], v2 offset:26624
  s_waitcnt lgkmcnt(4)
  v_mfma_f32_16x16x32_bf16 v[120:123], v[140:143], v[56:59], v[120:123]
  ds_read_b128 v[160:163], v2 offset:27648
  s_waitcnt lgkmcnt(4)
  v_mfma_f32_16x16x32_bf16 v[124:127], v[144:147], v[56:59], v[124:127]
  ds_read_b128 v[164:167], v2 offset:28672
  s_waitcnt lgkmcnt(4)
  v_mfma_f32_16x16x32_bf16 v[128:131], v[148:151], v[56:59], v[128:131]
  ds_read_b128 v[168:171], v2 offset:29696
  s_waitcnt vmcnt(13) lgkmcnt(4)
  v_mfma_f32_16x16x32_bf16 v[112:115], v[152:155], v[60:63], v[112:115]
  s_add_u32 m0, s27, 102400
  s_nop 0
  buffer_load_dwordx4 v21, s[4:7], s24 offen lds
  ds_read_b128 v[132:135], v2 offset:30720
  s_waitcnt lgkmcnt(4)
  v_mfma_f32_16x16x32_bf16 v[116:119], v[156:159], v[60:63], v[116:119]
  ds_read_b128 v[136:139], v2 offset:31744
  s_waitcnt lgkmcnt(4)
  v_mfma_f32_16x16x32_bf16 v[120:123], v[160:163], v[60:63], v[120:123]
  ds_read_b128 v[140:143], v2 offset:32768
  s_waitcnt lgkmcnt(4)
  v_mfma_f32_16x16x32_bf16 v[124:127], v[164:167], v[60:63], v[124:127]
  ds_read_b128 v[144:147], v2 offset:33792
  s_waitcnt lgkmcnt(4)
  v_mfma_f32_16x16x32_bf16 v[128:131], v[168:171], v[60:63], v[128:131]
  ds_read_b128 v[148:151], v2 offset:34816
  s_waitcnt vmcnt(13) lgkmcnt(4)
  v_mfma_f32_16x16x32_bf16 v[112:115], v[132:135], v[64:67], v[112:115]
  s_add_u32 m0, s27, 106496
  s_add_u32 s24, s24, 589824
  buffer_load_dwordx4 v20, s[4:7], s24 offen lds
  ds_read_b128 v[152:155], v2 offset:35840
  s_waitcnt lgkmcnt(4)
  v_mfma_f32_16x16x32_bf16 v[116:119], v[136:139], v[64:67], v[116:119]
  ds_read_b128 v[156:159], v2 offset:36864
  s_waitcnt lgkmcnt(4)
  v_mfma_f32_16x16x32_bf16 v[120:123], v[140:143], v[64:67], v[120:123]
  ds_read_b128 v[160:163], v2 offset:37888
  s_waitcnt lgkmcnt(4)
  v_mfma_f32_16x16x32_bf16 v[124:127], v[144:147], v[64:67], v[124:127]
  ds_read_b128 v[164:167], v2 offset:38912
  s_waitcnt lgkmcnt(4)
  v_mfma_f32_16x16x32_bf16 v[128:131], v[148:151], v[64:67], v[128:131]
  ds_read_b128 v[168:171], v2 offset:39936
  s_waitcnt vmcnt(13) lgkmcnt(4)
  v_mfma_f32_16x16x32_bf16 v[112:115], v[152:155], v[68:71], v[112:115]
  s_add_u32 m0, s27, 110592
  s_nop 0
  buffer_load_dwordx4 v21, s[4:7], s24 offen lds
  ds_read_b128 v[132:135], v2 offset:40960
  s_waitcnt lgkmcnt(4)
  v_mfma_f32_16x16x32_bf16 v[116:119], v[156:159], v[68:71], v[116:119]
  ds_read_b128 v[136:139], v2 offset:41984
  s_waitcnt lgkmcnt(4)
  v_mfma_f32_16x16x32_bf16 v[120:123], v[160:163], v[68:71], v[120:123]
  ds_read_b128 v[140:143], v2 offset:43008
  s_waitcnt lgkmcnt(4)
  v_mfma_f32_16x16x32_bf16 v[124:127], v[164:167], v[68:71], v[124:127]
  ds_read_b128 v[144:147], v2 offset:44032
  s_waitcnt lgkmcnt(4)
  v_mfma_f32_16x16x32_bf16 v[128:131], v[168:171], v[68:71], v[128:131]
  ds_read_b128 v[148:151], v2 offset:45056
  s_waitcnt vmcnt(13) lgkmcnt(4)
  v_mfma_f32_16x16x32_bf16 v[112:115], v[132:135], v[72:75], v[112:115]
  s_add_u32 m0, s27, 114688
  s_add_u32 s24, s24, 589824
  buffer_load_dwordx4 v20, s[4:7], s24 offen lds
  ds_read_b128 v[152:155], v38 offset:0
  s_waitcnt lgkmcnt(4)
  v_mfma_f32_16x16x32_bf16 v[116:119], v[136:139], v[72:75], v[116:119]
  ds_read_b128 v[156:159], v38 offset:1024
  s_waitcnt lgkmcnt(4)
  v_mfma_f32_16x16x32_bf16 v[120:123], v[140:143], v[72:75], v[120:123]
  ds_read_b128 v[160:163], v38 offset:2048
  s_waitcnt lgkmcnt(4)
  v_mfma_f32_16x16x32_bf16 v[124:127], v[144:147], v[72:75], v[124:127]
  ds_read_b128 v[164:167], v38 offset:3072
  s_waitcnt lgkmcnt(4)
  v_mfma_f32_16x16x32_bf16 v[128:131], v[148:151], v[72:75], v[128:131]
  ds_read_b128 v[168:171], v38 offset:4096
  s_waitcnt vmcnt(13) lgkmcnt(4)
  v_mfma_f32_16x16x32_bf16 v[112:115], v[152:155], v[76:79], v[112:115]
  s_add_u32 m0, s27, 118784
  s_nop 0
  buffer_load_dwordx4 v21, s[4:7], s24 offen lds
  ds_read_b128 v[132:135], v38 offset:5120
  s_waitcnt lgkmcnt(4)
  v_mfma_f32_16x16x32_bf16 v[116:119], v[156:159], v[76:79], v[116:119]
  ds_read_b128 v[136:139], v38 offset:6144
  s_waitcnt lgkmcnt(4)
  v_mfma_f32_16x16x32_bf16 v[120:123], v[160:163], v[76:79], v[120:123]
  ds_read_b128 v[140:143], v38 offset:7168
  s_waitcnt lgkmcnt(4)
  v_mfma_f32_16x16x32_bf16 v[124:127], v[164:167], v[76:79], v[124:127]
  ds_read_b128 v[144:147], v38 offset:8192
  s_waitcnt lgkmcnt(4)
  v_mfma_f32_16x16x32_bf16 v[128:131], v[168:171], v[76:79], v[128:131]
  ds_read_b128 v[148:151], v38 offset:9216
  s_waitcnt vmcnt(13) lgkmcnt(4)
  v_mfma_f32_16x16x32_bf16 v[112:115], v[132:135], v[80:83], v[112:115]
  s_add_u32 m0, s27, 122880
  s_add_u32 s24, s24, 589824
  buffer_load_dwordx4 v20, s[4:7], s24 offen lds
  ds_read_b128 v[152:155], v38 offset:10240
  s_waitcnt lgkmcnt(4)
  v_mfma_f32_16x16x32_bf16 v[116:119], v[136:139], v[80:83], v[116:119]
  ds_read_b128 v[156:159], v38 offset:11264
  s_waitcnt lgkmcnt(4)
  v_mfma_f32_16x16x32_bf16 v[120:123], v[140:143], v[80:83], v[120:123]
  ds_read_b128 v[160:163], v38 offset:12288
  s_waitcnt lgkmcnt(4)
  v_mfma_f32_16x16x32_bf16 v[124:127], v[144:147], v[80:83], v[124:127]
  ds_read_b128 v[164:167], v38 offset:13312
  s_waitcnt lgkmcnt(4)
  v_mfma_f32_16x16x32_bf16 v[128:131], v[148:151], v[80:83], v[128:131]
  ds_read_b128 v[168:171], v38 offset:14336
  s_waitcnt vmcnt(13) lgkmcnt(4)
  v_mfma_f32_16x16x32_bf16 v[112:115], v[152:155], v[84:87], v[112:115]
  s_add_u32 m0, s27, 126976
  s_nop 0
  buffer_load_dwordx4 v21, s[4:7], s24 offen lds
  ds_read_b128 v[132:135], v38 offset:15360
  s_waitcnt lgkmcnt(4)
  v_mfma_f32_16x16x32_bf16 v[116:119], v[156:159], v[84:87], v[116:119]
  ds_read_b128 v[136:139], v38 offset:16384
  s_waitcnt lgkmcnt(4)
  v_mfma_f32_16x16x32_bf16 v[120:123], v[160:163], v[84:87], v[120:123]
  ds_read_b128 v[140:143], v38 offset:17408
  s_waitcnt lgkmcnt(4)
  v_mfma_f32_16x16x32_bf16 v[124:127], v[164:167], v[84:87], v[124:127]
  ds_read_b128 v[144:147], v38 offset:18432
  s_waitcnt lgkmcnt(4)
  v_mfma_f32_16x16x32_bf16 v[128:131], v[168:171], v[84:87], v[128:131]
  ds_read_b128 v[148:151], v38 offset:19456
  s_waitcnt vmcnt(13) lgkmcnt(4)
  v_mfma_f32_16x16x32_bf16 v[112:115], v[132:135], v[88:91], v[112:115]
  s_add_u32 m0, s27, 131072
  s_add_u32 s24, s24, 589824
  buffer_load_dwordx4 v20, s[4:7], s24 offen lds
  ds_read_b128 v[152:155], v38 offset:20480
  s_waitcnt lgkmcnt(4)
  v_mfma_f32_16x16x32_bf16 v[116:119], v[136:139], v[88:91], v[116:119]
  ds_read_b128 v[156:159], v38 offset:21504
  s_waitcnt lgkmcnt(4)
  v_mfma_f32_16x16x32_bf16 v[120:123], v[140:143], v[88:91], v[120:123]
  ds_read_b128 v[160:163], v38 offset:22528
  s_waitcnt lgkmcnt(4)
  v_mfma_f32_16x16x32_bf16 v[124:127], v[144:147], v[88:91], v[124:127]
  ds_read_b128 v[164:167], v38 offset:23552
  s_waitcnt lgkmcnt(4)
  v_mfma_f32_16x16x32_bf16 v[128:131], v[148:151], v[88:91], v[128:131]
  ds_read_b128 v[168:171], v38 offset:24576
  s_waitcnt vmcnt(13) lgkmcnt(4)
  v_mfma_f32_16x16x32_bf16 v[112:115], v[152:155], v[92:95], v[112:115]
  s_add_u32 m0, s27, 135168
  s_nop 0
  buffer_load_dwordx4 v21, s[4:7], s24 offen lds
  ds_read_b128 v[132:135], v38 offset:25600
  s_waitcnt lgkmcnt(4)
  v_mfma_f32_16x16x32_bf16 v[116:119], v[156:159], v[92:95], v[116:119]
  ds_read_b128 v[136:139], v38 offset:26624
  s_waitcnt lgkmcnt(4)
  v_mfma_f32_16x16x32_bf16 v[120:123], v[160:163], v[92:95], v[120:123]
  ds_read_b128 v[140:143], v38 offset:27648
  s_waitcnt lgkmcnt(4)
  v_mfma_f32_16x16x32_bf16 v[124:127], v[164:167], v[92:95], v[124:127]
  ds_read_b128 v[144:147], v38 offset:28672
  s_waitcnt lgkmcnt(4)
  v_mfma_f32_16x16x32_bf16 v[128:131], v[168:171], v[92:95], v[128:131]
  ds_read_b128 v[148:151], v38 offset:29696
  s_waitcnt vmcnt(13) lgkmcnt(4)
  v_mfma_f32_16x16x32_bf16 v[112:115], v[132:135], v[96:99], v[112:115]
  s_add_u32 m0, s27, 139264
  s_add_u32 s24, s24, 589824
  buffer_load_dwordx4 v20, s[4:7], s24 offen lds
  ds_read_b128 v[152:155], v38 offset:30720
  s_waitcnt lgkmcnt(4)
  v_mfma_f32_16x16x32_bf16 v[116:119], v[136:139], v[96:99], v[116:119]
  ds_read_b128 v[156:159], v38 offset:31744
  s_waitcnt lgkmcnt(4)
  v_mfma_f32_16x16x32_bf16 v[120:123], v[140:143], v[96:99], v[120:123]
  ds_read_b128 v[160:163], v38 offset:32768
  s_waitcnt lgkmcnt(4)
  v_mfma_f32_16x16x32_bf16 v[124:127], v[144:147], v[96:99], v[124:127]
  ds_read_b128 v[164:167], v38 offset:33792
  s_waitcnt lgkmcnt(4)
  v_mfma_f32_16x16x32_bf16 v[128:131], v[148:151], v[96:99], v[128:131]
  ds_read_b128 v[168:171], v38 offset:34816
  s_waitcnt vmcnt(13) lgkmcnt(4)
  v_mfma_f32_16x16x32_bf16 v[112:115], v[152:155], v[100:103], v[112:115]
  s_add_u32 m0, s27, 143360
  s_nop 0
  buffer_load_dwordx4 v21, s[4:7], s24 offen lds
  ds_read_b128 v[132:135], v38 offset:35840
  s_waitcnt lgkmcnt(4)
  v_mfma_f32_16x16x32_bf16 v[116:119], v[156:159], v[100:103], v[116:119]
  ds_read_b128 v[136:139], v38 offset:36864
  s_waitcnt lgkmcnt(4)
  v_mfma_f32_16x16x32_bf16 v[120:123], v[160:163], v[100:103], v[120:123]
  ds_read_b128 v[140:143], v38 offset:37888
  s_waitcnt lgkmcnt(4)
  v_mfma_f32_16x16x32_bf16 v[124:127], v[164:167], v[100:103], v[124:127]
  ds_read_b128 v[144:147], v38 offset:38912
  s_waitcnt lgkmcnt(4)
  v_mfma_f32_16x16x32_bf16 v[128:131], v[168:171], v[100:103], v[128:131]
  ds_read_b128 v[148:151], v38 offset:39936
  s_waitcnt vmcnt(13) lgkmcnt(4)
  v_mfma_f32_16x16x32_bf16 v[112:115], v[132:135], v[104:107], v[112:115]
  buffer_load_dword v37, v36, s[12:15], s25 offen sc0 sc1
  ds_read_b128 v[152:155], v38 offset:40960
  s_waitcnt lgkmcnt(4)
  v_mfma_f32_16x16x32_bf16 v[116:119], v[136:139], v[104:107], v[116:119]
  ds_read_b128 v[156:159], v38 offset:41984
  s_waitcnt lgkmcnt(4)
  v_mfma_f32_16x16x32_bf16 v[120:123], v[140:143], v[104:107], v[120:123]
  ds_read_b128 v[160:163], v38 offset:43008
  s_waitcnt lgkmcnt(4)
  v_mfma_f32_16x16x32_bf16 v[124:127], v[144:147], v[104:107], v[124:127]
  ds_read_b128 v[164:167], v38 offset:44032
  s_waitcnt lgkmcnt(4)
  v_mfma_f32_16x16x32_bf16 v[128:131], v[148:151], v[104:107], v[128:131]
  ds_read_b128 v[168:171], v38 offset:45056
  s_waitcnt vmcnt(13) lgkmcnt(4)
  v_mfma_f32_16x16x32_bf16 v[112:115], v[152:155], v[108:111], v[112:115]
  s_waitcnt lgkmcnt(3)
  v_mfma_f32_16x16x32_bf16 v[116:119], v[156:159], v[108:111], v[116:119]
  s_waitcnt lgkmcnt(2)
  v_mfma_f32_16x16x32_bf16 v[120:123], v[160:163], v[108:111], v[120:123]
  s_waitcnt lgkmcnt(1)
  v_mfma_f32_16x16x32_bf16 v[124:127], v[164:167], v[108:111], v[124:127]
  s_waitcnt lgkmcnt(0)
  v_mfma_f32_16x16x32_bf16 v[128:131], v[168:171], v[108:111], v[128:131]
  v_pk_fma_f32 v[80:81], v[208:209], v[112:113], v[184:185]
  v_cvt_pk_bf16_f32 v88, v80, v81
  v_pk_mul_f32 v[80:81], v[80:81], v[212:213]
  v_cvt_pk_bf16_f32 v90, v80, v81
  v_pk_fma_f32 v[80:81], v[210:211], v[114:115], v[186:187]
  v_cvt_pk_bf16_f32 v89, v80, v81
  v_pk_mul_f32 v[80:81], v[80:81], v[214:215]
  v_cvt_pk_bf16_f32 v91, v80, v81
  v_dot2c_f32_bf16 v248, s101, v88
  v_dot2c_f32_bf16 v249, v88, v88
  v_dot2c_f32_bf16 v248, s101, v89
  v_dot2c_f32_bf16 v249, v89, v89
  v_permlane16_swap_b32 v88, v90
  v_permlane16_swap_b32 v89, v91
  buffer_store_dwordx4 v[88:91], v5, s[12:15], s55 offen offset:0 sc0 sc1
  v_pk_fma_f32 v[80:81], v[216:217], v[116:117], v[188:189]
  v_cvt_pk_bf16_f32 v92, v80, v81
  v_pk_mul_f32 v[80:81], v[80:81], v[220:221]
  v_cvt_pk_bf16_f32 v94, v80, v81
  v_pk_fma_f32 v[80:81], v[218:219], v[118:119], v[190:191]
  v_cvt_pk_bf16_f32 v93, v80, v81
  v_pk_mul_f32 v[80:81], v[80:81], v[222:223]
  v_cvt_pk_bf16_f32 v95, v80, v81
  v_dot2c_f32_bf16 v248, s101, v92
  v_dot2c_f32_bf16 v249, v92, v92
  v_dot2c_f32_bf16 v248, s101, v93
  v_dot2c_f32_bf16 v249, v93, v93
  v_permlane16_swap_b32 v92, v94
  v_permlane16_swap_b32 v93, v95
  buffer_store_dwordx4 v[92:95], v5, s[12:15], s55 offen offset:512 sc0 sc1
  v_pk_fma_f32 v[80:81], v[224:225], v[120:121], v[192:193]
  v_cvt_pk_bf16_f32 v96, v80, v81
  v_pk_mul_f32 v[80:81], v[80:81], v[228:229]
  v_cvt_pk_bf16_f32 v98, v80, v81
  v_pk_fma_f32 v[80:81], v[226:227], v[122:123], v[194:195]
  v_cvt_pk_bf16_f32 v97, v80, v81
  v_pk_mul_f32 v[80:81], v[80:81], v[230:231]
  v_cvt_pk_bf16_f32 v99, v80, v81
  v_dot2c_f32_bf16 v248, s101, v96
  v_dot2c_f32_bf16 v249, v96, v96
  v_dot2c_f32_bf16 v248, s101, v97
  v_dot2c_f32_bf16 v249, v97, v97
  v_permlane16_swap_b32 v96, v98
  v_permlane16_swap_b32 v97, v99
  buffer_store_dwordx4 v[96:99], v5, s[12:15], s55 offen offset:1024 sc0 sc1
  v_pk_fma_f32 v[80:81], v[232:233], v[124:125], v[196:197]
  v_cvt_pk_bf16_f32 v100, v80, v81
  v_pk_mul_f32 v[80:81], v[80:81], v[236:237]
  v_cvt_pk_bf16_f32 v102, v80, v81
  v_pk_fma_f32 v[80:81], v[234:235], v[126:127], v[198:199]
  v_cvt_pk_bf16_f32 v101, v80, v81
  v_pk_mul_f32 v[80:81], v[80:81], v[238:239]
  v_cvt_pk_bf16_f32 v103, v80, v81
  v_dot2c_f32_bf16 v248, s101, v100
  v_dot2c_f32_bf16 v249, v100, v100
  v_dot2c_f32_bf16 v248, s101, v101
  v_dot2c_f32_bf16 v249, v101, v101
  v_permlane16_swap_b32 v100, v102
  v_permlane16_swap_b32 v101, v103
  buffer_store_dwordx4 v[100:103], v5, s[12:15], s55 offen offset:1536 sc0 sc1
  v_pk_fma_f32 v[80:81], v[240:241], v[128:129], v[200:201]
  v_cvt_pk_bf16_f32 v104, v80, v81
  v_pk_mul_f32 v[80:81], v[80:81], v[244:245]
  v_cvt_pk_bf16_f32 v106, v80, v81
  v_pk_fma_f32 v[80:81], v[242:243], v[130:131], v[202:203]
  v_cvt_pk_bf16_f32 v105, v80, v81
  v_pk_mul_f32 v[80:81], v[80:81], v[246:247]
  v_cvt_pk_bf16_f32 v107, v80, v81
  s_mov_b32 exec_hi, 0
  v_dot2c_f32_bf16 v248, s101, v104
  v_dot2c_f32_bf16 v249, v104, v104
  v_dot2c_f32_bf16 v248, s101, v105
  v_dot2c_f32_bf16 v249, v105, v105
  v_permlane16_swap_b32 v104, v106
  v_permlane16_swap_b32 v105, v107
  buffer_store_dwordx4 v[104:107], v5, s[12:15], s55 offen offset:2048 sc0 sc1
  s_mov_b32 exec_hi, -1
  v_mov_b32 v86, v248
  v_mov_b32 v87, v249
  s_nop 0
  v_permlane16_swap_b32 v248, v86
  v_permlane16_swap_b32 v249, v87
  v_pk_add_f32 v[248:249], v[248:249], v[86:87]
  v_mov_b32 v86, v248
  v_mov_b32 v87, v249
  s_nop 0
  v_permlane32_swap_b32 v248, v86
  v_permlane32_swap_b32 v249, v87
  v_pk_add_f32 v[248:249], v[248:249], v[86:87]
  s_mov_b64 exec, 0xffff
  buffer_store_dwordx2 v[248:249], v39, s[12:15], s54 offen sc0 sc1
  s_mov_b64 exec, -1
  s_waitcnt vmcnt(6)
  v_cmp_ne_u32 s[40:41], 1, v37
  s_nop 0
  s_cmp_eq_u64 s[40:41], 0
  s_cbranch_scc1 L_vk_w
  s_mov_b32 s42, 0
L_vs_w:
  buffer_load_dword v37, v36, s[12:15], s25 offen sc0 sc1
  s_add_u32 s42, s42, 1
  s_waitcnt vmcnt(0)
  v_cmp_ne_u32 s[40:41], 1, v37
  s_cmp_gt_u32 s42, 0x40000
  s_cbranch_scc1 L_vk_w
  s_cmp_lg_u64 s[40:41], 0
  s_cbranch_scc1 L_vs_w
L_vk_w:
  buffer_load_dwordx2 v[56:57], v35, s[12:15], s26 offen offset:0 sc1
  buffer_load_dwordx2 v[58:59], v35, s[12:15], s26 offen offset:2304 sc1
  s_add_u32 s26, s26, 4608
  buffer_load_dwordx2 v[60:61], v35, s[12:15], s26 offen offset:0 sc1
  buffer_load_dwordx2 v[62:63], v35, s[12:15], s26 offen offset:2304 sc1
  s_add_u32 s26, s26, 4608
  buffer_load_dwordx2 v[64:65], v35, s[12:15], s26 offen offset:0 sc1
  buffer_load_dwordx2 v[66:67], v35, s[12:15], s26 offen offset:2304 sc1
  s_add_u32 s26, s26, 4608
  buffer_load_dwordx2 v[68:69], v35, s[12:15], s26 offen offset:0 sc1
  buffer_load_dwordx2 v[70:71], v35, s[12:15], s26 offen offset:2304 sc1
  s_add_u32 s26, s26, 4608
  buffer_load_dwordx2 v[72:73], v35, s[12:15], s26 offen offset:0 sc1
  buffer_load_dwordx2 v[74:75], v35, s[12:15], s26 offen offset:2304 sc1
  s_add_u32 s26, s26, 4608
  buffer_load_dwordx2 v[76:77], v35, s[12:15], s26 offen offset:0 sc1
  buffer_load_dwordx2 v[78:79], v35, s[12:15], s26 offen offset:2304 sc1
  s_add_u32 s26, s26, 4608
  v_mov_b32 v5, 1
  v_mov_b32 v6, 0
  s_lshl_b32 s25, s18, 2
  s_add_u32 s25, s25, s20
  s_mul_i32 s25, s25, 294912
  s_mul_i32 s22, s19, 9216
  s_add_u32 s25, s25, s22
  s_add_u32 s25, s25, 10158080
  s_lshl_b32 s22, s18, 3
  s_add_u32 s22, s22, s19
  s_lshl_b32 s22, s22, 1
  s_add_u32 s23, s22, s3
  s_xor_b32 s22, s23, 1
  s_lshl_b32 s16, s23, 7
  s_lshl_b32 s17, s22, 7
  s_lshl_b32 s21, s20, 2
  s_add_u32 s21, s21, 65536
  s_add_u32 s16, s16, s21
  s_add_u32 s17, s17, s21
  s_waitcnt vmcnt(12)
  s_mov_b64 exec, 1
  buffer_store_dword v5, v6, s[12:15], s30 offen sc0 sc1
  s_mov_b64 exec, -1
  s_waitcnt lgkmcnt(0)
  s_barrier
  s_add_u32 m0, s27, 0
  s_add_u32 s24, s24, 589824
  buffer_load_dwordx4 v20, s[4:7], s24 offen lds
  s_add_u32 m0, s27, 4096
  s_nop 0
  buffer_load_dwordx4 v21, s[4:7], s24 offen lds
  s_add_u32 m0, s27, 8192
  s_add_u32 s24, s24, 589824
  buffer_load_dwordx4 v20, s[4:7], s24 offen lds
  s_add_u32 m0, s27, 12288
  s_nop 0
  buffer_load_dwordx4 v21, s[4:7], s24 offen lds
  s_add_u32 m0, s27, 16384
  s_add_u32 s24, s24, 589824
  buffer_load_dwordx4 v20, s[4:7], s24 offen lds
  s_add_u32 m0, s27, 20480
  s_nop 0
  buffer_load_dwordx4 v21, s[4:7], s24 offen lds
  s_add_u32 m0, s27, 24576
  s_lshl_b32 s52, s35, 7
  buffer_load_dwordx4 v20, s[4:7], s52 offen lds
  s_add_u32 m0, s27, 28672
  s_nop 0
  buffer_load_dwordx4 v21, s[4:7], s52 offen lds
  v_lshlrev_b32 v36, 2, v3
  s_lshl_b32 s101, s18, 2
  s_add_u32 s101, s101, s20
  s_lshl_b32 s101, s101, 7
  s_add_u32 s101, s101, 114688
  s_lshl_b32 s30, s23, 2
  s_add_u32 s30, s30, s20
  s_mul_i32 s30, s30, 20480
  s_add_u32 s30, s30, 29032448
  s_lshl_b32 s31, s22, 2
  s_add_u32 s31, s31, s20
  s_mul_i32 s31, s31, 20480
  s_add_u32 s31, s31, 29032448
  s_waitcnt vmcnt(18)
  v_pk_add_f32 v[56:57], v[56:57], v[60:61]
  s_waitcnt vmcnt(17)
  v_pk_add_f32 v[58:59], v[58:59], v[62:63]
  s_waitcnt vmcnt(16)
  v_pk_add_f32 v[56:57], v[56:57], v[64:65]
  s_waitcnt vmcnt(15)
  v_pk_add_f32 v[58:59], v[58:59], v[66:67]
  s_waitcnt vmcnt(14)
  v_pk_add_f32 v[56:57], v[56:57], v[68:69]
  s_waitcnt vmcnt(13)
  v_pk_add_f32 v[58:59], v[58:59], v[70:71]
  s_waitcnt vmcnt(12)
  v_pk_add_f32 v[56:57], v[56:57], v[72:73]
  s_waitcnt vmcnt(11)
  v_pk_add_f32 v[58:59], v[58:59], v[74:75]
  s_waitcnt vmcnt(10)
  v_pk_add_f32 v[56:57], v[56:57], v[76:77]
  s_waitcnt vmcnt(9)
  v_pk_add_f32 v[58:59], v[58:59], v[78:79]
  s_mul_i32 s21, s20, 1280
  s_add_u32 s21, s21, 147456
  v_lshl_add_u32 v5, v0, 5, s21
  v_cvt_pk_bf16_f32 v49, v56, v58
  v_lshlrev_b32 v44, 16, v49
  v_and_b32 v45, 0xffff0000, v49
  v_sub_f32 v44, v56, v44
  v_sub_f32 v45, v58, v45
  v_cvt_pk_bf16_f32 v48, v56, v44
  v_cvt_pk_bf16_f32 v50, v45, v58
  v_mov_b32 v51, 0
  v_cvt_pk_bf16_f32 v53, v57, v59
  v_lshlrev_b32 v44, 16, v53
  v_and_b32 v45, 0xffff0000, v53
  v_sub_f32 v44, v57, v44
  v_sub_f32 v45, v59, v45
  v_cvt_pk_bf16_f32 v52, v57, v44
  v_cvt_pk_bf16_f32 v54, v45, v59
  v_mov_b32 v55, 0
  s_mov_b32 exec_hi, 0xff
  ds_write_b128 v5, v[48:51]
  ds_write_b128 v5, v[52:55] offset:16
  s_mov_b32 exec_hi, -1
  s_lshl_b32 s33, s18, 2
  s_add_u32 s33, s33, s20
  s_lshl_b32 s33, s33, 8
  s_and_b32 s21, s23, 15
  s_lshl_b32 s21, s21, 2
  s_add_u32 s33, s33, s21
  s_add_u32 s33, s33, 49152
  s_mov_b32 s26, s23
  s_cmp_eq_u32 s3, 1
  s_cbranch_scc1 L_c_h1
  v_lshlrev_b32 v36, 2, v3
  v_lshlrev_b32 v5, 8, v4
  v_lshl_add_u32 v5, v3, 3, v5
  v_add_u32 v7, 18432, v2
  s_lshl_b32 s23, s18, 2
  s_add_u32 s23, s23, s20
  s_lshl_b32 s22, s23, 7
  s_add_u32 s22, s22, 114688
  s_lshl_b32 s32, s23, 11
  s_add_u32 s32, s32, 52363264
  s_mul_i32 s23, s23, 36864
  s_add_u32 s23, s23, 50003968
  s_waitcnt lgkmcnt(0)
  s_barrier
  ds_read_b64_tr_b16 a[144:145], v12 offset:32768
  ds_read_b64_tr_b16 a[146:147], v12 offset:33280
  ds_read_b64_tr_b16 a[148:149], v13 offset:32768
  ds_read_b64_tr_b16 a[150:151], v13 offset:33280
  ds_read_b64_tr_b16 a[152:153], v14 offset:32768
  ds_read_b64_tr_b16 a[154:155], v14 offset:33280
  ds_read_b64_tr_b16 a[156:157], v15 offset:32768
  ds_read_b64_tr_b16 a[158:159], v15 offset:33280
  ds_read_b64_tr_b16 a[160:161], v12 offset:36864
  ds_read_b64_tr_b16 a[162:163], v12 offset:37376
  ds_read_b64_tr_b16 a[164:165], v13 offset:36864
  ds_read_b64_tr_b16 a[166:167], v13 offset:37376
  ds_read_b64_tr_b16 a[168:169], v14 offset:36864
  ds_read_b64_tr_b16 a[170:171], v14 offset:37376
  ds_read_b64_tr_b16 a[172:173], v15 offset:36864
  ds_read_b64_tr_b16 a[174:175], v15 offset:37376
  buffer_load_dword v37, v36, s[12:15], s22 offen sc0 sc1
  s_waitcnt vmcnt(0)
  v_cmp_ne_u32 s[40:41], 1, v37
  s_nop 0
  s_cmp_eq_u64 s[40:41], 0
  s_cbranch_scc1 L_vk_z0
  s_mov_b32 s42, 0
L_vs_z0:
  buffer_load_dword v37, v36, s[12:15], s22 offen sc0 sc1
  s_add_u32 s42, s42, 1
  s_waitcnt vmcnt(0)
  v_cmp_ne_u32 s[40:41], 1, v37
  s_cmp_gt_u32 s42, 0x40000
  s_cbranch_scc1 L_vk_z0
  s_cmp_lg_u64 s[40:41], 0
  s_cbranch_scc1 L_vs_z0
L_vk_z0:
  buffer_load_dwordx4 a[0:3], v2, s[12:15], s23 offen offset:0 sc1
  buffer_load_dwordx4 a[72:75], v7, s[12:15], s23 offen offset:0 sc1
  buffer_load_dwordx4 a[4:7], v2, s[12:15], s23 offen offset:1024 sc1
  buffer_load_dwordx4 a[76:79], v7, s[12:15], s23 offen offset:1024 sc1
  buffer_load_dwordx4 a[8:11], v2, s[12:15], s23 offen offset:2048 sc1
  buffer_load_dwordx4 a[80:83], v7, s[12:15], s23 offen offset:2048 sc1
  buffer_load_dwordx4 a[12:15], v2, s[12:15], s23 offen offset:3072 sc1
  buffer_load_dwordx4 a[84:87], v7, s[12:15], s23 offen offset:3072 sc1
  s_add_u32 s23, s23, 4096
  buffer_load_dwordx4 a[16:19], v2, s[12:15], s23 offen offset:0 sc1
  buffer_load_dwordx4 a[88:91], v7, s[12:15], s23 offen offset:0 sc1
  buffer_load_dwordx4 a[20:23], v2, s[12:15], s23 offen offset:1024 sc1
  buffer_load_dwordx4 a[92:95], v7, s[12:15], s23 offen offset:1024 sc1
  buffer_load_dwordx2 v[32:33], v5, s[12:15], s32 offen offset:0 sc1
  buffer_load_dwordx2 v[34:35], v5, s[12:15], s32 offen offset:128 sc1
  buffer_load_dwordx2 v[36:37], v5, s[12:15], s32 offen offset:1024 sc1
  buffer_load_dwordx2 v[38:39], v5, s[12:15], s32 offen offset:1152 sc1
  s_add_u32 s40, s29, 0
  s_sub_u32 s21, s40, 4
  s_cmp_ge_u32 s40, 4
  s_cselect_b32 s40, s21, s40
  s_add_u32 s41, s29, 1
  s_sub_u32 s21, s41, 4
  s_cmp_ge_u32 s41, 4
  s_cselect_b32 s41, s21, s41
  s_add_u32 s42, s29, 2
  s_sub_u32 s21, s42, 4
  s_cmp_ge_u32 s42, 4
  s_cselect_b32 s42, s21, s42
  s_add_u32 s43, s29, 3
  s_sub_u32 s21, s43, 4
  s_cmp_ge_u32 s43, 4
  s_cselect_b32 s43, s21, s43
  s_add_u32 s50, s28, 4
  s_sub_u32 s21, s50, 5
  s_cmp_ge_u32 s50, 9
  s_cselect_b32 s50, s21, s50
  s_add_u32 s51, s28, 5
  s_sub_u32 s21, s51, 5
  s_cmp_ge_u32 s51, 9
  s_cselect_b32 s51, s21, s51
  s_add_u32 s53, s28, 6
  s_sub_u32 s21, s53, 5
  s_cmp_ge_u32 s53, 9
  s_cselect_b32 s53, s21, s53
  s_add_u32 s54, s28, 7
  s_sub_u32 s21, s54, 5
  s_cmp_ge_u32 s54, 9
  s_cselect_b32 s54, s21, s54
  s_add_u32 s55, s28, 8
  s_sub_u32 s21, s55, 5
  s_cmp_ge_u32 s55, 9
  s_cselect_b32 s55, s21, s55
  s_lshr_b32 s47, s26, 2
  s_lshl_b32 s47, s47, 8
  s_add_u32 s47, s47, 49152
  s_add_u32 s48, s47, 64
  s_add_u32 s49, s47, 128
  s_mul_i32 s46, s26, 9216
  s_mul_i32 s45, s26, 73728
  s_add_u32 s45, s45, 10158080
  s_lshr_b32 s44, s26, 1
  s_mul_i32 s44, s44, 18432
  s_and_b32 s21, s26, 1
  s_lshl_b32 s21, s21, 7
  s_add_u32 s44, s44, s21
  s_add_u32 s44, s44, 7798784
  v_lshlrev_b32 v60, 3, v4
  v_and_b32 v61, 7, v0
  v_bfe_u32 v62, v0, 3, 1
  s_lshl_b32 s21, s20, 1
  v_add_u32 v62, s21, v62
  v_mul_u32_u24 v63, 1152, v61
  s_and_b32 s21, s26, 15
  s_lshl_b32 s21, s21, 5
  s_add_u32 s21, s21, 161792
  v_lshl_add_u32 v64, v61, 2, s21
  v_accvgpr_write_b32 a228, v64
  s_mov_b32 s21, s40
  s_lshl_b32 s22, s41, 8
  s_or_b32 s21, s21, s22
  s_lshl_b32 s22, s50, 16
  s_or_b32 s21, s21, s22
  s_lshl_b32 s22, s51, 24
  s_or_b32 s21, s21, s22
  v_bfe_u32 v64, s21, v60, 8
  v_lshl_add_u32 v64, v64, 3, v62
  v_lshlrev_b32 v65, 7, v64
  v_lshl_add_u32 v65, v61, 4, v65
  v_lshl_add_u32 v66, v64, 7, v65
  v_lshl_add_u32 v67, v64, 4, v63
  v_lshlrev_b32 v64, 5, v64
  v_add_u32 v64, 158976, v64
  v_accvgpr_write_b32 a216, v65
  v_accvgpr_write_b32 a219, v66
  v_accvgpr_write_b32 a222, v67
  v_accvgpr_write_b32 a225, v64
  s_mov_b32 s21, s42
  s_lshl_b32 s22, s53, 8
  s_or_b32 s21, s21, s22
  s_lshl_b32 s22, s54, 16
  s_or_b32 s21, s21, s22
  v_bfe_u32 v64, s21, v60, 8
  v_lshl_add_u32 v64, v64, 3, v62
  v_lshlrev_b32 v65, 7, v64
  v_lshl_add_u32 v65, v61, 4, v65
  v_lshl_add_u32 v66, v64, 7, v65
  v_lshl_add_u32 v67, v64, 4, v63
  v_lshlrev_b32 v64, 5, v64
  v_add_u32 v64, 158976, v64
  v_accvgpr_write_b32 a217, v65
  v_accvgpr_write_b32 a220, v66
  v_accvgpr_write_b32 a223, v67
  v_accvgpr_write_b32 a226, v64
  s_mov_b32 s21, s43
  s_lshl_b32 s22, s55, 8
  s_or_b32 s21, s21, s22
  v_bfe_u32 v64, s21, v60, 8
  v_lshl_add_u32 v64, v64, 3, v62
  v_lshlrev_b32 v65, 7, v64
  v_lshl_add_u32 v65, v61, 4, v65
  v_lshl_add_u32 v66, v64, 7, v65
  v_lshl_add_u32 v67, v64, 4, v63
  v_lshlrev_b32 v64, 5, v64
  v_add_u32 v64, 158976, v64
  v_accvgpr_write_b32 a218, v65
  v_accvgpr_write_b32 a221, v66
  v_accvgpr_write_b32 a224, v67
  v_accvgpr_write_b32 a227, v64
  s_waitcnt lgkmcnt(8)
  s_waitcnt vmcnt(15)
  v_mfma_f32_16x16x32_bf16 v[64:67], a[144:147], a[0:3], 0
  ds_read_b64_tr_b16 a[176:177], v12 offset:40960
  s_waitcnt vmcnt(14)
  v_mfma_f32_16x16x32_bf16 v[68:71], a[144:147], a[72:75], 0
  ds_read_b64_tr_b16 a[178:179], v12 offset:41472
  buffer_load_dwordx4 a[24:27], v2, s[12:15], s23 offen offset:2048 sc1
  v_mfma_f32_16x16x32_bf16 v[72:75], a[148:151], a[0:3], 0
  ds_read_b64_tr_b16 a[180:181], v13 offset:40960
  v_mfma_f32_16x16x32_bf16 v[76:79], a[148:151], a[72:75], 0
  ds_read_b64_tr_b16 a[182:183], v13 offset:41472
  v_mfma_f32_16x16x32_bf16 v[80:83], a[152:155], a[0:3], 0
  ds_read_b64_tr_b16 a[184:185], v14 offset:40960
  v_mfma_f32_16x16x32_bf16 v[84:87], a[152:155], a[72:75], 0
  ds_read_b64_tr_b16 a[186:187], v14 offset:41472
  buffer_load_dwordx4 a[96:99], v7, s[12:15], s23 offen offset:2048 sc1
  v_mfma_f32_16x16x32_bf16 v[88:91], a[156:159], a[0:3], 0
  ds_read_b64_tr_b16 a[188:189], v15 offset:40960
  v_mfma_f32_16x16x32_bf16 v[92:95], a[156:159], a[72:75], 0
  ds_read_b64_tr_b16 a[190:191], v15 offset:41472
  s_waitcnt lgkmcnt(8)
  s_waitcnt vmcnt(15)
  v_mfma_f32_16x16x32_bf16 v[64:67], a[160:163], a[4:7], v[64:67]
  ds_read_b64_tr_b16 a[192:193], v12 offset:45056
  s_waitcnt vmcnt(14)
  v_mfma_f32_16x16x32_bf16 v[68:71], a[160:163], a[76:79], v[68:71]
  ds_read_b64_tr_b16 a[194:195], v12 offset:45568
  buffer_load_dwordx4 a[28:31], v2, s[12:15], s23 offen offset:3072 sc1
  v_mfma_f32_16x16x32_bf16 v[72:75], a[164:167], a[4:7], v[72:75]
  ds_read_b64_tr_b16 a[196:197], v13 offset:45056
  v_mfma_f32_16x16x32_bf16 v[76:79], a[164:167], a[76:79], v[76:79]
  ds_read_b64_tr_b16 a[198:199], v13 offset:45568
  buffer_load_dwordx4 a[100:103], v7, s[12:15], s23 offen offset:3072 sc1
  v_mfma_f32_16x16x32_bf16 v[80:83], a[168:171], a[4:7], v[80:83]
  ds_read_b64_tr_b16 a[144:145], v14 offset:45056
  v_mfma_f32_16x16x32_bf16 v[84:87], a[168:171], a[76:79], v[84:87]
  ds_read_b64_tr_b16 a[146:147], v14 offset:45568
  s_add_u32 s23, s23, 4096
  v_mfma_f32_16x16x32_bf16 v[88:91], a[172:175], a[4:7], v[88:91]
  ds_read_b64_tr_b16 a[148:149], v15 offset:45056
  v_mfma_f32_16x16x32_bf16 v[92:95], a[172:175], a[76:79], v[92:95]
  ds_read_b64_tr_b16 a[150:151], v15 offset:45568
  s_waitcnt lgkmcnt(8)
  s_waitcnt vmcnt(15)
  v_mfma_f32_16x16x32_bf16 v[64:67], a[176:179], a[8:11], v[64:67]
  ds_read_b64_tr_b16 a[152:153], v12 offset:49152
  s_waitcnt vmcnt(14)
  v_mfma_f32_16x16x32_bf16 v[68:71], a[176:179], a[80:83], v[68:71]
  ds_read_b64_tr_b16 a[154:155], v12 offset:49664
  buffer_load_dwordx4 a[32:35], v2, s[12:15], s23 offen offset:0 sc1
  v_mfma_f32_16x16x32_bf16 v[72:75], a[180:183], a[8:11], v[72:75]
  ds_read_b64_tr_b16 a[156:157], v13 offset:49152
  v_mfma_f32_16x16x32_bf16 v[76:79], a[180:183], a[80:83], v[76:79]
  ds_read_b64_tr_b16 a[158:159], v13 offset:49664
  v_mfma_f32_16x16x32_bf16 v[80:83], a[184:187], a[8:11], v[80:83]
  ds_read_b64_tr_b16 a[160:161], v14 offset:49152
  v_mfma_f32_16x16x32_bf16 v[84:87], a[184:187], a[80:83], v[84:87]
  ds_read_b64_tr_b16 a[162:163], v14 offset:49664
  buffer_load_dwordx4 a[104:107], v7, s[12:15], s23 offen offset:0 sc1
  v_mfma_f32_16x16x32_bf16 v[88:91], a[188:191], a[8:11], v[88:91]
  ds_read_b64_tr_b16 a[164:165], v15 offset:49152
  v_mfma_f32_16x16x32_bf16 v[92:95], a[188:191], a[80:83], v[92:95]
  ds_read_b64_tr_b16 a[166:167], v15 offset:49664
  s_waitcnt lgkmcnt(8)
  s_waitcnt vmcnt(15)
  v_mfma_f32_16x16x32_bf16 v[64:67], a[192:195], a[12:15], v[64:67]
  ds_read_b64_tr_b16 a[168:169], v12 offset:53248
  buffer_load_dwordx4 a[36:39], v2, s[12:15], s23 offen offset:1024 sc1
  s_waitcnt vmcnt(15)
  v_mfma_f32_16x16x32_bf16 v[68:71], a[192:195], a[84:87], v[68:71]
  ds_read_b64_tr_b16 a[170:171], v12 offset:53760
  buffer_load_dwordx4 a[108:111], v7, s[12:15], s23 offen offset:1024 sc1
  v_cmp_eq_u32 vcc, 0, v4
  v_mfma_f32_16x16x32_bf16 v[72:75], a[196:199], a[12:15], v[72:75]
  ds_read_b64_tr_b16 a[172:173], v13 offset:53248
  s_lshl_b32 s22, s20, 7
  v_mfma_f32_16x16x32_bf16 v[76:79], a[196:199], a[84:87], v[76:79]
  ds_read_b64_tr_b16 a[174:175], v13 offset:53760
  s_add_u32 s22, s22, 161792
  v_lshl_add_u32 v6, v3, 2, s22
  v_mfma_f32_16x16x32_bf16 v[80:83], a[144:147], a[12:15], v[80:83]
  ds_read_b64_tr_b16 a[176:177], v14 offset:53248
  s_waitcnt vmcnt(10)
  v_add_f32 v32, v32, v34
  v_mfma_f32_16x16x32_bf16 v[84:87], a[144:147], a[84:87], v[84:87]
  ds_read_b64_tr_b16 a[178:179], v14 offset:53760
  v_add_f32 v33, v33, v35
  v_mov_b32 v34, v32
  v_mfma_f32_16x16x32_bf16 v[88:91], a[148:151], a[12:15], v[88:91]
  ds_read_b64_tr_b16 a[180:181], v15 offset:53248
  v_mov_b32 v35, v33
  v_mfma_f32_16x16x32_bf16 v[92:95], a[148:151], a[84:87], v[92:95]
  ds_read_b64_tr_b16 a[182:183], v15 offset:53760
  v_permlane16_swap_b32 v32, v34
  s_barrier
  s_waitcnt lgkmcnt(8)
  v_mfma_f32_16x16x32_bf16 v[64:67], a[152:155], a[16:19], v[64:67]
  ds_read_b64_tr_b16 a[184:185], v12 offset:57344
  buffer_load_dwordx4 a[40:43], v2, s[12:15], s23 offen offset:2048 sc1
  v_mfma_f32_16x16x32_bf16 v[68:71], a[152:155], a[88:91], v[68:71]
  ds_read_b64_tr_b16 a[186:187], v12 offset:57856
  buffer_load_dwordx4 a[112:115], v7, s[12:15], s23 offen offset:2048 sc1
  v_permlane16_swap_b32 v33, v35
  v_mfma_f32_16x16x32_bf16 v[72:75], a[156:159], a[16:19], v[72:75]
  ds_read_b64_tr_b16 a[188:189], v13 offset:57344
  v_add_f32 v32, v32, v34
  v_mfma_f32_16x16x32_bf16 v[76:79], a[156:159], a[88:91], v[76:79]
  ds_read_b64_tr_b16 a[190:191], v13 offset:57856
  v_add_f32 v33, v33, v35
  v_mov_b32 v34, v32
  v_mfma_f32_16x16x32_bf16 v[80:83], a[160:163], a[16:19], v[80:83]
  ds_read_b64_tr_b16 a[192:193], v14 offset:57344
  v_mov_b32 v35, v33
  v_mfma_f32_16x16x32_bf16 v[84:87], a[160:163], a[88:91], v[84:87]
  ds_read_b64_tr_b16 a[194:195], v14 offset:57856
  v_permlane32_swap_b32 v32, v34
  v_permlane32_swap_b32 v33, v35
  v_mfma_f32_16x16x32_bf16 v[88:91], a[164:167], a[16:19], v[88:91]
  ds_read_b64_tr_b16 a[196:197], v15 offset:57344
  v_add_f32 v32, v32, v34
  v_mfma_f32_16x16x32_bf16 v[92:95], a[164:167], a[88:91], v[92:95]
  ds_read_b64_tr_b16 a[198:199], v15 offset:57856
  v_add_f32 v33, v33, v35
  s_waitcnt lgkmcnt(8)
  v_mfma_f32_16x16x32_bf16 v[64:67], a[168:171], a[20:23], v[64:67]
  ds_read_b64_tr_b16 a[144:145], v12 offset:61440
  buffer_load_dwordx4 a[44:47], v2, s[12:15], s23 offen offset:3072 sc1
  buffer_load_dwordx4 a[116:119], v7, s[12:15], s23 offen offset:3072 sc1
  v_mfma_f32_16x16x32_bf16 v[68:71], a[168:171], a[92:95], v[68:71]
  ds_read_b64_tr_b16 a[146:147], v12 offset:61952
  s_add_u32 s23, s23, 4096
  v_mul_f32 v32, 0xbae38e39, v32
  v_mfma_f32_16x16x32_bf16 v[72:75], a[172:175], a[20:23], v[72:75]
  ds_read_b64_tr_b16 a[148:149], v13 offset:61440
  v_mul_f32 v33, 0x3ae38e39, v33
  v_mfma_f32_16x16x32_bf16 v[76:79], a[172:175], a[92:95], v[76:79]
  ds_read_b64_tr_b16 a[150:151], v13 offset:61952
  v_fma_f32 v33, -v32, v32, v33
  v_max_f32 v33, 0, v33
  v_mfma_f32_16x16x32_bf16 v[80:83], a[176:179], a[20:23], v[80:83]
  ds_read_b64_tr_b16 a[152:153], v14 offset:61440
  v_add_f32 v33, 0x3727c5ac, v33
  v_mfma_f32_16x16x32_bf16 v[84:87], a[176:179], a[92:95], v[84:87]
  ds_read_b64_tr_b16 a[154:155], v14 offset:61952
  v_rsq_f32 v34, v33
  s_nop 0
  v_mul_f32 v33, v33, v34
  v_mfma_f32_16x16x32_bf16 v[88:91], a[180:183], a[20:23], v[88:91]
  ds_read_b64_tr_b16 a[156:157], v15 offset:61440
  ds_write_b32 v6, v34 offset:0
  v_mfma_f32_16x16x32_bf16 v[92:95], a[180:183], a[92:95], v[92:95]
  ds_read_b64_tr_b16 a[158:159], v15 offset:61952
  v_cndmask_b32 v32, 0, v32, vcc
  s_waitcnt lgkmcnt(9)
  s_waitcnt vmcnt(11)
  v_mfma_f32_16x16x32_bf16 v[64:67], a[184:187], a[24:27], v[64:67]
  ds_read_b64_tr_b16 a[160:161], v16 offset:0
  buffer_load_dwordx4 a[48:51], v2, s[12:15], s23 offen offset:0 sc1
  s_waitcnt vmcnt(11)
  v_mfma_f32_16x16x32_bf16 v[68:71], a[184:187], a[96:99], v[68:71]
  ds_read_b64_tr_b16 a[162:163], v16 offset:512
  buffer_load_dwordx4 a[120:123], v7, s[12:15], s23 offen offset:0 sc1
  v_cndmask_b32 v33, 0, v33, vcc
  v_mfma_f32_16x16x32_bf16 v[72:75], a[188:191], a[24:27], v[72:75]
  ds_read_b64_tr_b16 a[164:165], v17 offset:0
  v_cvt_pk_bf16_f32 v27, v32, v33
  v_mfma_f32_16x16x32_bf16 v[76:79], a[188:191], a[96:99], v[76:79]
  ds_read_b64_tr_b16 a[166:167], v17 offset:512
  v_lshlrev_b32 v40, 16, v27
  v_and_b32 v41, 0xffff0000, v27
  v_mfma_f32_16x16x32_bf16 v[80:83], a[192:195], a[24:27], v[80:83]
  ds_read_b64_tr_b16 a[168:169], v18 offset:0
  v_sub_f32 v40, v32, v40
  v_mfma_f32_16x16x32_bf16 v[84:87], a[192:195], a[96:99], v[84:87]
  ds_read_b64_tr_b16 a[170:171], v18 offset:512
  v_sub_f32 v41, v33, v41
  v_cvt_pk_bf16_f32 v24, v32, v32
  v_mfma_f32_16x16x32_bf16 v[88:91], a[196:199], a[24:27], v[88:91]
  ds_read_b64_tr_b16 a[172:173], v19 offset:0
  v_cvt_pk_bf16_f32 v25, v40, v33
  v_mfma_f32_16x16x32_bf16 v[92:95], a[196:199], a[96:99], v[92:95]
  ds_read_b64_tr_b16 a[174:175], v19 offset:512
  v_cvt_pk_bf16_f32 v26, v33, v41
  s_waitcnt lgkmcnt(8)
  s_waitcnt vmcnt(11)
  v_mfma_f32_16x16x32_bf16 v[64:67], a[144:147], a[28:31], v[64:67]
  ds_read_b64_tr_b16 a[176:177], v16 offset:4096
  buffer_load_dwordx4 a[52:55], v2, s[12:15], s23 offen offset:1024 sc1
  s_waitcnt vmcnt(11)
  v_mfma_f32_16x16x32_bf16 v[68:71], a[144:147], a[100:103], v[68:71]
  ds_read_b64_tr_b16 a[178:179], v16 offset:4608
  buffer_load_dwordx4 a[124:127], v7, s[12:15], s23 offen offset:1024 sc1
  v_mov_b32 v27, 0
  v_mfma_f32_16x16x32_bf16 v[72:75], a[148:151], a[28:31], v[72:75]
  ds_read_b64_tr_b16 a[180:181], v17 offset:4096
  v_add_f32 v36, v36, v38
  v_mfma_f32_16x16x32_bf16 v[76:79], a[148:151], a[100:103], v[76:79]
  ds_read_b64_tr_b16 a[182:183], v17 offset:4608
  v_add_f32 v37, v37, v39
  v_mov_b32 v38, v36
  v_mfma_f32_16x16x32_bf16 v[80:83], a[152:155], a[28:31], v[80:83]
  ds_read_b64_tr_b16 a[184:185], v18 offset:4096
  v_mov_b32 v39, v37
  v_mfma_f32_16x16x32_bf16 v[84:87], a[152:155], a[100:103], v[84:87]
  ds_read_b64_tr_b16 a[186:187], v18 offset:4608
  v_permlane16_swap_b32 v36, v38
  v_permlane16_swap_b32 v37, v39
  v_mfma_f32_16x16x32_bf16 v[88:91], a[156:159], a[28:31], v[88:91]
  ds_read_b64_tr_b16 a[188:189], v19 offset:4096
  v_add_f32 v36, v36, v38
  v_mfma_f32_16x16x32_bf16 v[92:95], a[156:159], a[100:103], v[92:95]
  ds_read_b64_tr_b16 a[190:191], v19 offset:4608
  v_add_f32 v37, v37, v39
  s_waitcnt lgkmcnt(8)
  s_waitcnt vmcnt(11)
  v_mfma_f32_16x16x32_bf16 v[64:67], a[160:163], a[32:35], v[64:67]
  ds_read_b64_tr_b16 a[192:193], v16 offset:8192
  buffer_load_dwordx4 a[56:59], v2, s[12:15], s23 offen offset:2048 sc1
  s_waitcnt vmcnt(11)
  v_mfma_f32_16x16x32_bf16 v[68:71], a[160:163], a[104:107], v[68:71]
  ds_read_b64_tr_b16 a[194:195], v16 offset:8704
  buffer_load_dwordx4 a[128:131], v7, s[12:15], s23 offen offset:2048 sc1
  v_mov_b32 v38, v36
  v_mfma_f32_16x16x32_bf16 v[72:75], a[164:167], a[32:35], v[72:75]
  ds_read_b64_tr_b16 a[196:197], v17 offset:8192
  v_mov_b32 v39, v37
  v_mfma_f32_16x16x32_bf16 v[76:79], a[164:167], a[104:107], v[76:79]
  ds_read_b64_tr_b16 a[198:199], v17 offset:8704
  v_permlane32_swap_b32 v36, v38
  v_permlane32_swap_b32 v37, v39
  v_mfma_f32_16x16x32_bf16 v[80:83], a[168:171], a[32:35], v[80:83]
  ds_read_b64_tr_b16 a[144:145], v18 offset:8192
  v_add_f32 v36, v36, v38
  v_mfma_f32_16x16x32_bf16 v[84:87], a[168:171], a[104:107], v[84:87]
  ds_read_b64_tr_b16 a[146:147], v18 offset:8704
  v_add_f32 v37, v37, v39
  v_mul_f32 v36, 0xbae38e39, v36
  v_mfma_f32_16x16x32_bf16 v[88:91], a[172:175], a[32:35], v[88:91]
  ds_read_b64_tr_b16 a[148:149], v19 offset:8192
  v_mul_f32 v37, 0x3ae38e39, v37
  v_mfma_f32_16x16x32_bf16 v[92:95], a[172:175], a[104:107], v[92:95]
  ds_read_b64_tr_b16 a[150:151], v19 offset:8704
  v_fma_f32 v37, -v36, v36, v37
  s_waitcnt lgkmcnt(8)
  s_waitcnt vmcnt(11)
  v_mfma_f32_16x16x32_bf16 v[64:67], a[176:179], a[36:39], v[64:67]
  ds_read_b64_tr_b16 a[152:153], v16 offset:12288
  buffer_load_dwordx4 a[60:63], v2, s[12:15], s23 offen offset:3072 sc1
  buffer_load_dwordx4 a[132:135], v7, s[12:15], s23 offen offset:3072 sc1
  s_waitcnt vmcnt(12)
  v_mfma_f32_16x16x32_bf16 v[68:71], a[176:179], a[108:111], v[68:71]
  ds_read_b64_tr_b16 a[154:155], v16 offset:12800
  s_add_u32 s23, s23, 4096
  v_max_f32 v37, 0, v37
  v_mfma_f32_16x16x32_bf16 v[72:75], a[180:183], a[36:39], v[72:75]
  ds_read_b64_tr_b16 a[156:157], v17 offset:12288
  v_add_f32 v37, 0x3727c5ac, v37
  v_mfma_f32_16x16x32_bf16 v[76:79], a[180:183], a[108:111], v[76:79]
  ds_read_b64_tr_b16 a[158:159], v17 offset:12800
  v_rsq_f32 v38, v37
  s_nop 0
  v_mul_f32 v37, v37, v38
  v_mfma_f32_16x16x32_bf16 v[80:83], a[184:187], a[36:39], v[80:83]
  ds_read_b64_tr_b16 a[160:161], v18 offset:12288
  ds_write_b32 v6, v38 offset:64
  v_mfma_f32_16x16x32_bf16 v[84:87], a[184:187], a[108:111], v[84:87]
  ds_read_b64_tr_b16 a[162:163], v18 offset:12800
  v_cndmask_b32 v36, 0, v36, vcc
  v_cndmask_b32 v37, 0, v37, vcc
  v_mfma_f32_16x16x32_bf16 v[88:91], a[188:191], a[36:39], v[88:91]
  ds_read_b64_tr_b16 a[164:165], v19 offset:12288
  v_cvt_pk_bf16_f32 v31, v36, v37
  v_mfma_f32_16x16x32_bf16 v[92:95], a[188:191], a[108:111], v[92:95]
  ds_read_b64_tr_b16 a[166:167], v19 offset:12800
  v_lshlrev_b32 v40, 16, v31
  s_barrier
  s_waitcnt lgkmcnt(9)
  s_waitcnt vmcnt(11)
  v_mfma_f32_16x16x32_bf16 v[64:67], a[192:195], a[40:43], v[64:67]
  ds_read_b64_tr_b16 a[168:169], v8 offset:0
  buffer_load_dwordx4 a[64:67], v2, s[12:15], s23 offen offset:0 sc1
  s_waitcnt vmcnt(11)
  v_mfma_f32_16x16x32_bf16 v[68:71], a[192:195], a[112:115], v[68:71]
  ds_read_b64_tr_b16 a[170:171], v8 offset:512
  buffer_load_dwordx4 a[136:139], v7, s[12:15], s23 offen offset:0 sc1
  v_and_b32 v41, 0xffff0000, v31
  v_mfma_f32_16x16x32_bf16 v[72:75], a[196:199], a[40:43], v[72:75]
  ds_read_b64_tr_b16 a[172:173], v9 offset:0
  v_sub_f32 v40, v36, v40
  v_mfma_f32_16x16x32_bf16 v[76:79], a[196:199], a[112:115], v[76:79]
  ds_read_b64_tr_b16 a[174:175], v9 offset:512
  v_sub_f32 v41, v37, v41
  v_cvt_pk_bf16_f32 v28, v36, v36
  v_mfma_f32_16x16x32_bf16 v[80:83], a[144:147], a[40:43], v[80:83]
  ds_read_b64_tr_b16 a[176:177], v10 offset:0
  v_cvt_pk_bf16_f32 v29, v40, v37
  v_mfma_f32_16x16x32_bf16 v[84:87], a[144:147], a[112:115], v[84:87]
  ds_read_b64_tr_b16 a[178:179], v10 offset:512
  v_cvt_pk_bf16_f32 v30, v37, v41
  v_mov_b32 v31, 0
  v_mfma_f32_16x16x32_bf16 v[88:91], a[148:151], a[40:43], v[88:91]
  ds_read_b64_tr_b16 a[180:181], v11 offset:0
  v_lshlrev_b32 v3, 4, v3
  v_mfma_f32_16x16x32_bf16 v[92:95], a[148:151], a[112:115], v[92:95]
  ds_read_b64_tr_b16 a[182:183], v11 offset:512
  v_add_u32 v3, 147456, v3
  s_waitcnt lgkmcnt(8)
  s_waitcnt vmcnt(11)
  v_mfma_f32_16x16x32_bf16 v[64:67], a[152:155], a[44:47], v[64:67]
  ds_read_b64_tr_b16 a[184:185], v8 offset:4096
  buffer_load_dwordx4 a[68:71], v2, s[12:15], s23 offen offset:1024 sc1
  s_waitcnt vmcnt(11)
  v_mfma_f32_16x16x32_bf16 v[68:71], a[152:155], a[116:119], v[68:71]
  ds_read_b64_tr_b16 a[186:187], v8 offset:4608
  buffer_load_dwordx4 a[140:143], v7, s[12:15], s23 offen offset:1024 sc1
  s_add_u32 m0, s27, 32768
  v_mfma_f32_16x16x32_bf16 v[72:75], a[156:159], a[44:47], v[72:75]
  ds_read_b64_tr_b16 a[188:189], v9 offset:4096
  s_add_u32 s52, s52, 589824
  v_mfma_f32_16x16x32_bf16 v[76:79], a[156:159], a[116:119], v[76:79]
  ds_read_b64_tr_b16 a[190:191], v9 offset:4608
  buffer_load_dwordx4 v20, s[4:7], s52 offen lds
  v_mfma_f32_16x16x32_bf16 v[80:83], a[160:163], a[44:47], v[80:83]
  ds_read_b64_tr_b16 a[192:193], v10 offset:4096
  s_add_u32 m0, s27, 36864
  v_mfma_f32_16x16x32_bf16 v[84:87], a[160:163], a[116:119], v[84:87]
  ds_read_b64_tr_b16 a[194:195], v10 offset:4608
  buffer_load_dwordx4 v21, s[4:7], s52 offen lds
  v_mfma_f32_16x16x32_bf16 v[88:91], a[164:167], a[44:47], v[88:91]
  ds_read_b64_tr_b16 a[196:197], v11 offset:4096
  v_mov_b32 v5, 1
  v_mfma_f32_16x16x32_bf16 v[92:95], a[164:167], a[116:119], v[92:95]
  ds_read_b64_tr_b16 a[198:199], v11 offset:4608
  v_mov_b32 v6, 0
  s_waitcnt lgkmcnt(8)
  s_waitcnt vmcnt(13)
  v_mfma_f32_16x16x32_bf16 v[64:67], a[168:171], a[48:51], v[64:67]
  ds_read_b64_tr_b16 a[144:145], v8 offset:8192
  v_lshl_add_u32 v4, s34, 10, v3
  s_waitcnt vmcnt(12)
  v_mfma_f32_16x16x32_bf16 v[68:71], a[168:171], a[120:123], v[68:71]
  ds_read_b64_tr_b16 a[146:147], v8 offset:8704
  s_add_u32 m0, s27, 40960
  v_mfma_f32_16x16x32_bf16 v[72:75], a[172:175], a[48:51], v[72:75]
  ds_read_b64_tr_b16 a[148:149], v9 offset:8192
  s_add_u32 s52, s52, 589824
  v_mfma_f32_16x16x32_bf16 v[76:79], a[172:175], a[120:123], v[76:79]
  ds_read_b64_tr_b16 a[150:151], v9 offset:8704
  buffer_load_dwordx4 v20, s[4:7], s52 offen lds
  v_mfma_f32_16x16x32_bf16 v[80:83], a[176:179], a[48:51], v[80:83]
  ds_read_b64_tr_b16 a[152:153], v10 offset:8192
  s_add_u32 m0, s27, 45056
  v_mfma_f32_16x16x32_bf16 v[84:87], a[176:179], a[120:123], v[84:87]
  ds_read_b64_tr_b16 a[154:155], v10 offset:8704
  buffer_load_dwordx4 v21, s[4:7], s52 offen lds
  v_mfma_f32_16x16x32_bf16 v[88:91], a[180:183], a[48:51], v[88:91]
  ds_read_b64_tr_b16 a[156:157], v11 offset:8192
  v_mfma_f32_16x16x32_bf16 v[92:95], a[180:183], a[120:123], v[92:95]
  ds_read_b64_tr_b16 a[158:159], v11 offset:8704
  s_waitcnt lgkmcnt(8)
  s_waitcnt vmcnt(13)
  v_mfma_f32_16x16x32_bf16 v[64:67], a[184:187], a[52:55], v[64:67]
  ds_read_b64_tr_b16 a[160:161], v8 offset:12288
  ds_read_b128 a[232:235], v4 offset:0
  s_waitcnt vmcnt(12)
  v_mfma_f32_16x16x32_bf16 v[68:71], a[184:187], a[124:127], v[68:71]
  ds_read_b64_tr_b16 a[162:163], v8 offset:12800
  s_add_u32 m0, s27, 49152
  v_mfma_f32_16x16x32_bf16 v[72:75], a[188:191], a[52:55], v[72:75]
  ds_read_b64_tr_b16 a[164:165], v9 offset:12288
  s_add_u32 s52, s52, 589824
  v_mfma_f32_16x16x32_bf16 v[76:79], a[188:191], a[124:127], v[76:79]
  ds_read_b64_tr_b16 a[166:167], v9 offset:12800
  buffer_load_dwordx4 v20, s[4:7], s52 offen lds
  v_mfma_f32_16x16x32_bf16 v[80:83], a[192:195], a[52:55], v[80:83]
  ds_read_b64_tr_b16 a[168:169], v10 offset:12288
  s_add_u32 m0, s27, 53248
  v_mfma_f32_16x16x32_bf16 v[84:87], a[192:195], a[124:127], v[84:87]
  ds_read_b64_tr_b16 a[170:171], v10 offset:12800
  buffer_load_dwordx4 v21, s[4:7], s52 offen lds
  v_mfma_f32_16x16x32_bf16 v[88:91], a[196:199], a[52:55], v[88:91]
  ds_read_b64_tr_b16 a[172:173], v11 offset:12288
  v_mfma_f32_16x16x32_bf16 v[92:95], a[196:199], a[124:127], v[92:95]
  ds_read_b64_tr_b16 a[174:175], v11 offset:12800
  s_waitcnt lgkmcnt(9)
  s_waitcnt vmcnt(13)
  v_mfma_f32_16x16x32_bf16 v[64:67], a[144:147], a[56:59], v[64:67]
  ds_read_b64_tr_b16 a[176:177], v8 offset:16384
  ds_read_b128 a[236:239], v4 offset:256
  s_waitcnt vmcnt(12)
  v_mfma_f32_16x16x32_bf16 v[68:71], a[144:147], a[128:131], v[68:71]
  ds_read_b64_tr_b16 a[178:179], v8 offset:16896
  s_add_u32 m0, s27, 57344
  v_mfma_f32_16x16x32_bf16 v[72:75], a[148:151], a[56:59], v[72:75]
  ds_read_b64_tr_b16 a[180:181], v9 offset:16384
  s_add_u32 s52, s52, 589824
  v_mfma_f32_16x16x32_bf16 v[76:79], a[148:151], a[128:131], v[76:79]
  ds_read_b64_tr_b16 a[182:183], v9 offset:16896
  buffer_load_dwordx4 v20, s[4:7], s52 offen lds
  v_mfma_f32_16x16x32_bf16 v[80:83], a[152:155], a[56:59], v[80:83]
  ds_read_b64_tr_b16 a[184:185], v10 offset:16384
  s_add_u32 m0, s27, 61440
  v_mfma_f32_16x16x32_bf16 v[84:87], a[152:155], a[128:131], v[84:87]
  ds_read_b64_tr_b16 a[186:187], v10 offset:16896
  buffer_load_dwordx4 v21, s[4:7], s52 offen lds
  v_mfma_f32_16x16x32_bf16 v[88:91], a[156:159], a[56:59], v[88:91]
  ds_read_b64_tr_b16 a[188:189], v11 offset:16384
  v_mfma_f32_16x16x32_bf16 v[92:95], a[156:159], a[128:131], v[92:95]
  ds_read_b64_tr_b16 a[190:191], v11 offset:16896
  s_waitcnt lgkmcnt(9)
  s_waitcnt vmcnt(13)
  v_mfma_f32_16x16x32_bf16 v[64:67], a[160:163], a[60:63], v[64:67]
  ds_read_b64_tr_b16 a[192:193], v8 offset:20480
  ds_read_b128 a[240:243], v4 offset:512
  s_waitcnt vmcnt(12)
  v_mfma_f32_16x16x32_bf16 v[68:71], a[160:163], a[132:135], v[68:71]
  ds_read_b64_tr_b16 a[194:195], v8 offset:20992
  s_add_u32 m0, s27, 65536
  v_mfma_f32_16x16x32_bf16 v[72:75], a[164:167], a[60:63], v[72:75]
  ds_read_b64_tr_b16 a[196:197], v9 offset:20480
  s_add_u32 s52, s52, 589824
  v_mfma_f32_16x16x32_bf16 v[76:79], a[164:167], a[132:135], v[76:79]
  ds_read_b64_tr_b16 a[198:199], v9 offset:20992
  buffer_load_dwordx4 v20, s[4:7], s52 offen lds
  v_mfma_f32_16x16x32_bf16 v[80:83], a[168:171], a[60:63], v[80:83]
  ds_read_b64_tr_b16 a[144:145], v10 offset:20480
  s_add_u32 m0, s27, 69632
  v_mfma_f32_16x16x32_bf16 v[84:87], a[168:171], a[132:135], v[84:87]
  ds_read_b64_tr_b16 a[146:147], v10 offset:20992
  buffer_load_dwordx4 v21, s[4:7], s52 offen lds
  v_mfma_f32_16x16x32_bf16 v[88:91], a[172:175], a[60:63], v[88:91]
  ds_read_b64_tr_b16 a[148:149], v11 offset:20480
  v_mfma_f32_16x16x32_bf16 v[92:95], a[172:175], a[132:135], v[92:95]
  ds_read_b64_tr_b16 a[150:151], v11 offset:20992
  s_waitcnt vmcnt(6)
  s_barrier
  s_waitcnt lgkmcnt(9)
  v_mfma_f32_16x16x32_bf16 v[64:67], a[176:179], a[64:67], v[64:67]
  ds_read_b64_tr_b16 a[152:153], v8 offset:24576
  ds_read_b128 a[244:247], v4 offset:768
  v_mfma_f32_16x16x32_bf16 v[68:71], a[176:179], a[136:139], v[68:71]
  ds_read_b64_tr_b16 a[154:155], v8 offset:25088
  s_add_u32 m0, s27, 73728
  v_mfma_f32_16x16x32_bf16 v[72:75], a[180:183], a[64:67], v[72:75]
  ds_read_b64_tr_b16 a[156:157], v9 offset:24576
  s_add_u32 s52, s52, 589824
  v_mfma_f32_16x16x32_bf16 v[76:79], a[180:183], a[136:139], v[76:79]
  ds_read_b64_tr_b16 a[158:159], v9 offset:25088
  buffer_load_dwordx4 v20, s[4:7], s52 offen lds
  v_mfma_f32_16x16x32_bf16 v[80:83], a[184:187], a[64:67], v[80:83]
  ds_read_b64_tr_b16 a[160:161], v10 offset:24576
  s_add_u32 m0, s27, 77824
  v_mfma_f32_16x16x32_bf16 v[84:87], a[184:187], a[136:139], v[84:87]
  ds_read_b64_tr_b16 a[162:163], v10 offset:25088
  buffer_load_dwordx4 v21, s[4:7], s52 offen lds
  v_mfma_f32_16x16x32_bf16 v[88:91], a[188:191], a[64:67], v[88:91]
  ds_read_b64_tr_b16 a[164:165], v11 offset:24576
  v_mfma_f32_16x16x32_bf16 v[92:95], a[188:191], a[136:139], v[92:95]
  ds_read_b64_tr_b16 a[166:167], v11 offset:25088
  s_waitcnt lgkmcnt(9)
  v_mfma_f32_16x16x32_bf16 v[64:67], a[192:195], a[68:71], v[64:67]
  ds_read_b64_tr_b16 a[168:169], v8 offset:28672
  s_add_u32 m0, s27, 81920
  v_mfma_f32_16x16x32_bf16 v[68:71], a[192:195], a[140:143], v[68:71]
  ds_read_b64_tr_b16 a[170:171], v8 offset:29184
  s_add_u32 s52, s52, 589824
  v_mfma_f32_16x16x32_bf16 v[72:75], a[196:199], a[68:71], v[72:75]
  ds_read_b64_tr_b16 a[172:173], v9 offset:28672
  v_mfma_f32_16x16x32_bf16 v[76:79], a[196:199], a[140:143], v[76:79]
  ds_read_b64_tr_b16 a[174:175], v9 offset:29184
  buffer_load_dwordx4 v20, s[4:7], s52 offen lds
  v_mfma_f32_16x16x32_bf16 v[80:83], a[144:147], a[68:71], v[80:83]
  ds_read_b64_tr_b16 a[176:177], v10 offset:28672
  s_add_u32 m0, s27, 86016
  v_mfma_f32_16x16x32_bf16 v[84:87], a[144:147], a[140:143], v[84:87]
  ds_read_b64_tr_b16 a[178:179], v10 offset:29184
  buffer_load_dwordx4 v21, s[4:7], s52 offen lds
  v_mfma_f32_16x16x32_bf16 v[88:91], a[148:151], a[68:71], v[88:91]
  ds_read_b64_tr_b16 a[180:181], v11 offset:28672
  v_mfma_f32_16x16x32_bf16 v[92:95], a[148:151], a[140:143], v[92:95]
  ds_read_b64_tr_b16 a[182:183], v11 offset:29184
  v_mfma_f32_16x16x32_bf16 v[64:67], a[232:235], v[24:27], v[64:67]
  v_mfma_f32_16x16x32_bf16 v[68:71], a[232:235], v[28:31], v[68:71]
  v_mfma_f32_16x16x32_bf16 v[72:75], a[236:239], v[24:27], v[72:75]
  v_mfma_f32_16x16x32_bf16 v[76:79], a[236:239], v[28:31], v[76:79]
  v_mfma_f32_16x16x32_bf16 v[80:83], a[240:243], v[24:27], v[80:83]
  v_mfma_f32_16x16x32_bf16 v[84:87], a[240:243], v[28:31], v[84:87]
  s_waitcnt lgkmcnt(14)
  v_mfma_f32_16x16x32_bf16 v[88:91], a[244:247], v[24:27], v[88:91]
  v_mfma_f32_16x16x32_bf16 v[92:95], a[244:247], v[28:31], v[92:95]
  s_waitcnt lgkmcnt(8)
  v_mfma_f32_16x16x32_bf16 v[96:99], a[152:155], a[0:3], 0
  ds_read_b64_tr_b16 a[184:185], v8 offset:32768
  s_add_u32 m0, s27, 90112
  v_mfma_f32_16x16x32_bf16 v[100:103], a[152:155], a[72:75], 0
  ds_read_b64_tr_b16 a[186:187], v8 offset:33280
  s_add_u32 s52, s52, 589824
  v_mfma_f32_16x16x32_bf16 v[104:107], a[156:159], a[0:3], 0
  ds_read_b64_tr_b16 a[188:189], v9 offset:32768
  buffer_load_dwordx4 v20, s[4:7], s52 offen lds
  v_mfma_f32_16x16x32_bf16 v[108:111], a[156:159], a[72:75], 0
  ds_read_b64_tr_b16 a[190:191], v9 offset:33280
  s_add_u32 m0, s27, 94208
  v_mfma_f32_16x16x32_bf16 v[112:115], a[160:163], a[0:3], 0
  ds_read_b64_tr_b16 a[192:193], v10 offset:32768
  buffer_load_dwordx4 v21, s[4:7], s52 offen lds
  v_mfma_f32_16x16x32_bf16 v[116:119], a[160:163], a[72:75], 0
  ds_read_b64_tr_b16 a[194:195], v10 offset:33280
  v_cvt_pk_bf16_f32 v160, v64, v65
  v_mfma_f32_16x16x32_bf16 v[120:123], a[164:167], a[0:3], 0
  ds_read_b64_tr_b16 a[196:197], v11 offset:32768
  v_cvt_pk_bf16_f32 v161, v66, v67
  v_mfma_f32_16x16x32_bf16 v[124:127], a[164:167], a[72:75], 0
  ds_read_b64_tr_b16 a[198:199], v11 offset:33280
  v_cvt_pk_bf16_f32 v162, v72, v73
  s_waitcnt lgkmcnt(8)
  v_mfma_f32_16x16x32_bf16 v[96:99], a[168:171], a[4:7], v[96:99]
  ds_read_b64_tr_b16 a[144:145], v8 offset:36864
  s_add_u32 m0, s27, 98304
  v_mfma_f32_16x16x32_bf16 v[100:103], a[168:171], a[76:79], v[100:103]
  ds_read_b64_tr_b16 a[146:147], v8 offset:37376
  s_lshl_b32 s24, s36, 7
  v_mfma_f32_16x16x32_bf16 v[104:107], a[172:175], a[4:7], v[104:107]
  ds_read_b64_tr_b16 a[148:149], v9 offset:36864
  buffer_load_dwordx4 v20, s[4:7], s24 offen lds
  v_mfma_f32_16x16x32_bf16 v[108:111], a[172:175], a[76:79], v[108:111]
  ds_read_b64_tr_b16 a[150:151], v9 offset:37376
  s_add_u32 m0, s27, 102400
  v_mfma_f32_16x16x32_bf16 v[112:115], a[176:179], a[4:7], v[112:115]
  ds_read_b64_tr_b16 a[152:153], v10 offset:36864
  buffer_load_dwordx4 v21, s[4:7], s24 offen lds
  v_mfma_f32_16x16x32_bf16 v[116:119], a[176:179], a[76:79], v[116:119]
  ds_read_b64_tr_b16 a[154:155], v10 offset:37376
  v_cvt_pk_bf16_f32 v163, v74, v75
  v_mfma_f32_16x16x32_bf16 v[120:123], a[180:183], a[4:7], v[120:123]
  ds_read_b64_tr_b16 a[156:157], v11 offset:36864
  v_pk_max_i16 v160, v160, 0
  v_mfma_f32_16x16x32_bf16 v[124:127], a[180:183], a[76:79], v[124:127]
  ds_read_b64_tr_b16 a[158:159], v11 offset:37376
  v_pk_max_i16 v161, v161, 0
  s_waitcnt lgkmcnt(8)
  v_mfma_f32_16x16x32_bf16 v[96:99], a[184:187], a[8:11], v[96:99]
  ds_read_b64_tr_b16 a[160:161], v8 offset:40960
  s_add_u32 m0, s27, 106496
  v_mfma_f32_16x16x32_bf16 v[100:103], a[184:187], a[80:83], v[100:103]
  ds_read_b64_tr_b16 a[162:163], v8 offset:41472
  s_add_u32 s24, s24, 589824
  v_mfma_f32_16x16x32_bf16 v[104:107], a[188:191], a[8:11], v[104:107]
  ds_read_b64_tr_b16 a[164:165], v9 offset:40960
  buffer_load_dwordx4 v20, s[4:7], s24 offen lds
  v_mfma_f32_16x16x32_bf16 v[108:111], a[188:191], a[80:83], v[108:111]
  ds_read_b64_tr_b16 a[166:167], v9 offset:41472
  s_add_u32 m0, s27, 110592
  v_mfma_f32_16x16x32_bf16 v[112:115], a[192:195], a[8:11], v[112:115]
  ds_read_b64_tr_b16 a[168:169], v10 offset:40960
  buffer_load_dwordx4 v21, s[4:7], s24 offen lds
  v_mfma_f32_16x16x32_bf16 v[116:119], a[192:195], a[80:83], v[116:119]
  ds_read_b64_tr_b16 a[170:171], v10 offset:41472
  v_pk_max_i16 v162, v162, 0
  v_mfma_f32_16x16x32_bf16 v[120:123], a[196:199], a[8:11], v[120:123]
  ds_read_b64_tr_b16 a[172:173], v11 offset:40960
  v_pk_max_i16 v163, v163, 0
  v_mfma_f32_16x16x32_bf16 v[124:127], a[196:199], a[80:83], v[124:127]
  ds_read_b64_tr_b16 a[174:175], v11 offset:41472
  buffer_store_dwordx4 v[160:163], v2, s[12:15], s30 offen offset:0 sc0 sc1
  s_waitcnt lgkmcnt(8)
  v_mfma_f32_16x16x32_bf16 v[96:99], a[144:147], a[12:15], v[96:99]
  ds_read_b64_tr_b16 a[176:177], v8 offset:45056
  s_add_u32 m0, s27, 114688
  v_mfma_f32_16x16x32_bf16 v[100:103], a[144:147], a[84:87], v[100:103]
  ds_read_b64_tr_b16 a[178:179], v8 offset:45568
  s_add_u32 s24, s24, 589824
  v_mfma_f32_16x16x32_bf16 v[104:107], a[148:151], a[12:15], v[104:107]
  ds_read_b64_tr_b16 a[180:181], v9 offset:45056
  buffer_load_dwordx4 v20, s[4:7], s24 offen lds
  v_mfma_f32_16x16x32_bf16 v[108:111], a[148:151], a[84:87], v[108:111]
  ds_read_b64_tr_b16 a[182:183], v9 offset:45568
  s_add_u32 m0, s27, 118784
  v_mfma_f32_16x16x32_bf16 v[112:115], a[152:155], a[12:15], v[112:115]
  ds_read_b64_tr_b16 a[184:185], v10 offset:45056
  buffer_load_dwordx4 v21, s[4:7], s24 offen lds
  v_mfma_f32_16x16x32_bf16 v[116:119], a[152:155], a[84:87], v[116:119]
  ds_read_b64_tr_b16 a[186:187], v10 offset:45568
  v_cvt_pk_bf16_f32 v164, v68, v69
  v_mfma_f32_16x16x32_bf16 v[120:123], a[156:159], a[12:15], v[120:123]
  ds_read_b64_tr_b16 a[188:189], v11 offset:45056
  v_cvt_pk_bf16_f32 v165, v70, v71
  v_mfma_f32_16x16x32_bf16 v[124:127], a[156:159], a[84:87], v[124:127]
  ds_read_b64_tr_b16 a[190:191], v11 offset:45568
  v_cvt_pk_bf16_f32 v166, v76, v77
  s_waitcnt vmcnt(13)
  s_barrier
  s_waitcnt lgkmcnt(8)
  v_mfma_f32_16x16x32_bf16 v[96:99], a[160:163], a[16:19], v[96:99]
  ds_read_b64_tr_b16 a[192:193], v8 offset:49152
  s_add_u32 m0, s27, 122880
  v_mfma_f32_16x16x32_bf16 v[100:103], a[160:163], a[88:91], v[100:103]
  ds_read_b64_tr_b16 a[194:195], v8 offset:49664
  s_add_u32 s24, s24, 589824
  v_mfma_f32_16x16x32_bf16 v[104:107], a[164:167], a[16:19], v[104:107]
  ds_read_b64_tr_b16 a[196:197], v9 offset:49152
  buffer_load_dwordx4 v20, s[4:7], s24 offen lds
  v_mfma_f32_16x16x32_bf16 v[108:111], a[164:167], a[88:91], v[108:111]
  ds_read_b64_tr_b16 a[198:199], v9 offset:49664
  s_add_u32 m0, s27, 126976
  v_mfma_f32_16x16x32_bf16 v[112:115], a[168:171], a[16:19], v[112:115]
  ds_read_b64_tr_b16 a[144:145], v10 offset:49152
  buffer_load_dwordx4 v21, s[4:7], s24 offen lds
  v_mfma_f32_16x16x32_bf16 v[116:119], a[168:171], a[88:91], v[116:119]
  ds_read_b64_tr_b16 a[146:147], v10 offset:49664
  v_cvt_pk_bf16_f32 v167, v78, v79
  v_mfma_f32_16x16x32_bf16 v[120:123], a[172:175], a[16:19], v[120:123]
  ds_read_b64_tr_b16 a[148:149], v11 offset:49152
  v_pk_max_i16 v164, v164, 0
  v_mfma_f32_16x16x32_bf16 v[124:127], a[172:175], a[88:91], v[124:127]
  ds_read_b64_tr_b16 a[150:151], v11 offset:49664
  v_pk_max_i16 v165, v165, 0
  s_waitcnt lgkmcnt(8)
  v_mfma_f32_16x16x32_bf16 v[96:99], a[176:179], a[20:23], v[96:99]
  ds_read_b64_tr_b16 a[152:153], v8 offset:53248
  s_add_u32 m0, s27, 131072
  v_mfma_f32_16x16x32_bf16 v[100:103], a[176:179], a[92:95], v[100:103]
  ds_read_b64_tr_b16 a[154:155], v8 offset:53760
  s_add_u32 s24, s24, 589824
  v_mfma_f32_16x16x32_bf16 v[104:107], a[180:183], a[20:23], v[104:107]
  ds_read_b64_tr_b16 a[156:157], v9 offset:53248
  buffer_load_dwordx4 v20, s[4:7], s24 offen lds
  v_mfma_f32_16x16x32_bf16 v[108:111], a[180:183], a[92:95], v[108:111]
  ds_read_b64_tr_b16 a[158:159], v9 offset:53760
  s_add_u32 m0, s27, 135168
  v_mfma_f32_16x16x32_bf16 v[112:115], a[184:187], a[20:23], v[112:115]
  ds_read_b64_tr_b16 a[160:161], v10 offset:53248
  buffer_load_dwordx4 v21, s[4:7], s24 offen lds
  v_mfma_f32_16x16x32_bf16 v[116:119], a[184:187], a[92:95], v[116:119]
  ds_read_b64_tr_b16 a[162:163], v10 offset:53760
  v_pk_max_i16 v166, v166, 0
  v_mfma_f32_16x16x32_bf16 v[120:123], a[188:191], a[20:23], v[120:123]
  ds_read_b64_tr_b16 a[164:165], v11 offset:53248
  v_pk_max_i16 v167, v167, 0
  v_mfma_f32_16x16x32_bf16 v[124:127], a[188:191], a[92:95], v[124:127]
  ds_read_b64_tr_b16 a[166:167], v11 offset:53760
  buffer_store_dwordx4 v[164:167], v2, s[12:15], s30 offen offset:1024 sc0 sc1
  s_waitcnt lgkmcnt(8)
  v_mfma_f32_16x16x32_bf16 v[96:99], a[192:195], a[24:27], v[96:99]
  ds_read_b64_tr_b16 a[168:169], v8 offset:57344
  s_add_u32 m0, s27, 139264
  v_mfma_f32_16x16x32_bf16 v[100:103], a[192:195], a[96:99], v[100:103]
  ds_read_b64_tr_b16 a[170:171], v8 offset:57856
  s_add_u32 s24, s24, 589824
  v_mfma_f32_16x16x32_bf16 v[104:107], a[196:199], a[24:27], v[104:107]
  ds_read_b64_tr_b16 a[172:173], v9 offset:57344
  buffer_load_dwordx4 v20, s[4:7], s24 offen lds
  v_mfma_f32_16x16x32_bf16 v[108:111], a[196:199], a[96:99], v[108:111]
  ds_read_b64_tr_b16 a[174:175], v9 offset:57856
  v_cvt_pk_bf16_f32 v168, v80, v81
  v_mfma_f32_16x16x32_bf16 v[112:115], a[144:147], a[24:27], v[112:115]
  ds_read_b64_tr_b16 a[176:177], v10 offset:57344
  v_cvt_pk_bf16_f32 v169, v82, v83
  v_mfma_f32_16x16x32_bf16 v[116:119], a[144:147], a[96:99], v[116:119]
  ds_read_b64_tr_b16 a[178:179], v10 offset:57856
  v_cvt_pk_bf16_f32 v170, v88, v89
  v_mfma_f32_16x16x32_bf16 v[120:123], a[148:151], a[24:27], v[120:123]
  ds_read_b64_tr_b16 a[180:181], v11 offset:57344
  v_mfma_f32_16x16x32_bf16 v[124:127], a[148:151], a[96:99], v[124:127]
  ds_read_b64_tr_b16 a[182:183], v11 offset:57856
  s_waitcnt lgkmcnt(8)
  v_mfma_f32_16x16x32_bf16 v[96:99], a[152:155], a[28:31], v[96:99]
  ds_read_b64_tr_b16 a[184:185], v8 offset:61440
  s_add_u32 m0, s27, 143360
  v_mfma_f32_16x16x32_bf16 v[100:103], a[152:155], a[100:103], v[100:103]
  ds_read_b64_tr_b16 a[186:187], v8 offset:61952
  buffer_load_dwordx4 v21, s[4:7], s24 offen lds
  v_mfma_f32_16x16x32_bf16 v[104:107], a[156:159], a[28:31], v[104:107]
  ds_read_b64_tr_b16 a[188:189], v9 offset:61440
  v_mfma_f32_16x16x32_bf16 v[108:111], a[156:159], a[100:103], v[108:111]
  ds_read_b64_tr_b16 a[190:191], v9 offset:61952
  v_cvt_pk_bf16_f32 v171, v90, v91
  v_mfma_f32_16x16x32_bf16 v[112:115], a[160:163], a[28:31], v[112:115]
  ds_read_b64_tr_b16 a[192:193], v10 offset:61440
  v_pk_max_i16 v168, v168, 0
  v_mfma_f32_16x16x32_bf16 v[116:119], a[160:163], a[100:103], v[116:119]
  ds_read_b64_tr_b16 a[194:195], v10 offset:61952
  v_pk_max_i16 v169, v169, 0
  v_mfma_f32_16x16x32_bf16 v[120:123], a[164:167], a[28:31], v[120:123]
  ds_read_b64_tr_b16 a[196:197], v11 offset:61440
  v_mfma_f32_16x16x32_bf16 v[124:127], a[164:167], a[100:103], v[124:127]
  ds_read_b64_tr_b16 a[198:199], v11 offset:61952
  s_waitcnt lgkmcnt(8)
  v_mfma_f32_16x16x32_bf16 v[96:99], a[168:171], a[32:35], v[96:99]
  ds_read_b64_tr_b16 a[144:145], v12 offset:0
  s_add_u32 m0, s27, 0
  v_mfma_f32_16x16x32_bf16 v[100:103], a[168:171], a[104:107], v[100:103]
  ds_read_b64_tr_b16 a[146:147], v12 offset:512
  s_add_u32 s24, s24, 589824
  v_mfma_f32_16x16x32_bf16 v[104:107], a[172:175], a[32:35], v[104:107]
  ds_read_b64_tr_b16 a[148:149], v13 offset:0
  buffer_load_dwordx4 v20, s[4:7], s24 offen lds
  v_mfma_f32_16x16x32_bf16 v[108:111], a[172:175], a[104:107], v[108:111]
  ds_read_b64_tr_b16 a[150:151], v13 offset:512
  v_pk_max_i16 v170, v170, 0
  v_mfma_f32_16x16x32_bf16 v[112:115], a[176:179], a[32:35], v[112:115]
  ds_read_b64_tr_b16 a[152:153], v14 offset:0
  v_pk_max_i16 v171, v171, 0
  v_mfma_f32_16x16x32_bf16 v[116:119], a[176:179], a[104:107], v[116:119]
  ds_read_b64_tr_b16 a[154:155], v14 offset:512
  buffer_store_dwordx4 v[168:171], v2, s[12:15], s30 offen offset:2048 sc0 sc1
  v_mfma_f32_16x16x32_bf16 v[120:123], a[180:183], a[32:35], v[120:123]
  ds_read_b64_tr_b16 a[156:157], v15 offset:0
  v_mfma_f32_16x16x32_bf16 v[124:127], a[180:183], a[104:107], v[124:127]
  ds_read_b64_tr_b16 a[158:159], v15 offset:512
  s_waitcnt lgkmcnt(8)
  v_mfma_f32_16x16x32_bf16 v[96:99], a[184:187], a[36:39], v[96:99]
  ds_read_b64_tr_b16 a[160:161], v12 offset:4096
  s_add_u32 m0, s27, 4096
  v_mfma_f32_16x16x32_bf16 v[100:103], a[184:187], a[108:111], v[100:103]
  ds_read_b64_tr_b16 a[162:163], v12 offset:4608
  buffer_load_dwordx4 v21, s[4:7], s24 offen lds
  v_mfma_f32_16x16x32_bf16 v[104:107], a[188:191], a[36:39], v[104:107]
  ds_read_b64_tr_b16 a[164:165], v13 offset:4096
  v_mfma_f32_16x16x32_bf16 v[108:111], a[188:191], a[108:111], v[108:111]
  ds_read_b64_tr_b16 a[166:167], v13 offset:4608
  v_cvt_pk_bf16_f32 v172, v84, v85
  v_mfma_f32_16x16x32_bf16 v[112:115], a[192:195], a[36:39], v[112:115]
  ds_read_b64_tr_b16 a[168:169], v14 offset:4096
  v_cvt_pk_bf16_f32 v173, v86, v87
  v_mfma_f32_16x16x32_bf16 v[116:119], a[192:195], a[108:111], v[116:119]
  ds_read_b64_tr_b16 a[170:171], v14 offset:4608
  v_cvt_pk_bf16_f32 v174, v92, v93
  v_mfma_f32_16x16x32_bf16 v[120:123], a[196:199], a[36:39], v[120:123]
  ds_read_b64_tr_b16 a[172:173], v15 offset:4096
  v_mfma_f32_16x16x32_bf16 v[124:127], a[196:199], a[108:111], v[124:127]
  ds_read_b64_tr_b16 a[174:175], v15 offset:4608
  s_waitcnt vmcnt(17)
  s_barrier
  s_waitcnt lgkmcnt(8)
  v_mfma_f32_16x16x32_bf16 v[96:99], a[144:147], a[40:43], v[96:99]
  ds_read_b64_tr_b16 a[176:177], v12 offset:8192
  s_add_u32 m0, s27, 8192
  v_mfma_f32_16x16x32_bf16 v[100:103], a[144:147], a[112:115], v[100:103]
  ds_read_b64_tr_b16 a[178:179], v12 offset:8704
  s_add_u32 s24, s24, 589824
  v_mfma_f32_16x16x32_bf16 v[104:107], a[148:151], a[40:43], v[104:107]
  ds_read_b64_tr_b16 a[180:181], v13 offset:8192
  buffer_load_dwordx4 v20, s[4:7], s24 offen lds
  v_mfma_f32_16x16x32_bf16 v[108:111], a[148:151], a[112:115], v[108:111]
  ds_read_b64_tr_b16 a[182:183], v13 offset:8704
  v_cvt_pk_bf16_f32 v175, v94, v95
  v_mfma_f32_16x16x32_bf16 v[112:115], a[152:155], a[40:43], v[112:115]
  ds_read_b64_tr_b16 a[184:185], v14 offset:8192
  v_pk_max_i16 v172, v172, 0
  v_mfma_f32_16x16x32_bf16 v[116:119], a[152:155], a[112:115], v[116:119]
  ds_read_b64_tr_b16 a[186:187], v14 offset:8704
  v_pk_max_i16 v173, v173, 0
  v_mfma_f32_16x16x32_bf16 v[120:123], a[156:159], a[40:43], v[120:123]
  ds_read_b64_tr_b16 a[188:189], v15 offset:8192
  v_mfma_f32_16x16x32_bf16 v[124:127], a[156:159], a[112:115], v[124:127]
  ds_read_b64_tr_b16 a[190:191], v15 offset:8704
  s_waitcnt lgkmcnt(8)
  v_mfma_f32_16x16x32_bf16 v[96:99], a[160:163], a[44:47], v[96:99]
  ds_read_b64_tr_b16 a[192:193], v12 offset:12288
  s_add_u32 m0, s27, 12288
  v_mfma_f32_16x16x32_bf16 v[100:103], a[160:163], a[116:119], v[100:103]
  ds_read_b64_tr_b16 a[194:195], v12 offset:12800
  buffer_load_dwordx4 v21, s[4:7], s24 offen lds
  v_mfma_f32_16x16x32_bf16 v[104:107], a[164:167], a[44:47], v[104:107]
  ds_read_b64_tr_b16 a[196:197], v13 offset:12288
  v_pk_max_i16 v174, v174, 0
  v_mfma_f32_16x16x32_bf16 v[108:111], a[164:167], a[116:119], v[108:111]
  ds_read_b64_tr_b16 a[198:199], v13 offset:12800
  v_pk_max_i16 v175, v175, 0
  v_mfma_f32_16x16x32_bf16 v[112:115], a[168:171], a[44:47], v[112:115]
  ds_read_b64_tr_b16 a[144:145], v14 offset:12288
  buffer_store_dwordx4 v[172:175], v2, s[12:15], s30 offen offset:3072 sc0 sc1
  v_mfma_f32_16x16x32_bf16 v[116:119], a[168:171], a[116:119], v[116:119]
  ds_read_b64_tr_b16 a[146:147], v14 offset:12800
  s_add_u32 s30, s30, 4096
  v_mfma_f32_16x16x32_bf16 v[120:123], a[172:175], a[44:47], v[120:123]
  ds_read_b64_tr_b16 a[148:149], v15 offset:12288
  v_mfma_f32_16x16x32_bf16 v[124:127], a[172:175], a[116:119], v[124:127]
  ds_read_b64_tr_b16 a[150:151], v15 offset:12800
  s_waitcnt lgkmcnt(8)
  v_mfma_f32_16x16x32_bf16 v[96:99], a[176:179], a[48:51], v[96:99]
  ds_read_b64_tr_b16 a[152:153], v12 offset:16384
  v_lshl_add_u32 v4, s35, 10, v3
  v_mfma_f32_16x16x32_bf16 v[100:103], a[176:179], a[120:123], v[100:103]
  ds_read_b64_tr_b16 a[154:155], v12 offset:16896
  s_add_u32 m0, s27, 16384
  v_mfma_f32_16x16x32_bf16 v[104:107], a[180:183], a[48:51], v[104:107]
  ds_read_b64_tr_b16 a[156:157], v13 offset:16384
  v_mfma_f32_16x16x32_bf16 v[108:111], a[180:183], a[120:123], v[108:111]
  ds_read_b64_tr_b16 a[158:159], v13 offset:16896
  s_add_u32 s24, s24, 589824
  v_mfma_f32_16x16x32_bf16 v[112:115], a[184:187], a[48:51], v[112:115]
  ds_read_b64_tr_b16 a[160:161], v14 offset:16384
  v_mfma_f32_16x16x32_bf16 v[116:119], a[184:187], a[120:123], v[116:119]
  ds_read_b64_tr_b16 a[162:163], v14 offset:16896
  buffer_load_dwordx4 v20, s[4:7], s24 offen lds
  v_mfma_f32_16x16x32_bf16 v[120:123], a[188:191], a[48:51], v[120:123]
  ds_read_b64_tr_b16 a[164:165], v15 offset:16384
  v_mfma_f32_16x16x32_bf16 v[124:127], a[188:191], a[120:123], v[124:127]
  ds_read_b64_tr_b16 a[166:167], v15 offset:16896
  s_waitcnt lgkmcnt(8)
  v_mfma_f32_16x16x32_bf16 v[96:99], a[192:195], a[52:55], v[96:99]
  ds_read_b64_tr_b16 a[168:169], v12 offset:20480
  v_mfma_f32_16x16x32_bf16 v[100:103], a[192:195], a[124:127], v[100:103]
  ds_read_b64_tr_b16 a[170:171], v12 offset:20992
  ds_read_b128 a[200:203], v4 offset:0
  v_mfma_f32_16x16x32_bf16 v[104:107], a[196:199], a[52:55], v[104:107]
  ds_read_b64_tr_b16 a[172:173], v13 offset:20480
  v_mfma_f32_16x16x32_bf16 v[108:111], a[196:199], a[124:127], v[108:111]
  ds_read_b64_tr_b16 a[174:175], v13 offset:20992
  s_add_u32 m0, s27, 20480
  v_mfma_f32_16x16x32_bf16 v[112:115], a[144:147], a[52:55], v[112:115]
  ds_read_b64_tr_b16 a[176:177], v14 offset:20480
  v_mfma_f32_16x16x32_bf16 v[116:119], a[144:147], a[124:127], v[116:119]
  ds_read_b64_tr_b16 a[178:179], v14 offset:20992
  buffer_load_dwordx4 v21, s[4:7], s24 offen lds
  v_mfma_f32_16x16x32_bf16 v[120:123], a[148:151], a[52:55], v[120:123]
  ds_read_b64_tr_b16 a[180:181], v15 offset:20480
  v_mfma_f32_16x16x32_bf16 v[124:127], a[148:151], a[124:127], v[124:127]
  ds_read_b64_tr_b16 a[182:183], v15 offset:20992
  s_waitcnt lgkmcnt(9)
  v_mfma_f32_16x16x32_bf16 v[96:99], a[152:155], a[56:59], v[96:99]
  ds_read_b64_tr_b16 a[184:185], v12 offset:24576
  ds_read_b128 a[204:207], v4 offset:256
  v_mfma_f32_16x16x32_bf16 v[100:103], a[152:155], a[128:131], v[100:103]
  ds_read_b64_tr_b16 a[186:187], v12 offset:25088
  s_add_u32 m0, s27, 24576
  v_mfma_f32_16x16x32_bf16 v[104:107], a[156:159], a[56:59], v[104:107]
  ds_read_b64_tr_b16 a[188:189], v13 offset:24576
  v_mfma_f32_16x16x32_bf16 v[108:111], a[156:159], a[128:131], v[108:111]
  ds_read_b64_tr_b16 a[190:191], v13 offset:25088
  s_lshl_b32 s24, s37, 7
  v_mfma_f32_16x16x32_bf16 v[112:115], a[160:163], a[56:59], v[112:115]
  ds_read_b64_tr_b16 a[192:193], v14 offset:24576
  v_mfma_f32_16x16x32_bf16 v[116:119], a[160:163], a[128:131], v[116:119]
  ds_read_b64_tr_b16 a[194:195], v14 offset:25088
  buffer_load_dwordx4 v20, s[4:7], s24 offen lds
  v_mfma_f32_16x16x32_bf16 v[120:123], a[164:167], a[56:59], v[120:123]
  ds_read_b64_tr_b16 a[196:197], v15 offset:24576
  v_mfma_f32_16x16x32_bf16 v[124:127], a[164:167], a[128:131], v[124:127]
  ds_read_b64_tr_b16 a[198:199], v15 offset:25088
  s_waitcnt lgkmcnt(9)
  v_mfma_f32_16x16x32_bf16 v[96:99], a[168:171], a[60:63], v[96:99]
  ds_read_b64_tr_b16 a[144:145], v12 offset:28672
  v_mfma_f32_16x16x32_bf16 v[100:103], a[168:171], a[132:135], v[100:103]
  ds_read_b64_tr_b16 a[146:147], v12 offset:29184
  ds_read_b128 a[208:211], v4 offset:512
  v_mfma_f32_16x16x32_bf16 v[104:107], a[172:175], a[60:63], v[104:107]
  ds_read_b64_tr_b16 a[148:149], v13 offset:28672
  v_mfma_f32_16x16x32_bf16 v[108:111], a[172:175], a[132:135], v[108:111]
  ds_read_b64_tr_b16 a[150:151], v13 offset:29184
  s_add_u32 m0, s27, 28672
  v_mfma_f32_16x16x32_bf16 v[112:115], a[176:179], a[60:63], v[112:115]
  ds_read_b64_tr_b16 a[152:153], v14 offset:28672
  v_mfma_f32_16x16x32_bf16 v[116:119], a[176:179], a[132:135], v[116:119]
  ds_read_b64_tr_b16 a[154:155], v14 offset:29184
  buffer_load_dwordx4 v21, s[4:7], s24 offen lds
  v_mfma_f32_16x16x32_bf16 v[120:123], a[180:183], a[60:63], v[120:123]
  ds_read_b64_tr_b16 a[156:157], v15 offset:28672
  v_mfma_f32_16x16x32_bf16 v[124:127], a[180:183], a[132:135], v[124:127]
  ds_read_b64_tr_b16 a[158:159], v15 offset:29184
  s_waitcnt vmcnt(17)
  s_barrier
  s_waitcnt lgkmcnt(9)
  v_mfma_f32_16x16x32_bf16 v[96:99], a[184:187], a[64:67], v[96:99]
  ds_read_b64_tr_b16 a[160:161], v12 offset:32768
  ds_read_b128 a[212:215], v4 offset:768
  v_mfma_f32_16x16x32_bf16 v[100:103], a[184:187], a[136:139], v[100:103]
  ds_read_b64_tr_b16 a[162:163], v12 offset:33280
  s_add_u32 m0, s27, 32768
  v_mfma_f32_16x16x32_bf16 v[104:107], a[188:191], a[64:67], v[104:107]
  ds_read_b64_tr_b16 a[164:165], v13 offset:32768
  v_mfma_f32_16x16x32_bf16 v[108:111], a[188:191], a[136:139], v[108:111]
  ds_read_b64_tr_b16 a[166:167], v13 offset:33280
  s_add_u32 s24, s24, 589824
  v_mfma_f32_16x16x32_bf16 v[112:115], a[192:195], a[64:67], v[112:115]
  ds_read_b64_tr_b16 a[168:169], v14 offset:32768
  v_mfma_f32_16x16x32_bf16 v[116:119], a[192:195], a[136:139], v[116:119]
  ds_read_b64_tr_b16 a[170:171], v14 offset:33280
  buffer_load_dwordx4 v20, s[4:7], s24 offen lds
  v_mfma_f32_16x16x32_bf16 v[120:123], a[196:199], a[64:67], v[120:123]
  ds_read_b64_tr_b16 a[172:173], v15 offset:32768
  v_mfma_f32_16x16x32_bf16 v[124:127], a[196:199], a[136:139], v[124:127]
  ds_read_b64_tr_b16 a[174:175], v15 offset:33280
  s_waitcnt lgkmcnt(9)
  v_mfma_f32_16x16x32_bf16 v[96:99], a[144:147], a[68:71], v[96:99]
  ds_read_b64_tr_b16 a[176:177], v12 offset:36864
  v_mfma_f32_16x16x32_bf16 v[100:103], a[144:147], a[140:143], v[100:103]
  ds_read_b64_tr_b16 a[178:179], v12 offset:37376
  s_add_u32 m0, s27, 36864
  v_mfma_f32_16x16x32_bf16 v[104:107], a[148:151], a[68:71], v[104:107]
  ds_read_b64_tr_b16 a[180:181], v13 offset:36864
  v_mfma_f32_16x16x32_bf16 v[108:111], a[148:151], a[140:143], v[108:111]
  ds_read_b64_tr_b16 a[182:183], v13 offset:37376
  v_mfma_f32_16x16x32_bf16 v[112:115], a[152:155], a[68:71], v[112:115]
  ds_read_b64_tr_b16 a[184:185], v14 offset:36864
  v_mfma_f32_16x16x32_bf16 v[116:119], a[152:155], a[140:143], v[116:119]
  ds_read_b64_tr_b16 a[186:187], v14 offset:37376
  buffer_load_dwordx4 v21, s[4:7], s24 offen lds
  v_mfma_f32_16x16x32_bf16 v[120:123], a[156:159], a[68:71], v[120:123]
  ds_read_b64_tr_b16 a[188:189], v15 offset:36864
  v_mfma_f32_16x16x32_bf16 v[124:127], a[156:159], a[140:143], v[124:127]
  ds_read_b64_tr_b16 a[190:191], v15 offset:37376
  v_mfma_f32_16x16x32_bf16 v[96:99], a[200:203], v[24:27], v[96:99]
  v_mfma_f32_16x16x32_bf16 v[100:103], a[200:203], v[28:31], v[100:103]
  v_mfma_f32_16x16x32_bf16 v[104:107], a[204:207], v[24:27], v[104:107]
  v_mfma_f32_16x16x32_bf16 v[108:111], a[204:207], v[28:31], v[108:111]
  v_mfma_f32_16x16x32_bf16 v[112:115], a[208:211], v[24:27], v[112:115]
  v_mfma_f32_16x16x32_bf16 v[116:119], a[208:211], v[28:31], v[116:119]
  s_waitcnt lgkmcnt(14)
  v_mfma_f32_16x16x32_bf16 v[120:123], a[212:215], v[24:27], v[120:123]
  v_mfma_f32_16x16x32_bf16 v[124:127], a[212:215], v[28:31], v[124:127]
  s_waitcnt lgkmcnt(8)
  v_mfma_f32_16x16x32_bf16 v[128:131], a[160:163], a[0:3], 0
  ds_read_b64_tr_b16 a[192:193], v12 offset:40960
  s_add_u32 m0, s27, 40960
  v_mfma_f32_16x16x32_bf16 v[132:135], a[160:163], a[72:75], 0
  ds_read_b64_tr_b16 a[194:195], v12 offset:41472
  s_add_u32 s24, s24, 589824
  v_mfma_f32_16x16x32_bf16 v[136:139], a[164:167], a[0:3], 0
  ds_read_b64_tr_b16 a[196:197], v13 offset:40960
  buffer_load_dwordx4 v20, s[4:7], s24 offen lds
  v_mfma_f32_16x16x32_bf16 v[140:143], a[164:167], a[72:75], 0
  ds_read_b64_tr_b16 a[198:199], v13 offset:41472
  v_cvt_pk_bf16_f32 v176, v96, v97
  v_mfma_f32_16x16x32_bf16 v[144:147], a[168:171], a[0:3], 0
  ds_read_b64_tr_b16 a[144:145], v14 offset:40960
  v_cvt_pk_bf16_f32 v177, v98, v99
  v_mfma_f32_16x16x32_bf16 v[148:151], a[168:171], a[72:75], 0
  ds_read_b64_tr_b16 a[146:147], v14 offset:41472
  v_cvt_pk_bf16_f32 v178, v104, v105
  v_mfma_f32_16x16x32_bf16 v[152:155], a[172:175], a[0:3], 0
  ds_read_b64_tr_b16 a[148:149], v15 offset:40960
  v_mfma_f32_16x16x32_bf16 v[156:159], a[172:175], a[72:75], 0
  ds_read_b64_tr_b16 a[150:151], v15 offset:41472
  s_waitcnt lgkmcnt(8)
  v_mfma_f32_16x16x32_bf16 v[128:131], a[176:179], a[4:7], v[128:131]
  ds_read_b64_tr_b16 a[152:153], v12 offset:45056
  s_add_u32 m0, s27, 45056
  v_mfma_f32_16x16x32_bf16 v[132:135], a[176:179], a[76:79], v[132:135]
  ds_read_b64_tr_b16 a[154:155], v12 offset:45568
  buffer_load_dwordx4 v21, s[4:7], s24 offen lds
  v_mfma_f32_16x16x32_bf16 v[136:139], a[180:183], a[4:7], v[136:139]
  ds_read_b64_tr_b16 a[156:157], v13 offset:45056
  v_mfma_f32_16x16x32_bf16 v[140:143], a[180:183], a[76:79], v[140:143]
  ds_read_b64_tr_b16 a[158:159], v13 offset:45568
  v_cvt_pk_bf16_f32 v179, v106, v107
  v_mfma_f32_16x16x32_bf16 v[144:147], a[184:187], a[4:7], v[144:147]
  ds_read_b64_tr_b16 a[160:161], v14 offset:45056
  v_pk_max_i16 v176, v176, 0
  v_mfma_f32_16x16x32_bf16 v[148:151], a[184:187], a[76:79], v[148:151]
  ds_read_b64_tr_b16 a[162:163], v14 offset:45568
  v_pk_max_i16 v177, v177, 0
  v_mfma_f32_16x16x32_bf16 v[152:155], a[188:191], a[4:7], v[152:155]
  ds_read_b64_tr_b16 a[164:165], v15 offset:45056
  v_mfma_f32_16x16x32_bf16 v[156:159], a[188:191], a[76:79], v[156:159]
  ds_read_b64_tr_b16 a[166:167], v15 offset:45568
  s_waitcnt lgkmcnt(8)
  v_mfma_f32_16x16x32_bf16 v[128:131], a[192:195], a[8:11], v[128:131]
  ds_read_b64_tr_b16 a[168:169], v12 offset:49152
  s_add_u32 m0, s27, 49152
  v_mfma_f32_16x16x32_bf16 v[132:135], a[192:195], a[80:83], v[132:135]
  ds_read_b64_tr_b16 a[170:171], v12 offset:49664
  s_add_u32 s24, s24, 589824
  v_mfma_f32_16x16x32_bf16 v[136:139], a[196:199], a[8:11], v[136:139]
  ds_read_b64_tr_b16 a[172:173], v13 offset:49152
  buffer_load_dwordx4 v20, s[4:7], s24 offen lds
  v_mfma_f32_16x16x32_bf16 v[140:143], a[196:199], a[80:83], v[140:143]
  ds_read_b64_tr_b16 a[174:175], v13 offset:49664
  v_pk_max_i16 v178, v178, 0
  v_mfma_f32_16x16x32_bf16 v[144:147], a[144:147], a[8:11], v[144:147]
  ds_read_b64_tr_b16 a[176:177], v14 offset:49152
  v_pk_max_i16 v179, v179, 0
  v_mfma_f32_16x16x32_bf16 v[148:151], a[144:147], a[80:83], v[148:151]
  ds_read_b64_tr_b16 a[178:179], v14 offset:49664
  buffer_store_dwordx4 v[176:179], v2, s[12:15], s30 offen offset:0 sc0 sc1
  v_mfma_f32_16x16x32_bf16 v[152:155], a[148:151], a[8:11], v[152:155]
  ds_read_b64_tr_b16 a[180:181], v15 offset:49152
  v_mfma_f32_16x16x32_bf16 v[156:159], a[148:151], a[80:83], v[156:159]
  ds_read_b64_tr_b16 a[182:183], v15 offset:49664
  s_waitcnt lgkmcnt(8)
  v_mfma_f32_16x16x32_bf16 v[128:131], a[152:155], a[12:15], v[128:131]
  ds_read_b64_tr_b16 a[184:185], v12 offset:53248
  s_add_u32 m0, s27, 53248
  v_mfma_f32_16x16x32_bf16 v[132:135], a[152:155], a[84:87], v[132:135]
  ds_read_b64_tr_b16 a[186:187], v12 offset:53760
  buffer_load_dwordx4 v21, s[4:7], s24 offen lds
  v_mfma_f32_16x16x32_bf16 v[136:139], a[156:159], a[12:15], v[136:139]
  ds_read_b64_tr_b16 a[188:189], v13 offset:53248
  v_mfma_f32_16x16x32_bf16 v[140:143], a[156:159], a[84:87], v[140:143]
  ds_read_b64_tr_b16 a[190:191], v13 offset:53760
  v_cvt_pk_bf16_f32 v180, v100, v101
  v_mfma_f32_16x16x32_bf16 v[144:147], a[160:163], a[12:15], v[144:147]
  ds_read_b64_tr_b16 a[192:193], v14 offset:53248
  v_cvt_pk_bf16_f32 v181, v102, v103
  v_mfma_f32_16x16x32_bf16 v[148:151], a[160:163], a[84:87], v[148:151]
  ds_read_b64_tr_b16 a[194:195], v14 offset:53760
  v_cvt_pk_bf16_f32 v182, v108, v109
  v_mfma_f32_16x16x32_bf16 v[152:155], a[164:167], a[12:15], v[152:155]
  ds_read_b64_tr_b16 a[196:197], v15 offset:53248
  v_mfma_f32_16x16x32_bf16 v[156:159], a[164:167], a[84:87], v[156:159]
  ds_read_b64_tr_b16 a[198:199], v15 offset:53760
  s_waitcnt vmcnt(17)
  s_barrier
  s_waitcnt lgkmcnt(8)
  v_mfma_f32_16x16x32_bf16 v[128:131], a[168:171], a[16:19], v[128:131]
  ds_read_b64_tr_b16 a[144:145], v12 offset:57344
  s_add_u32 m0, s27, 57344
  v_mfma_f32_16x16x32_bf16 v[132:135], a[168:171], a[88:91], v[132:135]
  ds_read_b64_tr_b16 a[146:147], v12 offset:57856
  s_add_u32 s24, s24, 589824
  v_mfma_f32_16x16x32_bf16 v[136:139], a[172:175], a[16:19], v[136:139]
  ds_read_b64_tr_b16 a[148:149], v13 offset:57344
  buffer_load_dwordx4 v20, s[4:7], s24 offen lds
  v_mfma_f32_16x16x32_bf16 v[140:143], a[172:175], a[88:91], v[140:143]
  ds_read_b64_tr_b16 a[150:151], v13 offset:57856
  v_cvt_pk_bf16_f32 v183, v110, v111
  v_mfma_f32_16x16x32_bf16 v[144:147], a[176:179], a[16:19], v[144:147]
  ds_read_b64_tr_b16 a[152:153], v14 offset:57344
  v_pk_max_i16 v180, v180, 0
  v_mfma_f32_16x16x32_bf16 v[148:151], a[176:179], a[88:91], v[148:151]
  ds_read_b64_tr_b16 a[154:155], v14 offset:57856
  v_pk_max_i16 v181, v181, 0
  v_mfma_f32_16x16x32_bf16 v[152:155], a[180:183], a[16:19], v[152:155]
  ds_read_b64_tr_b16 a[156:157], v15 offset:57344
  v_mfma_f32_16x16x32_bf16 v[156:159], a[180:183], a[88:91], v[156:159]
  ds_read_b64_tr_b16 a[158:159], v15 offset:57856
  s_waitcnt lgkmcnt(8)
  v_mfma_f32_16x16x32_bf16 v[128:131], a[184:187], a[20:23], v[128:131]
  ds_read_b64_tr_b16 a[160:161], v12 offset:61440
  s_add_u32 m0, s27, 61440
  v_mfma_f32_16x16x32_bf16 v[132:135], a[184:187], a[92:95], v[132:135]
  ds_read_b64_tr_b16 a[162:163], v12 offset:61952
  buffer_load_dwordx4 v21, s[4:7], s24 offen lds
  v_mfma_f32_16x16x32_bf16 v[136:139], a[188:191], a[20:23], v[136:139]
  ds_read_b64_tr_b16 a[164:165], v13 offset:61440
  v_mfma_f32_16x16x32_bf16 v[140:143], a[188:191], a[92:95], v[140:143]
  ds_read_b64_tr_b16 a[166:167], v13 offset:61952
  v_pk_max_i16 v182, v182, 0
  v_mfma_f32_16x16x32_bf16 v[144:147], a[192:195], a[20:23], v[144:147]
  ds_read_b64_tr_b16 a[168:169], v14 offset:61440
  v_pk_max_i16 v183, v183, 0
  v_mfma_f32_16x16x32_bf16 v[148:151], a[192:195], a[92:95], v[148:151]
  ds_read_b64_tr_b16 a[170:171], v14 offset:61952
  buffer_store_dwordx4 v[180:183], v2, s[12:15], s30 offen offset:1024 sc0 sc1
  v_mfma_f32_16x16x32_bf16 v[152:155], a[196:199], a[20:23], v[152:155]
  ds_read_b64_tr_b16 a[172:173], v15 offset:61440
  v_mfma_f32_16x16x32_bf16 v[156:159], a[196:199], a[92:95], v[156:159]
  ds_read_b64_tr_b16 a[174:175], v15 offset:61952
  s_waitcnt lgkmcnt(8)
  v_mfma_f32_16x16x32_bf16 v[128:131], a[144:147], a[24:27], v[128:131]
  ds_read_b64_tr_b16 a[176:177], v16 offset:0
  s_add_u32 m0, s27, 65536
  v_mfma_f32_16x16x32_bf16 v[132:135], a[144:147], a[96:99], v[132:135]
  ds_read_b64_tr_b16 a[178:179], v16 offset:512
  s_add_u32 s24, s24, 589824
  v_mfma_f32_16x16x32_bf16 v[136:139], a[148:151], a[24:27], v[136:139]
  ds_read_b64_tr_b16 a[180:181], v17 offset:0
  buffer_load_dwordx4 v20, s[4:7], s24 offen lds
  v_mfma_f32_16x16x32_bf16 v[140:143], a[148:151], a[96:99], v[140:143]
  ds_read_b64_tr_b16 a[182:183], v17 offset:512
  v_cvt_pk_bf16_f32 v184, v112, v113
  v_mfma_f32_16x16x32_bf16 v[144:147], a[152:155], a[24:27], v[144:147]
  ds_read_b64_tr_b16 a[184:185], v18 offset:0
  v_cvt_pk_bf16_f32 v185, v114, v115
  v_mfma_f32_16x16x32_bf16 v[148:151], a[152:155], a[96:99], v[148:151]
  ds_read_b64_tr_b16 a[186:187], v18 offset:512
  v_cvt_pk_bf16_f32 v186, v120, v121
  v_mfma_f32_16x16x32_bf16 v[152:155], a[156:159], a[24:27], v[152:155]
  ds_read_b64_tr_b16 a[188:189], v19 offset:0
  v_mfma_f32_16x16x32_bf16 v[156:159], a[156:159], a[96:99], v[156:159]
  ds_read_b64_tr_b16 a[190:191], v19 offset:512
  s_waitcnt lgkmcnt(8)
  v_mfma_f32_16x16x32_bf16 v[128:131], a[160:163], a[28:31], v[128:131]
  ds_read_b64_tr_b16 a[192:193], v16 offset:4096
  s_add_u32 m0, s27, 69632
  v_mfma_f32_16x16x32_bf16 v[132:135], a[160:163], a[100:103], v[132:135]
  ds_read_b64_tr_b16 a[194:195], v16 offset:4608
  buffer_load_dwordx4 v21, s[4:7], s24 offen lds
  v_mfma_f32_16x16x32_bf16 v[136:139], a[164:167], a[28:31], v[136:139]
  ds_read_b64_tr_b16 a[196:197], v17 offset:4096
  v_mfma_f32_16x16x32_bf16 v[140:143], a[164:167], a[100:103], v[140:143]
  ds_read_b64_tr_b16 a[198:199], v17 offset:4608
  v_cvt_pk_bf16_f32 v187, v122, v123
  v_mfma_f32_16x16x32_bf16 v[144:147], a[168:171], a[28:31], v[144:147]
  ds_read_b64_tr_b16 a[144:145], v18 offset:4096
  v_pk_max_i16 v184, v184, 0
  v_mfma_f32_16x16x32_bf16 v[148:151], a[168:171], a[100:103], v[148:151]
  ds_read_b64_tr_b16 a[146:147], v18 offset:4608
  v_pk_max_i16 v185, v185, 0
  v_mfma_f32_16x16x32_bf16 v[152:155], a[172:175], a[28:31], v[152:155]
  ds_read_b64_tr_b16 a[148:149], v19 offset:4096
  v_mfma_f32_16x16x32_bf16 v[156:159], a[172:175], a[100:103], v[156:159]
  ds_read_b64_tr_b16 a[150:151], v19 offset:4608
  s_waitcnt lgkmcnt(8)
  v_mfma_f32_16x16x32_bf16 v[128:131], a[176:179], a[32:35], v[128:131]
  ds_read_b64_tr_b16 a[152:153], v16 offset:8192
  s_add_u32 m0, s27, 73728
  v_mfma_f32_16x16x32_bf16 v[132:135], a[176:179], a[104:107], v[132:135]
  ds_read_b64_tr_b16 a[154:155], v16 offset:8704
  s_add_u32 s24, s24, 589824
  v_mfma_f32_16x16x32_bf16 v[136:139], a[180:183], a[32:35], v[136:139]
  ds_read_b64_tr_b16 a[156:157], v17 offset:8192
  buffer_load_dwordx4 v20, s[4:7], s24 offen lds
  v_mfma_f32_16x16x32_bf16 v[140:143], a[180:183], a[104:107], v[140:143]
  ds_read_b64_tr_b16 a[158:159], v17 offset:8704
  v_pk_max_i16 v186, v186, 0
  v_mfma_f32_16x16x32_bf16 v[144:147], a[184:187], a[32:35], v[144:147]
  ds_read_b64_tr_b16 a[160:161], v18 offset:8192
  v_pk_max_i16 v187, v187, 0
  v_mfma_f32_16x16x32_bf16 v[148:151], a[184:187], a[104:107], v[148:151]
  ds_read_b64_tr_b16 a[162:163], v18 offset:8704
  buffer_store_dwordx4 v[184:187], v2, s[12:15], s30 offen offset:2048 sc0 sc1
  v_mfma_f32_16x16x32_bf16 v[152:155], a[188:191], a[32:35], v[152:155]
  ds_read_b64_tr_b16 a[164:165], v19 offset:8192
  v_mfma_f32_16x16x32_bf16 v[156:159], a[188:191], a[104:107], v[156:159]
  ds_read_b64_tr_b16 a[166:167], v19 offset:8704
  s_waitcnt lgkmcnt(8)
  v_mfma_f32_16x16x32_bf16 v[128:131], a[192:195], a[36:39], v[128:131]
  ds_read_b64_tr_b16 a[168:169], v16 offset:12288
  s_add_u32 m0, s27, 77824
  v_mfma_f32_16x16x32_bf16 v[132:135], a[192:195], a[108:111], v[132:135]
  ds_read_b64_tr_b16 a[170:171], v16 offset:12800
  buffer_load_dwordx4 v21, s[4:7], s24 offen lds
  v_mfma_f32_16x16x32_bf16 v[136:139], a[196:199], a[36:39], v[136:139]
  ds_read_b64_tr_b16 a[172:173], v17 offset:12288
  v_mfma_f32_16x16x32_bf16 v[140:143], a[196:199], a[108:111], v[140:143]
  ds_read_b64_tr_b16 a[174:175], v17 offset:12800
  v_cvt_pk_bf16_f32 v188, v116, v117
  v_mfma_f32_16x16x32_bf16 v[144:147], a[144:147], a[36:39], v[144:147]
  ds_read_b64_tr_b16 a[176:177], v18 offset:12288
  v_cvt_pk_bf16_f32 v189, v118, v119
  v_mfma_f32_16x16x32_bf16 v[148:151], a[144:147], a[108:111], v[148:151]
  ds_read_b64_tr_b16 a[178:179], v18 offset:12800
  v_cvt_pk_bf16_f32 v190, v124, v125
  v_mfma_f32_16x16x32_bf16 v[152:155], a[148:151], a[36:39], v[152:155]
  ds_read_b64_tr_b16 a[180:181], v19 offset:12288
  v_mfma_f32_16x16x32_bf16 v[156:159], a[148:151], a[108:111], v[156:159]
  ds_read_b64_tr_b16 a[182:183], v19 offset:12800
  s_waitcnt vmcnt(17)
  s_barrier
  s_waitcnt lgkmcnt(8)
  v_mfma_f32_16x16x32_bf16 v[128:131], a[152:155], a[40:43], v[128:131]
  ds_read_b64_tr_b16 a[184:185], v8 offset:0
  s_add_u32 m0, s27, 81920
  v_mfma_f32_16x16x32_bf16 v[132:135], a[152:155], a[112:115], v[132:135]
  ds_read_b64_tr_b16 a[186:187], v8 offset:512
  s_add_u32 s24, s24, 589824
  v_mfma_f32_16x16x32_bf16 v[136:139], a[156:159], a[40:43], v[136:139]
  ds_read_b64_tr_b16 a[188:189], v9 offset:0
  buffer_load_dwordx4 v20, s[4:7], s24 offen lds
  v_mfma_f32_16x16x32_bf16 v[140:143], a[156:159], a[112:115], v[140:143]
  ds_read_b64_tr_b16 a[190:191], v9 offset:512
  v_cvt_pk_bf16_f32 v191, v126, v127
  v_mfma_f32_16x16x32_bf16 v[144:147], a[160:163], a[40:43], v[144:147]
  ds_read_b64_tr_b16 a[192:193], v10 offset:0
  v_pk_max_i16 v188, v188, 0
  v_mfma_f32_16x16x32_bf16 v[148:151], a[160:163], a[112:115], v[148:151]
  ds_read_b64_tr_b16 a[194:195], v10 offset:512
  v_pk_max_i16 v189, v189, 0
  v_mfma_f32_16x16x32_bf16 v[152:155], a[164:167], a[40:43], v[152:155]
  ds_read_b64_tr_b16 a[196:197], v11 offset:0
  v_mfma_f32_16x16x32_bf16 v[156:159], a[164:167], a[112:115], v[156:159]
  ds_read_b64_tr_b16 a[198:199], v11 offset:512
  s_waitcnt lgkmcnt(8)
  v_mfma_f32_16x16x32_bf16 v[128:131], a[168:171], a[44:47], v[128:131]
  ds_read_b64_tr_b16 a[144:145], v8 offset:4096
  s_add_u32 m0, s27, 86016
  v_mfma_f32_16x16x32_bf16 v[132:135], a[168:171], a[116:119], v[132:135]
  ds_read_b64_tr_b16 a[146:147], v8 offset:4608
  buffer_load_dwordx4 v21, s[4:7], s24 offen lds
  v_mfma_f32_16x16x32_bf16 v[136:139], a[172:175], a[44:47], v[136:139]
  ds_read_b64_tr_b16 a[148:149], v9 offset:4096
  v_pk_max_i16 v190, v190, 0
  v_mfma_f32_16x16x32_bf16 v[140:143], a[172:175], a[116:119], v[140:143]
  ds_read_b64_tr_b16 a[150:151], v9 offset:4608
  v_pk_max_i16 v191, v191, 0
  v_mfma_f32_16x16x32_bf16 v[144:147], a[176:179], a[44:47], v[144:147]
  ds_read_b64_tr_b16 a[152:153], v10 offset:4096
  buffer_store_dwordx4 v[188:191], v2, s[12:15], s30 offen offset:3072 sc0 sc1
  v_mfma_f32_16x16x32_bf16 v[148:151], a[176:179], a[116:119], v[148:151]
  ds_read_b64_tr_b16 a[154:155], v10 offset:4608
  s_add_u32 s30, s30, 4096
  v_mfma_f32_16x16x32_bf16 v[152:155], a[180:183], a[44:47], v[152:155]
  ds_read_b64_tr_b16 a[156:157], v11 offset:4096
  v_mfma_f32_16x16x32_bf16 v[156:159], a[180:183], a[116:119], v[156:159]
  ds_read_b64_tr_b16 a[158:159], v11 offset:4608
  s_waitcnt lgkmcnt(8)
  v_mfma_f32_16x16x32_bf16 v[128:131], a[184:187], a[48:51], v[128:131]
  ds_read_b64_tr_b16 a[160:161], v8 offset:8192
  v_lshl_add_u32 v4, s36, 10, v3
  v_mfma_f32_16x16x32_bf16 v[132:135], a[184:187], a[120:123], v[132:135]
  ds_read_b64_tr_b16 a[162:163], v8 offset:8704
  s_add_u32 m0, s27, 90112
  v_mfma_f32_16x16x32_bf16 v[136:139], a[188:191], a[48:51], v[136:139]
  ds_read_b64_tr_b16 a[164:165], v9 offset:8192
  v_mfma_f32_16x16x32_bf16 v[140:143], a[188:191], a[120:123], v[140:143]
  ds_read_b64_tr_b16 a[166:167], v9 offset:8704
  s_add_u32 s24, s24, 589824
  v_mfma_f32_16x16x32_bf16 v[144:147], a[192:195], a[48:51], v[144:147]
  ds_read_b64_tr_b16 a[168:169], v10 offset:8192
  v_mfma_f32_16x16x32_bf16 v[148:151], a[192:195], a[120:123], v[148:151]
  ds_read_b64_tr_b16 a[170:171], v10 offset:8704
  buffer_load_dwordx4 v20, s[4:7], s24 offen lds
  v_mfma_f32_16x16x32_bf16 v[152:155], a[196:199], a[48:51], v[152:155]
  ds_read_b64_tr_b16 a[172:173], v11 offset:8192
  v_mfma_f32_16x16x32_bf16 v[156:159], a[196:199], a[120:123], v[156:159]
  ds_read_b64_tr_b16 a[174:175], v11 offset:8704
  s_waitcnt lgkmcnt(8)
  v_mfma_f32_16x16x32_bf16 v[128:131], a[144:147], a[52:55], v[128:131]
  ds_read_b64_tr_b16 a[176:177], v8 offset:12288
  v_mfma_f32_16x16x32_bf16 v[132:135], a[144:147], a[124:127], v[132:135]
  ds_read_b64_tr_b16 a[178:179], v8 offset:12800
  ds_read_b128 a[200:203], v4 offset:0
  v_mfma_f32_16x16x32_bf16 v[136:139], a[148:151], a[52:55], v[136:139]
  ds_read_b64_tr_b16 a[180:181], v9 offset:12288
  v_mfma_f32_16x16x32_bf16 v[140:143], a[148:151], a[124:127], v[140:143]
  ds_read_b64_tr_b16 a[182:183], v9 offset:12800
  s_add_u32 m0, s27, 94208
  v_mfma_f32_16x16x32_bf16 v[144:147], a[152:155], a[52:55], v[144:147]
  ds_read_b64_tr_b16 a[184:185], v10 offset:12288
  v_mfma_f32_16x16x32_bf16 v[148:151], a[152:155], a[124:127], v[148:151]
  ds_read_b64_tr_b16 a[186:187], v10 offset:12800
  buffer_load_dwordx4 v21, s[4:7], s24 offen lds
  v_mfma_f32_16x16x32_bf16 v[152:155], a[156:159], a[52:55], v[152:155]
  ds_read_b64_tr_b16 a[188:189], v11 offset:12288
  v_mfma_f32_16x16x32_bf16 v[156:159], a[156:159], a[124:127], v[156:159]
  ds_read_b64_tr_b16 a[190:191], v11 offset:12800
  s_waitcnt lgkmcnt(9)
  v_mfma_f32_16x16x32_bf16 v[128:131], a[160:163], a[56:59], v[128:131]
  ds_read_b64_tr_b16 a[192:193], v8 offset:16384
  ds_read_b128 a[204:207], v4 offset:256
  v_mfma_f32_16x16x32_bf16 v[132:135], a[160:163], a[128:131], v[132:135]
  ds_read_b64_tr_b16 a[194:195], v8 offset:16896
  s_add_u32 m0, s27, 98304
  v_mfma_f32_16x16x32_bf16 v[136:139], a[164:167], a[56:59], v[136:139]
  ds_read_b64_tr_b16 a[196:197], v9 offset:16384
  v_mfma_f32_16x16x32_bf16 v[140:143], a[164:167], a[128:131], v[140:143]
  ds_read_b64_tr_b16 a[198:199], v9 offset:16896
  s_lshl_b32 s24, s38, 7
  v_mfma_f32_16x16x32_bf16 v[144:147], a[168:171], a[56:59], v[144:147]
  ds_read_b64_tr_b16 a[144:145], v10 offset:16384
  v_mfma_f32_16x16x32_bf16 v[148:151], a[168:171], a[128:131], v[148:151]
  ds_read_b64_tr_b16 a[146:147], v10 offset:16896
  buffer_load_dwordx4 v20, s[4:7], s24 offen lds
  v_mfma_f32_16x16x32_bf16 v[152:155], a[172:175], a[56:59], v[152:155]
  ds_read_b64_tr_b16 a[148:149], v11 offset:16384
  v_mfma_f32_16x16x32_bf16 v[156:159], a[172:175], a[128:131], v[156:159]
  ds_read_b64_tr_b16 a[150:151], v11 offset:16896
  s_waitcnt lgkmcnt(9)
  v_mfma_f32_16x16x32_bf16 v[128:131], a[176:179], a[60:63], v[128:131]
  ds_read_b64_tr_b16 a[152:153], v8 offset:20480
  v_mfma_f32_16x16x32_bf16 v[132:135], a[176:179], a[132:135], v[132:135]
  ds_read_b64_tr_b16 a[154:155], v8 offset:20992
  ds_read_b128 a[208:211], v4 offset:512
  v_mfma_f32_16x16x32_bf16 v[136:139], a[180:183], a[60:63], v[136:139]
  ds_read_b64_tr_b16 a[156:157], v9 offset:20480
  v_mfma_f32_16x16x32_bf16 v[140:143], a[180:183], a[132:135], v[140:143]
  ds_read_b64_tr_b16 a[158:159], v9 offset:20992
  s_add_u32 m0, s27, 102400
  v_mfma_f32_16x16x32_bf16 v[144:147], a[184:187], a[60:63], v[144:147]
  ds_read_b64_tr_b16 a[160:161], v10 offset:20480
  v_mfma_f32_16x16x32_bf16 v[148:151], a[184:187], a[132:135], v[148:151]
  ds_read_b64_tr_b16 a[162:163], v10 offset:20992
  buffer_load_dwordx4 v21, s[4:7], s24 offen lds
  v_mfma_f32_16x16x32_bf16 v[152:155], a[188:191], a[60:63], v[152:155]
  ds_read_b64_tr_b16 a[164:165], v11 offset:20480
  v_mfma_f32_16x16x32_bf16 v[156:159], a[188:191], a[132:135], v[156:159]
  ds_read_b64_tr_b16 a[166:167], v11 offset:20992
  s_waitcnt vmcnt(18)
  s_barrier
  s_waitcnt lgkmcnt(9)
  v_mfma_f32_16x16x32_bf16 v[128:131], a[192:195], a[64:67], v[128:131]
  ds_read_b64_tr_b16 a[168:169], v8 offset:24576
  ds_read_b128 a[212:215], v4 offset:768
  v_mfma_f32_16x16x32_bf16 v[132:135], a[192:195], a[136:139], v[132:135]
  ds_read_b64_tr_b16 a[170:171], v8 offset:25088
  s_add_u32 m0, s27, 106496
  v_mfma_f32_16x16x32_bf16 v[136:139], a[196:199], a[64:67], v[136:139]
  ds_read_b64_tr_b16 a[172:173], v9 offset:24576
  v_mfma_f32_16x16x32_bf16 v[140:143], a[196:199], a[136:139], v[140:143]
  ds_read_b64_tr_b16 a[174:175], v9 offset:25088
  s_add_u32 s24, s24, 589824
  v_mfma_f32_16x16x32_bf16 v[144:147], a[144:147], a[64:67], v[144:147]
  ds_read_b64_tr_b16 a[176:177], v10 offset:24576
  v_mfma_f32_16x16x32_bf16 v[148:151], a[144:147], a[136:139], v[148:151]
  ds_read_b64_tr_b16 a[178:179], v10 offset:25088
  buffer_load_dwordx4 v20, s[4:7], s24 offen lds
  v_mfma_f32_16x16x32_bf16 v[152:155], a[148:151], a[64:67], v[152:155]
  ds_read_b64_tr_b16 a[180:181], v11 offset:24576
  v_mfma_f32_16x16x32_bf16 v[156:159], a[148:151], a[136:139], v[156:159]
  ds_read_b64_tr_b16 a[182:183], v11 offset:25088
  s_waitcnt lgkmcnt(9)
  v_mfma_f32_16x16x32_bf16 v[128:131], a[152:155], a[68:71], v[128:131]
  ds_read_b64_tr_b16 a[184:185], v8 offset:28672
  v_mfma_f32_16x16x32_bf16 v[132:135], a[152:155], a[140:143], v[132:135]
  ds_read_b64_tr_b16 a[186:187], v8 offset:29184
  s_add_u32 m0, s27, 110592
  v_mfma_f32_16x16x32_bf16 v[136:139], a[156:159], a[68:71], v[136:139]
  ds_read_b64_tr_b16 a[188:189], v9 offset:28672
  v_mfma_f32_16x16x32_bf16 v[140:143], a[156:159], a[140:143], v[140:143]
  ds_read_b64_tr_b16 a[190:191], v9 offset:29184
  v_mfma_f32_16x16x32_bf16 v[144:147], a[160:163], a[68:71], v[144:147]
  ds_read_b64_tr_b16 a[192:193], v10 offset:28672
  v_mfma_f32_16x16x32_bf16 v[148:151], a[160:163], a[140:143], v[148:151]
  ds_read_b64_tr_b16 a[194:195], v10 offset:29184
  buffer_load_dwordx4 v21, s[4:7], s24 offen lds
  v_mfma_f32_16x16x32_bf16 v[152:155], a[164:167], a[68:71], v[152:155]
  ds_read_b64_tr_b16 a[196:197], v11 offset:28672
  v_mfma_f32_16x16x32_bf16 v[156:159], a[164:167], a[140:143], v[156:159]
  ds_read_b64_tr_b16 a[198:199], v11 offset:29184
  v_mfma_f32_16x16x32_bf16 v[128:131], a[200:203], v[24:27], v[128:131]
  v_mfma_f32_16x16x32_bf16 v[132:135], a[200:203], v[28:31], v[132:135]
  v_mfma_f32_16x16x32_bf16 v[136:139], a[204:207], v[24:27], v[136:139]
  v_mfma_f32_16x16x32_bf16 v[140:143], a[204:207], v[28:31], v[140:143]
  v_mfma_f32_16x16x32_bf16 v[144:147], a[208:211], v[24:27], v[144:147]
  v_mfma_f32_16x16x32_bf16 v[148:151], a[208:211], v[28:31], v[148:151]
  s_waitcnt lgkmcnt(14)
  v_mfma_f32_16x16x32_bf16 v[152:155], a[212:215], v[24:27], v[152:155]
  v_mfma_f32_16x16x32_bf16 v[156:159], a[212:215], v[28:31], v[156:159]
  s_waitcnt lgkmcnt(8)
  v_mfma_f32_16x16x32_bf16 v[96:99], a[168:171], a[0:3], 0
  ds_read_b64_tr_b16 a[144:145], v8 offset:32768
  s_add_u32 m0, s27, 114688
  v_mfma_f32_16x16x32_bf16 v[100:103], a[168:171], a[72:75], 0
  ds_read_b64_tr_b16 a[146:147], v8 offset:33280
  s_add_u32 s24, s24, 589824
  v_mfma_f32_16x16x32_bf16 v[104:107], a[172:175], a[0:3], 0
  ds_read_b64_tr_b16 a[148:149], v9 offset:32768
  buffer_load_dwordx4 v20, s[4:7], s24 offen lds
  v_mfma_f32_16x16x32_bf16 v[108:111], a[172:175], a[72:75], 0
  ds_read_b64_tr_b16 a[150:151], v9 offset:33280
  v_cvt_pk_bf16_f32 v192, v128, v129
  v_mfma_f32_16x16x32_bf16 v[112:115], a[176:179], a[0:3], 0
  ds_read_b64_tr_b16 a[152:153], v10 offset:32768
  v_cvt_pk_bf16_f32 v193, v130, v131
  v_mfma_f32_16x16x32_bf16 v[116:119], a[176:179], a[72:75], 0
  ds_read_b64_tr_b16 a[154:155], v10 offset:33280
  v_cvt_pk_bf16_f32 v194, v136, v137
  v_mfma_f32_16x16x32_bf16 v[120:123], a[180:183], a[0:3], 0
  ds_read_b64_tr_b16 a[156:157], v11 offset:32768
  v_mfma_f32_16x16x32_bf16 v[124:127], a[180:183], a[72:75], 0
  ds_read_b64_tr_b16 a[158:159], v11 offset:33280
  s_waitcnt lgkmcnt(8)
  v_mfma_f32_16x16x32_bf16 v[96:99], a[184:187], a[4:7], v[96:99]
  ds_read_b64_tr_b16 a[160:161], v8 offset:36864
  s_add_u32 m0, s27, 118784
  v_mfma_f32_16x16x32_bf16 v[100:103], a[184:187], a[76:79], v[100:103]
  ds_read_b64_tr_b16 a[162:163], v8 offset:37376
  buffer_load_dwordx4 v21, s[4:7], s24 offen lds
  v_mfma_f32_16x16x32_bf16 v[104:107], a[188:191], a[4:7], v[104:107]
  ds_read_b64_tr_b16 a[164:165], v9 offset:36864
  v_mfma_f32_16x16x32_bf16 v[108:111], a[188:191], a[76:79], v[108:111]
  ds_read_b64_tr_b16 a[166:167], v9 offset:37376
  v_cvt_pk_bf16_f32 v195, v138, v139
  v_mfma_f32_16x16x32_bf16 v[112:115], a[192:195], a[4:7], v[112:115]
  ds_read_b64_tr_b16 a[168:169], v10 offset:36864
  v_pk_max_i16 v192, v192, 0
  v_mfma_f32_16x16x32_bf16 v[116:119], a[192:195], a[76:79], v[116:119]
  ds_read_b64_tr_b16 a[170:171], v10 offset:37376
  v_pk_max_i16 v193, v193, 0
  v_mfma_f32_16x16x32_bf16 v[120:123], a[196:199], a[4:7], v[120:123]
  ds_read_b64_tr_b16 a[172:173], v11 offset:36864
  v_mfma_f32_16x16x32_bf16 v[124:127], a[196:199], a[76:79], v[124:127]
  ds_read_b64_tr_b16 a[174:175], v11 offset:37376
  s_waitcnt lgkmcnt(8)
  v_mfma_f32_16x16x32_bf16 v[96:99], a[144:147], a[8:11], v[96:99]
  ds_read_b64_tr_b16 a[176:177], v8 offset:40960
  s_add_u32 m0, s27, 122880
  v_mfma_f32_16x16x32_bf16 v[100:103], a[144:147], a[80:83], v[100:103]
  ds_read_b64_tr_b16 a[178:179], v8 offset:41472
  s_add_u32 s24, s24, 589824
  v_mfma_f32_16x16x32_bf16 v[104:107], a[148:151], a[8:11], v[104:107]
  ds_read_b64_tr_b16 a[180:181], v9 offset:40960
  buffer_load_dwordx4 v20, s[4:7], s24 offen lds
  v_mfma_f32_16x16x32_bf16 v[108:111], a[148:151], a[80:83], v[108:111]
  ds_read_b64_tr_b16 a[182:183], v9 offset:41472
  v_pk_max_i16 v194, v194, 0
  v_mfma_f32_16x16x32_bf16 v[112:115], a[152:155], a[8:11], v[112:115]
  ds_read_b64_tr_b16 a[184:185], v10 offset:40960
  v_pk_max_i16 v195, v195, 0
  v_mfma_f32_16x16x32_bf16 v[116:119], a[152:155], a[80:83], v[116:119]
  ds_read_b64_tr_b16 a[186:187], v10 offset:41472
  buffer_store_dwordx4 v[192:195], v2, s[12:15], s30 offen offset:0 sc0 sc1
  v_mfma_f32_16x16x32_bf16 v[120:123], a[156:159], a[8:11], v[120:123]
  ds_read_b64_tr_b16 a[188:189], v11 offset:40960
  v_mfma_f32_16x16x32_bf16 v[124:127], a[156:159], a[80:83], v[124:127]
  ds_read_b64_tr_b16 a[190:191], v11 offset:41472
  s_waitcnt lgkmcnt(8)
  v_mfma_f32_16x16x32_bf16 v[96:99], a[160:163], a[12:15], v[96:99]
  ds_read_b64_tr_b16 a[192:193], v8 offset:45056
  s_add_u32 m0, s27, 126976
  v_mfma_f32_16x16x32_bf16 v[100:103], a[160:163], a[84:87], v[100:103]
  ds_read_b64_tr_b16 a[194:195], v8 offset:45568
  buffer_load_dwordx4 v21, s[4:7], s24 offen lds
  v_mfma_f32_16x16x32_bf16 v[104:107], a[164:167], a[12:15], v[104:107]
  ds_read_b64_tr_b16 a[196:197], v9 offset:45056
  v_mfma_f32_16x16x32_bf16 v[108:111], a[164:167], a[84:87], v[108:111]
  ds_read_b64_tr_b16 a[198:199], v9 offset:45568
  v_cvt_pk_bf16_f32 v196, v132, v133
  v_mfma_f32_16x16x32_bf16 v[112:115], a[168:171], a[12:15], v[112:115]
  ds_read_b64_tr_b16 a[144:145], v10 offset:45056
  v_cvt_pk_bf16_f32 v197, v134, v135
  v_mfma_f32_16x16x32_bf16 v[116:119], a[168:171], a[84:87], v[116:119]
  ds_read_b64_tr_b16 a[146:147], v10 offset:45568
  v_cvt_pk_bf16_f32 v198, v140, v141
  v_mfma_f32_16x16x32_bf16 v[120:123], a[172:175], a[12:15], v[120:123]
  ds_read_b64_tr_b16 a[148:149], v11 offset:45056
  v_mfma_f32_16x16x32_bf16 v[124:127], a[172:175], a[84:87], v[124:127]
  ds_read_b64_tr_b16 a[150:151], v11 offset:45568
  s_waitcnt vmcnt(17)
  s_barrier
  s_waitcnt lgkmcnt(8)
  v_mfma_f32_16x16x32_bf16 v[96:99], a[176:179], a[16:19], v[96:99]
  ds_read_b64_tr_b16 a[152:153], v8 offset:49152
  s_add_u32 m0, s27, 131072
  v_mfma_f32_16x16x32_bf16 v[100:103], a[176:179], a[88:91], v[100:103]
  ds_read_b64_tr_b16 a[154:155], v8 offset:49664
  s_add_u32 s24, s24, 589824
  v_mfma_f32_16x16x32_bf16 v[104:107], a[180:183], a[16:19], v[104:107]
  ds_read_b64_tr_b16 a[156:157], v9 offset:49152
  buffer_load_dwordx4 v20, s[4:7], s24 offen lds
  v_mfma_f32_16x16x32_bf16 v[108:111], a[180:183], a[88:91], v[108:111]
  ds_read_b64_tr_b16 a[158:159], v9 offset:49664
  v_cvt_pk_bf16_f32 v199, v142, v143
  v_mfma_f32_16x16x32_bf16 v[112:115], a[184:187], a[16:19], v[112:115]
  ds_read_b64_tr_b16 a[160:161], v10 offset:49152
  v_pk_max_i16 v196, v196, 0
  v_mfma_f32_16x16x32_bf16 v[116:119], a[184:187], a[88:91], v[116:119]
  ds_read_b64_tr_b16 a[162:163], v10 offset:49664
  v_pk_max_i16 v197, v197, 0
  v_mfma_f32_16x16x32_bf16 v[120:123], a[188:191], a[16:19], v[120:123]
  ds_read_b64_tr_b16 a[164:165], v11 offset:49152
  v_mfma_f32_16x16x32_bf16 v[124:127], a[188:191], a[88:91], v[124:127]
  ds_read_b64_tr_b16 a[166:167], v11 offset:49664
  s_waitcnt lgkmcnt(8)
  v_mfma_f32_16x16x32_bf16 v[96:99], a[192:195], a[20:23], v[96:99]
  ds_read_b64_tr_b16 a[168:169], v8 offset:53248
  s_add_u32 m0, s27, 135168
  v_mfma_f32_16x16x32_bf16 v[100:103], a[192:195], a[92:95], v[100:103]
  ds_read_b64_tr_b16 a[170:171], v8 offset:53760
  buffer_load_dwordx4 v21, s[4:7], s24 offen lds
  v_mfma_f32_16x16x32_bf16 v[104:107], a[196:199], a[20:23], v[104:107]
  ds_read_b64_tr_b16 a[172:173], v9 offset:53248
  v_mfma_f32_16x16x32_bf16 v[108:111], a[196:199], a[92:95], v[108:111]
  ds_read_b64_tr_b16 a[174:175], v9 offset:53760
  v_pk_max_i16 v198, v198, 0
  v_mfma_f32_16x16x32_bf16 v[112:115], a[144:147], a[20:23], v[112:115]
  ds_read_b64_tr_b16 a[176:177], v10 offset:53248
  v_pk_max_i16 v199, v199, 0
  v_mfma_f32_16x16x32_bf16 v[116:119], a[144:147], a[92:95], v[116:119]
  ds_read_b64_tr_b16 a[178:179], v10 offset:53760
  buffer_store_dwordx4 v[196:199], v2, s[12:15], s30 offen offset:1024 sc0 sc1
  v_mfma_f32_16x16x32_bf16 v[120:123], a[148:151], a[20:23], v[120:123]
  ds_read_b64_tr_b16 a[180:181], v11 offset:53248
  v_mfma_f32_16x16x32_bf16 v[124:127], a[148:151], a[92:95], v[124:127]
  ds_read_b64_tr_b16 a[182:183], v11 offset:53760
  s_waitcnt lgkmcnt(8)
  v_mfma_f32_16x16x32_bf16 v[96:99], a[152:155], a[24:27], v[96:99]
  ds_read_b64_tr_b16 a[184:185], v8 offset:57344
  s_add_u32 m0, s27, 139264
  v_mfma_f32_16x16x32_bf16 v[100:103], a[152:155], a[96:99], v[100:103]
  ds_read_b64_tr_b16 a[186:187], v8 offset:57856
  s_add_u32 s24, s24, 589824
  v_mfma_f32_16x16x32_bf16 v[104:107], a[156:159], a[24:27], v[104:107]
  ds_read_b64_tr_b16 a[188:189], v9 offset:57344
  buffer_load_dwordx4 v20, s[4:7], s24 offen lds
  v_mfma_f32_16x16x32_bf16 v[108:111], a[156:159], a[96:99], v[108:111]
  ds_read_b64_tr_b16 a[190:191], v9 offset:57856
  v_cvt_pk_bf16_f32 v200, v144, v145
  v_mfma_f32_16x16x32_bf16 v[112:115], a[160:163], a[24:27], v[112:115]
  ds_read_b64_tr_b16 a[192:193], v10 offset:57344
  v_cvt_pk_bf16_f32 v201, v146, v147
  v_mfma_f32_16x16x32_bf16 v[116:119], a[160:163], a[96:99], v[116:119]
  ds_read_b64_tr_b16 a[194:195], v10 offset:57856
  v_cvt_pk_bf16_f32 v202, v152, v153
  v_mfma_f32_16x16x32_bf16 v[120:123], a[164:167], a[24:27], v[120:123]
  ds_read_b64_tr_b16 a[196:197], v11 offset:57344
  v_mfma_f32_16x16x32_bf16 v[124:127], a[164:167], a[96:99], v[124:127]
  ds_read_b64_tr_b16 a[198:199], v11 offset:57856
  s_waitcnt lgkmcnt(8)
  v_mfma_f32_16x16x32_bf16 v[96:99], a[168:171], a[28:31], v[96:99]
  ds_read_b64_tr_b16 a[144:145], v8 offset:61440
  s_add_u32 m0, s27, 143360
  v_mfma_f32_16x16x32_bf16 v[100:103], a[168:171], a[100:103], v[100:103]
  ds_read_b64_tr_b16 a[146:147], v8 offset:61952
  buffer_load_dwordx4 v21, s[4:7], s24 offen lds
  v_mfma_f32_16x16x32_bf16 v[104:107], a[172:175], a[28:31], v[104:107]
  ds_read_b64_tr_b16 a[148:149], v9 offset:61440
  v_mfma_f32_16x16x32_bf16 v[108:111], a[172:175], a[100:103], v[108:111]
  ds_read_b64_tr_b16 a[150:151], v9 offset:61952
  v_cvt_pk_bf16_f32 v203, v154, v155
  v_mfma_f32_16x16x32_bf16 v[112:115], a[176:179], a[28:31], v[112:115]
  ds_read_b64_tr_b16 a[152:153], v10 offset:61440
  v_pk_max_i16 v200, v200, 0
  v_mfma_f32_16x16x32_bf16 v[116:119], a[176:179], a[100:103], v[116:119]
  ds_read_b64_tr_b16 a[154:155], v10 offset:61952
  v_pk_max_i16 v201, v201, 0
  v_mfma_f32_16x16x32_bf16 v[120:123], a[180:183], a[28:31], v[120:123]
  ds_read_b64_tr_b16 a[156:157], v11 offset:61440
  v_mfma_f32_16x16x32_bf16 v[124:127], a[180:183], a[100:103], v[124:127]
  ds_read_b64_tr_b16 a[158:159], v11 offset:61952
  s_waitcnt lgkmcnt(8)
  v_mfma_f32_16x16x32_bf16 v[96:99], a[184:187], a[32:35], v[96:99]
  ds_read_b64_tr_b16 a[160:161], v12 offset:0
  s_add_u32 m0, s27, 0
  v_mfma_f32_16x16x32_bf16 v[100:103], a[184:187], a[104:107], v[100:103]
  ds_read_b64_tr_b16 a[162:163], v12 offset:512
  s_add_u32 s24, s24, 589824
  v_mfma_f32_16x16x32_bf16 v[104:107], a[188:191], a[32:35], v[104:107]
  ds_read_b64_tr_b16 a[164:165], v13 offset:0
  buffer_load_dwordx4 v20, s[4:7], s24 offen lds
  v_mfma_f32_16x16x32_bf16 v[108:111], a[188:191], a[104:107], v[108:111]
  ds_read_b64_tr_b16 a[166:167], v13 offset:512
  v_pk_max_i16 v202, v202, 0
  v_mfma_f32_16x16x32_bf16 v[112:115], a[192:195], a[32:35], v[112:115]
  ds_read_b64_tr_b16 a[168:169], v14 offset:0
  v_pk_max_i16 v203, v203, 0
  v_mfma_f32_16x16x32_bf16 v[116:119], a[192:195], a[104:107], v[116:119]
  ds_read_b64_tr_b16 a[170:171], v14 offset:512
  buffer_store_dwordx4 v[200:203], v2, s[12:15], s30 offen offset:2048 sc0 sc1
  v_mfma_f32_16x16x32_bf16 v[120:123], a[196:199], a[32:35], v[120:123]
  ds_read_b64_tr_b16 a[172:173], v15 offset:0
  v_mfma_f32_16x16x32_bf16 v[124:127], a[196:199], a[104:107], v[124:127]
  ds_read_b64_tr_b16 a[174:175], v15 offset:512
  s_waitcnt lgkmcnt(8)
  v_mfma_f32_16x16x32_bf16 v[96:99], a[144:147], a[36:39], v[96:99]
  ds_read_b64_tr_b16 a[176:177], v12 offset:4096
  s_add_u32 m0, s27, 4096
  v_mfma_f32_16x16x32_bf16 v[100:103], a[144:147], a[108:111], v[100:103]
  ds_read_b64_tr_b16 a[178:179], v12 offset:4608
  buffer_load_dwordx4 v21, s[4:7], s24 offen lds
  v_mfma_f32_16x16x32_bf16 v[104:107], a[148:151], a[36:39], v[104:107]
  ds_read_b64_tr_b16 a[180:181], v13 offset:4096
  v_mfma_f32_16x16x32_bf16 v[108:111], a[148:151], a[108:111], v[108:111]
  ds_read_b64_tr_b16 a[182:183], v13 offset:4608
  v_cvt_pk_bf16_f32 v204, v148, v149
  v_mfma_f32_16x16x32_bf16 v[112:115], a[152:155], a[36:39], v[112:115]
  ds_read_b64_tr_b16 a[184:185], v14 offset:4096
  v_cvt_pk_bf16_f32 v205, v150, v151
  v_mfma_f32_16x16x32_bf16 v[116:119], a[152:155], a[108:111], v[116:119]
  ds_read_b64_tr_b16 a[186:187], v14 offset:4608
  v_cvt_pk_bf16_f32 v206, v156, v157
  v_mfma_f32_16x16x32_bf16 v[120:123], a[156:159], a[36:39], v[120:123]
  ds_read_b64_tr_b16 a[188:189], v15 offset:4096
  v_mfma_f32_16x16x32_bf16 v[124:127], a[156:159], a[108:111], v[124:127]
  ds_read_b64_tr_b16 a[190:191], v15 offset:4608
  s_waitcnt vmcnt(17)
  s_barrier
  s_waitcnt lgkmcnt(8)
  v_mfma_f32_16x16x32_bf16 v[96:99], a[160:163], a[40:43], v[96:99]
  ds_read_b64_tr_b16 a[192:193], v12 offset:8192
  s_add_u32 m0, s27, 8192
  v_mfma_f32_16x16x32_bf16 v[100:103], a[160:163], a[112:115], v[100:103]
  ds_read_b64_tr_b16 a[194:195], v12 offset:8704
  s_add_u32 s24, s24, 589824
  v_mfma_f32_16x16x32_bf16 v[104:107], a[164:167], a[40:43], v[104:107]
  ds_read_b64_tr_b16 a[196:197], v13 offset:8192
  buffer_load_dwordx4 v20, s[4:7], s24 offen lds
  v_mfma_f32_16x16x32_bf16 v[108:111], a[164:167], a[112:115], v[108:111]
  ds_read_b64_tr_b16 a[198:199], v13 offset:8704
  v_cvt_pk_bf16_f32 v207, v158, v159
  v_mfma_f32_16x16x32_bf16 v[112:115], a[168:171], a[40:43], v[112:115]
  ds_read_b64_tr_b16 a[144:145], v14 offset:8192
  v_pk_max_i16 v204, v204, 0
  v_mfma_f32_16x16x32_bf16 v[116:119], a[168:171], a[112:115], v[116:119]
  ds_read_b64_tr_b16 a[146:147], v14 offset:8704
  v_pk_max_i16 v205, v205, 0
  v_mfma_f32_16x16x32_bf16 v[120:123], a[172:175], a[40:43], v[120:123]
  ds_read_b64_tr_b16 a[148:149], v15 offset:8192
  v_mfma_f32_16x16x32_bf16 v[124:127], a[172:175], a[112:115], v[124:127]
  ds_read_b64_tr_b16 a[150:151], v15 offset:8704
  s_waitcnt lgkmcnt(8)
  v_mfma_f32_16x16x32_bf16 v[96:99], a[176:179], a[44:47], v[96:99]
  ds_read_b64_tr_b16 a[152:153], v12 offset:12288
  s_add_u32 m0, s27, 12288
  v_mfma_f32_16x16x32_bf16 v[100:103], a[176:179], a[116:119], v[100:103]
  ds_read_b64_tr_b16 a[154:155], v12 offset:12800
  buffer_load_dwordx4 v21, s[4:7], s24 offen lds
  v_mfma_f32_16x16x32_bf16 v[104:107], a[180:183], a[44:47], v[104:107]
  ds_read_b64_tr_b16 a[156:157], v13 offset:12288
  v_pk_max_i16 v206, v206, 0
  v_mfma_f32_16x16x32_bf16 v[108:111], a[180:183], a[116:119], v[108:111]
  ds_read_b64_tr_b16 a[158:159], v13 offset:12800
  v_pk_max_i16 v207, v207, 0
  v_mfma_f32_16x16x32_bf16 v[112:115], a[184:187], a[44:47], v[112:115]
  ds_read_b64_tr_b16 a[160:161], v14 offset:12288
  buffer_store_dwordx4 v[204:207], v2, s[12:15], s30 offen offset:3072 sc0 sc1
  v_mfma_f32_16x16x32_bf16 v[116:119], a[184:187], a[116:119], v[116:119]
  ds_read_b64_tr_b16 a[162:163], v14 offset:12800
  s_add_u32 s30, s30, 4096
  v_mfma_f32_16x16x32_bf16 v[120:123], a[188:191], a[44:47], v[120:123]
  ds_read_b64_tr_b16 a[164:165], v15 offset:12288
  v_mfma_f32_16x16x32_bf16 v[124:127], a[188:191], a[116:119], v[124:127]
  ds_read_b64_tr_b16 a[166:167], v15 offset:12800
  s_waitcnt lgkmcnt(8)
  v_mfma_f32_16x16x32_bf16 v[96:99], a[192:195], a[48:51], v[96:99]
  ds_read_b64_tr_b16 a[168:169], v12 offset:16384
  v_lshl_add_u32 v4, s37, 10, v3
  v_mfma_f32_16x16x32_bf16 v[100:103], a[192:195], a[120:123], v[100:103]
  ds_read_b64_tr_b16 a[170:171], v12 offset:16896
  s_add_u32 m0, s27, 16384
  v_mfma_f32_16x16x32_bf16 v[104:107], a[196:199], a[48:51], v[104:107]
  ds_read_b64_tr_b16 a[172:173], v13 offset:16384
  v_mfma_f32_16x16x32_bf16 v[108:111], a[196:199], a[120:123], v[108:111]
  ds_read_b64_tr_b16 a[174:175], v13 offset:16896
  s_add_u32 s24, s24, 589824
  v_mfma_f32_16x16x32_bf16 v[112:115], a[144:147], a[48:51], v[112:115]
  ds_read_b64_tr_b16 a[176:177], v14 offset:16384
  v_mfma_f32_16x16x32_bf16 v[116:119], a[144:147], a[120:123], v[116:119]
  ds_read_b64_tr_b16 a[178:179], v14 offset:16896
  buffer_load_dwordx4 v20, s[4:7], s24 offen lds
  v_mfma_f32_16x16x32_bf16 v[120:123], a[148:151], a[48:51], v[120:123]
  ds_read_b64_tr_b16 a[180:181], v15 offset:16384
  v_mfma_f32_16x16x32_bf16 v[124:127], a[148:151], a[120:123], v[124:127]
  ds_read_b64_tr_b16 a[182:183], v15 offset:16896
  s_waitcnt lgkmcnt(8)
  v_mfma_f32_16x16x32_bf16 v[96:99], a[152:155], a[52:55], v[96:99]
  ds_read_b64_tr_b16 a[184:185], v12 offset:20480
  v_mfma_f32_16x16x32_bf16 v[100:103], a[152:155], a[124:127], v[100:103]
  ds_read_b64_tr_b16 a[186:187], v12 offset:20992
  ds_read_b128 a[200:203], v4 offset:0
  v_mfma_f32_16x16x32_bf16 v[104:107], a[156:159], a[52:55], v[104:107]
  ds_read_b64_tr_b16 a[188:189], v13 offset:20480
  v_mfma_f32_16x16x32_bf16 v[108:111], a[156:159], a[124:127], v[108:111]
  ds_read_b64_tr_b16 a[190:191], v13 offset:20992
  s_add_u32 m0, s27, 20480
  v_mfma_f32_16x16x32_bf16 v[112:115], a[160:163], a[52:55], v[112:115]
  ds_read_b64_tr_b16 a[192:193], v14 offset:20480
  v_mfma_f32_16x16x32_bf16 v[116:119], a[160:163], a[124:127], v[116:119]
  ds_read_b64_tr_b16 a[194:195], v14 offset:20992
  buffer_load_dwordx4 v21, s[4:7], s24 offen lds
  v_mfma_f32_16x16x32_bf16 v[120:123], a[164:167], a[52:55], v[120:123]
  ds_read_b64_tr_b16 a[196:197], v15 offset:20480
  v_mfma_f32_16x16x32_bf16 v[124:127], a[164:167], a[124:127], v[124:127]
  ds_read_b64_tr_b16 a[198:199], v15 offset:20992
  s_waitcnt lgkmcnt(9)
  v_mfma_f32_16x16x32_bf16 v[96:99], a[168:171], a[56:59], v[96:99]
  ds_read_b64_tr_b16 a[144:145], v12 offset:24576
  ds_read_b128 a[204:207], v4 offset:256
  v_mfma_f32_16x16x32_bf16 v[100:103], a[168:171], a[128:131], v[100:103]
  ds_read_b64_tr_b16 a[146:147], v12 offset:25088
  s_add_u32 m0, s27, 24576
  v_mfma_f32_16x16x32_bf16 v[104:107], a[172:175], a[56:59], v[104:107]
  ds_read_b64_tr_b16 a[148:149], v13 offset:24576
  v_mfma_f32_16x16x32_bf16 v[108:111], a[172:175], a[128:131], v[108:111]
  ds_read_b64_tr_b16 a[150:151], v13 offset:25088
  s_add_u32 s24, s56, s65
  v_mfma_f32_16x16x32_bf16 v[112:115], a[176:179], a[56:59], v[112:115]
  ds_read_b64_tr_b16 a[152:153], v14 offset:24576
  v_mfma_f32_16x16x32_bf16 v[116:119], a[176:179], a[128:131], v[116:119]
  ds_read_b64_tr_b16 a[154:155], v14 offset:25088
  buffer_load_dwordx4 v22, s[8:11], s24 offen lds
  v_mfma_f32_16x16x32_bf16 v[120:123], a[180:183], a[56:59], v[120:123]
  ds_read_b64_tr_b16 a[156:157], v15 offset:24576
  v_mfma_f32_16x16x32_bf16 v[124:127], a[180:183], a[128:131], v[124:127]
  ds_read_b64_tr_b16 a[158:159], v15 offset:25088
  s_waitcnt lgkmcnt(9)
  v_mfma_f32_16x16x32_bf16 v[96:99], a[184:187], a[60:63], v[96:99]
  ds_read_b64_tr_b16 a[160:161], v12 offset:28672
  v_mfma_f32_16x16x32_bf16 v[100:103], a[184:187], a[132:135], v[100:103]
  ds_read_b64_tr_b16 a[162:163], v12 offset:29184
  ds_read_b128 a[208:211], v4 offset:512
  v_mfma_f32_16x16x32_bf16 v[104:107], a[188:191], a[60:63], v[104:107]
  ds_read_b64_tr_b16 a[164:165], v13 offset:28672
  v_mfma_f32_16x16x32_bf16 v[108:111], a[188:191], a[132:135], v[108:111]
  ds_read_b64_tr_b16 a[166:167], v13 offset:29184
  s_add_u32 m0, s27, 28672
  v_mfma_f32_16x16x32_bf16 v[112:115], a[192:195], a[60:63], v[112:115]
  ds_read_b64_tr_b16 a[168:169], v14 offset:28672
  v_mfma_f32_16x16x32_bf16 v[116:119], a[192:195], a[132:135], v[116:119]
  ds_read_b64_tr_b16 a[170:171], v14 offset:29184
  buffer_load_dwordx4 v23, s[8:11], s24 offen lds
  v_mfma_f32_16x16x32_bf16 v[120:123], a[196:199], a[60:63], v[120:123]
  ds_read_b64_tr_b16 a[172:173], v15 offset:28672
  v_mfma_f32_16x16x32_bf16 v[124:127], a[196:199], a[132:135], v[124:127]
  ds_read_b64_tr_b16 a[174:175], v15 offset:29184
  s_waitcnt vmcnt(18)
  s_barrier
  s_waitcnt lgkmcnt(9)
  v_mfma_f32_16x16x32_bf16 v[96:99], a[144:147], a[64:67], v[96:99]
  ds_read_b64_tr_b16 a[176:177], v12 offset:32768
  ds_read_b128 a[212:215], v4 offset:768
  v_mfma_f32_16x16x32_bf16 v[100:103], a[144:147], a[136:139], v[100:103]
  ds_read_b64_tr_b16 a[178:179], v12 offset:33280
  s_add_u32 m0, s27, 32768
  v_mfma_f32_16x16x32_bf16 v[104:107], a[148:151], a[64:67], v[104:107]
  ds_read_b64_tr_b16 a[180:181], v13 offset:32768
  v_mfma_f32_16x16x32_bf16 v[108:111], a[148:151], a[136:139], v[108:111]
  ds_read_b64_tr_b16 a[182:183], v13 offset:33280
  s_add_u32 s24, s57, s65
  v_mfma_f32_16x16x32_bf16 v[112:115], a[152:155], a[64:67], v[112:115]
  ds_read_b64_tr_b16 a[184:185], v14 offset:32768
  v_mfma_f32_16x16x32_bf16 v[116:119], a[152:155], a[136:139], v[116:119]
  ds_read_b64_tr_b16 a[186:187], v14 offset:33280
  buffer_load_dwordx4 v22, s[8:11], s24 offen lds
  v_mfma_f32_16x16x32_bf16 v[120:123], a[156:159], a[64:67], v[120:123]
  ds_read_b64_tr_b16 a[188:189], v15 offset:32768
  v_mfma_f32_16x16x32_bf16 v[124:127], a[156:159], a[136:139], v[124:127]
  ds_read_b64_tr_b16 a[190:191], v15 offset:33280
  s_waitcnt lgkmcnt(9)
  v_mfma_f32_16x16x32_bf16 v[96:99], a[160:163], a[68:71], v[96:99]
  ds_read_b64_tr_b16 a[192:193], v12 offset:36864
  v_mfma_f32_16x16x32_bf16 v[100:103], a[160:163], a[140:143], v[100:103]
  ds_read_b64_tr_b16 a[194:195], v12 offset:37376
  s_add_u32 m0, s27, 36864
  v_mfma_f32_16x16x32_bf16 v[104:107], a[164:167], a[68:71], v[104:107]
  ds_read_b64_tr_b16 a[196:197], v13 offset:36864
  v_mfma_f32_16x16x32_bf16 v[108:111], a[164:167], a[140:143], v[108:111]
  ds_read_b64_tr_b16 a[198:199], v13 offset:37376
  v_mfma_f32_16x16x32_bf16 v[112:115], a[168:171], a[68:71], v[112:115]
  ds_read_b64_tr_b16 a[144:145], v14 offset:36864
  v_mfma_f32_16x16x32_bf16 v[116:119], a[168:171], a[140:143], v[116:119]
  ds_read_b64_tr_b16 a[146:147], v14 offset:37376
  buffer_load_dwordx4 v23, s[8:11], s24 offen lds
  v_mfma_f32_16x16x32_bf16 v[120:123], a[172:175], a[68:71], v[120:123]
  ds_read_b64_tr_b16 a[148:149], v15 offset:36864
  v_mfma_f32_16x16x32_bf16 v[124:127], a[172:175], a[140:143], v[124:127]
  ds_read_b64_tr_b16 a[150:151], v15 offset:37376
  v_mfma_f32_16x16x32_bf16 v[96:99], a[200:203], v[24:27], v[96:99]
  v_mfma_f32_16x16x32_bf16 v[100:103], a[200:203], v[28:31], v[100:103]
  v_mfma_f32_16x16x32_bf16 v[104:107], a[204:207], v[24:27], v[104:107]
  v_mfma_f32_16x16x32_bf16 v[108:111], a[204:207], v[28:31], v[108:111]
  v_mfma_f32_16x16x32_bf16 v[112:115], a[208:211], v[24:27], v[112:115]
  v_mfma_f32_16x16x32_bf16 v[116:119], a[208:211], v[28:31], v[116:119]
  s_waitcnt lgkmcnt(14)
  v_mfma_f32_16x16x32_bf16 v[120:123], a[212:215], v[24:27], v[120:123]
  v_mfma_f32_16x16x32_bf16 v[124:127], a[212:215], v[28:31], v[124:127]
  s_waitcnt lgkmcnt(8)
  v_mfma_f32_16x16x32_bf16 v[128:131], a[176:179], a[0:3], 0
  ds_read_b64_tr_b16 a[152:153], v12 offset:40960
  s_add_u32 m0, s27, 40960
  v_mfma_f32_16x16x32_bf16 v[132:135], a[176:179], a[72:75], 0
  ds_read_b64_tr_b16 a[154:155], v12 offset:41472
  s_add_u32 s24, s58, s65
  v_mfma_f32_16x16x32_bf16 v[136:139], a[180:183], a[0:3], 0
  ds_read_b64_tr_b16 a[156:157], v13 offset:40960
  buffer_load_dwordx4 v22, s[8:11], s24 offen lds
  v_mfma_f32_16x16x32_bf16 v[140:143], a[180:183], a[72:75], 0
  ds_read_b64_tr_b16 a[158:159], v13 offset:41472
  v_cvt_pk_bf16_f32 v208, v96, v97
  v_mfma_f32_16x16x32_bf16 v[144:147], a[184:187], a[0:3], 0
  ds_read_b64_tr_b16 a[160:161], v14 offset:40960
  v_cvt_pk_bf16_f32 v209, v98, v99
  v_mfma_f32_16x16x32_bf16 v[148:151], a[184:187], a[72:75], 0
  ds_read_b64_tr_b16 a[162:163], v14 offset:41472
  v_cvt_pk_bf16_f32 v210, v104, v105
  v_mfma_f32_16x16x32_bf16 v[152:155], a[188:191], a[0:3], 0
  ds_read_b64_tr_b16 a[164:165], v15 offset:40960
  v_mfma_f32_16x16x32_bf16 v[156:159], a[188:191], a[72:75], 0
  ds_read_b64_tr_b16 a[166:167], v15 offset:41472
  s_waitcnt lgkmcnt(8)
  v_mfma_f32_16x16x32_bf16 v[128:131], a[192:195], a[4:7], v[128:131]
  ds_read_b64_tr_b16 a[168:169], v12 offset:45056
  s_waitcnt vmcnt(7)
  v_mfma_f32_16x16x32_bf16 v[132:135], a[192:195], a[76:79], v[132:135]
  ds_read_b64_tr_b16 a[170:171], v12 offset:45568
  s_mov_b64 exec, 1
  buffer_store_dword v5, v6, s[12:15], s16 offen offset:0 sc0 sc1
  s_mov_b64 exec, -1
  v_mfma_f32_16x16x32_bf16 v[136:139], a[196:199], a[4:7], v[136:139]
  ds_read_b64_tr_b16 a[172:173], v13 offset:45056
  s_add_u32 m0, s27, 45056
  v_mfma_f32_16x16x32_bf16 v[140:143], a[196:199], a[76:79], v[140:143]
  ds_read_b64_tr_b16 a[174:175], v13 offset:45568
  buffer_load_dwordx4 v23, s[8:11], s24 offen lds
  v_mfma_f32_16x16x32_bf16 v[144:147], a[144:147], a[4:7], v[144:147]
  ds_read_b64_tr_b16 a[176:177], v14 offset:45056
  v_cvt_pk_bf16_f32 v211, v106, v107
  v_mfma_f32_16x16x32_bf16 v[148:151], a[144:147], a[76:79], v[148:151]
  ds_read_b64_tr_b16 a[178:179], v14 offset:45568
  v_pk_max_i16 v208, v208, 0
  v_mfma_f32_16x16x32_bf16 v[152:155], a[148:151], a[4:7], v[152:155]
  ds_read_b64_tr_b16 a[180:181], v15 offset:45056
  v_pk_max_i16 v209, v209, 0
  v_mfma_f32_16x16x32_bf16 v[156:159], a[148:151], a[76:79], v[156:159]
  ds_read_b64_tr_b16 a[182:183], v15 offset:45568
  s_waitcnt lgkmcnt(8)
  v_mfma_f32_16x16x32_bf16 v[128:131], a[152:155], a[8:11], v[128:131]
  ds_read_b64_tr_b16 a[184:185], v12 offset:49152
  s_add_u32 m0, s27, 49152
  v_mfma_f32_16x16x32_bf16 v[132:135], a[152:155], a[80:83], v[132:135]
  ds_read_b64_tr_b16 a[186:187], v12 offset:49664
  s_add_u32 s24, s59, s65
  v_mfma_f32_16x16x32_bf16 v[136:139], a[156:159], a[8:11], v[136:139]
  ds_read_b64_tr_b16 a[188:189], v13 offset:49152
  buffer_load_dwordx4 v22, s[8:11], s24 offen lds
  v_mfma_f32_16x16x32_bf16 v[140:143], a[156:159], a[80:83], v[140:143]
  ds_read_b64_tr_b16 a[190:191], v13 offset:49664
  v_pk_max_i16 v210, v210, 0
  v_mfma_f32_16x16x32_bf16 v[144:147], a[160:163], a[8:11], v[144:147]
  ds_read_b64_tr_b16 a[192:193], v14 offset:49152
  v_pk_max_i16 v211, v211, 0
  v_mfma_f32_16x16x32_bf16 v[148:151], a[160:163], a[80:83], v[148:151]
  ds_read_b64_tr_b16 a[194:195], v14 offset:49664
  buffer_store_dwordx4 v[208:211], v2, s[12:15], s30 offen offset:0 sc0 sc1
  v_mfma_f32_16x16x32_bf16 v[152:155], a[164:167], a[8:11], v[152:155]
  ds_read_b64_tr_b16 a[196:197], v15 offset:49152
  v_mfma_f32_16x16x32_bf16 v[156:159], a[164:167], a[80:83], v[156:159]
  ds_read_b64_tr_b16 a[198:199], v15 offset:49664
  s_waitcnt lgkmcnt(8)
  v_mfma_f32_16x16x32_bf16 v[128:131], a[168:171], a[12:15], v[128:131]
  ds_read_b64_tr_b16 a[144:145], v12 offset:53248
  s_add_u32 m0, s27, 53248
  v_mfma_f32_16x16x32_bf16 v[132:135], a[168:171], a[84:87], v[132:135]
  ds_read_b64_tr_b16 a[146:147], v12 offset:53760
  buffer_load_dwordx4 v23, s[8:11], s24 offen lds
  v_mfma_f32_16x16x32_bf16 v[136:139], a[172:175], a[12:15], v[136:139]
  ds_read_b64_tr_b16 a[148:149], v13 offset:53248
  v_mfma_f32_16x16x32_bf16 v[140:143], a[172:175], a[84:87], v[140:143]
  ds_read_b64_tr_b16 a[150:151], v13 offset:53760
  v_cvt_pk_bf16_f32 v212, v100, v101
  v_mfma_f32_16x16x32_bf16 v[144:147], a[176:179], a[12:15], v[144:147]
  ds_read_b64_tr_b16 a[152:153], v14 offset:53248
  v_cvt_pk_bf16_f32 v213, v102, v103
  v_mfma_f32_16x16x32_bf16 v[148:151], a[176:179], a[84:87], v[148:151]
  ds_read_b64_tr_b16 a[154:155], v14 offset:53760
  v_cvt_pk_bf16_f32 v214, v108, v109
  v_mfma_f32_16x16x32_bf16 v[152:155], a[180:183], a[12:15], v[152:155]
  ds_read_b64_tr_b16 a[156:157], v15 offset:53248
  v_mfma_f32_16x16x32_bf16 v[156:159], a[180:183], a[84:87], v[156:159]
  ds_read_b64_tr_b16 a[158:159], v15 offset:53760
  s_barrier
  s_waitcnt lgkmcnt(8)
  v_mfma_f32_16x16x32_bf16 v[128:131], a[184:187], a[16:19], v[128:131]
  ds_read_b64_tr_b16 a[160:161], v12 offset:57344
  s_add_u32 m0, s27, 57344
  v_mfma_f32_16x16x32_bf16 v[132:135], a[184:187], a[88:91], v[132:135]
  ds_read_b64_tr_b16 a[162:163], v12 offset:57856
  s_add_u32 s24, s60, s65
  v_mfma_f32_16x16x32_bf16 v[136:139], a[188:191], a[16:19], v[136:139]
  ds_read_b64_tr_b16 a[164:165], v13 offset:57344
  buffer_load_dwordx4 v22, s[8:11], s24 offen lds
  v_mfma_f32_16x16x32_bf16 v[140:143], a[188:191], a[88:91], v[140:143]
  ds_read_b64_tr_b16 a[166:167], v13 offset:57856
  v_cvt_pk_bf16_f32 v215, v110, v111
  v_mfma_f32_16x16x32_bf16 v[144:147], a[192:195], a[16:19], v[144:147]
  ds_read_b64_tr_b16 a[168:169], v14 offset:57344
  v_pk_max_i16 v212, v212, 0
  v_mfma_f32_16x16x32_bf16 v[148:151], a[192:195], a[88:91], v[148:151]
  ds_read_b64_tr_b16 a[170:171], v14 offset:57856
  v_pk_max_i16 v213, v213, 0
  v_mfma_f32_16x16x32_bf16 v[152:155], a[196:199], a[16:19], v[152:155]
  ds_read_b64_tr_b16 a[172:173], v15 offset:57344
  v_mfma_f32_16x16x32_bf16 v[156:159], a[196:199], a[88:91], v[156:159]
  ds_read_b64_tr_b16 a[174:175], v15 offset:57856
  s_waitcnt lgkmcnt(8)
  v_mfma_f32_16x16x32_bf16 v[128:131], a[144:147], a[20:23], v[128:131]
  ds_read_b64_tr_b16 a[176:177], v12 offset:61440
  s_add_u32 m0, s27, 61440
  v_mfma_f32_16x16x32_bf16 v[132:135], a[144:147], a[92:95], v[132:135]
  ds_read_b64_tr_b16 a[178:179], v12 offset:61952
  buffer_load_dwordx4 v23, s[8:11], s24 offen lds
  v_mfma_f32_16x16x32_bf16 v[136:139], a[148:151], a[20:23], v[136:139]
  ds_read_b64_tr_b16 a[180:181], v13 offset:61440
  v_mfma_f32_16x16x32_bf16 v[140:143], a[148:151], a[92:95], v[140:143]
  ds_read_b64_tr_b16 a[182:183], v13 offset:61952
  v_pk_max_i16 v214, v214, 0
  v_mfma_f32_16x16x32_bf16 v[144:147], a[152:155], a[20:23], v[144:147]
  ds_read_b64_tr_b16 a[184:185], v14 offset:61440
  v_pk_max_i16 v215, v215, 0
  v_mfma_f32_16x16x32_bf16 v[148:151], a[152:155], a[92:95], v[148:151]
  ds_read_b64_tr_b16 a[186:187], v14 offset:61952
  buffer_store_dwordx4 v[212:215], v2, s[12:15], s30 offen offset:1024 sc0 sc1
  v_mfma_f32_16x16x32_bf16 v[152:155], a[156:159], a[20:23], v[152:155]
  ds_read_b64_tr_b16 a[188:189], v15 offset:61440
  v_mfma_f32_16x16x32_bf16 v[156:159], a[156:159], a[92:95], v[156:159]
  ds_read_b64_tr_b16 a[190:191], v15 offset:61952
  s_waitcnt lgkmcnt(8)
  v_mfma_f32_16x16x32_bf16 v[128:131], a[160:163], a[24:27], v[128:131]
  ds_read_b64_tr_b16 a[192:193], v16 offset:0
  s_add_u32 m0, s27, 65536
  v_mfma_f32_16x16x32_bf16 v[132:135], a[160:163], a[96:99], v[132:135]
  ds_read_b64_tr_b16 a[194:195], v16 offset:512
  s_add_u32 s24, s56, s66
  v_mfma_f32_16x16x32_bf16 v[136:139], a[164:167], a[24:27], v[136:139]
  ds_read_b64_tr_b16 a[196:197], v17 offset:0
  buffer_load_dwordx4 v22, s[8:11], s24 offen lds
  v_mfma_f32_16x16x32_bf16 v[140:143], a[164:167], a[96:99], v[140:143]
  ds_read_b64_tr_b16 a[198:199], v17 offset:512
  v_cvt_pk_bf16_f32 v216, v112, v113
  v_mfma_f32_16x16x32_bf16 v[144:147], a[168:171], a[24:27], v[144:147]
  ds_read_b64_tr_b16 a[144:145], v18 offset:0
  v_cvt_pk_bf16_f32 v217, v114, v115
  v_mfma_f32_16x16x32_bf16 v[148:151], a[168:171], a[96:99], v[148:151]
  ds_read_b64_tr_b16 a[146:147], v18 offset:512
  v_cvt_pk_bf16_f32 v218, v120, v121
  v_mfma_f32_16x16x32_bf16 v[152:155], a[172:175], a[24:27], v[152:155]
  ds_read_b64_tr_b16 a[148:149], v19 offset:0
  v_mfma_f32_16x16x32_bf16 v[156:159], a[172:175], a[96:99], v[156:159]
  ds_read_b64_tr_b16 a[150:151], v19 offset:512
  s_waitcnt lgkmcnt(8)
  v_mfma_f32_16x16x32_bf16 v[128:131], a[176:179], a[28:31], v[128:131]
  ds_read_b64_tr_b16 a[152:153], v16 offset:4096
  s_add_u32 m0, s27, 69632
  v_mfma_f32_16x16x32_bf16 v[132:135], a[176:179], a[100:103], v[132:135]
  ds_read_b64_tr_b16 a[154:155], v16 offset:4608
  buffer_load_dwordx4 v23, s[8:11], s24 offen lds
  v_mfma_f32_16x16x32_bf16 v[136:139], a[180:183], a[28:31], v[136:139]
  ds_read_b64_tr_b16 a[156:157], v17 offset:4096
  v_mfma_f32_16x16x32_bf16 v[140:143], a[180:183], a[100:103], v[140:143]
  ds_read_b64_tr_b16 a[158:159], v17 offset:4608
  v_cvt_pk_bf16_f32 v219, v122, v123
  v_mfma_f32_16x16x32_bf16 v[144:147], a[184:187], a[28:31], v[144:147]
  ds_read_b64_tr_b16 a[160:161], v18 offset:4096
  v_pk_max_i16 v216, v216, 0
  v_mfma_f32_16x16x32_bf16 v[148:151], a[184:187], a[100:103], v[148:151]
  ds_read_b64_tr_b16 a[162:163], v18 offset:4608
  v_pk_max_i16 v217, v217, 0
  v_mfma_f32_16x16x32_bf16 v[152:155], a[188:191], a[28:31], v[152:155]
  ds_read_b64_tr_b16 a[164:165], v19 offset:4096
  v_mfma_f32_16x16x32_bf16 v[156:159], a[188:191], a[100:103], v[156:159]
  ds_read_b64_tr_b16 a[166:167], v19 offset:4608
  s_waitcnt lgkmcnt(8)
  v_mfma_f32_16x16x32_bf16 v[128:131], a[192:195], a[32:35], v[128:131]
  ds_read_b64_tr_b16 a[168:169], v16 offset:8192
  s_add_u32 m0, s27, 73728
  v_mfma_f32_16x16x32_bf16 v[132:135], a[192:195], a[104:107], v[132:135]
  ds_read_b64_tr_b16 a[170:171], v16 offset:8704
  s_add_u32 s24, s57, s66
  v_mfma_f32_16x16x32_bf16 v[136:139], a[196:199], a[32:35], v[136:139]
  ds_read_b64_tr_b16 a[172:173], v17 offset:8192
  buffer_load_dwordx4 v22, s[8:11], s24 offen lds
  v_mfma_f32_16x16x32_bf16 v[140:143], a[196:199], a[104:107], v[140:143]
  ds_read_b64_tr_b16 a[174:175], v17 offset:8704
  v_pk_max_i16 v218, v218, 0
  v_mfma_f32_16x16x32_bf16 v[144:147], a[144:147], a[32:35], v[144:147]
  ds_read_b64_tr_b16 a[176:177], v18 offset:8192
  v_pk_max_i16 v219, v219, 0
  v_mfma_f32_16x16x32_bf16 v[148:151], a[144:147], a[104:107], v[148:151]
  ds_read_b64_tr_b16 a[178:179], v18 offset:8704
  buffer_store_dwordx4 v[216:219], v2, s[12:15], s30 offen offset:2048 sc0 sc1
  v_mfma_f32_16x16x32_bf16 v[152:155], a[148:151], a[32:35], v[152:155]
  ds_read_b64_tr_b16 a[180:181], v19 offset:8192
  v_mfma_f32_16x16x32_bf16 v[156:159], a[148:151], a[104:107], v[156:159]
  ds_read_b64_tr_b16 a[182:183], v19 offset:8704
  s_waitcnt lgkmcnt(8)
  v_mfma_f32_16x16x32_bf16 v[128:131], a[152:155], a[36:39], v[128:131]
  ds_read_b64_tr_b16 a[184:185], v16 offset:12288
  s_add_u32 m0, s27, 77824
  v_mfma_f32_16x16x32_bf16 v[132:135], a[152:155], a[108:111], v[132:135]
  ds_read_b64_tr_b16 a[186:187], v16 offset:12800
  buffer_load_dwordx4 v23, s[8:11], s24 offen lds
  v_mfma_f32_16x16x32_bf16 v[136:139], a[156:159], a[36:39], v[136:139]
  ds_read_b64_tr_b16 a[188:189], v17 offset:12288
  v_mfma_f32_16x16x32_bf16 v[140:143], a[156:159], a[108:111], v[140:143]
  ds_read_b64_tr_b16 a[190:191], v17 offset:12800
  v_cvt_pk_bf16_f32 v220, v116, v117
  v_mfma_f32_16x16x32_bf16 v[144:147], a[160:163], a[36:39], v[144:147]
  ds_read_b64_tr_b16 a[192:193], v18 offset:12288
  v_cvt_pk_bf16_f32 v221, v118, v119
  v_mfma_f32_16x16x32_bf16 v[148:151], a[160:163], a[108:111], v[148:151]
  ds_read_b64_tr_b16 a[194:195], v18 offset:12800
  v_cvt_pk_bf16_f32 v222, v124, v125
  v_mfma_f32_16x16x32_bf16 v[152:155], a[164:167], a[36:39], v[152:155]
  ds_read_b64_tr_b16 a[196:197], v19 offset:12288
  v_mfma_f32_16x16x32_bf16 v[156:159], a[164:167], a[108:111], v[156:159]
  ds_read_b64_tr_b16 a[198:199], v19 offset:12800
  s_waitcnt vmcnt(18)
  s_barrier
  s_waitcnt lgkmcnt(8)
  v_mfma_f32_16x16x32_bf16 v[128:131], a[168:171], a[40:43], v[128:131]
  ds_read_b64_tr_b16 a[144:145], v8 offset:0
  s_add_u32 m0, s27, 81920
  v_mfma_f32_16x16x32_bf16 v[132:135], a[168:171], a[112:115], v[132:135]
  ds_read_b64_tr_b16 a[146:147], v8 offset:512
  s_add_u32 s24, s58, s66
  v_mfma_f32_16x16x32_bf16 v[136:139], a[172:175], a[40:43], v[136:139]
  ds_read_b64_tr_b16 a[148:149], v9 offset:0
  buffer_load_dwordx4 v22, s[8:11], s24 offen lds
  v_mfma_f32_16x16x32_bf16 v[140:143], a[172:175], a[112:115], v[140:143]
  ds_read_b64_tr_b16 a[150:151], v9 offset:512
  v_cvt_pk_bf16_f32 v223, v126, v127
  v_mfma_f32_16x16x32_bf16 v[144:147], a[176:179], a[40:43], v[144:147]
  ds_read_b64_tr_b16 a[152:153], v10 offset:0
  v_pk_max_i16 v220, v220, 0
  v_mfma_f32_16x16x32_bf16 v[148:151], a[176:179], a[112:115], v[148:151]
  ds_read_b64_tr_b16 a[154:155], v10 offset:512
  v_pk_max_i16 v221, v221, 0
  v_mfma_f32_16x16x32_bf16 v[152:155], a[180:183], a[40:43], v[152:155]
  ds_read_b64_tr_b16 a[156:157], v11 offset:0
  v_mfma_f32_16x16x32_bf16 v[156:159], a[180:183], a[112:115], v[156:159]
  ds_read_b64_tr_b16 a[158:159], v11 offset:512
  s_waitcnt lgkmcnt(8)
  v_mfma_f32_16x16x32_bf16 v[128:131], a[184:187], a[44:47], v[128:131]
  ds_read_b64_tr_b16 a[160:161], v8 offset:4096
  s_add_u32 m0, s27, 86016
  v_mfma_f32_16x16x32_bf16 v[132:135], a[184:187], a[116:119], v[132:135]
  ds_read_b64_tr_b16 a[162:163], v8 offset:4608
  buffer_load_dwordx4 v23, s[8:11], s24 offen lds
  v_mfma_f32_16x16x32_bf16 v[136:139], a[188:191], a[44:47], v[136:139]
  ds_read_b64_tr_b16 a[164:165], v9 offset:4096
  v_pk_max_i16 v222, v222, 0
  v_mfma_f32_16x16x32_bf16 v[140:143], a[188:191], a[116:119], v[140:143]
  ds_read_b64_tr_b16 a[166:167], v9 offset:4608
  v_pk_max_i16 v223, v223, 0
  v_mfma_f32_16x16x32_bf16 v[144:147], a[192:195], a[44:47], v[144:147]
  ds_read_b64_tr_b16 a[168:169], v10 offset:4096
  buffer_store_dwordx4 v[220:223], v2, s[12:15], s30 offen offset:3072 sc0 sc1
  v_mfma_f32_16x16x32_bf16 v[148:151], a[192:195], a[116:119], v[148:151]
  ds_read_b64_tr_b16 a[170:171], v10 offset:4608
  s_add_u32 s30, s30, 4096
  v_mfma_f32_16x16x32_bf16 v[152:155], a[196:199], a[44:47], v[152:155]
  ds_read_b64_tr_b16 a[172:173], v11 offset:4096
  v_mfma_f32_16x16x32_bf16 v[156:159], a[196:199], a[116:119], v[156:159]
  ds_read_b64_tr_b16 a[174:175], v11 offset:4608
  s_waitcnt lgkmcnt(8)
  v_mfma_f32_16x16x32_bf16 v[128:131], a[144:147], a[48:51], v[128:131]
  ds_read_b64_tr_b16 a[176:177], v8 offset:8192
  v_lshl_add_u32 v4, s38, 10, v3
  v_mfma_f32_16x16x32_bf16 v[132:135], a[144:147], a[120:123], v[132:135]
  ds_read_b64_tr_b16 a[178:179], v8 offset:8704
  s_add_u32 m0, s27, 90112
  v_mfma_f32_16x16x32_bf16 v[136:139], a[148:151], a[48:51], v[136:139]
  ds_read_b64_tr_b16 a[180:181], v9 offset:8192
  v_mfma_f32_16x16x32_bf16 v[140:143], a[148:151], a[120:123], v[140:143]
  ds_read_b64_tr_b16 a[182:183], v9 offset:8704
  s_add_u32 s24, s59, s66
  v_mfma_f32_16x16x32_bf16 v[144:147], a[152:155], a[48:51], v[144:147]
  ds_read_b64_tr_b16 a[184:185], v10 offset:8192
  v_mfma_f32_16x16x32_bf16 v[148:151], a[152:155], a[120:123], v[148:151]
  ds_read_b64_tr_b16 a[186:187], v10 offset:8704
  buffer_load_dwordx4 v22, s[8:11], s24 offen lds
  v_mfma_f32_16x16x32_bf16 v[152:155], a[156:159], a[48:51], v[152:155]
  ds_read_b64_tr_b16 a[188:189], v11 offset:8192
  v_mfma_f32_16x16x32_bf16 v[156:159], a[156:159], a[120:123], v[156:159]
  ds_read_b64_tr_b16 a[190:191], v11 offset:8704
  s_waitcnt lgkmcnt(8)
  v_mfma_f32_16x16x32_bf16 v[128:131], a[160:163], a[52:55], v[128:131]
  ds_read_b64_tr_b16 a[192:193], v8 offset:12288
  v_mfma_f32_16x16x32_bf16 v[132:135], a[160:163], a[124:127], v[132:135]
  ds_read_b64_tr_b16 a[194:195], v8 offset:12800
  ds_read_b128 a[200:203], v4 offset:0
  v_mfma_f32_16x16x32_bf16 v[136:139], a[164:167], a[52:55], v[136:139]
  ds_read_b64_tr_b16 a[196:197], v9 offset:12288
  v_mfma_f32_16x16x32_bf16 v[140:143], a[164:167], a[124:127], v[140:143]
  ds_read_b64_tr_b16 a[198:199], v9 offset:12800
  s_add_u32 m0, s27, 94208
  v_mfma_f32_16x16x32_bf16 v[144:147], a[168:171], a[52:55], v[144:147]
  ds_read_b64_tr_b16 a[144:145], v10 offset:12288
  v_mfma_f32_16x16x32_bf16 v[148:151], a[168:171], a[124:127], v[148:151]
  ds_read_b64_tr_b16 a[146:147], v10 offset:12800
  buffer_load_dwordx4 v23, s[8:11], s24 offen lds
  v_mfma_f32_16x16x32_bf16 v[152:155], a[172:175], a[52:55], v[152:155]
  ds_read_b64_tr_b16 a[148:149], v11 offset:12288
  v_mfma_f32_16x16x32_bf16 v[156:159], a[172:175], a[124:127], v[156:159]
  ds_read_b64_tr_b16 a[150:151], v11 offset:12800
  s_waitcnt lgkmcnt(9)
  v_mfma_f32_16x16x32_bf16 v[128:131], a[176:179], a[56:59], v[128:131]
  ds_read_b64_tr_b16 a[152:153], v8 offset:16384
  ds_read_b128 a[204:207], v4 offset:256
  v_mfma_f32_16x16x32_bf16 v[132:135], a[176:179], a[128:131], v[132:135]
  ds_read_b64_tr_b16 a[154:155], v8 offset:16896
  s_add_u32 m0, s27, 98304
  v_mfma_f32_16x16x32_bf16 v[136:139], a[180:183], a[56:59], v[136:139]
  ds_read_b64_tr_b16 a[156:157], v9 offset:16384
  v_mfma_f32_16x16x32_bf16 v[140:143], a[180:183], a[128:131], v[140:143]
  ds_read_b64_tr_b16 a[158:159], v9 offset:16896
  s_add_u32 s24, s60, s66
  v_mfma_f32_16x16x32_bf16 v[144:147], a[184:187], a[56:59], v[144:147]
  ds_read_b64_tr_b16 a[160:161], v10 offset:16384
  v_mfma_f32_16x16x32_bf16 v[148:151], a[184:187], a[128:131], v[148:151]
  ds_read_b64_tr_b16 a[162:163], v10 offset:16896
  buffer_load_dwordx4 v22, s[8:11], s24 offen lds
  v_mfma_f32_16x16x32_bf16 v[152:155], a[188:191], a[56:59], v[152:155]
  ds_read_b64_tr_b16 a[164:165], v11 offset:16384
  v_mfma_f32_16x16x32_bf16 v[156:159], a[188:191], a[128:131], v[156:159]
  ds_read_b64_tr_b16 a[166:167], v11 offset:16896
  s_waitcnt lgkmcnt(9)
  v_mfma_f32_16x16x32_bf16 v[128:131], a[192:195], a[60:63], v[128:131]
  ds_read_b64_tr_b16 a[168:169], v8 offset:20480
  v_mfma_f32_16x16x32_bf16 v[132:135], a[192:195], a[132:135], v[132:135]
  ds_read_b64_tr_b16 a[170:171], v8 offset:20992
  ds_read_b128 a[208:211], v4 offset:512
  v_mfma_f32_16x16x32_bf16 v[136:139], a[196:199], a[60:63], v[136:139]
  ds_read_b64_tr_b16 a[172:173], v9 offset:20480
  v_mfma_f32_16x16x32_bf16 v[140:143], a[196:199], a[132:135], v[140:143]
  ds_read_b64_tr_b16 a[174:175], v9 offset:20992
  s_add_u32 m0, s27, 102400
  v_mfma_f32_16x16x32_bf16 v[144:147], a[144:147], a[60:63], v[144:147]
  ds_read_b64_tr_b16 a[176:177], v10 offset:20480
  v_mfma_f32_16x16x32_bf16 v[148:151], a[144:147], a[132:135], v[148:151]
  ds_read_b64_tr_b16 a[178:179], v10 offset:20992
  buffer_load_dwordx4 v23, s[8:11], s24 offen lds
  v_mfma_f32_16x16x32_bf16 v[152:155], a[148:151], a[60:63], v[152:155]
  ds_read_b64_tr_b16 a[180:181], v11 offset:20480
  v_mfma_f32_16x16x32_bf16 v[156:159], a[148:151], a[132:135], v[156:159]
  ds_read_b64_tr_b16 a[182:183], v11 offset:20992
  s_waitcnt vmcnt(18)
  s_barrier
  s_waitcnt lgkmcnt(9)
  v_mfma_f32_16x16x32_bf16 v[128:131], a[152:155], a[64:67], v[128:131]
  ds_read_b64_tr_b16 a[184:185], v8 offset:24576
  ds_read_b128 a[212:215], v4 offset:768
  v_mfma_f32_16x16x32_bf16 v[132:135], a[152:155], a[136:139], v[132:135]
  ds_read_b64_tr_b16 a[186:187], v8 offset:25088
  s_add_u32 m0, s27, 106496
  v_mfma_f32_16x16x32_bf16 v[136:139], a[156:159], a[64:67], v[136:139]
  ds_read_b64_tr_b16 a[188:189], v9 offset:24576
  v_mfma_f32_16x16x32_bf16 v[140:143], a[156:159], a[136:139], v[140:143]
  ds_read_b64_tr_b16 a[190:191], v9 offset:25088
  s_add_u32 s24, s61, s65
  v_mfma_f32_16x16x32_bf16 v[144:147], a[160:163], a[64:67], v[144:147]
  ds_read_b64_tr_b16 a[192:193], v10 offset:24576
  v_mfma_f32_16x16x32_bf16 v[148:151], a[160:163], a[136:139], v[148:151]
  ds_read_b64_tr_b16 a[194:195], v10 offset:25088
  buffer_load_dwordx4 v22, s[8:11], s24 offen lds
  v_mfma_f32_16x16x32_bf16 v[152:155], a[164:167], a[64:67], v[152:155]
  ds_read_b64_tr_b16 a[196:197], v11 offset:24576
  v_mfma_f32_16x16x32_bf16 v[156:159], a[164:167], a[136:139], v[156:159]
  ds_read_b64_tr_b16 a[198:199], v11 offset:25088
  s_waitcnt lgkmcnt(9)
  v_mfma_f32_16x16x32_bf16 v[128:131], a[168:171], a[68:71], v[128:131]
  ds_read_b64_tr_b16 a[144:145], v8 offset:28672
  v_mfma_f32_16x16x32_bf16 v[132:135], a[168:171], a[140:143], v[132:135]
  ds_read_b64_tr_b16 a[146:147], v8 offset:29184
  s_add_u32 m0, s27, 110592
  v_mfma_f32_16x16x32_bf16 v[136:139], a[172:175], a[68:71], v[136:139]
  ds_read_b64_tr_b16 a[148:149], v9 offset:28672
  v_mfma_f32_16x16x32_bf16 v[140:143], a[172:175], a[140:143], v[140:143]
  ds_read_b64_tr_b16 a[150:151], v9 offset:29184
  v_mfma_f32_16x16x32_bf16 v[144:147], a[176:179], a[68:71], v[144:147]
  ds_read_b64_tr_b16 a[152:153], v10 offset:28672
  v_mfma_f32_16x16x32_bf16 v[148:151], a[176:179], a[140:143], v[148:151]
  ds_read_b64_tr_b16 a[154:155], v10 offset:29184
  buffer_load_dwordx4 v23, s[8:11], s24 offen lds
  v_mfma_f32_16x16x32_bf16 v[152:155], a[180:183], a[68:71], v[152:155]
  ds_read_b64_tr_b16 a[156:157], v11 offset:28672
  v_mfma_f32_16x16x32_bf16 v[156:159], a[180:183], a[140:143], v[156:159]
  ds_read_b64_tr_b16 a[158:159], v11 offset:29184
  v_mfma_f32_16x16x32_bf16 v[128:131], a[200:203], v[24:27], v[128:131]
  v_mfma_f32_16x16x32_bf16 v[132:135], a[200:203], v[28:31], v[132:135]
  v_mfma_f32_16x16x32_bf16 v[136:139], a[204:207], v[24:27], v[136:139]
  v_mfma_f32_16x16x32_bf16 v[140:143], a[204:207], v[28:31], v[140:143]
  v_mfma_f32_16x16x32_bf16 v[144:147], a[208:211], v[24:27], v[144:147]
  v_mfma_f32_16x16x32_bf16 v[148:151], a[208:211], v[28:31], v[148:151]
  s_waitcnt lgkmcnt(14)
  v_mfma_f32_16x16x32_bf16 v[152:155], a[212:215], v[24:27], v[152:155]
  v_mfma_f32_16x16x32_bf16 v[156:159], a[212:215], v[28:31], v[156:159]
  s_waitcnt lgkmcnt(8)
  v_mfma_f32_16x16x32_bf16 v[32:35], a[184:187], v[160:163], 0
  ds_read_b64_tr_b16 a[160:161], v8 offset:32768
  s_add_u32 m0, s27, 114688
  v_mfma_f32_16x16x32_bf16 v[36:39], a[184:187], v[164:167], 0
  ds_read_b64_tr_b16 a[162:163], v8 offset:33280
  s_add_u32 s24, s62, s65
  buffer_load_dwordx4 v22, s[8:11], s24 offen lds
  v_mfma_f32_16x16x32_bf16 v[40:43], a[188:191], v[160:163], 0
  ds_read_b64_tr_b16 a[164:165], v9 offset:32768
  v_cvt_pk_bf16_f32 v224, v128, v129
  v_mfma_f32_16x16x32_bf16 v[44:47], a[188:191], v[164:167], 0
  ds_read_b64_tr_b16 a[166:167], v9 offset:33280
  v_cvt_pk_bf16_f32 v225, v130, v131
  v_mfma_f32_16x16x32_bf16 v[48:51], a[192:195], v[160:163], 0
  ds_read_b64_tr_b16 a[168:169], v10 offset:32768
  v_cvt_pk_bf16_f32 v226, v136, v137
  v_mfma_f32_16x16x32_bf16 v[52:55], a[192:195], v[164:167], 0
  ds_read_b64_tr_b16 a[170:171], v10 offset:33280
  v_cvt_pk_bf16_f32 v227, v138, v139
  v_pk_max_i16 v224, v224, 0
  v_mfma_f32_16x16x32_bf16 v[56:59], a[196:199], v[160:163], 0
  ds_read_b64_tr_b16 a[172:173], v11 offset:32768
  v_pk_max_i16 v225, v225, 0
  v_mfma_f32_16x16x32_bf16 v[60:63], a[196:199], v[164:167], 0
  ds_read_b64_tr_b16 a[174:175], v11 offset:33280
  v_pk_max_i16 v226, v226, 0
  s_waitcnt lgkmcnt(8)
  v_mfma_f32_16x16x32_bf16 v[32:35], a[144:147], v[168:171], v[32:35]
  ds_read_b64_tr_b16 a[176:177], v8 offset:36864
  s_add_u32 m0, s27, 118784
  v_mfma_f32_16x16x32_bf16 v[36:39], a[144:147], v[172:175], v[36:39]
  ds_read_b64_tr_b16 a[178:179], v8 offset:37376
  buffer_load_dwordx4 v23, s[8:11], s24 offen lds
  v_pk_max_i16 v227, v227, 0
  v_mfma_f32_16x16x32_bf16 v[40:43], a[148:151], v[168:171], v[40:43]
  ds_read_b64_tr_b16 a[180:181], v9 offset:36864
  buffer_store_dwordx4 v[224:227], v2, s[12:15], s30 offen offset:0 sc0 sc1
  v_mfma_f32_16x16x32_bf16 v[44:47], a[148:151], v[172:175], v[44:47]
  ds_read_b64_tr_b16 a[182:183], v9 offset:37376
  v_cvt_pk_bf16_f32 v228, v132, v133
  v_mfma_f32_16x16x32_bf16 v[48:51], a[152:155], v[168:171], v[48:51]
  ds_read_b64_tr_b16 a[184:185], v10 offset:36864
  v_cvt_pk_bf16_f32 v229, v134, v135
  v_mfma_f32_16x16x32_bf16 v[52:55], a[152:155], v[172:175], v[52:55]
  ds_read_b64_tr_b16 a[186:187], v10 offset:37376
  v_cvt_pk_bf16_f32 v230, v140, v141
  v_mfma_f32_16x16x32_bf16 v[56:59], a[156:159], v[168:171], v[56:59]
  ds_read_b64_tr_b16 a[188:189], v11 offset:36864
  v_cvt_pk_bf16_f32 v231, v142, v143
  v_mfma_f32_16x16x32_bf16 v[60:63], a[156:159], v[172:175], v[60:63]
  ds_read_b64_tr_b16 a[190:191], v11 offset:37376
  v_pk_max_i16 v228, v228, 0
  s_waitcnt lgkmcnt(8)
  v_mfma_f32_16x16x32_bf16 v[32:35], a[160:163], v[176:179], v[32:35]
  ds_read_b64_tr_b16 a[192:193], v8 offset:40960
  s_add_u32 m0, s27, 122880
  v_mfma_f32_16x16x32_bf16 v[36:39], a[160:163], v[180:183], v[36:39]
  ds_read_b64_tr_b16 a[194:195], v8 offset:41472
  s_add_u32 s24, s63, s65
  buffer_load_dwordx4 v22, s[8:11], s24 offen lds
  v_mfma_f32_16x16x32_bf16 v[40:43], a[164:167], v[176:179], v[40:43]
  ds_read_b64_tr_b16 a[196:197], v9 offset:40960
  v_pk_max_i16 v229, v229, 0
  v_mfma_f32_16x16x32_bf16 v[44:47], a[164:167], v[180:183], v[44:47]
  ds_read_b64_tr_b16 a[198:199], v9 offset:41472
  v_pk_max_i16 v230, v230, 0
  v_mfma_f32_16x16x32_bf16 v[48:51], a[168:171], v[176:179], v[48:51]
  ds_read_b64_tr_b16 a[144:145], v10 offset:40960
  v_pk_max_i16 v231, v231, 0
  v_mfma_f32_16x16x32_bf16 v[52:55], a[168:171], v[180:183], v[52:55]
  ds_read_b64_tr_b16 a[146:147], v10 offset:41472
  buffer_store_dwordx4 v[228:231], v2, s[12:15], s30 offen offset:1024 sc0 sc1
  v_cvt_pk_bf16_f32 v232, v144, v145
  v_mfma_f32_16x16x32_bf16 v[56:59], a[172:175], v[176:179], v[56:59]
  ds_read_b64_tr_b16 a[148:149], v11 offset:40960
  v_cvt_pk_bf16_f32 v233, v146, v147
  v_mfma_f32_16x16x32_bf16 v[60:63], a[172:175], v[180:183], v[60:63]
  ds_read_b64_tr_b16 a[150:151], v11 offset:41472
  v_cvt_pk_bf16_f32 v234, v152, v153
  s_waitcnt lgkmcnt(8)
  v_mfma_f32_16x16x32_bf16 v[32:35], a[176:179], v[184:187], v[32:35]
  ds_read_b64_tr_b16 a[152:153], v8 offset:45056
  buffer_load_dword v4, v6, s[12:15], s17 offen offset:16 sc0 sc1
  v_mfma_f32_16x16x32_bf16 v[36:39], a[176:179], v[188:191], v[36:39]
  ds_read_b64_tr_b16 a[154:155], v8 offset:45568
  s_add_u32 m0, s27, 126976
  s_nop 0
  buffer_load_dwordx4 v23, s[8:11], s24 offen lds
  v_mfma_f32_16x16x32_bf16 v[40:43], a[180:183], v[184:187], v[40:43]
  ds_read_b64_tr_b16 a[156:157], v9 offset:45056
  v_cvt_pk_bf16_f32 v235, v154, v155
  v_mfma_f32_16x16x32_bf16 v[44:47], a[180:183], v[188:191], v[44:47]
  ds_read_b64_tr_b16 a[158:159], v9 offset:45568
  v_pk_max_i16 v232, v232, 0
  v_mfma_f32_16x16x32_bf16 v[48:51], a[184:187], v[184:187], v[48:51]
  ds_read_b64_tr_b16 a[160:161], v10 offset:45056
  v_pk_max_i16 v233, v233, 0
  v_mfma_f32_16x16x32_bf16 v[52:55], a[184:187], v[188:191], v[52:55]
  ds_read_b64_tr_b16 a[162:163], v10 offset:45568
  v_pk_max_i16 v234, v234, 0
  v_pk_max_i16 v235, v235, 0
  v_mfma_f32_16x16x32_bf16 v[56:59], a[188:191], v[184:187], v[56:59]
  ds_read_b64_tr_b16 a[164:165], v11 offset:45056
  buffer_store_dwordx4 v[232:235], v2, s[12:15], s30 offen offset:2048 sc0 sc1
  v_mfma_f32_16x16x32_bf16 v[60:63], a[188:191], v[188:191], v[60:63]
  ds_read_b64_tr_b16 a[166:167], v11 offset:45568
  v_cvt_pk_bf16_f32 v236, v148, v149
  s_waitcnt vmcnt(20)
  s_barrier
  s_waitcnt lgkmcnt(8)
  v_mfma_f32_16x16x32_bf16 v[32:35], a[192:195], v[192:195], v[32:35]
  ds_read_b64_tr_b16 a[168:169], v8 offset:49152
  s_add_u32 m0, s27, 131072
  v_mfma_f32_16x16x32_bf16 v[36:39], a[192:195], v[196:199], v[36:39]
  ds_read_b64_tr_b16 a[170:171], v8 offset:49664
  s_add_u32 s24, s64, s65
  buffer_load_dwordx4 v22, s[8:11], s24 offen lds
  v_mfma_f32_16x16x32_bf16 v[40:43], a[196:199], v[192:195], v[40:43]
  ds_read_b64_tr_b16 a[172:173], v9 offset:49152
  v_cvt_pk_bf16_f32 v237, v150, v151
  v_mfma_f32_16x16x32_bf16 v[44:47], a[196:199], v[196:199], v[44:47]
  ds_read_b64_tr_b16 a[174:175], v9 offset:49664
  v_cvt_pk_bf16_f32 v238, v156, v157
  v_mfma_f32_16x16x32_bf16 v[48:51], a[144:147], v[192:195], v[48:51]
  ds_read_b64_tr_b16 a[176:177], v10 offset:49152
  v_cvt_pk_bf16_f32 v239, v158, v159
  v_mfma_f32_16x16x32_bf16 v[52:55], a[144:147], v[196:199], v[52:55]
  ds_read_b64_tr_b16 a[178:179], v10 offset:49664
  v_pk_max_i16 v236, v236, 0
  v_pk_max_i16 v237, v237, 0
  v_mfma_f32_16x16x32_bf16 v[56:59], a[148:151], v[192:195], v[56:59]
  ds_read_b64_tr_b16 a[180:181], v11 offset:49152
  v_pk_max_i16 v238, v238, 0
  v_mfma_f32_16x16x32_bf16 v[60:63], a[148:151], v[196:199], v[60:63]
  ds_read_b64_tr_b16 a[182:183], v11 offset:49664
  v_pk_max_i16 v239, v239, 0
  s_waitcnt lgkmcnt(8)
  v_mfma_f32_16x16x32_bf16 v[32:35], a[152:155], v[200:203], v[32:35]
  ds_read_b64_tr_b16 a[184:185], v8 offset:53248
  s_add_u32 m0, s27, 135168
  v_mfma_f32_16x16x32_bf16 v[36:39], a[152:155], v[204:207], v[36:39]
  ds_read_b64_tr_b16 a[186:187], v8 offset:53760
  buffer_load_dwordx4 v23, s[8:11], s24 offen lds
  v_mfma_f32_16x16x32_bf16 v[40:43], a[156:159], v[200:203], v[40:43]
  ds_read_b64_tr_b16 a[188:189], v9 offset:53248
  v_mfma_f32_16x16x32_bf16 v[44:47], a[156:159], v[204:207], v[44:47]
  ds_read_b64_tr_b16 a[190:191], v9 offset:53760
  buffer_store_dwordx4 v[236:239], v2, s[12:15], s30 offen offset:3072 sc0 sc1
  v_mfma_f32_16x16x32_bf16 v[48:51], a[160:163], v[200:203], v[48:51]
  ds_read_b64_tr_b16 a[192:193], v10 offset:53248
  v_mfma_f32_16x16x32_bf16 v[52:55], a[160:163], v[204:207], v[52:55]
  ds_read_b64_tr_b16 a[194:195], v10 offset:53760
  s_add_u32 s30, s30, 4096
  v_mfma_f32_16x16x32_bf16 v[56:59], a[164:167], v[200:203], v[56:59]
  ds_read_b64_tr_b16 a[196:197], v11 offset:53248
  v_mfma_f32_16x16x32_bf16 v[60:63], a[164:167], v[204:207], v[60:63]
  ds_read_b64_tr_b16 a[198:199], v11 offset:53760
  s_waitcnt lgkmcnt(8)
  v_mfma_f32_16x16x32_bf16 v[32:35], a[168:171], v[208:211], v[32:35]
  ds_read_b64_tr_b16 a[144:145], v8 offset:57344
  v_mfma_f32_16x16x32_bf16 v[36:39], a[168:171], v[212:215], v[36:39]
  ds_read_b64_tr_b16 a[146:147], v8 offset:57856
  s_add_u32 m0, s27, 139264
  v_mfma_f32_16x16x32_bf16 v[40:43], a[172:175], v[208:211], v[40:43]
  ds_read_b64_tr_b16 a[148:149], v9 offset:57344
  v_mfma_f32_16x16x32_bf16 v[44:47], a[172:175], v[212:215], v[44:47]
  ds_read_b64_tr_b16 a[150:151], v9 offset:57856
  s_add_u32 s24, s61, s66
  v_mfma_f32_16x16x32_bf16 v[48:51], a[176:179], v[208:211], v[48:51]
  ds_read_b64_tr_b16 a[152:153], v10 offset:57344
  v_mfma_f32_16x16x32_bf16 v[52:55], a[176:179], v[212:215], v[52:55]
  ds_read_b64_tr_b16 a[154:155], v10 offset:57856
  buffer_load_dwordx4 v22, s[8:11], s24 offen lds
  v_mfma_f32_16x16x32_bf16 v[56:59], a[180:183], v[208:211], v[56:59]
  ds_read_b64_tr_b16 a[156:157], v11 offset:57344
  v_mfma_f32_16x16x32_bf16 v[60:63], a[180:183], v[212:215], v[60:63]
  ds_read_b64_tr_b16 a[158:159], v11 offset:57856
  s_waitcnt lgkmcnt(8)
  v_mfma_f32_16x16x32_bf16 v[32:35], a[184:187], v[216:219], v[32:35]
  ds_read_b64_tr_b16 a[160:161], v8 offset:61440
  v_mfma_f32_16x16x32_bf16 v[36:39], a[184:187], v[220:223], v[36:39]
  ds_read_b64_tr_b16 a[162:163], v8 offset:61952
  s_add_u32 m0, s27, 143360
  v_mfma_f32_16x16x32_bf16 v[40:43], a[188:191], v[216:219], v[40:43]
  ds_read_b64_tr_b16 a[164:165], v9 offset:61440
  v_mfma_f32_16x16x32_bf16 v[44:47], a[188:191], v[220:223], v[44:47]
  ds_read_b64_tr_b16 a[166:167], v9 offset:61952
  v_mfma_f32_16x16x32_bf16 v[48:51], a[192:195], v[216:219], v[48:51]
  ds_read_b64_tr_b16 a[168:169], v10 offset:61440
  v_mfma_f32_16x16x32_bf16 v[52:55], a[192:195], v[220:223], v[52:55]
  ds_read_b64_tr_b16 a[170:171], v10 offset:61952
  buffer_load_dwordx4 v23, s[8:11], s24 offen lds
  v_mfma_f32_16x16x32_bf16 v[56:59], a[196:199], v[216:219], v[56:59]
  ds_read_b64_tr_b16 a[172:173], v11 offset:61440
  v_mfma_f32_16x16x32_bf16 v[60:63], a[196:199], v[220:223], v[60:63]
  ds_read_b64_tr_b16 a[174:175], v11 offset:61952
  s_waitcnt lgkmcnt(8)
  v_mfma_f32_16x16x32_bf16 v[32:35], a[144:147], v[224:227], v[32:35]
  ds_read_b64_tr_b16 a[176:177], v12 offset:0
  s_waitcnt vmcnt(7)
  v_readfirstlane_b32 s21, v4
  s_nop 0
  s_cmp_eq_u32 s21, 1
  s_cbranch_scc1 L_ok_0b
  s_mov_b32 s22, 0
L_sp_0b:
  buffer_load_dword v4, v6, s[12:15], s17 offen offset:16 sc0 sc1
  s_add_u32 s22, s22, 1
  s_waitcnt vmcnt(0)
  v_readfirstlane_b32 s21, v4
  s_cmp_gt_u32 s22, 0x40000
  s_cbranch_scc1 L_ok_0b
  s_cmp_lg_u32 s21, 1
  s_cbranch_scc1 L_sp_0b
L_ok_0b:
  v_mfma_f32_16x16x32_bf16 v[36:39], a[144:147], v[228:231], v[36:39]
  ds_read_b64_tr_b16 a[178:179], v12 offset:512
  buffer_load_dwordx4 a[0:3], v2, s[12:15], s31 offen offset:0 sc1
  v_mfma_f32_16x16x32_bf16 v[40:43], a[148:151], v[224:227], v[40:43]
  ds_read_b64_tr_b16 a[180:181], v13 offset:0
  buffer_load_dwordx4 a[4:7], v2, s[12:15], s31 offen offset:1024 sc1
  v_mfma_f32_16x16x32_bf16 v[44:47], a[148:151], v[228:231], v[44:47]
  ds_read_b64_tr_b16 a[182:183], v13 offset:512
  s_add_u32 m0, s27, 0
  v_mfma_f32_16x16x32_bf16 v[48:51], a[152:155], v[224:227], v[48:51]
  ds_read_b64_tr_b16 a[184:185], v14 offset:0
  s_add_u32 s24, s62, s66
  v_mfma_f32_16x16x32_bf16 v[52:55], a[152:155], v[228:231], v[52:55]
  ds_read_b64_tr_b16 a[186:187], v14 offset:512
  buffer_load_dwordx4 v22, s[8:11], s24 offen lds
  v_mfma_f32_16x16x32_bf16 v[56:59], a[156:159], v[224:227], v[56:59]
  ds_read_b64_tr_b16 a[188:189], v15 offset:0
  v_mfma_f32_16x16x32_bf16 v[60:63], a[156:159], v[228:231], v[60:63]
  ds_read_b64_tr_b16 a[190:191], v15 offset:512
  s_waitcnt lgkmcnt(8)
  v_mfma_f32_16x16x32_bf16 v[32:35], a[160:163], v[232:235], v[32:35]
  ds_read_b64_tr_b16 a[192:193], v12 offset:4096
  v_mfma_f32_16x16x32_bf16 v[36:39], a[160:163], v[236:239], v[36:39]
  ds_read_b64_tr_b16 a[194:195], v12 offset:4608
  buffer_load_dwordx4 a[8:11], v2, s[12:15], s31 offen offset:2048 sc1
  v_mfma_f32_16x16x32_bf16 v[40:43], a[164:167], v[232:235], v[40:43]
  ds_read_b64_tr_b16 a[196:197], v13 offset:4096
  v_mfma_f32_16x16x32_bf16 v[44:47], a[164:167], v[236:239], v[44:47]
  ds_read_b64_tr_b16 a[198:199], v13 offset:4608
  s_add_u32 m0, s27, 4096
  v_mfma_f32_16x16x32_bf16 v[48:51], a[168:171], v[232:235], v[48:51]
  ds_read_b64_tr_b16 a[144:145], v14 offset:4096
  v_mfma_f32_16x16x32_bf16 v[52:55], a[168:171], v[236:239], v[52:55]
  ds_read_b64_tr_b16 a[146:147], v14 offset:4608
  buffer_load_dwordx4 v23, s[8:11], s24 offen lds
  v_mfma_f32_16x16x32_bf16 v[56:59], a[172:175], v[232:235], v[56:59]
  ds_read_b64_tr_b16 a[148:149], v15 offset:4096
  v_mfma_f32_16x16x32_bf16 v[60:63], a[172:175], v[236:239], v[60:63]
  ds_read_b64_tr_b16 a[150:151], v15 offset:4608
  s_barrier
  s_waitcnt lgkmcnt(8)
  v_mfma_f32_16x16x32_bf16 v[64:67], a[176:179], v[160:163], 0
  ds_read_b64_tr_b16 a[152:153], v12 offset:8192
  buffer_load_dwordx4 a[12:15], v2, s[12:15], s31 offen offset:3072 sc1
  v_mfma_f32_16x16x32_bf16 v[68:71], a[176:179], v[164:167], 0
  ds_read_b64_tr_b16 a[154:155], v12 offset:8704
  s_add_u32 s31, s31, 4096
  v_mfma_f32_16x16x32_bf16 v[72:75], a[180:183], v[160:163], 0
  ds_read_b64_tr_b16 a[156:157], v13 offset:8192
  buffer_load_dwordx4 a[16:19], v2, s[12:15], s31 offen offset:0 sc1
  v_mfma_f32_16x16x32_bf16 v[76:79], a[180:183], v[164:167], 0
  ds_read_b64_tr_b16 a[158:159], v13 offset:8704
  s_add_u32 m0, s27, 8192
  v_mfma_f32_16x16x32_bf16 v[80:83], a[184:187], v[160:163], 0
  ds_read_b64_tr_b16 a[160:161], v14 offset:8192
  s_add_u32 s24, s63, s66
  v_mfma_f32_16x16x32_bf16 v[84:87], a[184:187], v[164:167], 0
  ds_read_b64_tr_b16 a[162:163], v14 offset:8704
  buffer_load_dwordx4 v22, s[8:11], s24 offen lds
  v_mfma_f32_16x16x32_bf16 v[88:91], a[188:191], v[160:163], 0
  ds_read_b64_tr_b16 a[164:165], v15 offset:8192
  v_mfma_f32_16x16x32_bf16 v[92:95], a[188:191], v[164:167], 0
  ds_read_b64_tr_b16 a[166:167], v15 offset:8704
  s_waitcnt lgkmcnt(8)
  v_mfma_f32_16x16x32_bf16 v[64:67], a[192:195], v[168:171], v[64:67]
  ds_read_b64_tr_b16 a[168:169], v12 offset:12288
  v_mfma_f32_16x16x32_bf16 v[68:71], a[192:195], v[172:175], v[68:71]
  ds_read_b64_tr_b16 a[170:171], v12 offset:12800
  buffer_load_dwordx4 a[20:23], v2, s[12:15], s31 offen offset:1024 sc1
  v_mfma_f32_16x16x32_bf16 v[72:75], a[196:199], v[168:171], v[72:75]
  ds_read_b64_tr_b16 a[172:173], v13 offset:12288
  v_mfma_f32_16x16x32_bf16 v[76:79], a[196:199], v[172:175], v[76:79]
  ds_read_b64_tr_b16 a[174:175], v13 offset:12800
  s_add_u32 m0, s27, 12288
  v_mfma_f32_16x16x32_bf16 v[80:83], a[144:147], v[168:171], v[80:83]
  ds_read_b64_tr_b16 a[176:177], v14 offset:12288
  v_mfma_f32_16x16x32_bf16 v[84:87], a[144:147], v[172:175], v[84:87]
  ds_read_b64_tr_b16 a[178:179], v14 offset:12800
  buffer_load_dwordx4 v23, s[8:11], s24 offen lds
  v_mfma_f32_16x16x32_bf16 v[88:91], a[148:151], v[168:171], v[88:91]
  ds_read_b64_tr_b16 a[180:181], v15 offset:12288
  v_mfma_f32_16x16x32_bf16 v[92:95], a[148:151], v[172:175], v[92:95]
  ds_read_b64_tr_b16 a[182:183], v15 offset:12800
  s_waitcnt lgkmcnt(8)
  v_mfma_f32_16x16x32_bf16 v[64:67], a[152:155], v[176:179], v[64:67]
  ds_read_b64_tr_b16 a[184:185], v12 offset:16384
  s_waitcnt vmcnt(12)
  v_mfma_f32_16x16x32_bf16 v[68:71], a[152:155], v[180:183], v[68:71]
  ds_read_b64_tr_b16 a[186:187], v12 offset:16896
  s_mov_b64 exec, 1
  buffer_store_dword v5, v6, s[12:15], s16 offen offset:16 sc0 sc1
  s_mov_b64 exec, -1
  v_mfma_f32_16x16x32_bf16 v[72:75], a[156:159], v[176:179], v[72:75]
  ds_read_b64_tr_b16 a[188:189], v13 offset:16384
  buffer_load_dwordx4 a[24:27], v2, s[12:15], s31 offen offset:2048 sc1
  v_mfma_f32_16x16x32_bf16 v[76:79], a[156:159], v[180:183], v[76:79]
  ds_read_b64_tr_b16 a[190:191], v13 offset:16896
  buffer_load_dwordx4 a[28:31], v2, s[12:15], s31 offen offset:3072 sc1
  v_mfma_f32_16x16x32_bf16 v[80:83], a[160:163], v[176:179], v[80:83]
  ds_read_b64_tr_b16 a[192:193], v14 offset:16384
  s_add_u32 s31, s31, 4096
  v_mfma_f32_16x16x32_bf16 v[84:87], a[160:163], v[180:183], v[84:87]
  ds_read_b64_tr_b16 a[194:195], v14 offset:16896
  s_add_u32 m0, s27, 16384
  v_mfma_f32_16x16x32_bf16 v[88:91], a[164:167], v[176:179], v[88:91]
  ds_read_b64_tr_b16 a[196:197], v15 offset:16384
  s_add_u32 s24, s64, s66
  v_mfma_f32_16x16x32_bf16 v[92:95], a[164:167], v[180:183], v[92:95]
  ds_read_b64_tr_b16 a[198:199], v15 offset:16896
  buffer_load_dwordx4 v22, s[8:11], s24 offen lds
  s_waitcnt lgkmcnt(8)
  v_mfma_f32_16x16x32_bf16 v[64:67], a[168:171], v[184:187], v[64:67]
  ds_read_b64_tr_b16 a[144:145], v12 offset:20480
  v_mfma_f32_16x16x32_bf16 v[68:71], a[168:171], v[188:191], v[68:71]
  ds_read_b64_tr_b16 a[146:147], v12 offset:20992
  buffer_load_dwordx4 a[32:35], v2, s[12:15], s31 offen offset:0 sc1
  v_mfma_f32_16x16x32_bf16 v[72:75], a[172:175], v[184:187], v[72:75]
  ds_read_b64_tr_b16 a[148:149], v13 offset:20480
  v_mfma_f32_16x16x32_bf16 v[76:79], a[172:175], v[188:191], v[76:79]
  ds_read_b64_tr_b16 a[150:151], v13 offset:20992
  s_add_u32 m0, s27, 20480
  v_mfma_f32_16x16x32_bf16 v[80:83], a[176:179], v[184:187], v[80:83]
  ds_read_b64_tr_b16 a[152:153], v14 offset:20480
  v_mfma_f32_16x16x32_bf16 v[84:87], a[176:179], v[188:191], v[84:87]
  ds_read_b64_tr_b16 a[154:155], v14 offset:20992
  buffer_load_dwordx4 v23, s[8:11], s24 offen lds
  v_mfma_f32_16x16x32_bf16 v[88:91], a[180:183], v[184:187], v[88:91]
  ds_read_b64_tr_b16 a[156:157], v15 offset:20480
  v_mfma_f32_16x16x32_bf16 v[92:95], a[180:183], v[188:191], v[92:95]
  ds_read_b64_tr_b16 a[158:159], v15 offset:20992
  s_waitcnt lgkmcnt(8)
  v_mfma_f32_16x16x32_bf16 v[64:67], a[184:187], v[192:195], v[64:67]
  ds_read_b64_tr_b16 a[160:161], v12 offset:24576
  buffer_load_dwordx4 a[36:39], v2, s[12:15], s31 offen offset:1024 sc1
  v_mfma_f32_16x16x32_bf16 v[68:71], a[184:187], v[196:199], v[68:71]
  ds_read_b64_tr_b16 a[162:163], v12 offset:25088
  buffer_load_dwordx4 a[40:43], v2, s[12:15], s31 offen offset:2048 sc1
  v_mfma_f32_16x16x32_bf16 v[72:75], a[188:191], v[192:195], v[72:75]
  ds_read_b64_tr_b16 a[164:165], v13 offset:24576
  v_mfma_f32_16x16x32_bf16 v[76:79], a[188:191], v[196:199], v[76:79]
  ds_read_b64_tr_b16 a[166:167], v13 offset:25088
  s_add_u32 m0, s27, 24576
  v_mfma_f32_16x16x32_bf16 v[80:83], a[192:195], v[192:195], v[80:83]
  ds_read_b64_tr_b16 a[168:169], v14 offset:24576
  s_add_u32 s24, s56, s67
  v_mfma_f32_16x16x32_bf16 v[84:87], a[192:195], v[196:199], v[84:87]
  ds_read_b64_tr_b16 a[170:171], v14 offset:25088
  buffer_load_dwordx4 v22, s[8:11], s24 offen lds
  v_mfma_f32_16x16x32_bf16 v[88:91], a[196:199], v[192:195], v[88:91]
  ds_read_b64_tr_b16 a[172:173], v15 offset:24576
  v_mfma_f32_16x16x32_bf16 v[92:95], a[196:199], v[196:199], v[92:95]
  ds_read_b64_tr_b16 a[174:175], v15 offset:25088
  s_waitcnt lgkmcnt(8)
  v_mfma_f32_16x16x32_bf16 v[64:67], a[144:147], v[200:203], v[64:67]
  ds_read_b64_tr_b16 a[176:177], v12 offset:28672
  buffer_load_dwordx4 a[44:47], v2, s[12:15], s31 offen offset:3072 sc1
  v_mfma_f32_16x16x32_bf16 v[68:71], a[144:147], v[204:207], v[68:71]
  ds_read_b64_tr_b16 a[178:179], v12 offset:29184
  s_add_u32 s31, s31, 4096
  v_mfma_f32_16x16x32_bf16 v[72:75], a[148:151], v[200:203], v[72:75]
  ds_read_b64_tr_b16 a[180:181], v13 offset:28672
  v_mfma_f32_16x16x32_bf16 v[76:79], a[148:151], v[204:207], v[76:79]
  ds_read_b64_tr_b16 a[182:183], v13 offset:29184
  s_add_u32 m0, s27, 28672
  v_mfma_f32_16x16x32_bf16 v[80:83], a[152:155], v[200:203], v[80:83]
  ds_read_b64_tr_b16 a[184:185], v14 offset:28672
  v_mfma_f32_16x16x32_bf16 v[84:87], a[152:155], v[204:207], v[84:87]
  ds_read_b64_tr_b16 a[186:187], v14 offset:29184
  buffer_load_dwordx4 v23, s[8:11], s24 offen lds
  v_mfma_f32_16x16x32_bf16 v[88:91], a[156:159], v[200:203], v[88:91]
  ds_read_b64_tr_b16 a[188:189], v15 offset:28672
  v_mfma_f32_16x16x32_bf16 v[92:95], a[156:159], v[204:207], v[92:95]
  ds_read_b64_tr_b16 a[190:191], v15 offset:29184
  s_barrier
  s_waitcnt lgkmcnt(8)
  v_mfma_f32_16x16x32_bf16 v[64:67], a[160:163], v[208:211], v[64:67]
  ds_read_b64_tr_b16 a[192:193], v12 offset:32768
  buffer_load_dwordx4 a[48:51], v2, s[12:15], s31 offen offset:0 sc1
  v_mfma_f32_16x16x32_bf16 v[68:71], a[160:163], v[212:215], v[68:71]
  ds_read_b64_tr_b16 a[194:195], v12 offset:33280
  buffer_load_dwordx4 a[52:55], v2, s[12:15], s31 offen offset:1024 sc1
  v_mfma_f32_16x16x32_bf16 v[72:75], a[164:167], v[208:211], v[72:75]
  ds_read_b64_tr_b16 a[196:197], v13 offset:32768
  v_mfma_f32_16x16x32_bf16 v[76:79], a[164:167], v[212:215], v[76:79]
  ds_read_b64_tr_b16 a[198:199], v13 offset:33280
  s_add_u32 m0, s27, 32768
  v_mfma_f32_16x16x32_bf16 v[80:83], a[168:171], v[208:211], v[80:83]
  ds_read_b64_tr_b16 a[144:145], v14 offset:32768
  s_add_u32 s24, s57, s67
  v_mfma_f32_16x16x32_bf16 v[84:87], a[168:171], v[212:215], v[84:87]
  ds_read_b64_tr_b16 a[146:147], v14 offset:33280
  buffer_load_dwordx4 v22, s[8:11], s24 offen lds
  v_mfma_f32_16x16x32_bf16 v[88:91], a[172:175], v[208:211], v[88:91]
  ds_read_b64_tr_b16 a[148:149], v15 offset:32768
  v_mfma_f32_16x16x32_bf16 v[92:95], a[172:175], v[212:215], v[92:95]
  ds_read_b64_tr_b16 a[150:151], v15 offset:33280
  s_waitcnt lgkmcnt(8)
  v_mfma_f32_16x16x32_bf16 v[64:67], a[176:179], v[216:219], v[64:67]
  ds_read_b64_tr_b16 a[152:153], v12 offset:36864
  v_mfma_f32_16x16x32_bf16 v[68:71], a[176:179], v[220:223], v[68:71]
  ds_read_b64_tr_b16 a[154:155], v12 offset:37376
  buffer_load_dwordx4 a[56:59], v2, s[12:15], s31 offen offset:2048 sc1
  v_mfma_f32_16x16x32_bf16 v[72:75], a[180:183], v[216:219], v[72:75]
  ds_read_b64_tr_b16 a[156:157], v13 offset:36864
  v_mfma_f32_16x16x32_bf16 v[76:79], a[180:183], v[220:223], v[76:79]
  ds_read_b64_tr_b16 a[158:159], v13 offset:37376
  s_add_u32 m0, s27, 36864
  v_mfma_f32_16x16x32_bf16 v[80:83], a[184:187], v[216:219], v[80:83]
  ds_read_b64_tr_b16 a[160:161], v14 offset:36864
  v_mfma_f32_16x16x32_bf16 v[84:87], a[184:187], v[220:223], v[84:87]
  ds_read_b64_tr_b16 a[162:163], v14 offset:37376
  buffer_load_dwordx4 v23, s[8:11], s24 offen lds
  v_mfma_f32_16x16x32_bf16 v[88:91], a[188:191], v[216:219], v[88:91]
  ds_read_b64_tr_b16 a[164:165], v15 offset:36864
  v_mfma_f32_16x16x32_bf16 v[92:95], a[188:191], v[220:223], v[92:95]
  ds_read_b64_tr_b16 a[166:167], v15 offset:37376
  s_waitcnt lgkmcnt(8)
  v_mfma_f32_16x16x32_bf16 v[64:67], a[192:195], v[224:227], v[64:67]
  ds_read_b64_tr_b16 a[168:169], v12 offset:40960
  buffer_load_dwordx4 a[60:63], v2, s[12:15], s31 offen offset:3072 sc1
  v_mfma_f32_16x16x32_bf16 v[68:71], a[192:195], v[228:231], v[68:71]
  ds_read_b64_tr_b16 a[170:171], v12 offset:41472
  s_add_u32 s31, s31, 4096
  v_mfma_f32_16x16x32_bf16 v[72:75], a[196:199], v[224:227], v[72:75]
  ds_read_b64_tr_b16 a[172:173], v13 offset:40960
  v_mfma_f32_16x16x32_bf16 v[76:79], a[196:199], v[228:231], v[76:79]
  ds_read_b64_tr_b16 a[174:175], v13 offset:41472
  s_add_u32 m0, s27, 40960
  v_mfma_f32_16x16x32_bf16 v[80:83], a[144:147], v[224:227], v[80:83]
  ds_read_b64_tr_b16 a[176:177], v14 offset:40960
  s_add_u32 s24, s58, s67
  v_mfma_f32_16x16x32_bf16 v[84:87], a[144:147], v[228:231], v[84:87]
  ds_read_b64_tr_b16 a[178:179], v14 offset:41472
  buffer_load_dwordx4 v22, s[8:11], s24 offen lds
  v_mfma_f32_16x16x32_bf16 v[88:91], a[148:151], v[224:227], v[88:91]
  ds_read_b64_tr_b16 a[180:181], v15 offset:40960
  v_mfma_f32_16x16x32_bf16 v[92:95], a[148:151], v[228:231], v[92:95]
  ds_read_b64_tr_b16 a[182:183], v15 offset:41472
  s_waitcnt lgkmcnt(8)
  v_mfma_f32_16x16x32_bf16 v[64:67], a[152:155], v[232:235], v[64:67]
  ds_read_b64_tr_b16 a[184:185], v12 offset:45056
  v_mfma_f32_16x16x32_bf16 v[68:71], a[152:155], v[236:239], v[68:71]
  ds_read_b64_tr_b16 a[186:187], v12 offset:45568
  s_add_u32 m0, s27, 45056
  v_mfma_f32_16x16x32_bf16 v[72:75], a[156:159], v[232:235], v[72:75]
  ds_read_b64_tr_b16 a[188:189], v13 offset:45056
  v_mfma_f32_16x16x32_bf16 v[76:79], a[156:159], v[236:239], v[76:79]
  ds_read_b64_tr_b16 a[190:191], v13 offset:45568
  v_mfma_f32_16x16x32_bf16 v[80:83], a[160:163], v[232:235], v[80:83]
  ds_read_b64_tr_b16 a[192:193], v14 offset:45056
  v_mfma_f32_16x16x32_bf16 v[84:87], a[160:163], v[236:239], v[84:87]
  ds_read_b64_tr_b16 a[194:195], v14 offset:45568
  buffer_load_dwordx4 v23, s[8:11], s24 offen lds
  v_mfma_f32_16x16x32_bf16 v[88:91], a[164:167], v[232:235], v[88:91]
  ds_read_b64_tr_b16 a[196:197], v15 offset:45056
  v_mfma_f32_16x16x32_bf16 v[92:95], a[164:167], v[236:239], v[92:95]
  ds_read_b64_tr_b16 a[198:199], v15 offset:45568
  s_waitcnt lgkmcnt(8)
  s_waitcnt vmcnt(28)
  v_mfma_f32_16x16x32_bf16 v[32:35], a[168:171], a[0:3], v[32:35]
  ds_read_b64_tr_b16 a[144:145], v12 offset:49152
  s_waitcnt vmcnt(27)
  v_mfma_f32_16x16x32_bf16 v[36:39], a[168:171], a[4:7], v[36:39]
  ds_read_b64_tr_b16 a[146:147], v12 offset:49664
  s_add_u32 m0, s27, 49152
  v_mfma_f32_16x16x32_bf16 v[40:43], a[172:175], a[0:3], v[40:43]
  ds_read_b64_tr_b16 a[148:149], v13 offset:49152
  v_mfma_f32_16x16x32_bf16 v[44:47], a[172:175], a[4:7], v[44:47]
  ds_read_b64_tr_b16 a[150:151], v13 offset:49664
  s_add_u32 s24, s59, s67
  v_mfma_f32_16x16x32_bf16 v[48:51], a[176:179], a[0:3], v[48:51]
  ds_read_b64_tr_b16 a[152:153], v14 offset:49152
  v_mfma_f32_16x16x32_bf16 v[52:55], a[176:179], a[4:7], v[52:55]
  ds_read_b64_tr_b16 a[154:155], v14 offset:49664
  buffer_load_dwordx4 v22, s[8:11], s24 offen lds
  v_mfma_f32_16x16x32_bf16 v[56:59], a[180:183], a[0:3], v[56:59]
  ds_read_b64_tr_b16 a[156:157], v15 offset:49152
  v_mfma_f32_16x16x32_bf16 v[60:63], a[180:183], a[4:7], v[60:63]
  ds_read_b64_tr_b16 a[158:159], v15 offset:49664
  s_waitcnt lgkmcnt(8)
  s_waitcnt vmcnt(26)
  v_mfma_f32_16x16x32_bf16 v[32:35], a[184:187], a[8:11], v[32:35]
  ds_read_b64_tr_b16 a[160:161], v12 offset:53248
  s_waitcnt vmcnt(24)
  v_mfma_f32_16x16x32_bf16 v[36:39], a[184:187], a[12:15], v[36:39]
  ds_read_b64_tr_b16 a[162:163], v12 offset:53760
  s_add_u32 m0, s27, 53248
  v_mfma_f32_16x16x32_bf16 v[40:43], a[188:191], a[8:11], v[40:43]
  ds_read_b64_tr_b16 a[164:165], v13 offset:53248
  v_mfma_f32_16x16x32_bf16 v[44:47], a[188:191], a[12:15], v[44:47]
  ds_read_b64_tr_b16 a[166:167], v13 offset:53760
  v_mfma_f32_16x16x32_bf16 v[48:51], a[192:195], a[8:11], v[48:51]
  ds_read_b64_tr_b16 a[168:169], v14 offset:53248
  v_mfma_f32_16x16x32_bf16 v[52:55], a[192:195], a[12:15], v[52:55]
  ds_read_b64_tr_b16 a[170:171], v14 offset:53760
  buffer_load_dwordx4 v23, s[8:11], s24 offen lds
  v_mfma_f32_16x16x32_bf16 v[56:59], a[196:199], a[8:11], v[56:59]
  ds_read_b64_tr_b16 a[172:173], v15 offset:53248
  v_mfma_f32_16x16x32_bf16 v[60:63], a[196:199], a[12:15], v[60:63]
  ds_read_b64_tr_b16 a[174:175], v15 offset:53760
  s_barrier
  s_waitcnt lgkmcnt(8)
  s_waitcnt vmcnt(24)
  v_mfma_f32_16x16x32_bf16 v[32:35], a[144:147], a[16:19], v[32:35]
  ds_read_b64_tr_b16 a[176:177], v12 offset:57344
  s_waitcnt vmcnt(22)
  v_mfma_f32_16x16x32_bf16 v[36:39], a[144:147], a[20:23], v[36:39]
  ds_read_b64_tr_b16 a[178:179], v12 offset:57856
  s_add_u32 m0, s27, 57344
  v_mfma_f32_16x16x32_bf16 v[40:43], a[148:151], a[16:19], v[40:43]
  ds_read_b64_tr_b16 a[180:181], v13 offset:57344
  v_mfma_f32_16x16x32_bf16 v[44:47], a[148:151], a[20:23], v[44:47]
  ds_read_b64_tr_b16 a[182:183], v13 offset:57856
  s_add_u32 s24, s60, s67
  v_mfma_f32_16x16x32_bf16 v[48:51], a[152:155], a[16:19], v[48:51]
  ds_read_b64_tr_b16 a[184:185], v14 offset:57344
  v_mfma_f32_16x16x32_bf16 v[52:55], a[152:155], a[20:23], v[52:55]
  ds_read_b64_tr_b16 a[186:187], v14 offset:57856
  buffer_load_dwordx4 v22, s[8:11], s24 offen lds
  v_mfma_f32_16x16x32_bf16 v[56:59], a[156:159], a[16:19], v[56:59]
  ds_read_b64_tr_b16 a[188:189], v15 offset:57344
  v_mfma_f32_16x16x32_bf16 v[60:63], a[156:159], a[20:23], v[60:63]
  ds_read_b64_tr_b16 a[190:191], v15 offset:57856
  s_waitcnt lgkmcnt(8)
  s_waitcnt vmcnt(20)
  v_mfma_f32_16x16x32_bf16 v[32:35], a[160:163], a[24:27], v[32:35]
  ds_read_b64_tr_b16 a[192:193], v12 offset:61440
  s_waitcnt vmcnt(19)
  v_mfma_f32_16x16x32_bf16 v[36:39], a[160:163], a[28:31], v[36:39]
  ds_read_b64_tr_b16 a[194:195], v12 offset:61952
  s_add_u32 m0, s27, 61440
  v_mfma_f32_16x16x32_bf16 v[40:43], a[164:167], a[24:27], v[40:43]
  ds_read_b64_tr_b16 a[196:197], v13 offset:61440
  v_mfma_f32_16x16x32_bf16 v[44:47], a[164:167], a[28:31], v[44:47]
  ds_read_b64_tr_b16 a[198:199], v13 offset:61952
  v_mfma_f32_16x16x32_bf16 v[48:51], a[168:171], a[24:27], v[48:51]
  ds_read_b64_tr_b16 a[144:145], v14 offset:61440
  v_mfma_f32_16x16x32_bf16 v[52:55], a[168:171], a[28:31], v[52:55]
  ds_read_b64_tr_b16 a[146:147], v14 offset:61952
  buffer_load_dwordx4 v23, s[8:11], s24 offen lds
  v_mfma_f32_16x16x32_bf16 v[56:59], a[172:175], a[24:27], v[56:59]
  ds_read_b64_tr_b16 a[148:149], v15 offset:61440
  v_mfma_f32_16x16x32_bf16 v[60:63], a[172:175], a[28:31], v[60:63]
  ds_read_b64_tr_b16 a[150:151], v15 offset:61952
  s_waitcnt lgkmcnt(8)
  s_waitcnt vmcnt(18)
  v_mfma_f32_16x16x32_bf16 v[32:35], a[176:179], a[32:35], v[32:35]
  ds_read_b64_tr_b16 a[152:153], v16 offset:0
  s_waitcnt vmcnt(16)
  v_mfma_f32_16x16x32_bf16 v[36:39], a[176:179], a[36:39], v[36:39]
  ds_read_b64_tr_b16 a[154:155], v16 offset:512
  s_add_u32 m0, s27, 65536
  v_mfma_f32_16x16x32_bf16 v[40:43], a[180:183], a[32:35], v[40:43]
  ds_read_b64_tr_b16 a[156:157], v17 offset:0
  v_mfma_f32_16x16x32_bf16 v[44:47], a[180:183], a[36:39], v[44:47]
  ds_read_b64_tr_b16 a[158:159], v17 offset:512
  s_add_u32 s24, s61, s67
  v_mfma_f32_16x16x32_bf16 v[48:51], a[184:187], a[32:35], v[48:51]
  ds_read_b64_tr_b16 a[160:161], v18 offset:0
  v_mfma_f32_16x16x32_bf16 v[52:55], a[184:187], a[36:39], v[52:55]
  ds_read_b64_tr_b16 a[162:163], v18 offset:512
  buffer_load_dwordx4 v22, s[8:11], s24 offen lds
  v_mfma_f32_16x16x32_bf16 v[56:59], a[188:191], a[32:35], v[56:59]
  ds_read_b64_tr_b16 a[164:165], v19 offset:0
  v_mfma_f32_16x16x32_bf16 v[60:63], a[188:191], a[36:39], v[60:63]
  ds_read_b64_tr_b16 a[166:167], v19 offset:512
  s_waitcnt lgkmcnt(8)
  s_waitcnt vmcnt(16)
  v_mfma_f32_16x16x32_bf16 v[32:35], a[192:195], a[40:43], v[32:35]
  ds_read_b64_tr_b16 a[168:169], v16 offset:4096
  s_waitcnt vmcnt(14)
  v_mfma_f32_16x16x32_bf16 v[36:39], a[192:195], a[44:47], v[36:39]
  ds_read_b64_tr_b16 a[170:171], v16 offset:4608
  s_add_u32 m0, s27, 69632
  v_mfma_f32_16x16x32_bf16 v[40:43], a[196:199], a[40:43], v[40:43]
  ds_read_b64_tr_b16 a[172:173], v17 offset:4096
  v_mfma_f32_16x16x32_bf16 v[44:47], a[196:199], a[44:47], v[44:47]
  ds_read_b64_tr_b16 a[174:175], v17 offset:4608
  v_mfma_f32_16x16x32_bf16 v[48:51], a[144:147], a[40:43], v[48:51]
  ds_read_b64_tr_b16 a[176:177], v18 offset:4096
  v_mfma_f32_16x16x32_bf16 v[52:55], a[144:147], a[44:47], v[52:55]
  ds_read_b64_tr_b16 a[178:179], v18 offset:4608
  buffer_load_dwordx4 v23, s[8:11], s24 offen lds
  v_mfma_f32_16x16x32_bf16 v[56:59], a[148:151], a[40:43], v[56:59]
  ds_read_b64_tr_b16 a[180:181], v19 offset:4096
  v_mfma_f32_16x16x32_bf16 v[60:63], a[148:151], a[44:47], v[60:63]
  ds_read_b64_tr_b16 a[182:183], v19 offset:4608
  s_waitcnt lgkmcnt(8)
  s_waitcnt vmcnt(13)
  v_mfma_f32_16x16x32_bf16 v[32:35], a[152:155], a[48:51], v[32:35]
  ds_read_b64_tr_b16 a[184:185], v16 offset:8192
  s_waitcnt vmcnt(12)
  v_mfma_f32_16x16x32_bf16 v[36:39], a[152:155], a[52:55], v[36:39]
  ds_read_b64_tr_b16 a[186:187], v16 offset:8704
  s_add_u32 m0, s27, 73728
  v_mfma_f32_16x16x32_bf16 v[40:43], a[156:159], a[48:51], v[40:43]
  ds_read_b64_tr_b16 a[188:189], v17 offset:8192
  v_mfma_f32_16x16x32_bf16 v[44:47], a[156:159], a[52:55], v[44:47]
  ds_read_b64_tr_b16 a[190:191], v17 offset:8704
  s_add_u32 s24, s62, s67
  v_mfma_f32_16x16x32_bf16 v[48:51], a[160:163], a[48:51], v[48:51]
  ds_read_b64_tr_b16 a[192:193], v18 offset:8192
  v_mfma_f32_16x16x32_bf16 v[52:55], a[160:163], a[52:55], v[52:55]
  ds_read_b64_tr_b16 a[194:195], v18 offset:8704
  buffer_load_dwordx4 v22, s[8:11], s24 offen lds
  v_mfma_f32_16x16x32_bf16 v[56:59], a[164:167], a[48:51], v[56:59]
  ds_read_b64_tr_b16 a[196:197], v19 offset:8192
  v_mfma_f32_16x16x32_bf16 v[60:63], a[164:167], a[52:55], v[60:63]
  ds_read_b64_tr_b16 a[198:199], v19 offset:8704
  s_waitcnt lgkmcnt(8)
  s_waitcnt vmcnt(11)
  v_mfma_f32_16x16x32_bf16 v[32:35], a[168:171], a[56:59], v[32:35]
  ds_read_b64_tr_b16 a[144:145], v16 offset:12288
  s_waitcnt vmcnt(9)
  v_mfma_f32_16x16x32_bf16 v[36:39], a[168:171], a[60:63], v[36:39]
  ds_read_b64_tr_b16 a[146:147], v16 offset:12800
  s_add_u32 m0, s27, 77824
  v_mfma_f32_16x16x32_bf16 v[40:43], a[172:175], a[56:59], v[40:43]
  ds_read_b64_tr_b16 a[148:149], v17 offset:12288
  v_mfma_f32_16x16x32_bf16 v[44:47], a[172:175], a[60:63], v[44:47]
  ds_read_b64_tr_b16 a[150:151], v17 offset:12800
  v_mfma_f32_16x16x32_bf16 v[48:51], a[176:179], a[56:59], v[48:51]
  ds_read_b64_tr_b16 a[152:153], v18 offset:12288
  v_mfma_f32_16x16x32_bf16 v[52:55], a[176:179], a[60:63], v[52:55]
  ds_read_b64_tr_b16 a[154:155], v18 offset:12800
  buffer_load_dwordx4 v23, s[8:11], s24 offen lds
  v_mfma_f32_16x16x32_bf16 v[56:59], a[180:183], a[56:59], v[56:59]
  ds_read_b64_tr_b16 a[156:157], v19 offset:12288
  v_mfma_f32_16x16x32_bf16 v[60:63], a[180:183], a[60:63], v[60:63]
  ds_read_b64_tr_b16 a[158:159], v19 offset:12800
  s_barrier
  s_waitcnt lgkmcnt(8)
  v_mfma_f32_16x16x32_bf16 v[64:67], a[184:187], a[0:3], v[64:67]
  ds_read_b64_tr_b16 a[160:161], v8 offset:0
  s_add_u32 m0, s27, 81920
  v_mfma_f32_16x16x32_bf16 v[68:71], a[184:187], a[4:7], v[68:71]
  ds_read_b64_tr_b16 a[162:163], v8 offset:512
  s_add_u32 s24, s63, s67
  v_mfma_f32_16x16x32_bf16 v[72:75], a[188:191], a[0:3], v[72:75]
  ds_read_b64_tr_b16 a[164:165], v9 offset:0
  buffer_load_dwordx4 v22, s[8:11], s24 offen lds
  v_mfma_f32_16x16x32_bf16 v[76:79], a[188:191], a[4:7], v[76:79]
  ds_read_b64_tr_b16 a[166:167], v9 offset:512
  s_lshl_b32 s23, s65, 3
  v_mfma_f32_16x16x32_bf16 v[80:83], a[192:195], a[0:3], v[80:83]
  ds_read_b64_tr_b16 a[168:169], v10 offset:0
  s_add_u32 s23, s23, s25
  v_mfma_f32_16x16x32_bf16 v[84:87], a[192:195], a[4:7], v[84:87]
  ds_read_b64_tr_b16 a[170:171], v10 offset:512
  v_cvt_pk_bf16_f32 v32, v32, v33
  v_mfma_f32_16x16x32_bf16 v[88:91], a[196:199], a[0:3], v[88:91]
  ds_read_b64_tr_b16 a[172:173], v11 offset:0
  v_cvt_pk_bf16_f32 v33, v34, v35
  v_mfma_f32_16x16x32_bf16 v[92:95], a[196:199], a[4:7], v[92:95]
  ds_read_b64_tr_b16 a[174:175], v11 offset:512
  v_cvt_pk_bf16_f32 v34, v36, v37
  s_waitcnt lgkmcnt(8)
  v_mfma_f32_16x16x32_bf16 v[64:67], a[144:147], a[8:11], v[64:67]
  ds_read_b64_tr_b16 a[176:177], v8 offset:4096
  s_add_u32 m0, s27, 86016
  v_mfma_f32_16x16x32_bf16 v[68:71], a[144:147], a[12:15], v[68:71]
  ds_read_b64_tr_b16 a[178:179], v8 offset:4608
  buffer_load_dwordx4 v23, s[8:11], s24 offen lds
  v_mfma_f32_16x16x32_bf16 v[72:75], a[148:151], a[8:11], v[72:75]
  ds_read_b64_tr_b16 a[180:181], v9 offset:4096
  v_cvt_pk_bf16_f32 v35, v38, v39
  v_mfma_f32_16x16x32_bf16 v[76:79], a[148:151], a[12:15], v[76:79]
  ds_read_b64_tr_b16 a[182:183], v9 offset:4608
  v_cvt_pk_bf16_f32 v40, v40, v41
  v_mfma_f32_16x16x32_bf16 v[80:83], a[152:155], a[8:11], v[80:83]
  ds_read_b64_tr_b16 a[184:185], v10 offset:4096
  v_cvt_pk_bf16_f32 v41, v42, v43
  v_mfma_f32_16x16x32_bf16 v[84:87], a[152:155], a[12:15], v[84:87]
  ds_read_b64_tr_b16 a[186:187], v10 offset:4608
  v_cvt_pk_bf16_f32 v42, v44, v45
  v_mfma_f32_16x16x32_bf16 v[88:91], a[156:159], a[8:11], v[88:91]
  ds_read_b64_tr_b16 a[188:189], v11 offset:4096
  v_mfma_f32_16x16x32_bf16 v[92:95], a[156:159], a[12:15], v[92:95]
  ds_read_b64_tr_b16 a[190:191], v11 offset:4608
  s_waitcnt lgkmcnt(8)
  v_mfma_f32_16x16x32_bf16 v[64:67], a[160:163], a[16:19], v[64:67]
  ds_read_b64_tr_b16 a[192:193], v8 offset:8192
  s_add_u32 m0, s27, 90112
  v_mfma_f32_16x16x32_bf16 v[68:71], a[160:163], a[20:23], v[68:71]
  ds_read_b64_tr_b16 a[194:195], v8 offset:8704
  s_add_u32 s24, s64, s67
  v_mfma_f32_16x16x32_bf16 v[72:75], a[164:167], a[16:19], v[72:75]
  ds_read_b64_tr_b16 a[196:197], v9 offset:8192
  buffer_load_dwordx4 v22, s[8:11], s24 offen lds
  v_mfma_f32_16x16x32_bf16 v[76:79], a[164:167], a[20:23], v[76:79]
  ds_read_b64_tr_b16 a[198:199], v9 offset:8704
  v_cvt_pk_bf16_f32 v43, v46, v47
  v_mfma_f32_16x16x32_bf16 v[80:83], a[168:171], a[16:19], v[80:83]
  ds_read_b64_tr_b16 a[144:145], v10 offset:8192
  v_cvt_pk_bf16_f32 v48, v48, v49
  v_mfma_f32_16x16x32_bf16 v[84:87], a[168:171], a[20:23], v[84:87]
  ds_read_b64_tr_b16 a[146:147], v10 offset:8704
  v_cvt_pk_bf16_f32 v49, v50, v51
  v_mfma_f32_16x16x32_bf16 v[88:91], a[172:175], a[16:19], v[88:91]
  ds_read_b64_tr_b16 a[148:149], v11 offset:8192
  v_cvt_pk_bf16_f32 v50, v52, v53
  v_mfma_f32_16x16x32_bf16 v[92:95], a[172:175], a[20:23], v[92:95]
  ds_read_b64_tr_b16 a[150:151], v11 offset:8704
  s_waitcnt lgkmcnt(8)
  v_mfma_f32_16x16x32_bf16 v[64:67], a[176:179], a[24:27], v[64:67]
  ds_read_b64_tr_b16 a[152:153], v8 offset:12288
  s_add_u32 m0, s27, 94208
  v_mfma_f32_16x16x32_bf16 v[68:71], a[176:179], a[28:31], v[68:71]
  ds_read_b64_tr_b16 a[154:155], v8 offset:12800
  buffer_load_dwordx4 v23, s[8:11], s24 offen lds
  v_mfma_f32_16x16x32_bf16 v[72:75], a[180:183], a[24:27], v[72:75]
  ds_read_b64_tr_b16 a[156:157], v9 offset:12288
  v_cvt_pk_bf16_f32 v51, v54, v55
  v_mfma_f32_16x16x32_bf16 v[76:79], a[180:183], a[28:31], v[76:79]
  ds_read_b64_tr_b16 a[158:159], v9 offset:12800
  v_cvt_pk_bf16_f32 v56, v56, v57
  v_mfma_f32_16x16x32_bf16 v[80:83], a[184:187], a[24:27], v[80:83]
  ds_read_b64_tr_b16 a[160:161], v10 offset:12288
  v_cvt_pk_bf16_f32 v57, v58, v59
  v_mfma_f32_16x16x32_bf16 v[84:87], a[184:187], a[28:31], v[84:87]
  ds_read_b64_tr_b16 a[162:163], v10 offset:12800
  v_cvt_pk_bf16_f32 v58, v60, v61
  v_mfma_f32_16x16x32_bf16 v[88:91], a[188:191], a[24:27], v[88:91]
  ds_read_b64_tr_b16 a[164:165], v11 offset:12288
  v_mfma_f32_16x16x32_bf16 v[92:95], a[188:191], a[28:31], v[92:95]
  ds_read_b64_tr_b16 a[166:167], v11 offset:12800
  s_waitcnt lgkmcnt(8)
  v_mfma_f32_16x16x32_bf16 v[64:67], a[192:195], a[32:35], v[64:67]
  ds_read_b64_tr_b16 a[168:169], v8 offset:16384
  s_add_u32 m0, s27, 98304
  v_mfma_f32_16x16x32_bf16 v[68:71], a[192:195], a[36:39], v[68:71]
  ds_read_b64_tr_b16 a[170:171], v8 offset:16896
  s_add_u32 s24, s56, s39
  v_mfma_f32_16x16x32_bf16 v[72:75], a[196:199], a[32:35], v[72:75]
  ds_read_b64_tr_b16 a[172:173], v9 offset:16384
  buffer_load_dwordx4 v22, s[8:11], s24 offen lds
  v_mfma_f32_16x16x32_bf16 v[76:79], a[196:199], a[36:39], v[76:79]
  ds_read_b64_tr_b16 a[174:175], v9 offset:16896
  v_cvt_pk_bf16_f32 v59, v62, v63
  v_mfma_f32_16x16x32_bf16 v[80:83], a[144:147], a[32:35], v[80:83]
  ds_read_b64_tr_b16 a[176:177], v10 offset:16384
  v_permlane16_swap_b32 v32, v34
  v_mfma_f32_16x16x32_bf16 v[84:87], a[144:147], a[36:39], v[84:87]
  ds_read_b64_tr_b16 a[178:179], v10 offset:16896
  v_permlane16_swap_b32 v33, v35
  v_mfma_f32_16x16x32_bf16 v[88:91], a[148:151], a[32:35], v[88:91]
  ds_read_b64_tr_b16 a[180:181], v11 offset:16384
  buffer_store_dwordx4 v[32:35], v1, s[12:15], s23 offen offset:0 sc0 sc1
  v_mfma_f32_16x16x32_bf16 v[92:95], a[148:151], a[36:39], v[92:95]
  ds_read_b64_tr_b16 a[182:183], v11 offset:16896
  s_waitcnt lgkmcnt(8)
  v_mfma_f32_16x16x32_bf16 v[64:67], a[152:155], a[40:43], v[64:67]
  ds_read_b64_tr_b16 a[184:185], v8 offset:20480
  s_add_u32 m0, s27, 102400
  v_mfma_f32_16x16x32_bf16 v[68:71], a[152:155], a[44:47], v[68:71]
  ds_read_b64_tr_b16 a[186:187], v8 offset:20992
  buffer_load_dwordx4 v23, s[8:11], s24 offen lds
  v_mfma_f32_16x16x32_bf16 v[72:75], a[156:159], a[40:43], v[72:75]
  ds_read_b64_tr_b16 a[188:189], v9 offset:20480
  v_permlane16_swap_b32 v40, v42
  v_mfma_f32_16x16x32_bf16 v[76:79], a[156:159], a[44:47], v[76:79]
  ds_read_b64_tr_b16 a[190:191], v9 offset:20992
  v_permlane16_swap_b32 v41, v43
  v_mfma_f32_16x16x32_bf16 v[80:83], a[160:163], a[40:43], v[80:83]
  ds_read_b64_tr_b16 a[192:193], v10 offset:20480
  buffer_store_dwordx4 v[40:43], v1, s[12:15], s23 offen offset:256 sc0 sc1
  v_mfma_f32_16x16x32_bf16 v[84:87], a[160:163], a[44:47], v[84:87]
  ds_read_b64_tr_b16 a[194:195], v10 offset:20992
  v_permlane16_swap_b32 v48, v50
  v_mfma_f32_16x16x32_bf16 v[88:91], a[164:167], a[40:43], v[88:91]
  ds_read_b64_tr_b16 a[196:197], v11 offset:20480
  v_mfma_f32_16x16x32_bf16 v[92:95], a[164:167], a[44:47], v[92:95]
  ds_read_b64_tr_b16 a[198:199], v11 offset:20992
  s_waitcnt vmcnt(16)
  s_barrier
  s_waitcnt lgkmcnt(8)
  v_mfma_f32_16x16x32_bf16 v[64:67], a[168:171], a[48:51], v[64:67]
  ds_read_b64_tr_b16 a[144:145], v8 offset:24576
  s_add_u32 m0, s27, 106496
  v_mfma_f32_16x16x32_bf16 v[68:71], a[168:171], a[52:55], v[68:71]
  ds_read_b64_tr_b16 a[146:147], v8 offset:25088
  s_add_u32 s24, s57, s39
  v_mfma_f32_16x16x32_bf16 v[72:75], a[172:175], a[48:51], v[72:75]
  ds_read_b64_tr_b16 a[148:149], v9 offset:24576
  buffer_load_dwordx4 v22, s[8:11], s24 offen lds
  v_mfma_f32_16x16x32_bf16 v[76:79], a[172:175], a[52:55], v[76:79]
  ds_read_b64_tr_b16 a[150:151], v9 offset:25088
  v_permlane16_swap_b32 v49, v51
  v_mfma_f32_16x16x32_bf16 v[80:83], a[176:179], a[48:51], v[80:83]
  ds_read_b64_tr_b16 a[152:153], v10 offset:24576
  buffer_store_dwordx4 v[48:51], v1, s[12:15], s23 offen offset:512 sc0 sc1
  v_mfma_f32_16x16x32_bf16 v[84:87], a[176:179], a[52:55], v[84:87]
  ds_read_b64_tr_b16 a[154:155], v10 offset:25088
  v_permlane16_swap_b32 v56, v58
  v_mfma_f32_16x16x32_bf16 v[88:91], a[180:183], a[48:51], v[88:91]
  ds_read_b64_tr_b16 a[156:157], v11 offset:24576
  v_permlane16_swap_b32 v57, v59
  v_mfma_f32_16x16x32_bf16 v[92:95], a[180:183], a[52:55], v[92:95]
  ds_read_b64_tr_b16 a[158:159], v11 offset:25088
  s_waitcnt lgkmcnt(8)
  v_mfma_f32_16x16x32_bf16 v[64:67], a[184:187], a[56:59], v[64:67]
  ds_read_b64_tr_b16 a[160:161], v8 offset:28672
  v_mfma_f32_16x16x32_bf16 v[68:71], a[184:187], a[60:63], v[68:71]
  ds_read_b64_tr_b16 a[162:163], v8 offset:29184
  s_add_u32 m0, s27, 110592
  v_mfma_f32_16x16x32_bf16 v[72:75], a[188:191], a[56:59], v[72:75]
  ds_read_b64_tr_b16 a[164:165], v9 offset:28672
  v_mfma_f32_16x16x32_bf16 v[76:79], a[188:191], a[60:63], v[76:79]
  ds_read_b64_tr_b16 a[166:167], v9 offset:29184
  buffer_load_dwordx4 v23, s[8:11], s24 offen lds
  v_mfma_f32_16x16x32_bf16 v[80:83], a[192:195], a[56:59], v[80:83]
  ds_read_b64_tr_b16 a[168:169], v10 offset:28672
  v_mfma_f32_16x16x32_bf16 v[84:87], a[192:195], a[60:63], v[84:87]
  ds_read_b64_tr_b16 a[170:171], v10 offset:29184
  buffer_store_dwordx4 v[56:59], v1, s[12:15], s23 offen offset:768 sc0 sc1
  v_mfma_f32_16x16x32_bf16 v[88:91], a[196:199], a[56:59], v[88:91]
  ds_read_b64_tr_b16 a[172:173], v11 offset:28672
  v_mfma_f32_16x16x32_bf16 v[92:95], a[196:199], a[60:63], v[92:95]
  ds_read_b64_tr_b16 a[174:175], v11 offset:29184
  s_waitcnt lgkmcnt(8)
  v_mfma_f32_16x16x32_bf16 v[96:99], a[144:147], v[160:163], 0
  ds_read_b64_tr_b16 a[176:177], v8 offset:32768
  s_add_u32 m0, s27, 114688
  v_mfma_f32_16x16x32_bf16 v[100:103], a[144:147], v[164:167], 0
  ds_read_b64_tr_b16 a[178:179], v8 offset:33280
  s_add_u32 s24, s58, s39
  v_mfma_f32_16x16x32_bf16 v[104:107], a[148:151], v[160:163], 0
  ds_read_b64_tr_b16 a[180:181], v9 offset:32768
  buffer_load_dwordx4 v22, s[8:11], s24 offen lds
  v_mfma_f32_16x16x32_bf16 v[108:111], a[148:151], v[164:167], 0
  ds_read_b64_tr_b16 a[182:183], v9 offset:33280
  s_lshl_b32 s23, s66, 3
  v_mfma_f32_16x16x32_bf16 v[112:115], a[152:155], v[160:163], 0
  ds_read_b64_tr_b16 a[184:185], v10 offset:32768
  s_add_u32 s23, s23, s25
  v_mfma_f32_16x16x32_bf16 v[116:119], a[152:155], v[164:167], 0
  ds_read_b64_tr_b16 a[186:187], v10 offset:33280
  v_cvt_pk_bf16_f32 v64, v64, v65
  v_mfma_f32_16x16x32_bf16 v[120:123], a[156:159], v[160:163], 0
  ds_read_b64_tr_b16 a[188:189], v11 offset:32768
  v_cvt_pk_bf16_f32 v65, v66, v67
  v_mfma_f32_16x16x32_bf16 v[124:127], a[156:159], v[164:167], 0
  ds_read_b64_tr_b16 a[190:191], v11 offset:33280
  v_cvt_pk_bf16_f32 v66, v68, v69
  s_waitcnt lgkmcnt(8)
  v_mfma_f32_16x16x32_bf16 v[96:99], a[160:163], v[168:171], v[96:99]
  ds_read_b64_tr_b16 a[192:193], v8 offset:36864
  s_add_u32 m0, s27, 118784
  v_mfma_f32_16x16x32_bf16 v[100:103], a[160:163], v[172:175], v[100:103]
  ds_read_b64_tr_b16 a[194:195], v8 offset:37376
  buffer_load_dwordx4 v23, s[8:11], s24 offen lds
  v_mfma_f32_16x16x32_bf16 v[104:107], a[164:167], v[168:171], v[104:107]
  ds_read_b64_tr_b16 a[196:197], v9 offset:36864
  v_cvt_pk_bf16_f32 v67, v70, v71
  v_mfma_f32_16x16x32_bf16 v[108:111], a[164:167], v[172:175], v[108:111]
  ds_read_b64_tr_b16 a[198:199], v9 offset:37376
  v_cvt_pk_bf16_f32 v72, v72, v73
  v_mfma_f32_16x16x32_bf16 v[112:115], a[168:171], v[168:171], v[112:115]
  ds_read_b64_tr_b16 a[144:145], v10 offset:36864
  v_cvt_pk_bf16_f32 v73, v74, v75
  v_mfma_f32_16x16x32_bf16 v[116:119], a[168:171], v[172:175], v[116:119]
  ds_read_b64_tr_b16 a[146:147], v10 offset:37376
  v_cvt_pk_bf16_f32 v74, v76, v77
  v_mfma_f32_16x16x32_bf16 v[120:123], a[172:175], v[168:171], v[120:123]
  ds_read_b64_tr_b16 a[148:149], v11 offset:36864
  v_mfma_f32_16x16x32_bf16 v[124:127], a[172:175], v[172:175], v[124:127]
  ds_read_b64_tr_b16 a[150:151], v11 offset:37376
  s_waitcnt lgkmcnt(8)
  v_mfma_f32_16x16x32_bf16 v[96:99], a[176:179], v[176:179], v[96:99]
  ds_read_b64_tr_b16 a[152:153], v8 offset:40960
  s_add_u32 m0, s27, 122880
  v_mfma_f32_16x16x32_bf16 v[100:103], a[176:179], v[180:183], v[100:103]
  ds_read_b64_tr_b16 a[154:155], v8 offset:41472
  s_add_u32 s24, s59, s39
  v_mfma_f32_16x16x32_bf16 v[104:107], a[180:183], v[176:179], v[104:107]
  ds_read_b64_tr_b16 a[156:157], v9 offset:40960
  buffer_load_dwordx4 v22, s[8:11], s24 offen lds
  v_mfma_f32_16x16x32_bf16 v[108:111], a[180:183], v[180:183], v[108:111]
  ds_read_b64_tr_b16 a[158:159], v9 offset:41472
  v_cvt_pk_bf16_f32 v75, v78, v79
  v_mfma_f32_16x16x32_bf16 v[112:115], a[184:187], v[176:179], v[112:115]
  ds_read_b64_tr_b16 a[160:161], v10 offset:40960
  v_cvt_pk_bf16_f32 v80, v80, v81
  v_mfma_f32_16x16x32_bf16 v[116:119], a[184:187], v[180:183], v[116:119]
  ds_read_b64_tr_b16 a[162:163], v10 offset:41472
  v_cvt_pk_bf16_f32 v81, v82, v83
  v_mfma_f32_16x16x32_bf16 v[120:123], a[188:191], v[176:179], v[120:123]
  ds_read_b64_tr_b16 a[164:165], v11 offset:40960
  v_cvt_pk_bf16_f32 v82, v84, v85
  v_mfma_f32_16x16x32_bf16 v[124:127], a[188:191], v[180:183], v[124:127]
  ds_read_b64_tr_b16 a[166:167], v11 offset:41472
  s_waitcnt lgkmcnt(8)
  v_mfma_f32_16x16x32_bf16 v[96:99], a[192:195], v[184:187], v[96:99]
  ds_read_b64_tr_b16 a[168:169], v8 offset:45056
  s_add_u32 m0, s27, 126976
  v_mfma_f32_16x16x32_bf16 v[100:103], a[192:195], v[188:191], v[100:103]
  ds_read_b64_tr_b16 a[170:171], v8 offset:45568
  buffer_load_dwordx4 v23, s[8:11], s24 offen lds
  v_mfma_f32_16x16x32_bf16 v[104:107], a[196:199], v[184:187], v[104:107]
  ds_read_b64_tr_b16 a[172:173], v9 offset:45056
  v_cvt_pk_bf16_f32 v83, v86, v87
  v_mfma_f32_16x16x32_bf16 v[108:111], a[196:199], v[188:191], v[108:111]
  ds_read_b64_tr_b16 a[174:175], v9 offset:45568
  v_cvt_pk_bf16_f32 v88, v88, v89
  v_mfma_f32_16x16x32_bf16 v[112:115], a[144:147], v[184:187], v[112:115]
  ds_read_b64_tr_b16 a[176:177], v10 offset:45056
  v_cvt_pk_bf16_f32 v89, v90, v91
  v_mfma_f32_16x16x32_bf16 v[116:119], a[144:147], v[188:191], v[116:119]
  ds_read_b64_tr_b16 a[178:179], v10 offset:45568
  v_cvt_pk_bf16_f32 v90, v92, v93
  v_mfma_f32_16x16x32_bf16 v[120:123], a[148:151], v[184:187], v[120:123]
  ds_read_b64_tr_b16 a[180:181], v11 offset:45056
  v_mfma_f32_16x16x32_bf16 v[124:127], a[148:151], v[188:191], v[124:127]
  ds_read_b64_tr_b16 a[182:183], v11 offset:45568
  s_waitcnt vmcnt(18)
  s_barrier
  s_waitcnt lgkmcnt(8)
  v_mfma_f32_16x16x32_bf16 v[96:99], a[152:155], v[192:195], v[96:99]
  ds_read_b64_tr_b16 a[184:185], v8 offset:49152
  s_add_u32 m0, s27, 131072
  v_mfma_f32_16x16x32_bf16 v[100:103], a[152:155], v[196:199], v[100:103]
  ds_read_b64_tr_b16 a[186:187], v8 offset:49664
  s_add_u32 s24, s60, s39
  v_mfma_f32_16x16x32_bf16 v[104:107], a[156:159], v[192:195], v[104:107]
  ds_read_b64_tr_b16 a[188:189], v9 offset:49152
  buffer_load_dwordx4 v22, s[8:11], s24 offen lds
  v_mfma_f32_16x16x32_bf16 v[108:111], a[156:159], v[196:199], v[108:111]
  ds_read_b64_tr_b16 a[190:191], v9 offset:49664
  v_cvt_pk_bf16_f32 v91, v94, v95
  v_mfma_f32_16x16x32_bf16 v[112:115], a[160:163], v[192:195], v[112:115]
  ds_read_b64_tr_b16 a[192:193], v10 offset:49152
  v_permlane16_swap_b32 v64, v66
  v_mfma_f32_16x16x32_bf16 v[116:119], a[160:163], v[196:199], v[116:119]
  ds_read_b64_tr_b16 a[194:195], v10 offset:49664
  v_permlane16_swap_b32 v65, v67
  v_mfma_f32_16x16x32_bf16 v[120:123], a[164:167], v[192:195], v[120:123]
  ds_read_b64_tr_b16 a[196:197], v11 offset:49152
  buffer_store_dwordx4 v[64:67], v1, s[12:15], s23 offen offset:0 sc0 sc1
  v_mfma_f32_16x16x32_bf16 v[124:127], a[164:167], v[196:199], v[124:127]
  ds_read_b64_tr_b16 a[198:199], v11 offset:49664
  s_waitcnt lgkmcnt(8)
  v_mfma_f32_16x16x32_bf16 v[96:99], a[168:171], v[200:203], v[96:99]
  ds_read_b64_tr_b16 a[144:145], v8 offset:53248
  s_add_u32 m0, s27, 135168
  v_mfma_f32_16x16x32_bf16 v[100:103], a[168:171], v[204:207], v[100:103]
  ds_read_b64_tr_b16 a[146:147], v8 offset:53760
  buffer_load_dwordx4 v23, s[8:11], s24 offen lds
  v_mfma_f32_16x16x32_bf16 v[104:107], a[172:175], v[200:203], v[104:107]
  ds_read_b64_tr_b16 a[148:149], v9 offset:53248
  v_permlane16_swap_b32 v72, v74
  v_mfma_f32_16x16x32_bf16 v[108:111], a[172:175], v[204:207], v[108:111]
  ds_read_b64_tr_b16 a[150:151], v9 offset:53760
  v_permlane16_swap_b32 v73, v75
  v_mfma_f32_16x16x32_bf16 v[112:115], a[176:179], v[200:203], v[112:115]
  ds_read_b64_tr_b16 a[152:153], v10 offset:53248
  buffer_store_dwordx4 v[72:75], v1, s[12:15], s23 offen offset:256 sc0 sc1
  v_mfma_f32_16x16x32_bf16 v[116:119], a[176:179], v[204:207], v[116:119]
  ds_read_b64_tr_b16 a[154:155], v10 offset:53760
  v_permlane16_swap_b32 v80, v82
  v_mfma_f32_16x16x32_bf16 v[120:123], a[180:183], v[200:203], v[120:123]
  ds_read_b64_tr_b16 a[156:157], v11 offset:53248
  v_mfma_f32_16x16x32_bf16 v[124:127], a[180:183], v[204:207], v[124:127]
  ds_read_b64_tr_b16 a[158:159], v11 offset:53760
  s_waitcnt lgkmcnt(8)
  v_mfma_f32_16x16x32_bf16 v[96:99], a[184:187], v[208:211], v[96:99]
  ds_read_b64_tr_b16 a[160:161], v8 offset:57344
  s_add_u32 m0, s27, 139264
  v_mfma_f32_16x16x32_bf16 v[100:103], a[184:187], v[212:215], v[100:103]
  ds_read_b64_tr_b16 a[162:163], v8 offset:57856
  s_add_u32 s24, s61, s39
  v_mfma_f32_16x16x32_bf16 v[104:107], a[188:191], v[208:211], v[104:107]
  ds_read_b64_tr_b16 a[164:165], v9 offset:57344
  buffer_load_dwordx4 v22, s[8:11], s24 offen lds
  v_mfma_f32_16x16x32_bf16 v[108:111], a[188:191], v[212:215], v[108:111]
  ds_read_b64_tr_b16 a[166:167], v9 offset:57856
  v_permlane16_swap_b32 v81, v83
  v_mfma_f32_16x16x32_bf16 v[112:115], a[192:195], v[208:211], v[112:115]
  ds_read_b64_tr_b16 a[168:169], v10 offset:57344
  buffer_store_dwordx4 v[80:83], v1, s[12:15], s23 offen offset:512 sc0 sc1
  v_mfma_f32_16x16x32_bf16 v[116:119], a[192:195], v[212:215], v[116:119]
  ds_read_b64_tr_b16 a[170:171], v10 offset:57856
  v_permlane16_swap_b32 v88, v90
  v_mfma_f32_16x16x32_bf16 v[120:123], a[196:199], v[208:211], v[120:123]
  ds_read_b64_tr_b16 a[172:173], v11 offset:57344
  v_permlane16_swap_b32 v89, v91
  v_mfma_f32_16x16x32_bf16 v[124:127], a[196:199], v[212:215], v[124:127]
  ds_read_b64_tr_b16 a[174:175], v11 offset:57856
  s_waitcnt lgkmcnt(8)
  v_mfma_f32_16x16x32_bf16 v[96:99], a[144:147], v[216:219], v[96:99]
  ds_read_b64_tr_b16 a[176:177], v8 offset:61440
  v_mfma_f32_16x16x32_bf16 v[100:103], a[144:147], v[220:223], v[100:103]
  ds_read_b64_tr_b16 a[178:179], v8 offset:61952
  s_add_u32 m0, s27, 143360
  v_mfma_f32_16x16x32_bf16 v[104:107], a[148:151], v[216:219], v[104:107]
  ds_read_b64_tr_b16 a[180:181], v9 offset:61440
  v_mfma_f32_16x16x32_bf16 v[108:111], a[148:151], v[220:223], v[108:111]
  ds_read_b64_tr_b16 a[182:183], v9 offset:61952
  buffer_load_dwordx4 v23, s[8:11], s24 offen lds
  v_mfma_f32_16x16x32_bf16 v[112:115], a[152:155], v[216:219], v[112:115]
  ds_read_b64_tr_b16 a[184:185], v10 offset:61440
  v_mfma_f32_16x16x32_bf16 v[116:119], a[152:155], v[220:223], v[116:119]
  ds_read_b64_tr_b16 a[186:187], v10 offset:61952
  buffer_store_dwordx4 v[88:91], v1, s[12:15], s23 offen offset:768 sc0 sc1
  v_mfma_f32_16x16x32_bf16 v[120:123], a[156:159], v[216:219], v[120:123]
  ds_read_b64_tr_b16 a[188:189], v11 offset:61440
  v_mfma_f32_16x16x32_bf16 v[124:127], a[156:159], v[220:223], v[124:127]
  ds_read_b64_tr_b16 a[190:191], v11 offset:61952
  s_waitcnt lgkmcnt(8)
  v_mfma_f32_16x16x32_bf16 v[96:99], a[160:163], v[224:227], v[96:99]
  ds_read_b64_tr_b16 a[192:193], v12 offset:0
  v_mfma_f32_16x16x32_bf16 v[100:103], a[160:163], v[228:231], v[100:103]
  ds_read_b64_tr_b16 a[194:195], v12 offset:512
  s_add_u32 m0, s27, 0
  v_mfma_f32_16x16x32_bf16 v[104:107], a[164:167], v[224:227], v[104:107]
  ds_read_b64_tr_b16 a[196:197], v13 offset:0
  v_mfma_f32_16x16x32_bf16 v[108:111], a[164:167], v[228:231], v[108:111]
  ds_read_b64_tr_b16 a[198:199], v13 offset:512
  s_add_u32 s24, s62, s39
  v_mfma_f32_16x16x32_bf16 v[112:115], a[168:171], v[224:227], v[112:115]
  ds_read_b64_tr_b16 a[144:145], v14 offset:0
  v_mfma_f32_16x16x32_bf16 v[116:119], a[168:171], v[228:231], v[116:119]
  ds_read_b64_tr_b16 a[146:147], v14 offset:512
  buffer_load_dwordx4 v22, s[8:11], s24 offen lds
  v_mfma_f32_16x16x32_bf16 v[120:123], a[172:175], v[224:227], v[120:123]
  ds_read_b64_tr_b16 a[148:149], v15 offset:0
  v_mfma_f32_16x16x32_bf16 v[124:127], a[172:175], v[228:231], v[124:127]
  ds_read_b64_tr_b16 a[150:151], v15 offset:512
  s_waitcnt lgkmcnt(8)
  v_mfma_f32_16x16x32_bf16 v[96:99], a[176:179], v[232:235], v[96:99]
  ds_read_b64_tr_b16 a[152:153], v12 offset:4096
  v_mfma_f32_16x16x32_bf16 v[100:103], a[176:179], v[236:239], v[100:103]
  ds_read_b64_tr_b16 a[154:155], v12 offset:4608
  s_add_u32 m0, s27, 4096
  v_mfma_f32_16x16x32_bf16 v[104:107], a[180:183], v[232:235], v[104:107]
  ds_read_b64_tr_b16 a[156:157], v13 offset:4096
  v_mfma_f32_16x16x32_bf16 v[108:111], a[180:183], v[236:239], v[108:111]
  ds_read_b64_tr_b16 a[158:159], v13 offset:4608
  v_mfma_f32_16x16x32_bf16 v[112:115], a[184:187], v[232:235], v[112:115]
  ds_read_b64_tr_b16 a[160:161], v14 offset:4096
  v_mfma_f32_16x16x32_bf16 v[116:119], a[184:187], v[236:239], v[116:119]
  ds_read_b64_tr_b16 a[162:163], v14 offset:4608
  buffer_load_dwordx4 v23, s[8:11], s24 offen lds
  v_mfma_f32_16x16x32_bf16 v[120:123], a[188:191], v[232:235], v[120:123]
  ds_read_b64_tr_b16 a[164:165], v15 offset:4096
  v_mfma_f32_16x16x32_bf16 v[124:127], a[188:191], v[236:239], v[124:127]
  ds_read_b64_tr_b16 a[166:167], v15 offset:4608
  s_waitcnt vmcnt(22)
  s_barrier
  s_waitcnt lgkmcnt(8)
  v_mfma_f32_16x16x32_bf16 v[96:99], a[192:195], a[0:3], v[96:99]
  ds_read_b64_tr_b16 a[168:169], v12 offset:8192
  v_mfma_f32_16x16x32_bf16 v[100:103], a[192:195], a[4:7], v[100:103]
  ds_read_b64_tr_b16 a[170:171], v12 offset:8704
  s_add_u32 m0, s27, 8192
  v_mfma_f32_16x16x32_bf16 v[104:107], a[196:199], a[0:3], v[104:107]
  ds_read_b64_tr_b16 a[172:173], v13 offset:8192
  v_mfma_f32_16x16x32_bf16 v[108:111], a[196:199], a[4:7], v[108:111]
  ds_read_b64_tr_b16 a[174:175], v13 offset:8704
  s_add_u32 s24, s63, s39
  v_mfma_f32_16x16x32_bf16 v[112:115], a[144:147], a[0:3], v[112:115]
  ds_read_b64_tr_b16 a[176:177], v14 offset:8192
  v_mfma_f32_16x16x32_bf16 v[116:119], a[144:147], a[4:7], v[116:119]
  ds_read_b64_tr_b16 a[178:179], v14 offset:8704
  buffer_load_dwordx4 v22, s[8:11], s24 offen lds
  v_mfma_f32_16x16x32_bf16 v[120:123], a[148:151], a[0:3], v[120:123]
  ds_read_b64_tr_b16 a[180:181], v15 offset:8192
  v_mfma_f32_16x16x32_bf16 v[124:127], a[148:151], a[4:7], v[124:127]
  ds_read_b64_tr_b16 a[182:183], v15 offset:8704
  s_waitcnt lgkmcnt(8)
  v_mfma_f32_16x16x32_bf16 v[96:99], a[152:155], a[8:11], v[96:99]
  ds_read_b64_tr_b16 a[184:185], v12 offset:12288
  v_mfma_f32_16x16x32_bf16 v[100:103], a[152:155], a[12:15], v[100:103]
  ds_read_b64_tr_b16 a[186:187], v12 offset:12800
  s_add_u32 m0, s27, 12288
  v_mfma_f32_16x16x32_bf16 v[104:107], a[156:159], a[8:11], v[104:107]
  ds_read_b64_tr_b16 a[188:189], v13 offset:12288
  v_mfma_f32_16x16x32_bf16 v[108:111], a[156:159], a[12:15], v[108:111]
  ds_read_b64_tr_b16 a[190:191], v13 offset:12800
  v_mfma_f32_16x16x32_bf16 v[112:115], a[160:163], a[8:11], v[112:115]
  ds_read_b64_tr_b16 a[192:193], v14 offset:12288
  v_mfma_f32_16x16x32_bf16 v[116:119], a[160:163], a[12:15], v[116:119]
  ds_read_b64_tr_b16 a[194:195], v14 offset:12800
  buffer_load_dwordx4 v23, s[8:11], s24 offen lds
  v_mfma_f32_16x16x32_bf16 v[120:123], a[164:167], a[8:11], v[120:123]
  ds_read_b64_tr_b16 a[196:197], v15 offset:12288
  v_mfma_f32_16x16x32_bf16 v[124:127], a[164:167], a[12:15], v[124:127]
  ds_read_b64_tr_b16 a[198:199], v15 offset:12800
  s_waitcnt lgkmcnt(8)
  v_mfma_f32_16x16x32_bf16 v[96:99], a[168:171], a[16:19], v[96:99]
  ds_read_b64_tr_b16 a[144:145], v12 offset:16384
  v_mfma_f32_16x16x32_bf16 v[100:103], a[168:171], a[20:23], v[100:103]
  ds_read_b64_tr_b16 a[146:147], v12 offset:16896
  s_add_u32 m0, s27, 16384
  v_mfma_f32_16x16x32_bf16 v[104:107], a[172:175], a[16:19], v[104:107]
  ds_read_b64_tr_b16 a[148:149], v13 offset:16384
  v_mfma_f32_16x16x32_bf16 v[108:111], a[172:175], a[20:23], v[108:111]
  ds_read_b64_tr_b16 a[150:151], v13 offset:16896
  s_add_u32 s24, s64, s39
  v_mfma_f32_16x16x32_bf16 v[112:115], a[176:179], a[16:19], v[112:115]
  ds_read_b64_tr_b16 a[152:153], v14 offset:16384
  v_mfma_f32_16x16x32_bf16 v[116:119], a[176:179], a[20:23], v[116:119]
  ds_read_b64_tr_b16 a[154:155], v14 offset:16896
  buffer_load_dwordx4 v22, s[8:11], s24 offen lds
  v_mfma_f32_16x16x32_bf16 v[120:123], a[180:183], a[16:19], v[120:123]
  ds_read_b64_tr_b16 a[156:157], v15 offset:16384
  v_mfma_f32_16x16x32_bf16 v[124:127], a[180:183], a[20:23], v[124:127]
  ds_read_b64_tr_b16 a[158:159], v15 offset:16896
  s_waitcnt lgkmcnt(8)
  v_mfma_f32_16x16x32_bf16 v[96:99], a[184:187], a[24:27], v[96:99]
  ds_read_b64_tr_b16 a[160:161], v12 offset:20480
  v_mfma_f32_16x16x32_bf16 v[100:103], a[184:187], a[28:31], v[100:103]
  ds_read_b64_tr_b16 a[162:163], v12 offset:20992
  s_add_u32 m0, s27, 20480
  v_mfma_f32_16x16x32_bf16 v[104:107], a[188:191], a[24:27], v[104:107]
  ds_read_b64_tr_b16 a[164:165], v13 offset:20480
  v_mfma_f32_16x16x32_bf16 v[108:111], a[188:191], a[28:31], v[108:111]
  ds_read_b64_tr_b16 a[166:167], v13 offset:20992
  v_mfma_f32_16x16x32_bf16 v[112:115], a[192:195], a[24:27], v[112:115]
  ds_read_b64_tr_b16 a[168:169], v14 offset:20480
  v_mfma_f32_16x16x32_bf16 v[116:119], a[192:195], a[28:31], v[116:119]
  ds_read_b64_tr_b16 a[170:171], v14 offset:20992
  buffer_load_dwordx4 v23, s[8:11], s24 offen lds
  v_mfma_f32_16x16x32_bf16 v[120:123], a[196:199], a[24:27], v[120:123]
  ds_read_b64_tr_b16 a[172:173], v15 offset:20480
  v_mfma_f32_16x16x32_bf16 v[124:127], a[196:199], a[28:31], v[124:127]
  ds_read_b64_tr_b16 a[174:175], v15 offset:20992
  s_waitcnt lgkmcnt(8)
  v_mfma_f32_16x16x32_bf16 v[96:99], a[144:147], a[32:35], v[96:99]
  ds_read_b64_tr_b16 a[176:177], v12 offset:24576
  v_mfma_f32_16x16x32_bf16 v[100:103], a[144:147], a[36:39], v[100:103]
  ds_read_b64_tr_b16 a[178:179], v12 offset:25088
  v_mfma_f32_16x16x32_bf16 v[104:107], a[148:151], a[32:35], v[104:107]
  ds_read_b64_tr_b16 a[180:181], v13 offset:24576
  v_mfma_f32_16x16x32_bf16 v[108:111], a[148:151], a[36:39], v[108:111]
  ds_read_b64_tr_b16 a[182:183], v13 offset:25088
  v_mfma_f32_16x16x32_bf16 v[112:115], a[152:155], a[32:35], v[112:115]
  ds_read_b64_tr_b16 a[184:185], v14 offset:24576
  v_mfma_f32_16x16x32_bf16 v[116:119], a[152:155], a[36:39], v[116:119]
  ds_read_b64_tr_b16 a[186:187], v14 offset:25088
  v_mfma_f32_16x16x32_bf16 v[120:123], a[156:159], a[32:35], v[120:123]
  ds_read_b64_tr_b16 a[188:189], v15 offset:24576
  v_mfma_f32_16x16x32_bf16 v[124:127], a[156:159], a[36:39], v[124:127]
  ds_read_b64_tr_b16 a[190:191], v15 offset:25088
  s_waitcnt lgkmcnt(8)
  v_mfma_f32_16x16x32_bf16 v[96:99], a[160:163], a[40:43], v[96:99]
  ds_read_b64_tr_b16 a[192:193], v12 offset:28672
  v_mfma_f32_16x16x32_bf16 v[100:103], a[160:163], a[44:47], v[100:103]
  ds_read_b64_tr_b16 a[194:195], v12 offset:29184
  v_mfma_f32_16x16x32_bf16 v[104:107], a[164:167], a[40:43], v[104:107]
  ds_read_b64_tr_b16 a[196:197], v13 offset:28672
  v_mfma_f32_16x16x32_bf16 v[108:111], a[164:167], a[44:47], v[108:111]
  ds_read_b64_tr_b16 a[198:199], v13 offset:29184
  v_mfma_f32_16x16x32_bf16 v[112:115], a[168:171], a[40:43], v[112:115]
  ds_read_b64_tr_b16 a[144:145], v14 offset:28672
  v_mfma_f32_16x16x32_bf16 v[116:119], a[168:171], a[44:47], v[116:119]
  ds_read_b64_tr_b16 a[146:147], v14 offset:29184
  v_mfma_f32_16x16x32_bf16 v[120:123], a[172:175], a[40:43], v[120:123]
  ds_read_b64_tr_b16 a[148:149], v15 offset:28672
  v_mfma_f32_16x16x32_bf16 v[124:127], a[172:175], a[44:47], v[124:127]
  ds_read_b64_tr_b16 a[150:151], v15 offset:29184
  s_waitcnt vmcnt(16)
  s_barrier
  s_waitcnt lgkmcnt(8)
  v_mfma_f32_16x16x32_bf16 v[96:99], a[176:179], a[48:51], v[96:99]
  ds_read_b64_tr_b16 a[152:153], v12 offset:32768
  v_mfma_f32_16x16x32_bf16 v[100:103], a[176:179], a[52:55], v[100:103]
  ds_read_b64_tr_b16 a[154:155], v12 offset:33280
  v_mfma_f32_16x16x32_bf16 v[104:107], a[180:183], a[48:51], v[104:107]
  ds_read_b64_tr_b16 a[156:157], v13 offset:32768
  v_mfma_f32_16x16x32_bf16 v[108:111], a[180:183], a[52:55], v[108:111]
  ds_read_b64_tr_b16 a[158:159], v13 offset:33280
  v_mfma_f32_16x16x32_bf16 v[112:115], a[184:187], a[48:51], v[112:115]
  ds_read_b64_tr_b16 a[160:161], v14 offset:32768
  v_mfma_f32_16x16x32_bf16 v[116:119], a[184:187], a[52:55], v[116:119]
  ds_read_b64_tr_b16 a[162:163], v14 offset:33280
  v_mfma_f32_16x16x32_bf16 v[120:123], a[188:191], a[48:51], v[120:123]
  ds_read_b64_tr_b16 a[164:165], v15 offset:32768
  v_mfma_f32_16x16x32_bf16 v[124:127], a[188:191], a[52:55], v[124:127]
  ds_read_b64_tr_b16 a[166:167], v15 offset:33280
  s_waitcnt lgkmcnt(8)
  v_mfma_f32_16x16x32_bf16 v[96:99], a[192:195], a[56:59], v[96:99]
  ds_read_b64_tr_b16 a[168:169], v12 offset:36864
  v_mfma_f32_16x16x32_bf16 v[100:103], a[192:195], a[60:63], v[100:103]
  ds_read_b64_tr_b16 a[170:171], v12 offset:37376
  v_mfma_f32_16x16x32_bf16 v[104:107], a[196:199], a[56:59], v[104:107]
  ds_read_b64_tr_b16 a[172:173], v13 offset:36864
  v_mfma_f32_16x16x32_bf16 v[108:111], a[196:199], a[60:63], v[108:111]
  ds_read_b64_tr_b16 a[174:175], v13 offset:37376
  v_mfma_f32_16x16x32_bf16 v[112:115], a[144:147], a[56:59], v[112:115]
  ds_read_b64_tr_b16 a[176:177], v14 offset:36864
  v_mfma_f32_16x16x32_bf16 v[116:119], a[144:147], a[60:63], v[116:119]
  ds_read_b64_tr_b16 a[178:179], v14 offset:37376
  v_mfma_f32_16x16x32_bf16 v[120:123], a[148:151], a[56:59], v[120:123]
  ds_read_b64_tr_b16 a[180:181], v15 offset:36864
  v_mfma_f32_16x16x32_bf16 v[124:127], a[148:151], a[60:63], v[124:127]
  ds_read_b64_tr_b16 a[182:183], v15 offset:37376
  s_waitcnt lgkmcnt(8)
  v_mfma_f32_16x16x32_bf16 v[128:131], a[152:155], v[160:163], 0
  ds_read_b64_tr_b16 a[184:185], v12 offset:40960
  s_lshl_b32 s23, s67, 3
  v_mfma_f32_16x16x32_bf16 v[132:135], a[152:155], v[164:167], 0
  ds_read_b64_tr_b16 a[186:187], v12 offset:41472
  s_add_u32 s23, s23, s25
  v_cvt_pk_bf16_f32 v96, v96, v97
  v_mfma_f32_16x16x32_bf16 v[136:139], a[156:159], v[160:163], 0
  ds_read_b64_tr_b16 a[188:189], v13 offset:40960
  v_cvt_pk_bf16_f32 v97, v98, v99
  v_mfma_f32_16x16x32_bf16 v[140:143], a[156:159], v[164:167], 0
  ds_read_b64_tr_b16 a[190:191], v13 offset:41472
  v_cvt_pk_bf16_f32 v98, v100, v101
  v_cvt_pk_bf16_f32 v99, v102, v103
  v_mfma_f32_16x16x32_bf16 v[144:147], a[160:163], v[160:163], 0
  ds_read_b64_tr_b16 a[192:193], v14 offset:40960
  v_cvt_pk_bf16_f32 v104, v104, v105
  v_mfma_f32_16x16x32_bf16 v[148:151], a[160:163], v[164:167], 0
  ds_read_b64_tr_b16 a[194:195], v14 offset:41472
  v_cvt_pk_bf16_f32 v105, v106, v107
  v_cvt_pk_bf16_f32 v106, v108, v109
  v_mfma_f32_16x16x32_bf16 v[152:155], a[164:167], v[160:163], 0
  ds_read_b64_tr_b16 a[196:197], v15 offset:40960
  v_cvt_pk_bf16_f32 v107, v110, v111
  v_mfma_f32_16x16x32_bf16 v[156:159], a[164:167], v[164:167], 0
  ds_read_b64_tr_b16 a[198:199], v15 offset:41472
  v_cvt_pk_bf16_f32 v112, v112, v113
  s_waitcnt lgkmcnt(8)
  v_mfma_f32_16x16x32_bf16 v[128:131], a[168:171], v[168:171], v[128:131]
  ds_read_b64_tr_b16 a[144:145], v12 offset:45056
  v_cvt_pk_bf16_f32 v113, v114, v115
  v_mfma_f32_16x16x32_bf16 v[132:135], a[168:171], v[172:175], v[132:135]
  ds_read_b64_tr_b16 a[146:147], v12 offset:45568
  v_cvt_pk_bf16_f32 v114, v116, v117
  v_cvt_pk_bf16_f32 v115, v118, v119
  v_mfma_f32_16x16x32_bf16 v[136:139], a[172:175], v[168:171], v[136:139]
  ds_read_b64_tr_b16 a[148:149], v13 offset:45056
  v_cvt_pk_bf16_f32 v120, v120, v121
  v_mfma_f32_16x16x32_bf16 v[140:143], a[172:175], v[172:175], v[140:143]
  ds_read_b64_tr_b16 a[150:151], v13 offset:45568
  v_cvt_pk_bf16_f32 v121, v122, v123
  v_mfma_f32_16x16x32_bf16 v[144:147], a[176:179], v[168:171], v[144:147]
  ds_read_b64_tr_b16 a[152:153], v14 offset:45056
  v_cvt_pk_bf16_f32 v122, v124, v125
  v_mfma_f32_16x16x32_bf16 v[148:151], a[176:179], v[172:175], v[148:151]
  ds_read_b64_tr_b16 a[154:155], v14 offset:45568
  v_cvt_pk_bf16_f32 v123, v126, v127
  v_permlane16_swap_b32 v96, v98
  v_mfma_f32_16x16x32_bf16 v[152:155], a[180:183], v[168:171], v[152:155]
  ds_read_b64_tr_b16 a[156:157], v15 offset:45056
  v_permlane16_swap_b32 v97, v99
  v_mfma_f32_16x16x32_bf16 v[156:159], a[180:183], v[172:175], v[156:159]
  ds_read_b64_tr_b16 a[158:159], v15 offset:45568
  buffer_store_dwordx4 v[96:99], v1, s[12:15], s23 offen offset:0 sc0 sc1
  s_waitcnt lgkmcnt(8)
  v_mfma_f32_16x16x32_bf16 v[128:131], a[184:187], v[176:179], v[128:131]
  ds_read_b64_tr_b16 a[160:161], v12 offset:49152
  v_permlane16_swap_b32 v104, v106
  v_mfma_f32_16x16x32_bf16 v[132:135], a[184:187], v[180:183], v[132:135]
  ds_read_b64_tr_b16 a[162:163], v12 offset:49664
  v_permlane16_swap_b32 v105, v107
  buffer_store_dwordx4 v[104:107], v1, s[12:15], s23 offen offset:256 sc0 sc1
  v_mfma_f32_16x16x32_bf16 v[136:139], a[188:191], v[176:179], v[136:139]
  ds_read_b64_tr_b16 a[164:165], v13 offset:49152
  v_permlane16_swap_b32 v112, v114
  v_mfma_f32_16x16x32_bf16 v[140:143], a[188:191], v[180:183], v[140:143]
  ds_read_b64_tr_b16 a[166:167], v13 offset:49664
  v_permlane16_swap_b32 v113, v115
  v_mfma_f32_16x16x32_bf16 v[144:147], a[192:195], v[176:179], v[144:147]
  ds_read_b64_tr_b16 a[168:169], v14 offset:49152
  buffer_store_dwordx4 v[112:115], v1, s[12:15], s23 offen offset:512 sc0 sc1
  v_mfma_f32_16x16x32_bf16 v[148:151], a[192:195], v[180:183], v[148:151]
  ds_read_b64_tr_b16 a[170:171], v14 offset:49664
  v_permlane16_swap_b32 v120, v122
  v_mfma_f32_16x16x32_bf16 v[152:155], a[196:199], v[176:179], v[152:155]
  ds_read_b64_tr_b16 a[172:173], v15 offset:49152
  v_permlane16_swap_b32 v121, v123
  v_mfma_f32_16x16x32_bf16 v[156:159], a[196:199], v[180:183], v[156:159]
  ds_read_b64_tr_b16 a[174:175], v15 offset:49664
  buffer_store_dwordx4 v[120:123], v1, s[12:15], s23 offen offset:768 sc0 sc1
  s_waitcnt lgkmcnt(8)
  v_mfma_f32_16x16x32_bf16 v[128:131], a[144:147], v[184:187], v[128:131]
  ds_read_b64_tr_b16 a[176:177], v12 offset:53248
  v_mfma_f32_16x16x32_bf16 v[132:135], a[144:147], v[188:191], v[132:135]
  ds_read_b64_tr_b16 a[178:179], v12 offset:53760
  v_mfma_f32_16x16x32_bf16 v[136:139], a[148:151], v[184:187], v[136:139]
  ds_read_b64_tr_b16 a[180:181], v13 offset:53248
  v_mfma_f32_16x16x32_bf16 v[140:143], a[148:151], v[188:191], v[140:143]
  ds_read_b64_tr_b16 a[182:183], v13 offset:53760
  v_mfma_f32_16x16x32_bf16 v[144:147], a[152:155], v[184:187], v[144:147]
  ds_read_b64_tr_b16 a[184:185], v14 offset:53248
  v_mfma_f32_16x16x32_bf16 v[148:151], a[152:155], v[188:191], v[148:151]
  ds_read_b64_tr_b16 a[186:187], v14 offset:53760
  v_mfma_f32_16x16x32_bf16 v[152:155], a[156:159], v[184:187], v[152:155]
  ds_read_b64_tr_b16 a[188:189], v15 offset:53248
  v_mfma_f32_16x16x32_bf16 v[156:159], a[156:159], v[188:191], v[156:159]
  ds_read_b64_tr_b16 a[190:191], v15 offset:53760
  s_waitcnt vmcnt(4)
  s_barrier
  s_waitcnt lgkmcnt(8)
  v_mfma_f32_16x16x32_bf16 v[128:131], a[160:163], v[192:195], v[128:131]
  ds_read_b64_tr_b16 a[192:193], v12 offset:57344
  v_mfma_f32_16x16x32_bf16 v[132:135], a[160:163], v[196:199], v[132:135]
  ds_read_b64_tr_b16 a[194:195], v12 offset:57856
  v_mfma_f32_16x16x32_bf16 v[136:139], a[164:167], v[192:195], v[136:139]
  ds_read_b64_tr_b16 a[196:197], v13 offset:57344
  v_mfma_f32_16x16x32_bf16 v[140:143], a[164:167], v[196:199], v[140:143]
  ds_read_b64_tr_b16 a[198:199], v13 offset:57856
  v_mfma_f32_16x16x32_bf16 v[144:147], a[168:171], v[192:195], v[144:147]
  ds_read_b64_tr_b16 a[144:145], v14 offset:57344
  v_mfma_f32_16x16x32_bf16 v[148:151], a[168:171], v[196:199], v[148:151]
  ds_read_b64_tr_b16 a[146:147], v14 offset:57856
  v_mfma_f32_16x16x32_bf16 v[152:155], a[172:175], v[192:195], v[152:155]
  ds_read_b64_tr_b16 a[148:149], v15 offset:57344
  v_mfma_f32_16x16x32_bf16 v[156:159], a[172:175], v[196:199], v[156:159]
  ds_read_b64_tr_b16 a[150:151], v15 offset:57856
  s_waitcnt lgkmcnt(8)
  v_mfma_f32_16x16x32_bf16 v[128:131], a[176:179], v[200:203], v[128:131]
  ds_read_b64_tr_b16 a[152:153], v12 offset:61440
  v_and_b32 v29, 15, v0
  v_mfma_f32_16x16x32_bf16 v[132:135], a[176:179], v[204:207], v[132:135]
  ds_read_b64_tr_b16 a[154:155], v12 offset:61952
  v_lshlrev_b32 v29, 2, v29
  v_mfma_f32_16x16x32_bf16 v[136:139], a[180:183], v[200:203], v[136:139]
  ds_read_b64_tr_b16 a[156:157], v13 offset:61440
  v_accvgpr_read_b32 v28, a216
  v_mfma_f32_16x16x32_bf16 v[140:143], a[180:183], v[204:207], v[140:143]
  ds_read_b64_tr_b16 a[158:159], v13 offset:61952
  s_mov_b32 s43, s45
  v_mfma_f32_16x16x32_bf16 v[144:147], a[184:187], v[200:203], v[144:147]
  ds_read_b64_tr_b16 a[160:161], v14 offset:61440
  v_accvgpr_read_b32 v24, a219
  v_mfma_f32_16x16x32_bf16 v[148:151], a[184:187], v[204:207], v[148:151]
  ds_read_b64_tr_b16 a[162:163], v14 offset:61952
  v_accvgpr_read_b32 v25, a220
  v_mfma_f32_16x16x32_bf16 v[152:155], a[188:191], v[200:203], v[152:155]
  ds_read_b64_tr_b16 a[164:165], v15 offset:61440
  v_accvgpr_read_b32 v26, a221
  v_mfma_f32_16x16x32_bf16 v[156:159], a[188:191], v[204:207], v[156:159]
  ds_read_b64_tr_b16 a[166:167], v15 offset:61952
  s_waitcnt lgkmcnt(8)
  v_mfma_f32_16x16x32_bf16 v[128:131], a[192:195], v[208:211], v[128:131]
  ds_read_b64_tr_b16 a[168:169], v16 offset:0
  v_mfma_f32_16x16x32_bf16 v[132:135], a[192:195], v[212:215], v[132:135]
  ds_read_b64_tr_b16 a[170:171], v16 offset:512
  v_mfma_f32_16x16x32_bf16 v[136:139], a[196:199], v[208:211], v[136:139]
  ds_read_b64_tr_b16 a[172:173], v17 offset:0
  v_mfma_f32_16x16x32_bf16 v[140:143], a[196:199], v[212:215], v[140:143]
  ds_read_b64_tr_b16 a[174:175], v17 offset:512
  v_mfma_f32_16x16x32_bf16 v[144:147], a[144:147], v[208:211], v[144:147]
  ds_read_b64_tr_b16 a[176:177], v18 offset:0
  v_mfma_f32_16x16x32_bf16 v[148:151], a[144:147], v[212:215], v[148:151]
  ds_read_b64_tr_b16 a[178:179], v18 offset:512
  v_mfma_f32_16x16x32_bf16 v[152:155], a[148:151], v[208:211], v[152:155]
  ds_read_b64_tr_b16 a[180:181], v19 offset:0
  v_mfma_f32_16x16x32_bf16 v[156:159], a[148:151], v[212:215], v[156:159]
  ds_read_b64_tr_b16 a[182:183], v19 offset:512
  s_waitcnt lgkmcnt(8)
  v_mfma_f32_16x16x32_bf16 v[128:131], a[152:155], v[216:219], v[128:131]
  ds_read_b64_tr_b16 a[184:185], v16 offset:4096
  v_mfma_f32_16x16x32_bf16 v[132:135], a[152:155], v[220:223], v[132:135]
  ds_read_b64_tr_b16 a[186:187], v16 offset:4608
  s_waitcnt vmcnt(0)
  v_mfma_f32_16x16x32_bf16 v[136:139], a[156:159], v[216:219], v[136:139]
  ds_read_b64_tr_b16 a[188:189], v17 offset:4096
  v_mfma_f32_16x16x32_bf16 v[140:143], a[156:159], v[220:223], v[140:143]
  ds_read_b64_tr_b16 a[190:191], v17 offset:4608
  s_mov_b64 exec, 1
  buffer_store_dword v5, v6, s[12:15], s33 offen offset:64 sc0 sc1
  s_mov_b64 exec, -1
  v_mfma_f32_16x16x32_bf16 v[144:147], a[160:163], v[216:219], v[144:147]
  ds_read_b64_tr_b16 a[192:193], v18 offset:4096
  v_mfma_f32_16x16x32_bf16 v[148:151], a[160:163], v[220:223], v[148:151]
  ds_read_b64_tr_b16 a[194:195], v18 offset:4608
  buffer_load_dwordx4 v[64:67], v24, s[12:15], s44 offen sc1
  v_mfma_f32_16x16x32_bf16 v[152:155], a[164:167], v[216:219], v[152:155]
  ds_read_b64_tr_b16 a[196:197], v19 offset:4096
  v_mfma_f32_16x16x32_bf16 v[156:159], a[164:167], v[220:223], v[156:159]
  ds_read_b64_tr_b16 a[198:199], v19 offset:4608
  s_waitcnt lgkmcnt(8)
  v_mfma_f32_16x16x32_bf16 v[128:131], a[168:171], v[224:227], v[128:131]
  ds_read_b64_tr_b16 a[144:145], v16 offset:8192
  v_mfma_f32_16x16x32_bf16 v[132:135], a[168:171], v[228:231], v[132:135]
  ds_read_b64_tr_b16 a[146:147], v16 offset:8704
  buffer_load_dwordx4 v[68:71], v25, s[12:15], s44 offen sc1
  v_mfma_f32_16x16x32_bf16 v[136:139], a[172:175], v[224:227], v[136:139]
  ds_read_b64_tr_b16 a[148:149], v17 offset:8192
  v_mfma_f32_16x16x32_bf16 v[140:143], a[172:175], v[228:231], v[140:143]
  ds_read_b64_tr_b16 a[150:151], v17 offset:8704
  v_mfma_f32_16x16x32_bf16 v[144:147], a[176:179], v[224:227], v[144:147]
  ds_read_b64_tr_b16 a[152:153], v18 offset:8192
  v_mfma_f32_16x16x32_bf16 v[148:151], a[176:179], v[228:231], v[148:151]
  ds_read_b64_tr_b16 a[154:155], v18 offset:8704
  v_mfma_f32_16x16x32_bf16 v[152:155], a[180:183], v[224:227], v[152:155]
  ds_read_b64_tr_b16 a[156:157], v19 offset:8192
  v_mfma_f32_16x16x32_bf16 v[156:159], a[180:183], v[228:231], v[156:159]
  ds_read_b64_tr_b16 a[158:159], v19 offset:8704
  s_waitcnt lgkmcnt(8)
  v_mfma_f32_16x16x32_bf16 v[128:131], a[184:187], v[232:235], v[128:131]
  ds_read_b64_tr_b16 a[160:161], v16 offset:12288
  v_mfma_f32_16x16x32_bf16 v[132:135], a[184:187], v[236:239], v[132:135]
  ds_read_b64_tr_b16 a[162:163], v16 offset:12800
  buffer_load_dwordx4 v[72:75], v26, s[12:15], s44 offen sc1
  v_mfma_f32_16x16x32_bf16 v[136:139], a[188:191], v[232:235], v[136:139]
  ds_read_b64_tr_b16 a[164:165], v17 offset:12288
  v_mfma_f32_16x16x32_bf16 v[140:143], a[188:191], v[236:239], v[140:143]
  ds_read_b64_tr_b16 a[166:167], v17 offset:12800
  v_mfma_f32_16x16x32_bf16 v[144:147], a[192:195], v[232:235], v[144:147]
  ds_read_b64_tr_b16 a[168:169], v18 offset:12288
  v_mfma_f32_16x16x32_bf16 v[148:151], a[192:195], v[236:239], v[148:151]
  ds_read_b64_tr_b16 a[170:171], v18 offset:12800
  v_mfma_f32_16x16x32_bf16 v[152:155], a[196:199], v[232:235], v[152:155]
  ds_read_b64_tr_b16 a[172:173], v19 offset:12288
  v_mfma_f32_16x16x32_bf16 v[156:159], a[196:199], v[236:239], v[156:159]
  ds_read_b64_tr_b16 a[174:175], v19 offset:12800
  s_waitcnt lgkmcnt(8)
  v_mfma_f32_16x16x32_bf16 v[128:131], a[144:147], a[0:3], v[128:131]
  ds_read_b64_tr_b16 a[176:177], v8 offset:0
  v_mfma_f32_16x16x32_bf16 v[132:135], a[144:147], a[4:7], v[132:135]
  ds_read_b64_tr_b16 a[178:179], v8 offset:512
  v_mfma_f32_16x16x32_bf16 v[136:139], a[148:151], a[0:3], v[136:139]
  ds_read_b64_tr_b16 a[180:181], v9 offset:0
  v_mfma_f32_16x16x32_bf16 v[140:143], a[148:151], a[4:7], v[140:143]
  ds_read_b64_tr_b16 a[182:183], v9 offset:512
  v_mfma_f32_16x16x32_bf16 v[144:147], a[152:155], a[0:3], v[144:147]
  ds_read_b64_tr_b16 a[184:185], v10 offset:0
  v_mfma_f32_16x16x32_bf16 v[148:151], a[152:155], a[4:7], v[148:151]
  ds_read_b64_tr_b16 a[186:187], v10 offset:512
  v_mfma_f32_16x16x32_bf16 v[152:155], a[156:159], a[0:3], v[152:155]
  ds_read_b64_tr_b16 a[188:189], v11 offset:0
  v_mfma_f32_16x16x32_bf16 v[156:159], a[156:159], a[4:7], v[156:159]
  ds_read_b64_tr_b16 a[190:191], v11 offset:512
  s_waitcnt lgkmcnt(8)
  v_mfma_f32_16x16x32_bf16 v[128:131], a[160:163], a[8:11], v[128:131]
  ds_read_b64_tr_b16 a[192:193], v8 offset:4096
  v_mfma_f32_16x16x32_bf16 v[132:135], a[160:163], a[12:15], v[132:135]
  ds_read_b64_tr_b16 a[194:195], v8 offset:4608
  v_mfma_f32_16x16x32_bf16 v[136:139], a[164:167], a[8:11], v[136:139]
  ds_read_b64_tr_b16 a[196:197], v9 offset:4096
  v_mfma_f32_16x16x32_bf16 v[140:143], a[164:167], a[12:15], v[140:143]
  ds_read_b64_tr_b16 a[198:199], v9 offset:4608
  v_mfma_f32_16x16x32_bf16 v[144:147], a[168:171], a[8:11], v[144:147]
  ds_read_b64_tr_b16 a[144:145], v10 offset:4096
  v_mfma_f32_16x16x32_bf16 v[148:151], a[168:171], a[12:15], v[148:151]
  ds_read_b64_tr_b16 a[146:147], v10 offset:4608
  v_mfma_f32_16x16x32_bf16 v[152:155], a[172:175], a[8:11], v[152:155]
  ds_read_b64_tr_b16 a[148:149], v11 offset:4096
  v_mfma_f32_16x16x32_bf16 v[156:159], a[172:175], a[12:15], v[156:159]
  ds_read_b64_tr_b16 a[150:151], v11 offset:4608
  s_waitcnt lgkmcnt(8)
  v_mfma_f32_16x16x32_bf16 v[128:131], a[176:179], a[16:19], v[128:131]
  ds_read_b64_tr_b16 a[152:153], v8 offset:8192
  v_mfma_f32_16x16x32_bf16 v[132:135], a[176:179], a[20:23], v[132:135]
  ds_read_b64_tr_b16 a[154:155], v8 offset:8704
  v_mfma_f32_16x16x32_bf16 v[136:139], a[180:183], a[16:19], v[136:139]
  ds_read_b64_tr_b16 a[156:157], v9 offset:8192
  v_mfma_f32_16x16x32_bf16 v[140:143], a[180:183], a[20:23], v[140:143]
  ds_read_b64_tr_b16 a[158:159], v9 offset:8704
  v_mfma_f32_16x16x32_bf16 v[144:147], a[184:187], a[16:19], v[144:147]
  ds_read_b64_tr_b16 a[160:161], v10 offset:8192
  v_mfma_f32_16x16x32_bf16 v[148:151], a[184:187], a[20:23], v[148:151]
  ds_read_b64_tr_b16 a[162:163], v10 offset:8704
  v_mfma_f32_16x16x32_bf16 v[152:155], a[188:191], a[16:19], v[152:155]
  ds_read_b64_tr_b16 a[164:165], v11 offset:8192
  v_mfma_f32_16x16x32_bf16 v[156:159], a[188:191], a[20:23], v[156:159]
  ds_read_b64_tr_b16 a[166:167], v11 offset:8704
  s_waitcnt lgkmcnt(8)
  v_mfma_f32_16x16x32_bf16 v[128:131], a[192:195], a[24:27], v[128:131]
  ds_read_b64_tr_b16 a[168:169], v8 offset:12288
  v_mfma_f32_16x16x32_bf16 v[132:135], a[192:195], a[28:31], v[132:135]
  ds_read_b64_tr_b16 a[170:171], v8 offset:12800
  v_mfma_f32_16x16x32_bf16 v[136:139], a[196:199], a[24:27], v[136:139]
  ds_read_b64_tr_b16 a[172:173], v9 offset:12288
  v_mfma_f32_16x16x32_bf16 v[140:143], a[196:199], a[28:31], v[140:143]
  ds_read_b64_tr_b16 a[174:175], v9 offset:12800
  v_mfma_f32_16x16x32_bf16 v[144:147], a[144:147], a[24:27], v[144:147]
  ds_read_b64_tr_b16 a[176:177], v10 offset:12288
  v_mfma_f32_16x16x32_bf16 v[148:151], a[144:147], a[28:31], v[148:151]
  ds_read_b64_tr_b16 a[178:179], v10 offset:12800
  v_mfma_f32_16x16x32_bf16 v[152:155], a[148:151], a[24:27], v[152:155]
  ds_read_b64_tr_b16 a[180:181], v11 offset:12288
  v_mfma_f32_16x16x32_bf16 v[156:159], a[148:151], a[28:31], v[156:159]
  ds_read_b64_tr_b16 a[182:183], v11 offset:12800
  s_waitcnt lgkmcnt(8)
  v_mfma_f32_16x16x32_bf16 v[128:131], a[152:155], a[32:35], v[128:131]
  ds_read_b64_tr_b16 a[184:185], v8 offset:16384
  v_mfma_f32_16x16x32_bf16 v[132:135], a[152:155], a[36:39], v[132:135]
  ds_read_b64_tr_b16 a[186:187], v8 offset:16896
  v_mfma_f32_16x16x32_bf16 v[136:139], a[156:159], a[32:35], v[136:139]
  ds_read_b64_tr_b16 a[188:189], v9 offset:16384
  v_mfma_f32_16x16x32_bf16 v[140:143], a[156:159], a[36:39], v[140:143]
  ds_read_b64_tr_b16 a[190:191], v9 offset:16896
  v_mfma_f32_16x16x32_bf16 v[144:147], a[160:163], a[32:35], v[144:147]
  ds_read_b64_tr_b16 a[192:193], v10 offset:16384
  v_mfma_f32_16x16x32_bf16 v[148:151], a[160:163], a[36:39], v[148:151]
  ds_read_b64_tr_b16 a[194:195], v10 offset:16896
  v_mfma_f32_16x16x32_bf16 v[152:155], a[164:167], a[32:35], v[152:155]
  ds_read_b64_tr_b16 a[196:197], v11 offset:16384
  v_mfma_f32_16x16x32_bf16 v[156:159], a[164:167], a[36:39], v[156:159]
  ds_read_b64_tr_b16 a[198:199], v11 offset:16896
  s_waitcnt lgkmcnt(8)
  v_mfma_f32_16x16x32_bf16 v[128:131], a[168:171], a[40:43], v[128:131]
  ds_read_b64_tr_b16 a[144:145], v8 offset:20480
  v_mfma_f32_16x16x32_bf16 v[132:135], a[168:171], a[44:47], v[132:135]
  ds_read_b64_tr_b16 a[146:147], v8 offset:20992
  v_mfma_f32_16x16x32_bf16 v[136:139], a[172:175], a[40:43], v[136:139]
  ds_read_b64_tr_b16 a[148:149], v9 offset:20480
  v_mfma_f32_16x16x32_bf16 v[140:143], a[172:175], a[44:47], v[140:143]
  ds_read_b64_tr_b16 a[150:151], v9 offset:20992
  v_mfma_f32_16x16x32_bf16 v[144:147], a[176:179], a[40:43], v[144:147]
  ds_read_b64_tr_b16 a[152:153], v10 offset:20480
  v_mfma_f32_16x16x32_bf16 v[148:151], a[176:179], a[44:47], v[148:151]
  ds_read_b64_tr_b16 a[154:155], v10 offset:20992
  v_mfma_f32_16x16x32_bf16 v[152:155], a[180:183], a[40:43], v[152:155]
  ds_read_b64_tr_b16 a[156:157], v11 offset:20480
  v_mfma_f32_16x16x32_bf16 v[156:159], a[180:183], a[44:47], v[156:159]
  ds_read_b64_tr_b16 a[158:159], v11 offset:20992
  s_waitcnt lgkmcnt(8)
  v_mfma_f32_16x16x32_bf16 v[128:131], a[184:187], a[48:51], v[128:131]
  v_mfma_f32_16x16x32_bf16 v[132:135], a[184:187], a[52:55], v[132:135]
  v_mfma_f32_16x16x32_bf16 v[136:139], a[188:191], a[48:51], v[136:139]
  v_mfma_f32_16x16x32_bf16 v[140:143], a[188:191], a[52:55], v[140:143]
  v_mfma_f32_16x16x32_bf16 v[144:147], a[192:195], a[48:51], v[144:147]
  v_mfma_f32_16x16x32_bf16 v[148:151], a[192:195], a[52:55], v[148:151]
  v_mfma_f32_16x16x32_bf16 v[152:155], a[196:199], a[48:51], v[152:155]
  v_mfma_f32_16x16x32_bf16 v[156:159], a[196:199], a[52:55], v[156:159]
  s_waitcnt lgkmcnt(0)
  v_mfma_f32_16x16x32_bf16 v[128:131], a[144:147], a[56:59], v[128:131]
  v_mfma_f32_16x16x32_bf16 v[132:135], a[144:147], a[60:63], v[132:135]
  buffer_load_dword v7, v29, s[12:15], s48 offen sc0 sc1
  v_mfma_f32_16x16x32_bf16 v[136:139], a[148:151], a[56:59], v[136:139]
  v_mfma_f32_16x16x32_bf16 v[140:143], a[148:151], a[60:63], v[140:143]
  v_mfma_f32_16x16x32_bf16 v[144:147], a[152:155], a[56:59], v[144:147]
  v_mfma_f32_16x16x32_bf16 v[148:151], a[152:155], a[60:63], v[148:151]
  v_mfma_f32_16x16x32_bf16 v[152:155], a[156:159], a[56:59], v[152:155]
  v_mfma_f32_16x16x32_bf16 v[156:159], a[156:159], a[60:63], v[156:159]
  s_lshl_b32 s23, s39, 3
  s_add_u32 s23, s23, s25
  v_cvt_pk_bf16_f32 v128, v128, v129
  v_cvt_pk_bf16_f32 v129, v130, v131
  v_cvt_pk_bf16_f32 v130, v132, v133
  v_cvt_pk_bf16_f32 v131, v134, v135
  v_cvt_pk_bf16_f32 v136, v136, v137
  v_cvt_pk_bf16_f32 v137, v138, v139
  v_cvt_pk_bf16_f32 v138, v140, v141
  v_cvt_pk_bf16_f32 v139, v142, v143
  v_cvt_pk_bf16_f32 v144, v144, v145
  v_cvt_pk_bf16_f32 v145, v146, v147
  v_cvt_pk_bf16_f32 v146, v148, v149
  v_cvt_pk_bf16_f32 v147, v150, v151
  v_cvt_pk_bf16_f32 v152, v152, v153
  v_cvt_pk_bf16_f32 v153, v154, v155
  v_cvt_pk_bf16_f32 v154, v156, v157
  v_cvt_pk_bf16_f32 v155, v158, v159
  v_permlane16_swap_b32 v128, v130
  v_permlane16_swap_b32 v129, v131
  buffer_store_dwordx4 v[128:131], v1, s[12:15], s23 offen offset:0 sc0 sc1
  v_permlane16_swap_b32 v136, v138
  v_permlane16_swap_b32 v137, v139
  buffer_store_dwordx4 v[136:139], v1, s[12:15], s23 offen offset:256 sc0 sc1
  v_permlane16_swap_b32 v144, v146
  v_permlane16_swap_b32 v145, v147
  buffer_store_dwordx4 v[144:147], v1, s[12:15], s23 offen offset:512 sc0 sc1
  v_permlane16_swap_b32 v152, v154
  v_permlane16_swap_b32 v153, v155
  buffer_store_dwordx4 v[152:155], v1, s[12:15], s23 offen offset:768 sc0 sc1
  s_waitcnt vmcnt(4)
  v_cmp_ne_u32 s[40:41], 1, v7
  s_nop 0
  s_cmp_eq_u64 s[40:41], 0
  s_cbranch_scc1 L_vk_p20
  s_mov_b32 s42, 0
L_vs_p20:
  buffer_load_dword v7, v29, s[12:15], s48 offen sc0 sc1
  s_add_u32 s42, s42, 1
  s_waitcnt vmcnt(0)
  v_cmp_ne_u32 s[40:41], 1, v7
  s_cmp_gt_u32 s42, 0x40000
  s_cbranch_scc1 L_vk_p20
  s_cmp_lg_u64 s[40:41], 0
  s_cbranch_scc1 L_vs_p20
L_vk_p20:
  buffer_load_dwordx4 v[32:35], v28, s[12:15], s43 offen sc1
  s_add_u32 s43, s43, 9216
  buffer_load_dwordx4 v[36:39], v28, s[12:15], s43 offen sc1
  s_add_u32 s43, s43, 9216
  s_waitcnt vmcnt(2)
  s_mov_b64 exec, 1
  buffer_store_dword v5, v6, s[12:15], s33 offen offset:128 sc0 sc1
  s_mov_b64 exec, -1
  buffer_load_dwordx4 v[40:43], v28, s[12:15], s43 offen sc1
  s_add_u32 s43, s43, 9216
  buffer_load_dwordx4 v[44:47], v28, s[12:15], s43 offen sc1
  s_add_u32 s43, s43, 9216
  buffer_load_dwordx4 v[48:51], v28, s[12:15], s43 offen sc1
  s_add_u32 s43, s43, 9216
  buffer_load_dwordx4 v[52:55], v28, s[12:15], s43 offen sc1
  s_add_u32 s43, s43, 9216
  buffer_load_dwordx4 v[56:59], v28, s[12:15], s43 offen sc1
  s_add_u32 s43, s43, 9216
  buffer_load_dwordx4 v[60:63], v28, s[12:15], s43 offen sc1
  s_add_u32 s43, s43, 9216
L_c_join:
  v_accvgpr_read_b32 v13, a217
  v_accvgpr_read_b32 v14, a218
  v_accvgpr_read_b32 v8, a222
  v_accvgpr_read_b32 v24, a225
  ds_read_b128 v[200:203], v24
  ds_read_b128 v[204:207], v24 offset:16
  v_accvgpr_read_b32 v9, a223
  v_accvgpr_read_b32 v24, a226
  ds_read_b128 v[208:211], v24
  ds_read_b128 v[212:215], v24 offset:16
  v_accvgpr_read_b32 v10, a224
  v_accvgpr_read_b32 v24, a227
  ds_read_b128 v[216:219], v24
  ds_read_b128 v[220:223], v24 offset:16
  v_add_u32 v15, 36864, v14
  s_nop 1
  v_permlane32_swap_b32 v14, v15
  v_accvgpr_read_b32 v24, a228
  ds_read_b32 v26, v24
  s_mov_b32 s26, 0x3f80
  s_mov_b32 s27, 0x3f800000
  v_mov_b32 v12, v28
  s_mov_b32 exec_hi, 65535
  s_mov_b32 s21, s45
  buffer_load_dwordx4 v[96:99], v13, s[12:15], s21 offen sc1
  s_add_u32 s21, s21, 9216
  buffer_load_dwordx4 v[100:103], v13, s[12:15], s21 offen sc1
  s_add_u32 s21, s21, 9216
  buffer_load_dwordx4 v[104:107], v13, s[12:15], s21 offen sc1
  s_add_u32 s21, s21, 9216
  buffer_load_dwordx4 v[108:111], v13, s[12:15], s21 offen sc1
  s_add_u32 s21, s21, 9216
  buffer_load_dwordx4 v[112:115], v13, s[12:15], s21 offen sc1
  s_add_u32 s21, s21, 9216
  buffer_load_dwordx4 v[116:119], v13, s[12:15], s21 offen sc1
  s_add_u32 s21, s21, 9216
  s_mov_b32 exec_hi, -1
  buffer_load_dword v4, v29, s[12:15], s49 offen sc0 sc1
  s_mov_b32 exec_hi, 65535
  buffer_load_dwordx4 v[120:123], v13, s[12:15], s21 offen sc1
  s_add_u32 s21, s21, 9216
  buffer_load_dwordx4 v[124:127], v13, s[12:15], s21 offen sc1
  s_mov_b32 exec_hi, -1
  s_waitcnt lgkmcnt(0)
  v_pk_mul_f32 v[200:201], v[200:201], v[26:27] op_sel_hi:[1,0]
  v_pk_mul_f32 v[202:203], v[202:203], v[26:27] op_sel_hi:[1,0]
  v_pk_mul_f32 v[204:205], v[204:205], v[26:27] op_sel_hi:[1,0]
  v_pk_mul_f32 v[206:207], v[206:207], v[26:27] op_sel_hi:[1,0]
  s_waitcnt vmcnt(17)
  v_lshlrev_b32 v80, 16, v32
  v_and_b32 v81, 0xffff0000, v32
  v_lshlrev_b32 v82, 16, v33
  v_and_b32 v83, 0xffff0000, v33
  v_lshlrev_b32 v84, 16, v34
  v_and_b32 v85, 0xffff0000, v34
  v_lshlrev_b32 v86, 16, v35
  v_and_b32 v87, 0xffff0000, v35
  s_waitcnt vmcnt(16)
  v_dot2c_f32_bf16 v80, s26, v36
  v_dot2c_f32_bf16 v81, s27, v36
  v_dot2c_f32_bf16 v82, s26, v37
  v_dot2c_f32_bf16 v83, s27, v37
  v_dot2c_f32_bf16 v84, s26, v38
  v_dot2c_f32_bf16 v85, s27, v38
  v_dot2c_f32_bf16 v86, s26, v39
  v_dot2c_f32_bf16 v87, s27, v39
  s_waitcnt vmcnt(14)
  v_dot2c_f32_bf16 v80, s26, v40
  v_dot2c_f32_bf16 v81, s27, v40
  v_dot2c_f32_bf16 v82, s26, v41
  v_dot2c_f32_bf16 v83, s27, v41
  v_dot2c_f32_bf16 v84, s26, v42
  v_dot2c_f32_bf16 v85, s27, v42
  v_dot2c_f32_bf16 v86, s26, v43
  v_dot2c_f32_bf16 v87, s27, v43
  s_waitcnt vmcnt(13)
  v_dot2c_f32_bf16 v80, s26, v44
  v_dot2c_f32_bf16 v81, s27, v44
  v_dot2c_f32_bf16 v82, s26, v45
  v_dot2c_f32_bf16 v83, s27, v45
  v_dot2c_f32_bf16 v84, s26, v46
  v_dot2c_f32_bf16 v85, s27, v46
  v_dot2c_f32_bf16 v86, s26, v47
  v_dot2c_f32_bf16 v87, s27, v47
  s_waitcnt vmcnt(12)
  v_dot2c_f32_bf16 v80, s26, v48
  v_dot2c_f32_bf16 v81, s27, v48
  v_dot2c_f32_bf16 v82, s26, v49
  v_dot2c_f32_bf16 v83, s27, v49
  v_dot2c_f32_bf16 v84, s26, v50
  v_dot2c_f32_bf16 v85, s27, v50
  v_dot2c_f32_bf16 v86, s26, v51
  v_dot2c_f32_bf16 v87, s27, v51
  s_waitcnt vmcnt(11)
  v_dot2c_f32_bf16 v80, s26, v52
  v_dot2c_f32_bf16 v81, s27, v52
  v_dot2c_f32_bf16 v82, s26, v53
  v_dot2c_f32_bf16 v83, s27, v53
  v_dot2c_f32_bf16 v84, s26, v54
  v_dot2c_f32_bf16 v85, s27, v54
  v_dot2c_f32_bf16 v86, s26, v55
  v_dot2c_f32_bf16 v87, s27, v55
  s_waitcnt vmcnt(10)
  v_dot2c_f32_bf16 v80, s26, v56
  v_dot2c_f32_bf16 v81, s27, v56
  v_dot2c_f32_bf16 v82, s26, v57
  v_dot2c_f32_bf16 v83, s27, v57
  v_dot2c_f32_bf16 v84, s26, v58
  v_dot2c_f32_bf16 v85, s27, v58
  v_dot2c_f32_bf16 v86, s26, v59
  v_dot2c_f32_bf16 v87, s27, v59
  s_waitcnt vmcnt(9)
  v_dot2c_f32_bf16 v80, s26, v60
  v_dot2c_f32_bf16 v81, s27, v60
  v_dot2c_f32_bf16 v82, s26, v61
  v_dot2c_f32_bf16 v83, s27, v61
  v_dot2c_f32_bf16 v84, s26, v62
  v_dot2c_f32_bf16 v85, s27, v62
  v_dot2c_f32_bf16 v86, s26, v63
  v_dot2c_f32_bf16 v87, s27, v63
  v_lshlrev_b32 v88, 16, v64
  v_and_b32 v89, 0xffff0000, v64
  v_pk_fma_f32 v[88:89], v[80:81], v[200:201], v[88:89]
  v_cvt_pk_bf16_f32 v64, v88, v89
  v_lshlrev_b32 v88, 16, v65
  v_and_b32 v89, 0xffff0000, v65
  v_pk_fma_f32 v[88:89], v[82:83], v[202:203], v[88:89]
  v_cvt_pk_bf16_f32 v65, v88, v89
  v_lshlrev_b32 v88, 16, v66
  v_and_b32 v89, 0xffff0000, v66
  v_pk_fma_f32 v[88:89], v[84:85], v[204:205], v[88:89]
  v_cvt_pk_bf16_f32 v66, v88, v89
  v_lshlrev_b32 v88, 16, v67
  v_and_b32 v89, 0xffff0000, v67
  v_pk_fma_f32 v[88:89], v[86:87], v[206:207], v[88:89]
  v_cvt_pk_bf16_f32 v67, v88, v89
  s_mov_b32 exec_hi, -1
  buffer_store_dwordx4 v[64:67], v8, s[68:71], s46 offen
  s_mov_b32 exec_hi, -1
  s_waitcnt vmcnt(3)
  v_cmp_ne_u32 s[40:41], 1, v4
  s_nop 0
  s_cmp_eq_u64 s[40:41], 0
  s_cbranch_scc1 L_vk_p3
  s_mov_b32 s42, 0
L_vs_p3:
  buffer_load_dword v4, v29, s[12:15], s49 offen sc0 sc1
  s_add_u32 s42, s42, 1
  s_waitcnt vmcnt(0)
  v_cmp_ne_u32 s[40:41], 1, v4
  s_cmp_gt_u32 s42, 0x40000
  s_cbranch_scc1 L_vk_p3
  s_cmp_lg_u64 s[40:41], 0
  s_cbranch_scc1 L_vs_p3
L_vk_p3:
  s_mov_b32 s21, s45
  buffer_load_dwordx4 v[128:131], v14, s[12:15], s21 offen sc1
  s_add_u32 s21, s21, 9216
  buffer_load_dwordx4 v[132:135], v14, s[12:15], s21 offen sc1
  s_add_u32 s21, s21, 9216
  buffer_load_dwordx4 v[136:139], v14, s[12:15], s21 offen sc1
  s_add_u32 s21, s21, 9216
  buffer_load_dwordx4 v[140:143], v14, s[12:15], s21 offen sc1
  s_add_u32 s21, s21, 9216
  v_pk_mul_f32 v[208:209], v[208:209], v[26:27] op_sel_hi:[1,0]
  v_pk_mul_f32 v[210:211], v[210:211], v[26:27] op_sel_hi:[1,0]
  v_pk_mul_f32 v[212:213], v[212:213], v[26:27] op_sel_hi:[1,0]
  v_pk_mul_f32 v[214:215], v[214:215], v[26:27] op_sel_hi:[1,0]
  v_lshlrev_b32 v80, 16, v96
  v_and_b32 v81, 0xffff0000, v96
  v_lshlrev_b32 v82, 16, v97
  v_and_b32 v83, 0xffff0000, v97
  v_lshlrev_b32 v84, 16, v98
  v_and_b32 v85, 0xffff0000, v98
  v_lshlrev_b32 v86, 16, v99
  v_and_b32 v87, 0xffff0000, v99
  v_dot2c_f32_bf16 v80, s26, v100
  v_dot2c_f32_bf16 v81, s27, v100
  v_dot2c_f32_bf16 v82, s26, v101
  v_dot2c_f32_bf16 v83, s27, v101
  v_dot2c_f32_bf16 v84, s26, v102
  v_dot2c_f32_bf16 v85, s27, v102
  v_dot2c_f32_bf16 v86, s26, v103
  v_dot2c_f32_bf16 v87, s27, v103
  v_dot2c_f32_bf16 v80, s26, v104
  v_dot2c_f32_bf16 v81, s27, v104
  v_dot2c_f32_bf16 v82, s26, v105
  v_dot2c_f32_bf16 v83, s27, v105
  v_dot2c_f32_bf16 v84, s26, v106
  v_dot2c_f32_bf16 v85, s27, v106
  v_dot2c_f32_bf16 v86, s26, v107
  v_dot2c_f32_bf16 v87, s27, v107
  v_dot2c_f32_bf16 v80, s26, v108
  v_dot2c_f32_bf16 v81, s27, v108
  v_dot2c_f32_bf16 v82, s26, v109
  v_dot2c_f32_bf16 v83, s27, v109
  v_dot2c_f32_bf16 v84, s26, v110
  v_dot2c_f32_bf16 v85, s27, v110
  v_dot2c_f32_bf16 v86, s26, v111
  v_dot2c_f32_bf16 v87, s27, v111
  v_dot2c_f32_bf16 v80, s26, v112
  v_dot2c_f32_bf16 v81, s27, v112
  v_dot2c_f32_bf16 v82, s26, v113
  v_dot2c_f32_bf16 v83, s27, v113
  v_dot2c_f32_bf16 v84, s26, v114
  v_dot2c_f32_bf16 v85, s27, v114
  v_dot2c_f32_bf16 v86, s26, v115
  v_dot2c_f32_bf16 v87, s27, v115
  v_dot2c_f32_bf16 v80, s26, v116
  v_dot2c_f32_bf16 v81, s27, v116
  v_dot2c_f32_bf16 v82, s26, v117
  v_dot2c_f32_bf16 v83, s27, v117
  v_dot2c_f32_bf16 v84, s26, v118
  v_dot2c_f32_bf16 v85, s27, v118
  v_dot2c_f32_bf16 v86, s26, v119
  v_dot2c_f32_bf16 v87, s27, v119
  s_waitcnt vmcnt(6)
  v_dot2c_f32_bf16 v80, s26, v120
  v_dot2c_f32_bf16 v81, s27, v120
  v_dot2c_f32_bf16 v82, s26, v121
  v_dot2c_f32_bf16 v83, s27, v121
  v_dot2c_f32_bf16 v84, s26, v122
  v_dot2c_f32_bf16 v85, s27, v122
  v_dot2c_f32_bf16 v86, s26, v123
  v_dot2c_f32_bf16 v87, s27, v123
  s_waitcnt vmcnt(5)
  v_dot2c_f32_bf16 v80, s26, v124
  v_dot2c_f32_bf16 v81, s27, v124
  v_dot2c_f32_bf16 v82, s26, v125
  v_dot2c_f32_bf16 v83, s27, v125
  v_dot2c_f32_bf16 v84, s26, v126
  v_dot2c_f32_bf16 v85, s27, v126
  v_dot2c_f32_bf16 v86, s26, v127
  v_dot2c_f32_bf16 v87, s27, v127
  v_lshlrev_b32 v88, 16, v68
  v_and_b32 v89, 0xffff0000, v68
  v_pk_fma_f32 v[88:89], v[80:81], v[208:209], v[88:89]
  v_cvt_pk_bf16_f32 v68, v88, v89
  v_lshlrev_b32 v88, 16, v69
  v_and_b32 v89, 0xffff0000, v69
  v_pk_fma_f32 v[88:89], v[82:83], v[210:211], v[88:89]
  v_cvt_pk_bf16_f32 v69, v88, v89
  v_lshlrev_b32 v88, 16, v70
  v_and_b32 v89, 0xffff0000, v70
  v_pk_fma_f32 v[88:89], v[84:85], v[212:213], v[88:89]
  v_cvt_pk_bf16_f32 v70, v88, v89
  v_lshlrev_b32 v88, 16, v71
  v_and_b32 v89, 0xffff0000, v71
  v_pk_fma_f32 v[88:89], v[86:87], v[214:215], v[88:89]
  v_cvt_pk_bf16_f32 v71, v88, v89
  s_mov_b32 exec_hi, 65535
  buffer_store_dwordx4 v[68:71], v9, s[68:71], s46 offen
  s_mov_b32 exec_hi, -1
  v_pk_mul_f32 v[216:217], v[216:217], v[26:27] op_sel_hi:[1,0]
  v_pk_mul_f32 v[218:219], v[218:219], v[26:27] op_sel_hi:[1,0]
  v_pk_mul_f32 v[220:221], v[220:221], v[26:27] op_sel_hi:[1,0]
  v_pk_mul_f32 v[222:223], v[222:223], v[26:27] op_sel_hi:[1,0]
  s_waitcnt vmcnt(4)
  v_lshlrev_b32 v80, 16, v128
  v_and_b32 v81, 0xffff0000, v128
  v_lshlrev_b32 v82, 16, v129
  v_and_b32 v83, 0xffff0000, v129
  v_lshlrev_b32 v84, 16, v130
  v_and_b32 v85, 0xffff0000, v130
  v_lshlrev_b32 v86, 16, v131
  v_and_b32 v87, 0xffff0000, v131
  s_waitcnt vmcnt(3)
  v_dot2c_f32_bf16 v80, s26, v132
  v_dot2c_f32_bf16 v81, s27, v132
  v_dot2c_f32_bf16 v82, s26, v133
  v_dot2c_f32_bf16 v83, s27, v133
  v_dot2c_f32_bf16 v84, s26, v134
  v_dot2c_f32_bf16 v85, s27, v134
  v_dot2c_f32_bf16 v86, s26, v135
  v_dot2c_f32_bf16 v87, s27, v135
  s_waitcnt vmcnt(2)
  v_dot2c_f32_bf16 v80, s26, v136
  v_dot2c_f32_bf16 v81, s27, v136
  v_dot2c_f32_bf16 v82, s26, v137
  v_dot2c_f32_bf16 v83, s27, v137
  v_dot2c_f32_bf16 v84, s26, v138
  v_dot2c_f32_bf16 v85, s27, v138
  v_dot2c_f32_bf16 v86, s26, v139
  v_dot2c_f32_bf16 v87, s27, v139
  s_waitcnt vmcnt(1)
  v_dot2c_f32_bf16 v80, s26, v140
  v_dot2c_f32_bf16 v81, s27, v140
  v_dot2c_f32_bf16 v82, s26, v141
  v_dot2c_f32_bf16 v83, s27, v141
  v_dot2c_f32_bf16 v84, s26, v142
  v_dot2c_f32_bf16 v85, s27, v142
  v_dot2c_f32_bf16 v86, s26, v143
  v_dot2c_f32_bf16 v87, s27, v143
  v_permlane32_swap_b32 v80, v32
  v_permlane32_swap_b32 v81, v33
  v_permlane32_swap_b32 v82, v34
  v_permlane32_swap_b32 v83, v35
  v_permlane32_swap_b32 v84, v36
  v_permlane32_swap_b32 v85, v37
  v_permlane32_swap_b32 v86, v38
  v_permlane32_swap_b32 v87, v39
  v_add_f32 v80, v80, v32
  v_add_f32 v81, v81, v33
  v_add_f32 v82, v82, v34
  v_add_f32 v83, v83, v35
  v_add_f32 v84, v84, v36
  v_add_f32 v85, v85, v37
  v_add_f32 v86, v86, v38
  v_add_f32 v87, v87, v39
  v_lshlrev_b32 v88, 16, v72
  v_and_b32 v89, 0xffff0000, v72
  v_pk_fma_f32 v[88:89], v[80:81], v[216:217], v[88:89]
  v_cvt_pk_bf16_f32 v72, v88, v89
  v_lshlrev_b32 v88, 16, v73
  v_and_b32 v89, 0xffff0000, v73
  v_pk_fma_f32 v[88:89], v[82:83], v[218:219], v[88:89]
  v_cvt_pk_bf16_f32 v73, v88, v89
  v_lshlrev_b32 v88, 16, v74
  v_and_b32 v89, 0xffff0000, v74
  v_pk_fma_f32 v[88:89], v[84:85], v[220:221], v[88:89]
  v_cvt_pk_bf16_f32 v74, v88, v89
  v_lshlrev_b32 v88, 16, v75
  v_and_b32 v89, 0xffff0000, v75
  v_pk_fma_f32 v[88:89], v[86:87], v[222:223], v[88:89]
  v_cvt_pk_bf16_f32 v75, v88, v89
  s_mov_b32 exec_hi, 0
  buffer_store_dwordx4 v[72:75], v10, s[68:71], s46 offen
  s_mov_b32 exec_hi, -1
L_end_kf_kernel:
  s_endpgm
L_a_c1:
  ds_read_b128 v[88:91], v2 offset:0
  ds_read_b128 v[92:95], v2 offset:18432
  ds_read_b128 v[96:99], v2 offset:36864
  ds_read_b128 v[100:103], v1 offset:0
  ds_read_b128 v[104:107], v1 offset:18432
  s_waitcnt vmcnt(11) lgkmcnt(4)
  v_mfma_f32_16x16x32_bf16 v[16:19], a[0:3], v[88:91], 0
  ds_read_b128 v[108:111], v2 offset:1024
  s_waitcnt vmcnt(10)
  v_mfma_f32_16x16x32_bf16 v[36:39], a[4:7], v[88:91], 0
  ds_read_b128 v[128:131], v172 offset:0
  s_waitcnt vmcnt(9)
  v_mfma_f32_16x16x32_bf16 v[56:59], a[8:11], v[88:91], 0
  s_waitcnt lgkmcnt(5)
  v_mfma_f32_16x16x32_bf16 v[20:23], a[0:3], v[92:95], 0
  buffer_load_dwordx4 a[48:51], v8, s[12:15], s39 offen
  v_mfma_f32_16x16x32_bf16 v[40:43], a[4:7], v[92:95], 0
  ds_read_b128 v[112:115], v2 offset:19456
  v_mfma_f32_16x16x32_bf16 v[60:63], a[8:11], v[92:95], 0
  s_waitcnt vmcnt(9)
  v_mfma_f32_16x16x32_bf16 v[76:79], a[12:15], v[92:95], 0
  buffer_load_dwordx4 a[52:55], v9, s[12:15], s39 offen
  s_waitcnt lgkmcnt(5)
  v_mfma_f32_16x16x32_bf16 v[24:27], a[0:3], v[96:99], 0
  ds_read_b128 v[116:119], v2 offset:37888
  v_mfma_f32_16x16x32_bf16 v[44:47], a[4:7], v[96:99], 0
  v_mfma_f32_16x16x32_bf16 v[64:67], a[8:11], v[96:99], 0
  ds_read_b128 v[132:135], v172 offset:16
  v_mfma_f32_16x16x32_bf16 v[80:83], a[12:15], v[96:99], 0
  buffer_load_dwordx4 a[56:59], v10, s[12:15], s39 offen
  s_waitcnt lgkmcnt(6)
  v_mfma_f32_16x16x32_bf16 v[28:31], a[0:3], v[100:103], 0
  v_mfma_f32_16x16x32_bf16 v[48:51], a[4:7], v[100:103], 0
  ds_read_b128 v[120:123], v1 offset:1024
  v_mfma_f32_16x16x32_bf16 v[68:71], a[8:11], v[100:103], 0
  buffer_load_dwordx4 a[60:63], v11, s[12:15], s39 offen
  s_add_u32 s39, s39, 1024
  s_waitcnt lgkmcnt(6)
  v_mfma_f32_16x16x32_bf16 v[32:35], a[0:3], v[104:107], 0
  v_mfma_f32_16x16x32_bf16 v[52:55], a[4:7], v[104:107], 0
  ds_read_b128 v[124:127], v1 offset:19456
  v_mfma_f32_16x16x32_bf16 v[72:75], a[8:11], v[104:107], 0
  s_waitcnt vmcnt(11) lgkmcnt(6)
  v_mfma_f32_16x16x32_bf16 v[16:19], a[16:19], v[108:111], v[16:19]
  ds_read_b128 v[88:91], v2 offset:2048
  s_waitcnt vmcnt(10)
  v_mfma_f32_16x16x32_bf16 v[36:39], a[20:23], v[108:111], v[36:39]
  ds_read_b128 v[136:139], v172 offset:128
  s_waitcnt vmcnt(9)
  v_mfma_f32_16x16x32_bf16 v[56:59], a[24:27], v[108:111], v[56:59]
  s_waitcnt lgkmcnt(6)
  v_mfma_f32_16x16x32_bf16 v[20:23], a[16:19], v[112:115], v[20:23]
  buffer_load_dwordx4 a[64:67], v8, s[12:15], s39 offen
  v_mfma_f32_16x16x32_bf16 v[40:43], a[20:23], v[112:115], v[40:43]
  ds_read_b128 v[92:95], v2 offset:20480
  v_mfma_f32_16x16x32_bf16 v[60:63], a[24:27], v[112:115], v[60:63]
  s_waitcnt vmcnt(9)
  v_mfma_f32_16x16x32_bf16 v[76:79], a[28:31], v[112:115], v[76:79]
  buffer_load_dwordx4 a[68:71], v9, s[12:15], s39 offen
  s_waitcnt lgkmcnt(6)
  v_mfma_f32_16x16x32_bf16 v[24:27], a[16:19], v[116:119], v[24:27]
  ds_read_b128 v[96:99], v2 offset:38912
  v_mfma_f32_16x16x32_bf16 v[44:47], a[20:23], v[116:119], v[44:47]
  v_mfma_f32_16x16x32_bf16 v[64:67], a[24:27], v[116:119], v[64:67]
  ds_read_b128 v[140:143], v172 offset:144
  v_mfma_f32_16x16x32_bf16 v[80:83], a[28:31], v[116:119], v[80:83]
  buffer_load_dwordx4 a[72:75], v10, s[12:15], s39 offen
  s_waitcnt lgkmcnt(6)
  v_mfma_f32_16x16x32_bf16 v[28:31], a[16:19], v[120:123], v[28:31]
  v_mfma_f32_16x16x32_bf16 v[48:51], a[20:23], v[120:123], v[48:51]
  ds_read_b128 v[100:103], v1 offset:2048
  v_mfma_f32_16x16x32_bf16 v[68:71], a[24:27], v[120:123], v[68:71]
  buffer_load_dwordx4 a[76:79], v11, s[12:15], s39 offen
  s_add_u32 s39, s39, 1024
  s_waitcnt lgkmcnt(6)
  v_mfma_f32_16x16x32_bf16 v[32:35], a[16:19], v[124:127], v[32:35]
  v_mfma_f32_16x16x32_bf16 v[52:55], a[20:23], v[124:127], v[52:55]
  ds_read_b128 v[104:107], v1 offset:20480
  v_mfma_f32_16x16x32_bf16 v[72:75], a[24:27], v[124:127], v[72:75]
  s_waitcnt vmcnt(11) lgkmcnt(6)
  v_mfma_f32_16x16x32_bf16 v[16:19], a[32:35], v[88:91], v[16:19]
  ds_read_b128 v[108:111], v2 offset:3072
  s_waitcnt vmcnt(10)
  v_mfma_f32_16x16x32_bf16 v[36:39], a[36:39], v[88:91], v[36:39]
  ds_read_b128 v[144:147], v172 offset:256
  s_waitcnt vmcnt(9)
  v_mfma_f32_16x16x32_bf16 v[56:59], a[40:43], v[88:91], v[56:59]
  s_waitcnt lgkmcnt(6)
  v_mfma_f32_16x16x32_bf16 v[20:23], a[32:35], v[92:95], v[20:23]
  buffer_load_dwordx4 a[80:83], v8, s[12:15], s39 offen
  v_mfma_f32_16x16x32_bf16 v[40:43], a[36:39], v[92:95], v[40:43]
  ds_read_b128 v[112:115], v2 offset:21504
  v_mfma_f32_16x16x32_bf16 v[60:63], a[40:43], v[92:95], v[60:63]
  s_waitcnt vmcnt(9)
  v_mfma_f32_16x16x32_bf16 v[76:79], a[44:47], v[92:95], v[76:79]
  buffer_load_dwordx4 a[84:87], v9, s[12:15], s39 offen
  s_waitcnt lgkmcnt(6)
  v_mfma_f32_16x16x32_bf16 v[24:27], a[32:35], v[96:99], v[24:27]
  ds_read_b128 v[116:119], v2 offset:39936
  v_mfma_f32_16x16x32_bf16 v[44:47], a[36:39], v[96:99], v[44:47]
  v_mfma_f32_16x16x32_bf16 v[64:67], a[40:43], v[96:99], v[64:67]
  ds_read_b128 v[148:151], v172 offset:272
  v_mfma_f32_16x16x32_bf16 v[80:83], a[44:47], v[96:99], v[80:83]
  buffer_load_dwordx4 a[88:91], v10, s[12:15], s39 offen
  s_waitcnt lgkmcnt(6)
  v_mfma_f32_16x16x32_bf16 v[28:31], a[32:35], v[100:103], v[28:31]
  v_mfma_f32_16x16x32_bf16 v[48:51], a[36:39], v[100:103], v[48:51]
  ds_read_b128 v[120:123], v1 offset:3072
  v_mfma_f32_16x16x32_bf16 v[68:71], a[40:43], v[100:103], v[68:71]
  buffer_load_dwordx4 a[92:95], v11, s[12:15], s39 offen
  s_add_u32 s39, s39, 1024
  s_waitcnt lgkmcnt(6)
  v_mfma_f32_16x16x32_bf16 v[32:35], a[32:35], v[104:107], v[32:35]
  v_mfma_f32_16x16x32_bf16 v[52:55], a[36:39], v[104:107], v[52:55]
  ds_read_b128 v[124:127], v1 offset:21504
  v_mfma_f32_16x16x32_bf16 v[72:75], a[40:43], v[104:107], v[72:75]
  s_waitcnt vmcnt(11) lgkmcnt(6)
  v_mfma_f32_16x16x32_bf16 v[16:19], a[48:51], v[108:111], v[16:19]
  ds_read_b128 v[88:91], v2 offset:4096
  s_waitcnt vmcnt(10)
  v_mfma_f32_16x16x32_bf16 v[36:39], a[52:55], v[108:111], v[36:39]
  v_cvt_pk_bf16_f32 v184, v128, v129
  s_waitcnt vmcnt(9)
  v_mfma_f32_16x16x32_bf16 v[56:59], a[56:59], v[108:111], v[56:59]
  s_waitcnt lgkmcnt(5)
  v_mfma_f32_16x16x32_bf16 v[20:23], a[48:51], v[112:115], v[20:23]
  buffer_load_dwordx4 a[96:99], v8, s[12:15], s39 offen
  v_mfma_f32_16x16x32_bf16 v[40:43], a[52:55], v[112:115], v[40:43]
  ds_read_b128 v[92:95], v2 offset:22528
  v_mfma_f32_16x16x32_bf16 v[60:63], a[56:59], v[112:115], v[60:63]
  s_waitcnt vmcnt(9)
  v_mfma_f32_16x16x32_bf16 v[76:79], a[60:63], v[112:115], v[76:79]
  buffer_load_dwordx4 a[100:103], v9, s[12:15], s39 offen
  s_waitcnt lgkmcnt(5)
  v_mfma_f32_16x16x32_bf16 v[24:27], a[48:51], v[116:119], v[24:27]
  ds_read_b128 v[96:99], v2 offset:40960
  v_mfma_f32_16x16x32_bf16 v[44:47], a[52:55], v[116:119], v[44:47]
  v_mfma_f32_16x16x32_bf16 v[64:67], a[56:59], v[116:119], v[64:67]
  v_cvt_pk_bf16_f32 v185, v130, v131
  v_mfma_f32_16x16x32_bf16 v[80:83], a[60:63], v[116:119], v[80:83]
  buffer_load_dwordx4 a[104:107], v10, s[12:15], s39 offen
  s_waitcnt lgkmcnt(4)
  v_mfma_f32_16x16x32_bf16 v[28:31], a[48:51], v[120:123], v[28:31]
  v_mfma_f32_16x16x32_bf16 v[48:51], a[52:55], v[120:123], v[48:51]
  ds_read_b128 v[100:103], v1 offset:4096
  v_mfma_f32_16x16x32_bf16 v[68:71], a[56:59], v[120:123], v[68:71]
  buffer_load_dwordx4 a[108:111], v11, s[12:15], s39 offen
  s_add_u32 s39, s39, 1024
  s_waitcnt lgkmcnt(4)
  v_mfma_f32_16x16x32_bf16 v[32:35], a[48:51], v[124:127], v[32:35]
  v_mfma_f32_16x16x32_bf16 v[52:55], a[52:55], v[124:127], v[52:55]
  ds_read_b128 v[104:107], v1 offset:22528
  v_mfma_f32_16x16x32_bf16 v[72:75], a[56:59], v[124:127], v[72:75]
  s_waitcnt vmcnt(11) lgkmcnt(4)
  v_mfma_f32_16x16x32_bf16 v[16:19], a[64:67], v[88:91], v[16:19]
  ds_read_b128 v[108:111], v2 offset:5120
  s_waitcnt vmcnt(10)
  v_mfma_f32_16x16x32_bf16 v[36:39], a[68:71], v[88:91], v[36:39]
  v_cvt_pk_bf16_f32 v186, v132, v133
  s_waitcnt vmcnt(9)
  v_mfma_f32_16x16x32_bf16 v[56:59], a[72:75], v[88:91], v[56:59]
  s_waitcnt lgkmcnt(4)
  v_mfma_f32_16x16x32_bf16 v[20:23], a[64:67], v[92:95], v[20:23]
  buffer_load_dwordx4 a[112:115], v8, s[12:15], s39 offen
  v_mfma_f32_16x16x32_bf16 v[40:43], a[68:71], v[92:95], v[40:43]
  ds_read_b128 v[112:115], v2 offset:23552
  v_mfma_f32_16x16x32_bf16 v[60:63], a[72:75], v[92:95], v[60:63]
  s_waitcnt vmcnt(9)
  v_mfma_f32_16x16x32_bf16 v[76:79], a[76:79], v[92:95], v[76:79]
  buffer_load_dwordx4 a[116:119], v9, s[12:15], s39 offen
  s_waitcnt lgkmcnt(4)
  v_mfma_f32_16x16x32_bf16 v[24:27], a[64:67], v[96:99], v[24:27]
  ds_read_b128 v[116:119], v2 offset:41984
  v_mfma_f32_16x16x32_bf16 v[44:47], a[68:71], v[96:99], v[44:47]
  v_mfma_f32_16x16x32_bf16 v[64:67], a[72:75], v[96:99], v[64:67]
  v_cvt_pk_bf16_f32 v187, v134, v135
  v_mfma_f32_16x16x32_bf16 v[80:83], a[76:79], v[96:99], v[80:83]
  buffer_load_dwordx4 a[120:123], v10, s[12:15], s39 offen
  s_waitcnt lgkmcnt(4)
  v_mfma_f32_16x16x32_bf16 v[28:31], a[64:67], v[100:103], v[28:31]
  v_mfma_f32_16x16x32_bf16 v[48:51], a[68:71], v[100:103], v[48:51]
  ds_read_b128 v[120:123], v1 offset:5120
  v_mfma_f32_16x16x32_bf16 v[68:71], a[72:75], v[100:103], v[68:71]
  buffer_load_dwordx4 a[124:127], v11, s[12:15], s39 offen
  s_add_u32 s39, s39, 1024
  s_waitcnt lgkmcnt(4)
  v_mfma_f32_16x16x32_bf16 v[32:35], a[64:67], v[104:107], v[32:35]
  v_mfma_f32_16x16x32_bf16 v[52:55], a[68:71], v[104:107], v[52:55]
  ds_read_b128 v[124:127], v1 offset:23552
  v_mfma_f32_16x16x32_bf16 v[72:75], a[72:75], v[104:107], v[72:75]
  s_waitcnt vmcnt(11) lgkmcnt(4)
  v_mfma_f32_16x16x32_bf16 v[16:19], a[80:83], v[108:111], v[16:19]
  ds_read_b128 v[88:91], v2 offset:6144
  s_waitcnt vmcnt(10)
  v_mfma_f32_16x16x32_bf16 v[36:39], a[84:87], v[108:111], v[36:39]
  v_cvt_pk_bf16_f32 v188, v136, v137
  s_waitcnt vmcnt(9)
  v_mfma_f32_16x16x32_bf16 v[56:59], a[88:91], v[108:111], v[56:59]
  s_waitcnt lgkmcnt(4)
  v_mfma_f32_16x16x32_bf16 v[20:23], a[80:83], v[112:115], v[20:23]
  buffer_load_dwordx4 a[128:131], v8, s[12:15], s39 offen
  v_mfma_f32_16x16x32_bf16 v[40:43], a[84:87], v[112:115], v[40:43]
  ds_read_b128 v[92:95], v2 offset:24576
  v_mfma_f32_16x16x32_bf16 v[60:63], a[88:91], v[112:115], v[60:63]
  s_waitcnt vmcnt(9)
  v_mfma_f32_16x16x32_bf16 v[76:79], a[92:95], v[112:115], v[76:79]
  buffer_load_dwordx4 a[132:135], v9, s[12:15], s39 offen
  s_waitcnt lgkmcnt(4)
  v_mfma_f32_16x16x32_bf16 v[24:27], a[80:83], v[116:119], v[24:27]
  ds_read_b128 v[96:99], v2 offset:43008
  v_mfma_f32_16x16x32_bf16 v[44:47], a[84:87], v[116:119], v[44:47]
  v_mfma_f32_16x16x32_bf16 v[64:67], a[88:91], v[116:119], v[64:67]
  v_cvt_pk_bf16_f32 v189, v138, v139
  v_mfma_f32_16x16x32_bf16 v[80:83], a[92:95], v[116:119], v[80:83]
  buffer_load_dwordx4 a[136:139], v10, s[12:15], s39 offen
  s_waitcnt lgkmcnt(4)
  v_mfma_f32_16x16x32_bf16 v[28:31], a[80:83], v[120:123], v[28:31]
  v_mfma_f32_16x16x32_bf16 v[48:51], a[84:87], v[120:123], v[48:51]
  ds_read_b128 v[100:103], v1 offset:6144
  v_mfma_f32_16x16x32_bf16 v[68:71], a[88:91], v[120:123], v[68:71]
  buffer_load_dwordx4 a[140:143], v11, s[12:15], s39 offen
  s_add_u32 s39, s39, 1024
  s_waitcnt lgkmcnt(4)
  v_mfma_f32_16x16x32_bf16 v[32:35], a[80:83], v[124:127], v[32:35]
  v_mfma_f32_16x16x32_bf16 v[52:55], a[84:87], v[124:127], v[52:55]
  ds_read_b128 v[104:107], v1 offset:24576
  v_mfma_f32_16x16x32_bf16 v[72:75], a[88:91], v[124:127], v[72:75]
  s_waitcnt vmcnt(11) lgkmcnt(4)
  v_mfma_f32_16x16x32_bf16 v[16:19], a[96:99], v[88:91], v[16:19]
  ds_read_b128 v[108:111], v2 offset:7168
  s_waitcnt vmcnt(10)
  v_mfma_f32_16x16x32_bf16 v[36:39], a[100:103], v[88:91], v[36:39]
  v_cvt_pk_bf16_f32 v190, v140, v141
  s_waitcnt vmcnt(9)
  v_mfma_f32_16x16x32_bf16 v[56:59], a[104:107], v[88:91], v[56:59]
  s_waitcnt lgkmcnt(4)
  v_mfma_f32_16x16x32_bf16 v[20:23], a[96:99], v[92:95], v[20:23]
  buffer_load_dwordx4 a[144:147], v8, s[12:15], s39 offen
  v_mfma_f32_16x16x32_bf16 v[40:43], a[100:103], v[92:95], v[40:43]
  ds_read_b128 v[112:115], v2 offset:25600
  v_mfma_f32_16x16x32_bf16 v[60:63], a[104:107], v[92:95], v[60:63]
  s_waitcnt vmcnt(9)
  v_mfma_f32_16x16x32_bf16 v[76:79], a[108:111], v[92:95], v[76:79]
  buffer_load_dwordx4 a[148:151], v9, s[12:15], s39 offen
  s_waitcnt lgkmcnt(4)
  v_mfma_f32_16x16x32_bf16 v[24:27], a[96:99], v[96:99], v[24:27]
  ds_read_b128 v[116:119], v2 offset:44032
  v_mfma_f32_16x16x32_bf16 v[44:47], a[100:103], v[96:99], v[44:47]
  v_mfma_f32_16x16x32_bf16 v[64:67], a[104:107], v[96:99], v[64:67]
  v_cvt_pk_bf16_f32 v191, v142, v143
  v_mfma_f32_16x16x32_bf16 v[80:83], a[108:111], v[96:99], v[80:83]
  buffer_load_dwordx4 a[152:155], v10, s[12:15], s39 offen
  s_waitcnt lgkmcnt(4)
  v_mfma_f32_16x16x32_bf16 v[28:31], a[96:99], v[100:103], v[28:31]
  v_mfma_f32_16x16x32_bf16 v[48:51], a[100:103], v[100:103], v[48:51]
  ds_read_b128 v[120:123], v1 offset:7168
  v_mfma_f32_16x16x32_bf16 v[68:71], a[104:107], v[100:103], v[68:71]
  buffer_load_dwordx4 a[156:159], v11, s[12:15], s39 offen
  s_add_u32 s39, s39, 1024
  s_waitcnt lgkmcnt(4)
  v_mfma_f32_16x16x32_bf16 v[32:35], a[96:99], v[104:107], v[32:35]
  v_mfma_f32_16x16x32_bf16 v[52:55], a[100:103], v[104:107], v[52:55]
  ds_read_b128 v[124:127], v1 offset:25600
  v_mfma_f32_16x16x32_bf16 v[72:75], a[104:107], v[104:107], v[72:75]
  s_waitcnt vmcnt(11) lgkmcnt(4)
  v_mfma_f32_16x16x32_bf16 v[16:19], a[112:115], v[108:111], v[16:19]
  ds_read_b128 v[88:91], v2 offset:8192
  s_waitcnt vmcnt(10)
  v_mfma_f32_16x16x32_bf16 v[36:39], a[116:119], v[108:111], v[36:39]
  v_cvt_pk_bf16_f32 v192, v144, v145
  s_waitcnt vmcnt(9)
  v_mfma_f32_16x16x32_bf16 v[56:59], a[120:123], v[108:111], v[56:59]
  s_waitcnt lgkmcnt(4)
  v_mfma_f32_16x16x32_bf16 v[20:23], a[112:115], v[112:115], v[20:23]
  buffer_load_dwordx4 a[160:163], v8, s[12:15], s39 offen
  v_mfma_f32_16x16x32_bf16 v[40:43], a[116:119], v[112:115], v[40:43]
  ds_read_b128 v[92:95], v2 offset:26624
  v_mfma_f32_16x16x32_bf16 v[60:63], a[120:123], v[112:115], v[60:63]
  s_waitcnt vmcnt(9)
  v_mfma_f32_16x16x32_bf16 v[76:79], a[124:127], v[112:115], v[76:79]
  buffer_load_dwordx4 a[164:167], v9, s[12:15], s39 offen
  s_waitcnt lgkmcnt(4)
  v_mfma_f32_16x16x32_bf16 v[24:27], a[112:115], v[116:119], v[24:27]
  ds_read_b128 v[96:99], v2 offset:45056
  v_mfma_f32_16x16x32_bf16 v[44:47], a[116:119], v[116:119], v[44:47]
  v_mfma_f32_16x16x32_bf16 v[64:67], a[120:123], v[116:119], v[64:67]
  v_cvt_pk_bf16_f32 v193, v146, v147
  v_mfma_f32_16x16x32_bf16 v[80:83], a[124:127], v[116:119], v[80:83]
  buffer_load_dwordx4 a[168:171], v10, s[12:15], s39 offen
  s_waitcnt lgkmcnt(4)
  v_mfma_f32_16x16x32_bf16 v[28:31], a[112:115], v[120:123], v[28:31]
  v_mfma_f32_16x16x32_bf16 v[48:51], a[116:119], v[120:123], v[48:51]
  ds_read_b128 v[100:103], v1 offset:8192
  v_mfma_f32_16x16x32_bf16 v[68:71], a[120:123], v[120:123], v[68:71]
  buffer_load_dwordx4 a[172:175], v11, s[12:15], s39 offen
  s_add_u32 s39, s39, 1024
  s_waitcnt lgkmcnt(4)
  v_mfma_f32_16x16x32_bf16 v[32:35], a[112:115], v[124:127], v[32:35]
  v_mfma_f32_16x16x32_bf16 v[52:55], a[116:119], v[124:127], v[52:55]
  ds_read_b128 v[104:107], v1 offset:26624
  v_mfma_f32_16x16x32_bf16 v[72:75], a[120:123], v[124:127], v[72:75]
  s_waitcnt vmcnt(11) lgkmcnt(4)
  v_mfma_f32_16x16x32_bf16 v[16:19], a[128:131], v[88:91], v[16:19]
  ds_read_b128 v[108:111], v2 offset:9216
  s_waitcnt vmcnt(10)
  v_mfma_f32_16x16x32_bf16 v[36:39], a[132:135], v[88:91], v[36:39]
  v_cvt_pk_bf16_f32 v194, v148, v149
  s_waitcnt vmcnt(9)
  v_mfma_f32_16x16x32_bf16 v[56:59], a[136:139], v[88:91], v[56:59]
  s_waitcnt lgkmcnt(4)
  v_mfma_f32_16x16x32_bf16 v[20:23], a[128:131], v[92:95], v[20:23]
  buffer_load_dwordx4 a[176:179], v8, s[12:15], s39 offen
  v_mfma_f32_16x16x32_bf16 v[40:43], a[132:135], v[92:95], v[40:43]
  ds_read_b128 v[112:115], v2 offset:27648
  v_mfma_f32_16x16x32_bf16 v[60:63], a[136:139], v[92:95], v[60:63]
  s_waitcnt vmcnt(9)
  v_mfma_f32_16x16x32_bf16 v[76:79], a[140:143], v[92:95], v[76:79]
  buffer_load_dwordx4 a[180:183], v9, s[12:15], s39 offen
  s_waitcnt lgkmcnt(4)
  v_mfma_f32_16x16x32_bf16 v[24:27], a[128:131], v[96:99], v[24:27]
  ds_read_b128 v[116:119], v2 offset:46080
  v_mfma_f32_16x16x32_bf16 v[44:47], a[132:135], v[96:99], v[44:47]
  v_mfma_f32_16x16x32_bf16 v[64:67], a[136:139], v[96:99], v[64:67]
  v_cvt_pk_bf16_f32 v195, v150, v151
  v_mfma_f32_16x16x32_bf16 v[80:83], a[140:143], v[96:99], v[80:83]
  buffer_load_dwordx4 a[184:187], v10, s[12:15], s39 offen
  s_waitcnt lgkmcnt(4)
  v_mfma_f32_16x16x32_bf16 v[28:31], a[128:131], v[100:103], v[28:31]
  v_mfma_f32_16x16x32_bf16 v[48:51], a[132:135], v[100:103], v[48:51]
  ds_read_b128 v[120:123], v1 offset:9216
  v_mfma_f32_16x16x32_bf16 v[68:71], a[136:139], v[100:103], v[68:71]
  buffer_load_dwordx4 a[188:191], v11, s[12:15], s39 offen
  s_add_u32 s39, s39, 1024
  s_waitcnt lgkmcnt(4)
  v_mfma_f32_16x16x32_bf16 v[32:35], a[128:131], v[104:107], v[32:35]
  v_mfma_f32_16x16x32_bf16 v[52:55], a[132:135], v[104:107], v[52:55]
  ds_read_b128 v[124:127], v1 offset:27648
  v_mfma_f32_16x16x32_bf16 v[72:75], a[136:139], v[104:107], v[72:75]
  s_waitcnt vmcnt(11) lgkmcnt(4)
  v_mfma_f32_16x16x32_bf16 v[16:19], a[144:147], v[108:111], v[16:19]
  ds_read_b128 v[88:91], v2 offset:10240
  s_waitcnt vmcnt(10)
  v_mfma_f32_16x16x32_bf16 v[36:39], a[148:151], v[108:111], v[36:39]
  buffer_load_dwordx4 a[192:195], v8, s[12:15], s39 offen
  s_waitcnt vmcnt(10)
  v_mfma_f32_16x16x32_bf16 v[56:59], a[152:155], v[108:111], v[56:59]
  s_waitcnt lgkmcnt(4)
  v_mfma_f32_16x16x32_bf16 v[20:23], a[144:147], v[112:115], v[20:23]
  ds_read_b128 v[92:95], v2 offset:28672
  v_mfma_f32_16x16x32_bf16 v[40:43], a[148:151], v[112:115], v[40:43]
  v_mfma_f32_16x16x32_bf16 v[60:63], a[152:155], v[112:115], v[60:63]
  buffer_load_dwordx4 a[196:199], v9, s[12:15], s39 offen
  s_waitcnt vmcnt(10)
  v_mfma_f32_16x16x32_bf16 v[76:79], a[156:159], v[112:115], v[76:79]
  s_waitcnt lgkmcnt(4)
  v_mfma_f32_16x16x32_bf16 v[24:27], a[144:147], v[116:119], v[24:27]
  ds_read_b128 v[96:99], v2 offset:47104
  v_mfma_f32_16x16x32_bf16 v[44:47], a[148:151], v[116:119], v[44:47]
  v_mfma_f32_16x16x32_bf16 v[64:67], a[152:155], v[116:119], v[64:67]
  buffer_load_dwordx4 a[200:203], v10, s[12:15], s39 offen
  v_mfma_f32_16x16x32_bf16 v[80:83], a[156:159], v[116:119], v[80:83]
  s_waitcnt lgkmcnt(4)
  v_mfma_f32_16x16x32_bf16 v[28:31], a[144:147], v[120:123], v[28:31]
  ds_read_b128 v[100:103], v1 offset:10240
  v_mfma_f32_16x16x32_bf16 v[48:51], a[148:151], v[120:123], v[48:51]
  v_mfma_f32_16x16x32_bf16 v[68:71], a[152:155], v[120:123], v[68:71]
  buffer_load_dwordx4 a[204:207], v11, s[12:15], s39 offen
  s_add_u32 s39, s39, 1024
  s_waitcnt lgkmcnt(4)
  v_mfma_f32_16x16x32_bf16 v[32:35], a[144:147], v[124:127], v[32:35]
  v_mfma_f32_16x16x32_bf16 v[52:55], a[148:151], v[124:127], v[52:55]
  ds_read_b128 v[104:107], v1 offset:28672
  v_mfma_f32_16x16x32_bf16 v[72:75], a[152:155], v[124:127], v[72:75]
  s_waitcnt vmcnt(11) lgkmcnt(4)
  v_mfma_f32_16x16x32_bf16 v[16:19], a[160:163], v[88:91], v[16:19]
  ds_read_b128 v[108:111], v2 offset:11264
  s_waitcnt vmcnt(10)
  v_mfma_f32_16x16x32_bf16 v[36:39], a[164:167], v[88:91], v[36:39]
  buffer_load_dwordx4 a[208:211], v8, s[12:15], s39 offen
  s_waitcnt vmcnt(10)
  v_mfma_f32_16x16x32_bf16 v[56:59], a[168:171], v[88:91], v[56:59]
  s_waitcnt lgkmcnt(4)
  v_mfma_f32_16x16x32_bf16 v[20:23], a[160:163], v[92:95], v[20:23]
  ds_read_b128 v[112:115], v2 offset:29696
  v_mfma_f32_16x16x32_bf16 v[40:43], a[164:167], v[92:95], v[40:43]
  v_mfma_f32_16x16x32_bf16 v[60:63], a[168:171], v[92:95], v[60:63]
  buffer_load_dwordx4 a[212:215], v9, s[12:15], s39 offen
  s_waitcnt vmcnt(10)
  v_mfma_f32_16x16x32_bf16 v[76:79], a[172:175], v[92:95], v[76:79]
  s_waitcnt lgkmcnt(4)
  v_mfma_f32_16x16x32_bf16 v[24:27], a[160:163], v[96:99], v[24:27]
  ds_read_b128 v[116:119], v2 offset:48128
  v_mfma_f32_16x16x32_bf16 v[44:47], a[164:167], v[96:99], v[44:47]
  v_mfma_f32_16x16x32_bf16 v[64:67], a[168:171], v[96:99], v[64:67]
  buffer_load_dwordx4 a[216:219], v10, s[12:15], s39 offen
  v_mfma_f32_16x16x32_bf16 v[80:83], a[172:175], v[96:99], v[80:83]
  s_waitcnt lgkmcnt(4)
  v_mfma_f32_16x16x32_bf16 v[28:31], a[160:163], v[100:103], v[28:31]
  ds_read_b128 v[120:123], v1 offset:11264
  v_mfma_f32_16x16x32_bf16 v[48:51], a[164:167], v[100:103], v[48:51]
  v_mfma_f32_16x16x32_bf16 v[68:71], a[168:171], v[100:103], v[68:71]
  buffer_load_dwordx4 a[220:223], v11, s[12:15], s39 offen
  s_add_u32 s39, s39, 1024
  s_waitcnt lgkmcnt(4)
  v_mfma_f32_16x16x32_bf16 v[32:35], a[160:163], v[104:107], v[32:35]
  v_mfma_f32_16x16x32_bf16 v[52:55], a[164:167], v[104:107], v[52:55]
  ds_read_b128 v[124:127], v1 offset:29696
  v_mfma_f32_16x16x32_bf16 v[72:75], a[168:171], v[104:107], v[72:75]
  s_waitcnt vmcnt(11) lgkmcnt(4)
  v_mfma_f32_16x16x32_bf16 v[16:19], a[176:179], v[108:111], v[16:19]
  ds_read_b128 v[88:91], v2 offset:12288
  s_waitcnt vmcnt(10)
  v_mfma_f32_16x16x32_bf16 v[36:39], a[180:183], v[108:111], v[36:39]
  buffer_load_dwordx4 a[224:227], v8, s[12:15], s39 offen
  s_waitcnt vmcnt(10)
  v_mfma_f32_16x16x32_bf16 v[56:59], a[184:187], v[108:111], v[56:59]
  s_waitcnt lgkmcnt(4)
  v_mfma_f32_16x16x32_bf16 v[20:23], a[176:179], v[112:115], v[20:23]
  ds_read_b128 v[92:95], v2 offset:30720
  v_mfma_f32_16x16x32_bf16 v[40:43], a[180:183], v[112:115], v[40:43]
  v_mfma_f32_16x16x32_bf16 v[60:63], a[184:187], v[112:115], v[60:63]
  buffer_load_dwordx4 a[228:231], v9, s[12:15], s39 offen
  s_waitcnt vmcnt(10)
  v_mfma_f32_16x16x32_bf16 v[76:79], a[188:191], v[112:115], v[76:79]
  s_waitcnt lgkmcnt(4)
  v_mfma_f32_16x16x32_bf16 v[24:27], a[176:179], v[116:119], v[24:27]
  ds_read_b128 v[96:99], v2 offset:49152
  v_mfma_f32_16x16x32_bf16 v[44:47], a[180:183], v[116:119], v[44:47]
  v_mfma_f32_16x16x32_bf16 v[64:67], a[184:187], v[116:119], v[64:67]
  buffer_load_dwordx4 a[232:235], v10, s[12:15], s39 offen
  v_mfma_f32_16x16x32_bf16 v[80:83], a[188:191], v[116:119], v[80:83]
  s_waitcnt lgkmcnt(4)
  v_mfma_f32_16x16x32_bf16 v[28:31], a[176:179], v[120:123], v[28:31]
  ds_read_b128 v[100:103], v1 offset:12288
  v_mfma_f32_16x16x32_bf16 v[48:51], a[180:183], v[120:123], v[48:51]
  v_mfma_f32_16x16x32_bf16 v[68:71], a[184:187], v[120:123], v[68:71]
  buffer_load_dwordx4 a[236:239], v11, s[12:15], s39 offen
  s_add_u32 s39, s39, 1024
  s_waitcnt lgkmcnt(4)
  v_mfma_f32_16x16x32_bf16 v[32:35], a[176:179], v[124:127], v[32:35]
  v_mfma_f32_16x16x32_bf16 v[52:55], a[180:183], v[124:127], v[52:55]
  ds_read_b128 v[104:107], v1 offset:30720
  v_mfma_f32_16x16x32_bf16 v[72:75], a[184:187], v[124:127], v[72:75]
  s_waitcnt vmcnt(11) lgkmcnt(4)
  v_mfma_f32_16x16x32_bf16 v[16:19], a[192:195], v[88:91], v[16:19]
  ds_read_b128 v[108:111], v2 offset:13312
  s_waitcnt vmcnt(10)
  v_mfma_f32_16x16x32_bf16 v[36:39], a[196:199], v[88:91], v[36:39]
  buffer_load_dwordx4 a[240:243], v8, s[12:15], s39 offen
  s_waitcnt vmcnt(10)
  v_mfma_f32_16x16x32_bf16 v[56:59], a[200:203], v[88:91], v[56:59]
  s_waitcnt lgkmcnt(4)
  v_mfma_f32_16x16x32_bf16 v[20:23], a[192:195], v[92:95], v[20:23]
  ds_read_b128 v[112:115], v2 offset:31744
  v_mfma_f32_16x16x32_bf16 v[40:43], a[196:199], v[92:95], v[40:43]
  v_mfma_f32_16x16x32_bf16 v[60:63], a[200:203], v[92:95], v[60:63]
  buffer_load_dwordx4 a[244:247], v9, s[12:15], s39 offen
  s_waitcnt vmcnt(10)
  v_mfma_f32_16x16x32_bf16 v[76:79], a[204:207], v[92:95], v[76:79]
  s_waitcnt lgkmcnt(4)
  v_mfma_f32_16x16x32_bf16 v[24:27], a[192:195], v[96:99], v[24:27]
  ds_read_b128 v[116:119], v2 offset:50176
  v_mfma_f32_16x16x32_bf16 v[44:47], a[196:199], v[96:99], v[44:47]
  v_mfma_f32_16x16x32_bf16 v[64:67], a[200:203], v[96:99], v[64:67]
  buffer_load_dwordx4 a[248:251], v10, s[12:15], s39 offen
  v_mfma_f32_16x16x32_bf16 v[80:83], a[204:207], v[96:99], v[80:83]
  s_waitcnt lgkmcnt(4)
  v_mfma_f32_16x16x32_bf16 v[28:31], a[192:195], v[100:103], v[28:31]
  ds_read_b128 v[120:123], v1 offset:13312
  v_mfma_f32_16x16x32_bf16 v[48:51], a[196:199], v[100:103], v[48:51]
  v_mfma_f32_16x16x32_bf16 v[68:71], a[200:203], v[100:103], v[68:71]
  buffer_load_dwordx4 a[252:255], v11, s[12:15], s39 offen
  s_add_u32 s39, s39, 1024
  s_waitcnt lgkmcnt(4)
  v_mfma_f32_16x16x32_bf16 v[32:35], a[192:195], v[104:107], v[32:35]
  v_mfma_f32_16x16x32_bf16 v[52:55], a[196:199], v[104:107], v[52:55]
  ds_read_b128 v[124:127], v1 offset:31744
  v_mfma_f32_16x16x32_bf16 v[72:75], a[200:203], v[104:107], v[72:75]
  s_waitcnt vmcnt(11) lgkmcnt(4)
  v_mfma_f32_16x16x32_bf16 v[16:19], a[208:211], v[108:111], v[16:19]
  ds_read_b128 v[88:91], v2 offset:14336
  s_waitcnt vmcnt(10)
  v_mfma_f32_16x16x32_bf16 v[36:39], a[212:215], v[108:111], v[36:39]
  buffer_load_dwordx4 v[224:227], v8, s[12:15], s39 offen
  s_waitcnt vmcnt(10)
  v_mfma_f32_16x16x32_bf16 v[56:59], a[216:219], v[108:111], v[56:59]
  s_waitcnt lgkmcnt(4)
  v_mfma_f32_16x16x32_bf16 v[20:23], a[208:211], v[112:115], v[20:23]
  ds_read_b128 v[92:95], v2 offset:32768
  v_mfma_f32_16x16x32_bf16 v[40:43], a[212:215], v[112:115], v[40:43]
  v_mfma_f32_16x16x32_bf16 v[60:63], a[216:219], v[112:115], v[60:63]
  buffer_load_dwordx4 v[228:231], v9, s[12:15], s39 offen
  s_waitcnt vmcnt(10)
  v_mfma_f32_16x16x32_bf16 v[76:79], a[220:223], v[112:115], v[76:79]
  s_waitcnt lgkmcnt(4)
  v_mfma_f32_16x16x32_bf16 v[24:27], a[208:211], v[116:119], v[24:27]
  ds_read_b128 v[96:99], v2 offset:51200
  v_mfma_f32_16x16x32_bf16 v[44:47], a[212:215], v[116:119], v[44:47]
  v_mfma_f32_16x16x32_bf16 v[64:67], a[216:219], v[116:119], v[64:67]
  buffer_load_dwordx4 v[232:235], v10, s[12:15], s39 offen
  v_mfma_f32_16x16x32_bf16 v[80:83], a[220:223], v[116:119], v[80:83]
  s_waitcnt lgkmcnt(4)
  v_mfma_f32_16x16x32_bf16 v[28:31], a[208:211], v[120:123], v[28:31]
  ds_read_b128 v[100:103], v1 offset:14336
  v_mfma_f32_16x16x32_bf16 v[48:51], a[212:215], v[120:123], v[48:51]
  v_mfma_f32_16x16x32_bf16 v[68:71], a[216:219], v[120:123], v[68:71]
  buffer_load_dwordx4 v[236:239], v11, s[12:15], s39 offen
  s_add_u32 s39, s39, 1024
  s_waitcnt lgkmcnt(4)
  v_mfma_f32_16x16x32_bf16 v[32:35], a[208:211], v[124:127], v[32:35]
  v_mfma_f32_16x16x32_bf16 v[52:55], a[212:215], v[124:127], v[52:55]
  ds_read_b128 v[104:107], v1 offset:32768
  v_mfma_f32_16x16x32_bf16 v[72:75], a[216:219], v[124:127], v[72:75]
  s_waitcnt vmcnt(11) lgkmcnt(4)
  v_mfma_f32_16x16x32_bf16 v[16:19], a[224:227], v[88:91], v[16:19]
  ds_read_b128 v[108:111], v2 offset:15360
  s_waitcnt vmcnt(10)
  v_mfma_f32_16x16x32_bf16 v[36:39], a[228:231], v[88:91], v[36:39]
  buffer_load_dwordx4 v[240:243], v8, s[12:15], s39 offen
  s_waitcnt vmcnt(10)
  v_mfma_f32_16x16x32_bf16 v[56:59], a[232:235], v[88:91], v[56:59]
  s_waitcnt lgkmcnt(4)
  v_mfma_f32_16x16x32_bf16 v[20:23], a[224:227], v[92:95], v[20:23]
  ds_read_b128 v[112:115], v2 offset:33792
  v_mfma_f32_16x16x32_bf16 v[40:43], a[228:231], v[92:95], v[40:43]
  v_mfma_f32_16x16x32_bf16 v[60:63], a[232:235], v[92:95], v[60:63]
  buffer_load_dwordx4 v[244:247], v9, s[12:15], s39 offen
  s_waitcnt vmcnt(10)
  v_mfma_f32_16x16x32_bf16 v[76:79], a[236:239], v[92:95], v[76:79]
  s_waitcnt lgkmcnt(4)
  v_mfma_f32_16x16x32_bf16 v[24:27], a[224:227], v[96:99], v[24:27]
  ds_read_b128 v[116:119], v2 offset:52224
  v_mfma_f32_16x16x32_bf16 v[44:47], a[228:231], v[96:99], v[44:47]
  v_mfma_f32_16x16x32_bf16 v[64:67], a[232:235], v[96:99], v[64:67]
  buffer_load_dwordx4 v[248:251], v10, s[12:15], s39 offen
  v_mfma_f32_16x16x32_bf16 v[80:83], a[236:239], v[96:99], v[80:83]
  s_waitcnt lgkmcnt(4)
  v_mfma_f32_16x16x32_bf16 v[28:31], a[224:227], v[100:103], v[28:31]
  ds_read_b128 v[120:123], v1 offset:15360
  v_mfma_f32_16x16x32_bf16 v[48:51], a[228:231], v[100:103], v[48:51]
  v_mfma_f32_16x16x32_bf16 v[68:71], a[232:235], v[100:103], v[68:71]
  buffer_load_dwordx4 v[252:255], v11, s[12:15], s39 offen
  s_waitcnt lgkmcnt(4)
  v_mfma_f32_16x16x32_bf16 v[32:35], a[224:227], v[104:107], v[32:35]
  v_mfma_f32_16x16x32_bf16 v[52:55], a[228:231], v[104:107], v[52:55]
  ds_read_b128 v[124:127], v1 offset:33792
  v_mfma_f32_16x16x32_bf16 v[72:75], a[232:235], v[104:107], v[72:75]
  s_waitcnt vmcnt(11) lgkmcnt(4)
  v_mfma_f32_16x16x32_bf16 v[16:19], a[240:243], v[108:111], v[16:19]
  ds_read_b128 v[88:91], v2 offset:16384
  s_waitcnt vmcnt(10)
  v_mfma_f32_16x16x32_bf16 v[36:39], a[244:247], v[108:111], v[36:39]
  s_add_u32 m0, s44, 0
  s_nop 0
  buffer_load_dwordx4 v222, s[48:51], s57 offen offset:0  lds
  s_add_u32 s57, s57, s63
  s_waitcnt vmcnt(10)
  v_mfma_f32_16x16x32_bf16 v[56:59], a[248:251], v[108:111], v[56:59]
  buffer_load_dwordx2 v[174:175], v161, s[64:67], s47 offen offset:0
  s_waitcnt lgkmcnt(4)
  v_mfma_f32_16x16x32_bf16 v[20:23], a[240:243], v[112:115], v[20:23]
  ds_read_b128 v[92:95], v2 offset:34816
  v_mfma_f32_16x16x32_bf16 v[40:43], a[244:247], v[112:115], v[40:43]
  v_mfma_f32_16x16x32_bf16 v[60:63], a[248:251], v[112:115], v[60:63]
  buffer_load_dwordx4 v223, s[48:51], s57 offen offset:1024  lds
  s_add_u32 s57, s57, s63
  s_waitcnt vmcnt(11)
  v_mfma_f32_16x16x32_bf16 v[76:79], a[252:255], v[112:115], v[76:79]
  buffer_load_dwordx2 v[176:177], v161, s[64:67], s47 offen offset:32
  s_waitcnt lgkmcnt(4)
  v_mfma_f32_16x16x32_bf16 v[24:27], a[240:243], v[116:119], v[24:27]
  ds_read_b128 v[96:99], v2 offset:53248
  v_mfma_f32_16x16x32_bf16 v[44:47], a[244:247], v[116:119], v[44:47]
  v_mfma_f32_16x16x32_bf16 v[64:67], a[248:251], v[116:119], v[64:67]
  buffer_load_dwordx4 v222, s[48:51], s57 offen offset:2048  lds
  s_add_u32 s57, s57, s63
  v_mfma_f32_16x16x32_bf16 v[80:83], a[252:255], v[116:119], v[80:83]
  buffer_load_dwordx2 v[178:179], v161, s[64:67], s47 offen offset:64
  s_waitcnt lgkmcnt(4)
  v_mfma_f32_16x16x32_bf16 v[28:31], a[240:243], v[120:123], v[28:31]
  ds_read_b128 v[100:103], v1 offset:16384
  v_mfma_f32_16x16x32_bf16 v[48:51], a[244:247], v[120:123], v[48:51]
  v_mfma_f32_16x16x32_bf16 v[68:71], a[248:251], v[120:123], v[68:71]
  buffer_load_dwordx4 v223, s[48:51], s57 offen offset:3072  lds
  s_add_u32 s57, s57, s62
  s_waitcnt lgkmcnt(4)
  v_mfma_f32_16x16x32_bf16 v[32:35], a[240:243], v[124:127], v[32:35]
  buffer_load_dwordx2 v[180:181], v161, s[64:67], s47 offen offset:96
  v_mfma_f32_16x16x32_bf16 v[52:55], a[244:247], v[124:127], v[52:55]
  ds_read_b128 v[104:107], v1 offset:34816
  v_mfma_f32_16x16x32_bf16 v[72:75], a[248:251], v[124:127], v[72:75]
  s_waitcnt vmcnt(15) lgkmcnt(4)
  v_mfma_f32_16x16x32_bf16 v[16:19], v[224:227], v[88:91], v[16:19]
  ds_read_b128 v[108:111], v2 offset:17408
  s_waitcnt vmcnt(14)
  v_mfma_f32_16x16x32_bf16 v[36:39], v[228:231], v[88:91], v[36:39]
  s_add_u32 m0, s44, 4096
  s_nop 0
  buffer_load_dwordx4 v222, s[48:51], s57 offen offset:0  lds
  s_add_u32 s57, s57, s63
  s_waitcnt vmcnt(14)
  v_mfma_f32_16x16x32_bf16 v[56:59], v[232:235], v[88:91], v[56:59]
  s_waitcnt lgkmcnt(4)
  v_mfma_f32_16x16x32_bf16 v[20:23], v[224:227], v[92:95], v[20:23]
  buffer_load_dwordx2 v[182:183], v161, s[64:67], s47 offen offset:128
  v_mfma_f32_16x16x32_bf16 v[40:43], v[228:231], v[92:95], v[40:43]
  v_mfma_f32_16x16x32_bf16 v[60:63], v[232:235], v[92:95], v[60:63]
  buffer_load_dwordx4 v223, s[48:51], s57 offen offset:1024  lds
  s_add_u32 s57, s57, s63
  s_waitcnt vmcnt(15)
  v_mfma_f32_16x16x32_bf16 v[76:79], v[236:239], v[92:95], v[76:79]
  ds_read_b128 v[112:115], v2 offset:35840
  s_waitcnt lgkmcnt(4)
  v_mfma_f32_16x16x32_bf16 v[24:27], v[224:227], v[96:99], v[24:27]
  v_mfma_f32_16x16x32_bf16 v[44:47], v[228:231], v[96:99], v[44:47]
  ds_read_b128 v[116:119], v2 offset:54272
  v_mfma_f32_16x16x32_bf16 v[64:67], v[232:235], v[96:99], v[64:67]
  v_mfma_f32_16x16x32_bf16 v[80:83], v[236:239], v[96:99], v[80:83]
  buffer_load_dwordx4 v222, s[48:51], s57 offen offset:2048  lds
  s_add_u32 s57, s57, s63
  s_waitcnt lgkmcnt(4)
  v_mfma_f32_16x16x32_bf16 v[28:31], v[224:227], v[100:103], v[28:31]
  ds_read_b128 v[120:123], v1 offset:17408
  v_mfma_f32_16x16x32_bf16 v[48:51], v[228:231], v[100:103], v[48:51]
  v_mfma_f32_16x16x32_bf16 v[68:71], v[232:235], v[100:103], v[68:71]
  buffer_load_dwordx4 v223, s[48:51], s57 offen offset:3072  lds
  s_add_u32 s57, s57, s62
  s_waitcnt lgkmcnt(4)
  v_mfma_f32_16x16x32_bf16 v[32:35], v[224:227], v[104:107], v[32:35]
  v_mfma_f32_16x16x32_bf16 v[52:55], v[228:231], v[104:107], v[52:55]
  ds_read_b128 v[124:127], v1 offset:35840
  v_mfma_f32_16x16x32_bf16 v[72:75], v[232:235], v[104:107], v[72:75]
  s_waitcnt vmcnt(16) lgkmcnt(4)
  v_mfma_f32_16x16x32_bf16 v[16:19], v[240:243], v[108:111], v[16:19]
  s_waitcnt vmcnt(15)
  v_mfma_f32_16x16x32_bf16 v[36:39], v[244:247], v[108:111], v[36:39]
  s_waitcnt vmcnt(14)
  v_mfma_f32_16x16x32_bf16 v[56:59], v[248:251], v[108:111], v[56:59]
  s_waitcnt lgkmcnt(3)
  v_mfma_f32_16x16x32_bf16 v[20:23], v[240:243], v[112:115], v[20:23]
  v_mfma_f32_16x16x32_bf16 v[40:43], v[244:247], v[112:115], v[40:43]
  v_mfma_f32_16x16x32_bf16 v[60:63], v[248:251], v[112:115], v[60:63]
  s_waitcnt vmcnt(13)
  v_mfma_f32_16x16x32_bf16 v[76:79], v[252:255], v[112:115], v[76:79]
  s_add_u32 m0, s44, 8192
  s_nop 0
  buffer_load_dwordx4 v222, s[48:51], s57 offen offset:0  lds
  s_add_u32 s57, s57, s63
  s_waitcnt lgkmcnt(2)
  v_mfma_f32_16x16x32_bf16 v[24:27], v[240:243], v[116:119], v[24:27]
  v_mfma_f32_16x16x32_bf16 v[44:47], v[244:247], v[116:119], v[44:47]
  buffer_load_dwordx4 v223, s[48:51], s57 offen offset:1024  lds
  s_add_u32 s57, s57, s63
  v_mfma_f32_16x16x32_bf16 v[64:67], v[248:251], v[116:119], v[64:67]
  v_mfma_f32_16x16x32_bf16 v[80:83], v[252:255], v[116:119], v[80:83]
  s_waitcnt lgkmcnt(1)
  v_mfma_f32_16x16x32_bf16 v[28:31], v[240:243], v[120:123], v[28:31]
  buffer_load_dwordx4 v222, s[48:51], s57 offen offset:2048  lds
  s_add_u32 s57, s57, s63
  v_mfma_f32_16x16x32_bf16 v[48:51], v[244:247], v[120:123], v[48:51]
  v_mfma_f32_16x16x32_bf16 v[68:71], v[248:251], v[120:123], v[68:71]
  s_waitcnt lgkmcnt(0)
  v_mfma_f32_16x16x32_bf16 v[32:35], v[240:243], v[124:127], v[32:35]
  buffer_load_dwordx4 v223, s[48:51], s57 offen offset:3072  lds
  s_add_u32 s57, s57, s62
  v_mfma_f32_16x16x32_bf16 v[52:55], v[244:247], v[124:127], v[52:55]
  v_mfma_f32_16x16x32_bf16 v[72:75], v[248:251], v[124:127], v[72:75]
  s_barrier
  v_cvt_pk_bf16_f32 v16, v16, v17
  v_cvt_pk_bf16_f32 v17, v18, v19
  ds_write_b64 v12, v[16:17] offset:0
  v_cvt_pk_bf16_f32 v20, v20, v21
  v_cvt_pk_bf16_f32 v21, v22, v23
  ds_write_b64 v12, v[20:21] offset:768
  v_cvt_pk_bf16_f32 v24, v24, v25
  v_cvt_pk_bf16_f32 v25, v26, v27
  ds_write_b64 v12, v[24:25] offset:1536
  v_cvt_pk_bf16_f32 v28, v28, v29
  v_cvt_pk_bf16_f32 v29, v30, v31
  ds_write_b64 v12, v[28:29] offset:2304
  v_cvt_pk_bf16_f32 v32, v32, v33
  v_cvt_pk_bf16_f32 v33, v34, v35
  ds_write_b64 v12, v[32:33] offset:3072
  v_cvt_pk_bf16_f32 v36, v36, v37
  v_cvt_pk_bf16_f32 v37, v38, v39
  ds_write_b64 v13, v[36:37] offset:0
  v_cvt_pk_bf16_f32 v40, v40, v41
  v_cvt_pk_bf16_f32 v41, v42, v43
  ds_write_b64 v13, v[40:41] offset:768
  v_cvt_pk_bf16_f32 v44, v44, v45
  v_cvt_pk_bf16_f32 v45, v46, v47
  ds_write_b64 v13, v[44:45] offset:1536
  v_cvt_pk_bf16_f32 v48, v48, v49
  v_cvt_pk_bf16_f32 v49, v50, v51
  ds_write_b64 v13, v[48:49] offset:2304
  v_cvt_pk_bf16_f32 v52, v52, v53
  v_cvt_pk_bf16_f32 v53, v54, v55
  ds_write_b64 v13, v[52:53] offset:3072
  ds_write_b128 v14, v[56:59] offset:0
  ds_write_b128 v14, v[60:63] offset:1280
  ds_write_b128 v14, v[64:67] offset:2560
  ds_write_b128 v14, v[68:71] offset:3840
  ds_write_b128 v14, v[72:75] offset:5120
  v_cvt_pk_bf16_f32 v76, v76, v77
  v_cvt_pk_bf16_f32 v77, v78, v79
  ds_write_b64 v15, v[76:77] offset:768
  v_cvt_pk_bf16_f32 v80, v80, v81
  v_cvt_pk_bf16_f32 v81, v82, v83
  ds_write_b64 v15, v[80:81] offset:1536
  s_waitcnt lgkmcnt(0)
  s_branch L_a_join
L_a_c2:
  ds_read_b128 v[88:91], v2 offset:0
  ds_read_b128 v[92:95], v2 offset:18432
  ds_read_b128 v[96:99], v2 offset:36864
  ds_read_b128 v[100:103], v1 offset:0
  ds_read_b128 v[104:107], v1 offset:18432
  s_waitcnt vmcnt(11) lgkmcnt(4)
  v_mfma_f32_16x16x32_bf16 v[16:19], a[0:3], v[88:91], 0
  ds_read_b128 v[108:111], v2 offset:1024
  s_waitcnt vmcnt(10)
  v_mfma_f32_16x16x32_bf16 v[36:39], a[4:7], v[88:91], 0
  ds_read_b128 v[128:131], v172 offset:0
  s_waitcnt vmcnt(9)
  v_mfma_f32_16x16x32_bf16 v[56:59], a[8:11], v[88:91], 0
  s_waitcnt lgkmcnt(5)
  v_mfma_f32_16x16x32_bf16 v[20:23], a[0:3], v[92:95], 0
  buffer_load_dwordx4 a[48:51], v8, s[12:15], s39 offen
  v_mfma_f32_16x16x32_bf16 v[40:43], a[4:7], v[92:95], 0
  ds_read_b128 v[112:115], v2 offset:19456
  v_mfma_f32_16x16x32_bf16 v[60:63], a[8:11], v[92:95], 0
  s_waitcnt lgkmcnt(5)
  v_mfma_f32_16x16x32_bf16 v[24:27], a[0:3], v[96:99], 0
  buffer_load_dwordx4 a[52:55], v9, s[12:15], s39 offen
  v_mfma_f32_16x16x32_bf16 v[44:47], a[4:7], v[96:99], 0
  ds_read_b128 v[116:119], v2 offset:37888
  v_mfma_f32_16x16x32_bf16 v[64:67], a[8:11], v[96:99], 0
  s_waitcnt lgkmcnt(5)
  v_mfma_f32_16x16x32_bf16 v[28:31], a[0:3], v[100:103], 0
  ds_read_b128 v[132:135], v172 offset:16
  v_mfma_f32_16x16x32_bf16 v[48:51], a[4:7], v[100:103], 0
  buffer_load_dwordx4 a[56:59], v10, s[12:15], s39 offen
  v_mfma_f32_16x16x32_bf16 v[68:71], a[8:11], v[100:103], 0
  s_waitcnt vmcnt(11)
  v_mfma_f32_16x16x32_bf16 v[76:79], a[12:15], v[100:103], 0
  ds_read_b128 v[120:123], v1 offset:1024
  s_waitcnt lgkmcnt(6)
  v_mfma_f32_16x16x32_bf16 v[32:35], a[0:3], v[104:107], 0
  buffer_load_dwordx4 a[60:63], v11, s[12:15], s39 offen
  s_add_u32 s39, s39, 1024
  v_mfma_f32_16x16x32_bf16 v[52:55], a[4:7], v[104:107], 0
  v_mfma_f32_16x16x32_bf16 v[72:75], a[8:11], v[104:107], 0
  ds_read_b128 v[124:127], v1 offset:19456
  v_mfma_f32_16x16x32_bf16 v[80:83], a[12:15], v[104:107], 0
  s_waitcnt vmcnt(11) lgkmcnt(6)
  v_mfma_f32_16x16x32_bf16 v[16:19], a[16:19], v[108:111], v[16:19]
  ds_read_b128 v[88:91], v2 offset:2048
  s_waitcnt vmcnt(10)
  v_mfma_f32_16x16x32_bf16 v[36:39], a[20:23], v[108:111], v[36:39]
  ds_read_b128 v[136:139], v172 offset:128
  s_waitcnt vmcnt(9)
  v_mfma_f32_16x16x32_bf16 v[56:59], a[24:27], v[108:111], v[56:59]
  s_waitcnt lgkmcnt(6)
  v_mfma_f32_16x16x32_bf16 v[20:23], a[16:19], v[112:115], v[20:23]
  buffer_load_dwordx4 a[64:67], v8, s[12:15], s39 offen
  v_mfma_f32_16x16x32_bf16 v[40:43], a[20:23], v[112:115], v[40:43]
  ds_read_b128 v[92:95], v2 offset:20480
  v_mfma_f32_16x16x32_bf16 v[60:63], a[24:27], v[112:115], v[60:63]
  s_waitcnt lgkmcnt(6)
  v_mfma_f32_16x16x32_bf16 v[24:27], a[16:19], v[116:119], v[24:27]
  buffer_load_dwordx4 a[68:71], v9, s[12:15], s39 offen
  v_mfma_f32_16x16x32_bf16 v[44:47], a[20:23], v[116:119], v[44:47]
  ds_read_b128 v[96:99], v2 offset:38912
  v_mfma_f32_16x16x32_bf16 v[64:67], a[24:27], v[116:119], v[64:67]
  s_waitcnt lgkmcnt(5)
  v_mfma_f32_16x16x32_bf16 v[28:31], a[16:19], v[120:123], v[28:31]
  ds_read_b128 v[140:143], v172 offset:144
  v_mfma_f32_16x16x32_bf16 v[48:51], a[20:23], v[120:123], v[48:51]
  buffer_load_dwordx4 a[72:75], v10, s[12:15], s39 offen
  v_mfma_f32_16x16x32_bf16 v[68:71], a[24:27], v[120:123], v[68:71]
  s_waitcnt vmcnt(11)
  v_mfma_f32_16x16x32_bf16 v[76:79], a[28:31], v[120:123], v[76:79]
  ds_read_b128 v[100:103], v1 offset:2048
  s_waitcnt lgkmcnt(6)
  v_mfma_f32_16x16x32_bf16 v[32:35], a[16:19], v[124:127], v[32:35]
  buffer_load_dwordx4 a[76:79], v11, s[12:15], s39 offen
  s_add_u32 s39, s39, 1024
  v_mfma_f32_16x16x32_bf16 v[52:55], a[20:23], v[124:127], v[52:55]
  v_mfma_f32_16x16x32_bf16 v[72:75], a[24:27], v[124:127], v[72:75]
  ds_read_b128 v[104:107], v1 offset:20480
  v_mfma_f32_16x16x32_bf16 v[80:83], a[28:31], v[124:127], v[80:83]
  s_waitcnt vmcnt(11) lgkmcnt(6)
  v_mfma_f32_16x16x32_bf16 v[16:19], a[32:35], v[88:91], v[16:19]
  ds_read_b128 v[108:111], v2 offset:3072
  s_waitcnt vmcnt(10)
  v_mfma_f32_16x16x32_bf16 v[36:39], a[36:39], v[88:91], v[36:39]
  ds_read_b128 v[144:147], v172 offset:256
  s_waitcnt vmcnt(9)
  v_mfma_f32_16x16x32_bf16 v[56:59], a[40:43], v[88:91], v[56:59]
  s_waitcnt lgkmcnt(6)
  v_mfma_f32_16x16x32_bf16 v[20:23], a[32:35], v[92:95], v[20:23]
  buffer_load_dwordx4 a[80:83], v8, s[12:15], s39 offen
  v_mfma_f32_16x16x32_bf16 v[40:43], a[36:39], v[92:95], v[40:43]
  ds_read_b128 v[112:115], v2 offset:21504
  v_mfma_f32_16x16x32_bf16 v[60:63], a[40:43], v[92:95], v[60:63]
  s_waitcnt lgkmcnt(6)
  v_mfma_f32_16x16x32_bf16 v[24:27], a[32:35], v[96:99], v[24:27]
  buffer_load_dwordx4 a[84:87], v9, s[12:15], s39 offen
  v_mfma_f32_16x16x32_bf16 v[44:47], a[36:39], v[96:99], v[44:47]
  ds_read_b128 v[116:119], v2 offset:39936
  v_mfma_f32_16x16x32_bf16 v[64:67], a[40:43], v[96:99], v[64:67]
  s_waitcnt lgkmcnt(5)
  v_mfma_f32_16x16x32_bf16 v[28:31], a[32:35], v[100:103], v[28:31]
  ds_read_b128 v[148:151], v172 offset:272
  v_mfma_f32_16x16x32_bf16 v[48:51], a[36:39], v[100:103], v[48:51]
  buffer_load_dwordx4 a[88:91], v10, s[12:15], s39 offen
  v_mfma_f32_16x16x32_bf16 v[68:71], a[40:43], v[100:103], v[68:71]
  s_waitcnt vmcnt(11)
  v_mfma_f32_16x16x32_bf16 v[76:79], a[44:47], v[100:103], v[76:79]
  ds_read_b128 v[120:123], v1 offset:3072
  s_waitcnt lgkmcnt(6)
  v_mfma_f32_16x16x32_bf16 v[32:35], a[32:35], v[104:107], v[32:35]
  buffer_load_dwordx4 a[92:95], v11, s[12:15], s39 offen
  s_add_u32 s39, s39, 1024
  v_mfma_f32_16x16x32_bf16 v[52:55], a[36:39], v[104:107], v[52:55]
  v_mfma_f32_16x16x32_bf16 v[72:75], a[40:43], v[104:107], v[72:75]
  ds_read_b128 v[124:127], v1 offset:21504
  v_mfma_f32_16x16x32_bf16 v[80:83], a[44:47], v[104:107], v[80:83]
  s_waitcnt vmcnt(11) lgkmcnt(6)
  v_mfma_f32_16x16x32_bf16 v[16:19], a[48:51], v[108:111], v[16:19]
  ds_read_b128 v[88:91], v2 offset:4096
  s_waitcnt vmcnt(10)
  v_mfma_f32_16x16x32_bf16 v[36:39], a[52:55], v[108:111], v[36:39]
  v_cvt_pk_bf16_f32 v184, v128, v129
  s_waitcnt vmcnt(9)
  v_mfma_f32_16x16x32_bf16 v[56:59], a[56:59], v[108:111], v[56:59]
  s_waitcnt lgkmcnt(5)
  v_mfma_f32_16x16x32_bf16 v[20:23], a[48:51], v[112:115], v[20:23]
  buffer_load_dwordx4 a[96:99], v8, s[12:15], s39 offen
  v_mfma_f32_16x16x32_bf16 v[40:43], a[52:55], v[112:115], v[40:43]
  ds_read_b128 v[92:95], v2 offset:22528
  v_mfma_f32_16x16x32_bf16 v[60:63], a[56:59], v[112:115], v[60:63]
  s_waitcnt lgkmcnt(5)
  v_mfma_f32_16x16x32_bf16 v[24:27], a[48:51], v[116:119], v[24:27]
  buffer_load_dwordx4 a[100:103], v9, s[12:15], s39 offen
  v_mfma_f32_16x16x32_bf16 v[44:47], a[52:55], v[116:119], v[44:47]
  ds_read_b128 v[96:99], v2 offset:40960
  v_mfma_f32_16x16x32_bf16 v[64:67], a[56:59], v[116:119], v[64:67]
  s_waitcnt lgkmcnt(4)
  v_mfma_f32_16x16x32_bf16 v[28:31], a[48:51], v[120:123], v[28:31]
  v_cvt_pk_bf16_f32 v185, v130, v131
  v_mfma_f32_16x16x32_bf16 v[48:51], a[52:55], v[120:123], v[48:51]
  buffer_load_dwordx4 a[104:107], v10, s[12:15], s39 offen
  v_mfma_f32_16x16x32_bf16 v[68:71], a[56:59], v[120:123], v[68:71]
  s_waitcnt vmcnt(11)
  v_mfma_f32_16x16x32_bf16 v[76:79], a[60:63], v[120:123], v[76:79]
  ds_read_b128 v[100:103], v1 offset:4096
  s_waitcnt lgkmcnt(4)
  v_mfma_f32_16x16x32_bf16 v[32:35], a[48:51], v[124:127], v[32:35]
  buffer_load_dwordx4 a[108:111], v11, s[12:15], s39 offen
  s_add_u32 s39, s39, 1024
  v_mfma_f32_16x16x32_bf16 v[52:55], a[52:55], v[124:127], v[52:55]
  v_mfma_f32_16x16x32_bf16 v[72:75], a[56:59], v[124:127], v[72:75]
  ds_read_b128 v[104:107], v1 offset:22528
  v_mfma_f32_16x16x32_bf16 v[80:83], a[60:63], v[124:127], v[80:83]
  s_waitcnt vmcnt(11) lgkmcnt(4)
  v_mfma_f32_16x16x32_bf16 v[16:19], a[64:67], v[88:91], v[16:19]
  ds_read_b128 v[108:111], v2 offset:5120
  s_waitcnt vmcnt(10)
  v_mfma_f32_16x16x32_bf16 v[36:39], a[68:71], v[88:91], v[36:39]
  v_cvt_pk_bf16_f32 v186, v132, v133
  s_waitcnt vmcnt(9)
  v_mfma_f32_16x16x32_bf16 v[56:59], a[72:75], v[88:91], v[56:59]
  s_waitcnt lgkmcnt(4)
  v_mfma_f32_16x16x32_bf16 v[20:23], a[64:67], v[92:95], v[20:23]
  buffer_load_dwordx4 a[112:115], v8, s[12:15], s39 offen
  v_mfma_f32_16x16x32_bf16 v[40:43], a[68:71], v[92:95], v[40:43]
  ds_read_b128 v[112:115], v2 offset:23552
  v_mfma_f32_16x16x32_bf16 v[60:63], a[72:75], v[92:95], v[60:63]
  s_waitcnt lgkmcnt(4)
  v_mfma_f32_16x16x32_bf16 v[24:27], a[64:67], v[96:99], v[24:27]
  buffer_load_dwordx4 a[116:119], v9, s[12:15], s39 offen
  v_mfma_f32_16x16x32_bf16 v[44:47], a[68:71], v[96:99], v[44:47]
  ds_read_b128 v[116:119], v2 offset:41984
  v_mfma_f32_16x16x32_bf16 v[64:67], a[72:75], v[96:99], v[64:67]
  s_waitcnt lgkmcnt(4)
  v_mfma_f32_16x16x32_bf16 v[28:31], a[64:67], v[100:103], v[28:31]
  v_cvt_pk_bf16_f32 v187, v134, v135
  v_mfma_f32_16x16x32_bf16 v[48:51], a[68:71], v[100:103], v[48:51]
  buffer_load_dwordx4 a[120:123], v10, s[12:15], s39 offen
  v_mfma_f32_16x16x32_bf16 v[68:71], a[72:75], v[100:103], v[68:71]
  s_waitcnt vmcnt(11)
  v_mfma_f32_16x16x32_bf16 v[76:79], a[76:79], v[100:103], v[76:79]
  ds_read_b128 v[120:123], v1 offset:5120
  s_waitcnt lgkmcnt(4)
  v_mfma_f32_16x16x32_bf16 v[32:35], a[64:67], v[104:107], v[32:35]
  buffer_load_dwordx4 a[124:127], v11, s[12:15], s39 offen
  s_add_u32 s39, s39, 1024
  v_mfma_f32_16x16x32_bf16 v[52:55], a[68:71], v[104:107], v[52:55]
  v_mfma_f32_16x16x32_bf16 v[72:75], a[72:75], v[104:107], v[72:75]
  ds_read_b128 v[124:127], v1 offset:23552
  v_mfma_f32_16x16x32_bf16 v[80:83], a[76:79], v[104:107], v[80:83]
  s_waitcnt vmcnt(11) lgkmcnt(4)
  v_mfma_f32_16x16x32_bf16 v[16:19], a[80:83], v[108:111], v[16:19]
  ds_read_b128 v[88:91], v2 offset:6144
  s_waitcnt vmcnt(10)
  v_mfma_f32_16x16x32_bf16 v[36:39], a[84:87], v[108:111], v[36:39]
  v_cvt_pk_bf16_f32 v188, v136, v137
  s_waitcnt vmcnt(9)
  v_mfma_f32_16x16x32_bf16 v[56:59], a[88:91], v[108:111], v[56:59]
  s_waitcnt lgkmcnt(4)
  v_mfma_f32_16x16x32_bf16 v[20:23], a[80:83], v[112:115], v[20:23]
  buffer_load_dwordx4 a[128:131], v8, s[12:15], s39 offen
  v_mfma_f32_16x16x32_bf16 v[40:43], a[84:87], v[112:115], v[40:43]
  ds_read_b128 v[92:95], v2 offset:24576
  v_mfma_f32_16x16x32_bf16 v[60:63], a[88:91], v[112:115], v[60:63]
  s_waitcnt lgkmcnt(4)
  v_mfma_f32_16x16x32_bf16 v[24:27], a[80:83], v[116:119], v[24:27]
  buffer_load_dwordx4 a[132:135], v9, s[12:15], s39 offen
  v_mfma_f32_16x16x32_bf16 v[44:47], a[84:87], v[116:119], v[44:47]
  ds_read_b128 v[96:99], v2 offset:43008
  v_mfma_f32_16x16x32_bf16 v[64:67], a[88:91], v[116:119], v[64:67]
  s_waitcnt lgkmcnt(4)
  v_mfma_f32_16x16x32_bf16 v[28:31], a[80:83], v[120:123], v[28:31]
  v_cvt_pk_bf16_f32 v189, v138, v139
  v_mfma_f32_16x16x32_bf16 v[48:51], a[84:87], v[120:123], v[48:51]
  buffer_load_dwordx4 a[136:139], v10, s[12:15], s39 offen
  v_mfma_f32_16x16x32_bf16 v[68:71], a[88:91], v[120:123], v[68:71]
  s_waitcnt vmcnt(11)
  v_mfma_f32_16x16x32_bf16 v[76:79], a[92:95], v[120:123], v[76:79]
  ds_read_b128 v[100:103], v1 offset:6144
  s_waitcnt lgkmcnt(4)
  v_mfma_f32_16x16x32_bf16 v[32:35], a[80:83], v[124:127], v[32:35]
  buffer_load_dwordx4 a[140:143], v11, s[12:15], s39 offen
  s_add_u32 s39, s39, 1024
  v_mfma_f32_16x16x32_bf16 v[52:55], a[84:87], v[124:127], v[52:55]
  v_mfma_f32_16x16x32_bf16 v[72:75], a[88:91], v[124:127], v[72:75]
  ds_read_b128 v[104:107], v1 offset:24576
  v_mfma_f32_16x16x32_bf16 v[80:83], a[92:95], v[124:127], v[80:83]
  s_waitcnt vmcnt(11) lgkmcnt(4)
  v_mfma_f32_16x16x32_bf16 v[16:19], a[96:99], v[88:91], v[16:19]
  ds_read_b128 v[108:111], v2 offset:7168
  s_waitcnt vmcnt(10)
  v_mfma_f32_16x16x32_bf16 v[36:39], a[100:103], v[88:91], v[36:39]
  v_cvt_pk_bf16_f32 v190, v140, v141
  s_waitcnt vmcnt(9)
  v_mfma_f32_16x16x32_bf16 v[56:59], a[104:107], v[88:91], v[56:59]
  s_waitcnt lgkmcnt(4)
  v_mfma_f32_16x16x32_bf16 v[20:23], a[96:99], v[92:95], v[20:23]
  buffer_load_dwordx4 a[144:147], v8, s[12:15], s39 offen
  v_mfma_f32_16x16x32_bf16 v[40:43], a[100:103], v[92:95], v[40:43]
  ds_read_b128 v[112:115], v2 offset:25600
  v_mfma_f32_16x16x32_bf16 v[60:63], a[104:107], v[92:95], v[60:63]
  s_waitcnt lgkmcnt(4)
  v_mfma_f32_16x16x32_bf16 v[24:27], a[96:99], v[96:99], v[24:27]
  buffer_load_dwordx4 a[148:151], v9, s[12:15], s39 offen
  v_mfma_f32_16x16x32_bf16 v[44:47], a[100:103], v[96:99], v[44:47]
  ds_read_b128 v[116:119], v2 offset:44032
  v_mfma_f32_16x16x32_bf16 v[64:67], a[104:107], v[96:99], v[64:67]
  s_waitcnt lgkmcnt(4)
  v_mfma_f32_16x16x32_bf16 v[28:31], a[96:99], v[100:103], v[28:31]
  v_cvt_pk_bf16_f32 v191, v142, v143
  v_mfma_f32_16x16x32_bf16 v[48:51], a[100:103], v[100:103], v[48:51]
  buffer_load_dwordx4 a[152:155], v10, s[12:15], s39 offen
  v_mfma_f32_16x16x32_bf16 v[68:71], a[104:107], v[100:103], v[68:71]
  s_waitcnt vmcnt(11)
  v_mfma_f32_16x16x32_bf16 v[76:79], a[108:111], v[100:103], v[76:79]
  ds_read_b128 v[120:123], v1 offset:7168
  s_waitcnt lgkmcnt(4)
  v_mfma_f32_16x16x32_bf16 v[32:35], a[96:99], v[104:107], v[32:35]
  buffer_load_dwordx4 a[156:159], v11, s[12:15], s39 offen
  s_add_u32 s39, s39, 1024
  v_mfma_f32_16x16x32_bf16 v[52:55], a[100:103], v[104:107], v[52:55]
  v_mfma_f32_16x16x32_bf16 v[72:75], a[104:107], v[104:107], v[72:75]
  ds_read_b128 v[124:127], v1 offset:25600
  v_mfma_f32_16x16x32_bf16 v[80:83], a[108:111], v[104:107], v[80:83]
  s_waitcnt vmcnt(11) lgkmcnt(4)
  v_mfma_f32_16x16x32_bf16 v[16:19], a[112:115], v[108:111], v[16:19]
  ds_read_b128 v[88:91], v2 offset:8192
  s_waitcnt vmcnt(10)
  v_mfma_f32_16x16x32_bf16 v[36:39], a[116:119], v[108:111], v[36:39]
  v_cvt_pk_bf16_f32 v192, v144, v145
  s_waitcnt vmcnt(9)
  v_mfma_f32_16x16x32_bf16 v[56:59], a[120:123], v[108:111], v[56:59]
  s_waitcnt lgkmcnt(4)
  v_mfma_f32_16x16x32_bf16 v[20:23], a[112:115], v[112:115], v[20:23]
  buffer_load_dwordx4 a[160:163], v8, s[12:15], s39 offen
  v_mfma_f32_16x16x32_bf16 v[40:43], a[116:119], v[112:115], v[40:43]
  ds_read_b128 v[92:95], v2 offset:26624
  v_mfma_f32_16x16x32_bf16 v[60:63], a[120:123], v[112:115], v[60:63]
  s_waitcnt lgkmcnt(4)
  v_mfma_f32_16x16x32_bf16 v[24:27], a[112:115], v[116:119], v[24:27]
  buffer_load_dwordx4 a[164:167], v9, s[12:15], s39 offen
  v_mfma_f32_16x16x32_bf16 v[44:47], a[116:119], v[116:119], v[44:47]
  ds_read_b128 v[96:99], v2 offset:45056
  v_mfma_f32_16x16x32_bf16 v[64:67], a[120:123], v[116:119], v[64:67]
  s_waitcnt lgkmcnt(4)
  v_mfma_f32_16x16x32_bf16 v[28:31], a[112:115], v[120:123], v[28:31]
  v_cvt_pk_bf16_f32 v193, v146, v147
  v_mfma_f32_16x16x32_bf16 v[48:51], a[116:119], v[120:123], v[48:51]
  buffer_load_dwordx4 a[168:171], v10, s[12:15], s39 offen
  v_mfma_f32_16x16x32_bf16 v[68:71], a[120:123], v[120:123], v[68:71]
  s_waitcnt vmcnt(11)
  v_mfma_f32_16x16x32_bf16 v[76:79], a[124:127], v[120:123], v[76:79]
  ds_read_b128 v[100:103], v1 offset:8192
  s_waitcnt lgkmcnt(4)
  v_mfma_f32_16x16x32_bf16 v[32:35], a[112:115], v[124:127], v[32:35]
  buffer_load_dwordx4 a[172:175], v11, s[12:15], s39 offen
  s_add_u32 s39, s39, 1024
  v_mfma_f32_16x16x32_bf16 v[52:55], a[116:119], v[124:127], v[52:55]
  v_mfma_f32_16x16x32_bf16 v[72:75], a[120:123], v[124:127], v[72:75]
  ds_read_b128 v[104:107], v1 offset:26624
  v_mfma_f32_16x16x32_bf16 v[80:83], a[124:127], v[124:127], v[80:83]
  s_waitcnt vmcnt(11) lgkmcnt(4)
  v_mfma_f32_16x16x32_bf16 v[16:19], a[128:131], v[88:91], v[16:19]
  ds_read_b128 v[108:111], v2 offset:9216
  s_waitcnt vmcnt(10)
  v_mfma_f32_16x16x32_bf16 v[36:39], a[132:135], v[88:91], v[36:39]
  v_cvt_pk_bf16_f32 v194, v148, v149
  s_waitcnt vmcnt(9)
  v_mfma_f32_16x16x32_bf16 v[56:59], a[136:139], v[88:91], v[56:59]
  s_waitcnt lgkmcnt(4)
  v_mfma_f32_16x16x32_bf16 v[20:23], a[128:131], v[92:95], v[20:23]
  buffer_load_dwordx4 a[176:179], v8, s[12:15], s39 offen
  v_mfma_f32_16x16x32_bf16 v[40:43], a[132:135], v[92:95], v[40:43]
  ds_read_b128 v[112:115], v2 offset:27648
  v_mfma_f32_16x16x32_bf16 v[60:63], a[136:139], v[92:95], v[60:63]
  s_waitcnt lgkmcnt(4)
  v_mfma_f32_16x16x32_bf16 v[24:27], a[128:131], v[96:99], v[24:27]
  buffer_load_dwordx4 a[180:183], v9, s[12:15], s39 offen
  v_mfma_f32_16x16x32_bf16 v[44:47], a[132:135], v[96:99], v[44:47]
  ds_read_b128 v[116:119], v2 offset:46080
  v_mfma_f32_16x16x32_bf16 v[64:67], a[136:139], v[96:99], v[64:67]
  s_waitcnt lgkmcnt(4)
  v_mfma_f32_16x16x32_bf16 v[28:31], a[128:131], v[100:103], v[28:31]
  v_cvt_pk_bf16_f32 v195, v150, v151
  v_mfma_f32_16x16x32_bf16 v[48:51], a[132:135], v[100:103], v[48:51]
  buffer_load_dwordx4 a[184:187], v10, s[12:15], s39 offen
  v_mfma_f32_16x16x32_bf16 v[68:71], a[136:139], v[100:103], v[68:71]
  s_waitcnt vmcnt(11)
  v_mfma_f32_16x16x32_bf16 v[76:79], a[140:143], v[100:103], v[76:79]
  ds_read_b128 v[120:123], v1 offset:9216
  s_waitcnt lgkmcnt(4)
  v_mfma_f32_16x16x32_bf16 v[32:35], a[128:131], v[104:107], v[32:35]
  buffer_load_dwordx4 a[188:191], v11, s[12:15], s39 offen
  s_add_u32 s39, s39, 1024
  v_mfma_f32_16x16x32_bf16 v[52:55], a[132:135], v[104:107], v[52:55]
  v_mfma_f32_16x16x32_bf16 v[72:75], a[136:139], v[104:107], v[72:75]
  ds_read_b128 v[124:127], v1 offset:27648
  v_mfma_f32_16x16x32_bf16 v[80:83], a[140:143], v[104:107], v[80:83]
  s_waitcnt vmcnt(11) lgkmcnt(4)
  v_mfma_f32_16x16x32_bf16 v[16:19], a[144:147], v[108:111], v[16:19]
  ds_read_b128 v[88:91], v2 offset:10240
  s_waitcnt vmcnt(10)
  v_mfma_f32_16x16x32_bf16 v[36:39], a[148:151], v[108:111], v[36:39]
  buffer_load_dwordx4 a[192:195], v8, s[12:15], s39 offen
  s_waitcnt vmcnt(10)
  v_mfma_f32_16x16x32_bf16 v[56:59], a[152:155], v[108:111], v[56:59]
  s_waitcnt lgkmcnt(4)
  v_mfma_f32_16x16x32_bf16 v[20:23], a[144:147], v[112:115], v[20:23]
  ds_read_b128 v[92:95], v2 offset:28672
  v_mfma_f32_16x16x32_bf16 v[40:43], a[148:151], v[112:115], v[40:43]
  v_mfma_f32_16x16x32_bf16 v[60:63], a[152:155], v[112:115], v[60:63]
  buffer_load_dwordx4 a[196:199], v9, s[12:15], s39 offen
  s_waitcnt lgkmcnt(4)
  v_mfma_f32_16x16x32_bf16 v[24:27], a[144:147], v[116:119], v[24:27]
  v_mfma_f32_16x16x32_bf16 v[44:47], a[148:151], v[116:119], v[44:47]
  ds_read_b128 v[96:99], v2 offset:47104
  v_mfma_f32_16x16x32_bf16 v[64:67], a[152:155], v[116:119], v[64:67]
  s_waitcnt lgkmcnt(4)
  v_mfma_f32_16x16x32_bf16 v[28:31], a[144:147], v[120:123], v[28:31]
  buffer_load_dwordx4 a[200:203], v10, s[12:15], s39 offen
  v_mfma_f32_16x16x32_bf16 v[48:51], a[148:151], v[120:123], v[48:51]
  v_mfma_f32_16x16x32_bf16 v[68:71], a[152:155], v[120:123], v[68:71]
  ds_read_b128 v[100:103], v1 offset:10240
  s_waitcnt vmcnt(11)
  v_mfma_f32_16x16x32_bf16 v[76:79], a[156:159], v[120:123], v[76:79]
  s_waitcnt lgkmcnt(4)
  v_mfma_f32_16x16x32_bf16 v[32:35], a[144:147], v[124:127], v[32:35]
  buffer_load_dwordx4 a[204:207], v11, s[12:15], s39 offen
  s_add_u32 s39, s39, 1024
  v_mfma_f32_16x16x32_bf16 v[52:55], a[148:151], v[124:127], v[52:55]
  v_mfma_f32_16x16x32_bf16 v[72:75], a[152:155], v[124:127], v[72:75]
  ds_read_b128 v[104:107], v1 offset:28672
  v_mfma_f32_16x16x32_bf16 v[80:83], a[156:159], v[124:127], v[80:83]
  s_waitcnt vmcnt(11) lgkmcnt(4)
  v_mfma_f32_16x16x32_bf16 v[16:19], a[160:163], v[88:91], v[16:19]
  ds_read_b128 v[108:111], v2 offset:11264
  s_waitcnt vmcnt(10)
  v_mfma_f32_16x16x32_bf16 v[36:39], a[164:167], v[88:91], v[36:39]
  buffer_load_dwordx4 a[208:211], v8, s[12:15], s39 offen
  s_waitcnt vmcnt(10)
  v_mfma_f32_16x16x32_bf16 v[56:59], a[168:171], v[88:91], v[56:59]
  s_waitcnt lgkmcnt(4)
  v_mfma_f32_16x16x32_bf16 v[20:23], a[160:163], v[92:95], v[20:23]
  ds_read_b128 v[112:115], v2 offset:29696
  v_mfma_f32_16x16x32_bf16 v[40:43], a[164:167], v[92:95], v[40:43]
  v_mfma_f32_16x16x32_bf16 v[60:63], a[168:171], v[92:95], v[60:63]
  buffer_load_dwordx4 a[212:215], v9, s[12:15], s39 offen
  s_waitcnt lgkmcnt(4)
  v_mfma_f32_16x16x32_bf16 v[24:27], a[160:163], v[96:99], v[24:27]
  v_mfma_f32_16x16x32_bf16 v[44:47], a[164:167], v[96:99], v[44:47]
  ds_read_b128 v[116:119], v2 offset:48128
  v_mfma_f32_16x16x32_bf16 v[64:67], a[168:171], v[96:99], v[64:67]
  s_waitcnt lgkmcnt(4)
  v_mfma_f32_16x16x32_bf16 v[28:31], a[160:163], v[100:103], v[28:31]
  buffer_load_dwordx4 a[216:219], v10, s[12:15], s39 offen
  v_mfma_f32_16x16x32_bf16 v[48:51], a[164:167], v[100:103], v[48:51]
  v_mfma_f32_16x16x32_bf16 v[68:71], a[168:171], v[100:103], v[68:71]
  ds_read_b128 v[120:123], v1 offset:11264
  s_waitcnt vmcnt(11)
  v_mfma_f32_16x16x32_bf16 v[76:79], a[172:175], v[100:103], v[76:79]
  s_waitcnt lgkmcnt(4)
  v_mfma_f32_16x16x32_bf16 v[32:35], a[160:163], v[104:107], v[32:35]
  buffer_load_dwordx4 a[220:223], v11, s[12:15], s39 offen
  s_add_u32 s39, s39, 1024
  v_mfma_f32_16x16x32_bf16 v[52:55], a[164:167], v[104:107], v[52:55]
  v_mfma_f32_16x16x32_bf16 v[72:75], a[168:171], v[104:107], v[72:75]
  ds_read_b128 v[124:127], v1 offset:29696
  v_mfma_f32_16x16x32_bf16 v[80:83], a[172:175], v[104:107], v[80:83]
  s_waitcnt vmcnt(11) lgkmcnt(4)
  v_mfma_f32_16x16x32_bf16 v[16:19], a[176:179], v[108:111], v[16:19]
  ds_read_b128 v[88:91], v2 offset:12288
  s_waitcnt vmcnt(10)
  v_mfma_f32_16x16x32_bf16 v[36:39], a[180:183], v[108:111], v[36:39]
  buffer_load_dwordx4 a[224:227], v8, s[12:15], s39 offen
  s_waitcnt vmcnt(10)
  v_mfma_f32_16x16x32_bf16 v[56:59], a[184:187], v[108:111], v[56:59]
  s_waitcnt lgkmcnt(4)
  v_mfma_f32_16x16x32_bf16 v[20:23], a[176:179], v[112:115], v[20:23]
  ds_read_b128 v[92:95], v2 offset:30720
  v_mfma_f32_16x16x32_bf16 v[40:43], a[180:183], v[112:115], v[40:43]
  v_mfma_f32_16x16x32_bf16 v[60:63], a[184:187], v[112:115], v[60:63]
  buffer_load_dwordx4 a[228:231], v9, s[12:15], s39 offen
  s_waitcnt lgkmcnt(4)
  v_mfma_f32_16x16x32_bf16 v[24:27], a[176:179], v[116:119], v[24:27]
  v_mfma_f32_16x16x32_bf16 v[44:47], a[180:183], v[116:119], v[44:47]
  ds_read_b128 v[96:99], v2 offset:49152
  v_mfma_f32_16x16x32_bf16 v[64:67], a[184:187], v[116:119], v[64:67]
  s_waitcnt lgkmcnt(4)
  v_mfma_f32_16x16x32_bf16 v[28:31], a[176:179], v[120:123], v[28:31]
  buffer_load_dwordx4 a[232:235], v10, s[12:15], s39 offen
  v_mfma_f32_16x16x32_bf16 v[48:51], a[180:183], v[120:123], v[48:51]
  v_mfma_f32_16x16x32_bf16 v[68:71], a[184:187], v[120:123], v[68:71]
  ds_read_b128 v[100:103], v1 offset:12288
  s_waitcnt vmcnt(11)
  v_mfma_f32_16x16x32_bf16 v[76:79], a[188:191], v[120:123], v[76:79]
  s_waitcnt lgkmcnt(4)
  v_mfma_f32_16x16x32_bf16 v[32:35], a[176:179], v[124:127], v[32:35]
  buffer_load_dwordx4 a[236:239], v11, s[12:15], s39 offen
  s_add_u32 s39, s39, 1024
  v_mfma_f32_16x16x32_bf16 v[52:55], a[180:183], v[124:127], v[52:55]
  v_mfma_f32_16x16x32_bf16 v[72:75], a[184:187], v[124:127], v[72:75]
  ds_read_b128 v[104:107], v1 offset:30720
  v_mfma_f32_16x16x32_bf16 v[80:83], a[188:191], v[124:127], v[80:83]
  s_waitcnt vmcnt(11) lgkmcnt(4)
  v_mfma_f32_16x16x32_bf16 v[16:19], a[192:195], v[88:91], v[16:19]
  ds_read_b128 v[108:111], v2 offset:13312
  s_waitcnt vmcnt(10)
  v_mfma_f32_16x16x32_bf16 v[36:39], a[196:199], v[88:91], v[36:39]
  buffer_load_dwordx4 a[240:243], v8, s[12:15], s39 offen
  s_waitcnt vmcnt(10)
  v_mfma_f32_16x16x32_bf16 v[56:59], a[200:203], v[88:91], v[56:59]
  s_waitcnt lgkmcnt(4)
  v_mfma_f32_16x16x32_bf16 v[20:23], a[192:195], v[92:95], v[20:23]
  ds_read_b128 v[112:115], v2 offset:31744
  v_mfma_f32_16x16x32_bf16 v[40:43], a[196:199], v[92:95], v[40:43]
  v_mfma_f32_16x16x32_bf16 v[60:63], a[200:203], v[92:95], v[60:63]
  buffer_load_dwordx4 a[244:247], v9, s[12:15], s39 offen
  s_waitcnt lgkmcnt(4)
  v_mfma_f32_16x16x32_bf16 v[24:27], a[192:195], v[96:99], v[24:27]
  v_mfma_f32_16x16x32_bf16 v[44:47], a[196:199], v[96:99], v[44:47]
  ds_read_b128 v[116:119], v2 offset:50176
  v_mfma_f32_16x16x32_bf16 v[64:67], a[200:203], v[96:99], v[64:67]
  s_waitcnt lgkmcnt(4)
  v_mfma_f32_16x16x32_bf16 v[28:31], a[192:195], v[100:103], v[28:31]
  buffer_load_dwordx4 a[248:251], v10, s[12:15], s39 offen
  v_mfma_f32_16x16x32_bf16 v[48:51], a[196:199], v[100:103], v[48:51]
  v_mfma_f32_16x16x32_bf16 v[68:71], a[200:203], v[100:103], v[68:71]
  ds_read_b128 v[120:123], v1 offset:13312
  s_waitcnt vmcnt(11)
  v_mfma_f32_16x16x32_bf16 v[76:79], a[204:207], v[100:103], v[76:79]
  s_waitcnt lgkmcnt(4)
  v_mfma_f32_16x16x32_bf16 v[32:35], a[192:195], v[104:107], v[32:35]
  buffer_load_dwordx4 a[252:255], v11, s[12:15], s39 offen
  s_add_u32 s39, s39, 1024
  v_mfma_f32_16x16x32_bf16 v[52:55], a[196:199], v[104:107], v[52:55]
  v_mfma_f32_16x16x32_bf16 v[72:75], a[200:203], v[104:107], v[72:75]
  ds_read_b128 v[124:127], v1 offset:31744
  v_mfma_f32_16x16x32_bf16 v[80:83], a[204:207], v[104:107], v[80:83]
  s_waitcnt vmcnt(11) lgkmcnt(4)
  v_mfma_f32_16x16x32_bf16 v[16:19], a[208:211], v[108:111], v[16:19]
  ds_read_b128 v[88:91], v2 offset:14336
  s_waitcnt vmcnt(10)
  v_mfma_f32_16x16x32_bf16 v[36:39], a[212:215], v[108:111], v[36:39]
  buffer_load_dwordx4 v[224:227], v8, s[12:15], s39 offen
  s_waitcnt vmcnt(10)
  v_mfma_f32_16x16x32_bf16 v[56:59], a[216:219], v[108:111], v[56:59]
  s_waitcnt lgkmcnt(4)
  v_mfma_f32_16x16x32_bf16 v[20:23], a[208:211], v[112:115], v[20:23]
  ds_read_b128 v[92:95], v2 offset:32768
  v_mfma_f32_16x16x32_bf16 v[40:43], a[212:215], v[112:115], v[40:43]
  v_mfma_f32_16x16x32_bf16 v[60:63], a[216:219], v[112:115], v[60:63]
  buffer_load_dwordx4 v[228:231], v9, s[12:15], s39 offen
  s_waitcnt lgkmcnt(4)
  v_mfma_f32_16x16x32_bf16 v[24:27], a[208:211], v[116:119], v[24:27]
  v_mfma_f32_16x16x32_bf16 v[44:47], a[212:215], v[116:119], v[44:47]
  ds_read_b128 v[96:99], v2 offset:51200
  v_mfma_f32_16x16x32_bf16 v[64:67], a[216:219], v[116:119], v[64:67]
  s_waitcnt lgkmcnt(4)
  v_mfma_f32_16x16x32_bf16 v[28:31], a[208:211], v[120:123], v[28:31]
  buffer_load_dwordx4 v[232:235], v10, s[12:15], s39 offen
  v_mfma_f32_16x16x32_bf16 v[48:51], a[212:215], v[120:123], v[48:51]
  v_mfma_f32_16x16x32_bf16 v[68:71], a[216:219], v[120:123], v[68:71]
  ds_read_b128 v[100:103], v1 offset:14336
  s_waitcnt vmcnt(11)
  v_mfma_f32_16x16x32_bf16 v[76:79], a[220:223], v[120:123], v[76:79]
  s_waitcnt lgkmcnt(4)
  v_mfma_f32_16x16x32_bf16 v[32:35], a[208:211], v[124:127], v[32:35]
  buffer_load_dwordx4 v[236:239], v11, s[12:15], s39 offen
  s_add_u32 s39, s39, 1024
  v_mfma_f32_16x16x32_bf16 v[52:55], a[212:215], v[124:127], v[52:55]
  v_mfma_f32_16x16x32_bf16 v[72:75], a[216:219], v[124:127], v[72:75]
  ds_read_b128 v[104:107], v1 offset:32768
  v_mfma_f32_16x16x32_bf16 v[80:83], a[220:223], v[124:127], v[80:83]
  s_waitcnt vmcnt(11) lgkmcnt(4)
  v_mfma_f32_16x16x32_bf16 v[16:19], a[224:227], v[88:91], v[16:19]
  ds_read_b128 v[108:111], v2 offset:15360
  s_waitcnt vmcnt(10)
  v_mfma_f32_16x16x32_bf16 v[36:39], a[228:231], v[88:91], v[36:39]
  buffer_load_dwordx4 v[240:243], v8, s[12:15], s39 offen
  s_waitcnt vmcnt(10)
  v_mfma_f32_16x16x32_bf16 v[56:59], a[232:235], v[88:91], v[56:59]
  s_waitcnt lgkmcnt(4)
  v_mfma_f32_16x16x32_bf16 v[20:23], a[224:227], v[92:95], v[20:23]
  ds_read_b128 v[112:115], v2 offset:33792
  v_mfma_f32_16x16x32_bf16 v[40:43], a[228:231], v[92:95], v[40:43]
  v_mfma_f32_16x16x32_bf16 v[60:63], a[232:235], v[92:95], v[60:63]
  buffer_load_dwordx4 v[244:247], v9, s[12:15], s39 offen
  s_waitcnt lgkmcnt(4)
  v_mfma_f32_16x16x32_bf16 v[24:27], a[224:227], v[96:99], v[24:27]
  v_mfma_f32_16x16x32_bf16 v[44:47], a[228:231], v[96:99], v[44:47]
  ds_read_b128 v[116:119], v2 offset:52224
  v_mfma_f32_16x16x32_bf16 v[64:67], a[232:235], v[96:99], v[64:67]
  s_waitcnt lgkmcnt(4)
  v_mfma_f32_16x16x32_bf16 v[28:31], a[224:227], v[100:103], v[28:31]
  buffer_load_dwordx4 v[248:251], v10, s[12:15], s39 offen
  v_mfma_f32_16x16x32_bf16 v[48:51], a[228:231], v[100:103], v[48:51]
  v_mfma_f32_16x16x32_bf16 v[68:71], a[232:235], v[100:103], v[68:71]
  ds_read_b128 v[120:123], v1 offset:15360
  s_waitcnt vmcnt(11)
  v_mfma_f32_16x16x32_bf16 v[76:79], a[236:239], v[100:103], v[76:79]
  s_waitcnt lgkmcnt(4)
  v_mfma_f32_16x16x32_bf16 v[32:35], a[224:227], v[104:107], v[32:35]
  buffer_load_dwordx4 v[252:255], v11, s[12:15], s39 offen
  v_mfma_f32_16x16x32_bf16 v[52:55], a[228:231], v[104:107], v[52:55]
  v_mfma_f32_16x16x32_bf16 v[72:75], a[232:235], v[104:107], v[72:75]
  ds_read_b128 v[124:127], v1 offset:33792
  v_mfma_f32_16x16x32_bf16 v[80:83], a[236:239], v[104:107], v[80:83]
  s_waitcnt vmcnt(11) lgkmcnt(4)
  v_mfma_f32_16x16x32_bf16 v[16:19], a[240:243], v[108:111], v[16:19]
  ds_read_b128 v[88:91], v2 offset:16384
  s_waitcnt vmcnt(10)
  v_mfma_f32_16x16x32_bf16 v[36:39], a[244:247], v[108:111], v[36:39]
  s_add_u32 m0, s44, 0
  s_nop 0
  buffer_load_dwordx4 v222, s[48:51], s57 offen offset:0  lds
  s_add_u32 s57, s57, s63
  s_waitcnt vmcnt(10)
  v_mfma_f32_16x16x32_bf16 v[56:59], a[248:251], v[108:111], v[56:59]
  buffer_load_dwordx2 v[174:175], v161, s[64:67], s47 offen offset:0
  s_waitcnt lgkmcnt(4)
  v_mfma_f32_16x16x32_bf16 v[20:23], a[240:243], v[112:115], v[20:23]
  ds_read_b128 v[92:95], v2 offset:34816
  v_mfma_f32_16x16x32_bf16 v[40:43], a[244:247], v[112:115], v[40:43]
  v_mfma_f32_16x16x32_bf16 v[60:63], a[248:251], v[112:115], v[60:63]
  buffer_load_dwordx4 v223, s[48:51], s57 offen offset:1024  lds
  s_add_u32 s57, s57, s63
  s_waitcnt lgkmcnt(4)
  v_mfma_f32_16x16x32_bf16 v[24:27], a[240:243], v[116:119], v[24:27]
  buffer_load_dwordx2 v[176:177], v161, s[64:67], s47 offen offset:32
  v_mfma_f32_16x16x32_bf16 v[44:47], a[244:247], v[116:119], v[44:47]
  ds_read_b128 v[96:99], v2 offset:53248
  v_mfma_f32_16x16x32_bf16 v[64:67], a[248:251], v[116:119], v[64:67]
  s_waitcnt lgkmcnt(4)
  v_mfma_f32_16x16x32_bf16 v[28:31], a[240:243], v[120:123], v[28:31]
  buffer_load_dwordx4 v222, s[48:51], s57 offen offset:2048  lds
  s_add_u32 s57, s57, s63
  v_mfma_f32_16x16x32_bf16 v[48:51], a[244:247], v[120:123], v[48:51]
  buffer_load_dwordx2 v[178:179], v161, s[64:67], s47 offen offset:64
  v_mfma_f32_16x16x32_bf16 v[68:71], a[248:251], v[120:123], v[68:71]
  ds_read_b128 v[100:103], v1 offset:16384
  s_waitcnt vmcnt(14)
  v_mfma_f32_16x16x32_bf16 v[76:79], a[252:255], v[120:123], v[76:79]
  s_waitcnt lgkmcnt(4)
  v_mfma_f32_16x16x32_bf16 v[32:35], a[240:243], v[124:127], v[32:35]
  buffer_load_dwordx4 v223, s[48:51], s57 offen offset:3072  lds
  s_add_u32 s57, s57, s62
  v_mfma_f32_16x16x32_bf16 v[52:55], a[244:247], v[124:127], v[52:55]
  buffer_load_dwordx2 v[180:181], v161, s[64:67], s47 offen offset:96
  v_mfma_f32_16x16x32_bf16 v[72:75], a[248:251], v[124:127], v[72:75]
  ds_read_b128 v[104:107], v1 offset:34816
  v_mfma_f32_16x16x32_bf16 v[80:83], a[252:255], v[124:127], v[80:83]
  s_waitcnt vmcnt(15) lgkmcnt(4)
  v_mfma_f32_16x16x32_bf16 v[16:19], v[224:227], v[88:91], v[16:19]
  ds_read_b128 v[108:111], v2 offset:17408
  s_waitcnt vmcnt(14)
  v_mfma_f32_16x16x32_bf16 v[36:39], v[228:231], v[88:91], v[36:39]
  s_add_u32 m0, s44, 4096
  s_nop 0
  buffer_load_dwordx4 v222, s[48:51], s57 offen offset:0  lds
  s_add_u32 s57, s57, s63
  s_waitcnt vmcnt(14)
  v_mfma_f32_16x16x32_bf16 v[56:59], v[232:235], v[88:91], v[56:59]
  s_waitcnt lgkmcnt(4)
  v_mfma_f32_16x16x32_bf16 v[20:23], v[224:227], v[92:95], v[20:23]
  buffer_load_dwordx2 v[182:183], v161, s[64:67], s47 offen offset:128
  v_mfma_f32_16x16x32_bf16 v[40:43], v[228:231], v[92:95], v[40:43]
  v_mfma_f32_16x16x32_bf16 v[60:63], v[232:235], v[92:95], v[60:63]
  buffer_load_dwordx4 v223, s[48:51], s57 offen offset:1024  lds
  s_add_u32 s57, s57, s63
  s_waitcnt lgkmcnt(3)
  v_mfma_f32_16x16x32_bf16 v[24:27], v[224:227], v[96:99], v[24:27]
  ds_read_b128 v[112:115], v2 offset:35840
  v_mfma_f32_16x16x32_bf16 v[44:47], v[228:231], v[96:99], v[44:47]
  v_mfma_f32_16x16x32_bf16 v[64:67], v[232:235], v[96:99], v[64:67]
  ds_read_b128 v[116:119], v2 offset:54272
  s_waitcnt lgkmcnt(4)
  v_mfma_f32_16x16x32_bf16 v[28:31], v[224:227], v[100:103], v[28:31]
  v_mfma_f32_16x16x32_bf16 v[48:51], v[228:231], v[100:103], v[48:51]
  buffer_load_dwordx4 v222, s[48:51], s57 offen offset:2048  lds
  s_add_u32 s57, s57, s63
  v_mfma_f32_16x16x32_bf16 v[68:71], v[232:235], v[100:103], v[68:71]
  ds_read_b128 v[120:123], v1 offset:17408
  s_waitcnt vmcnt(16)
  v_mfma_f32_16x16x32_bf16 v[76:79], v[236:239], v[100:103], v[76:79]
  s_waitcnt lgkmcnt(4)
  v_mfma_f32_16x16x32_bf16 v[32:35], v[224:227], v[104:107], v[32:35]
  buffer_load_dwordx4 v223, s[48:51], s57 offen offset:3072  lds
  s_add_u32 s57, s57, s62
  v_mfma_f32_16x16x32_bf16 v[52:55], v[228:231], v[104:107], v[52:55]
  v_mfma_f32_16x16x32_bf16 v[72:75], v[232:235], v[104:107], v[72:75]
  ds_read_b128 v[124:127], v1 offset:35840
  v_mfma_f32_16x16x32_bf16 v[80:83], v[236:239], v[104:107], v[80:83]
  s_waitcnt vmcnt(16) lgkmcnt(4)
  v_mfma_f32_16x16x32_bf16 v[16:19], v[240:243], v[108:111], v[16:19]
  s_waitcnt vmcnt(15)
  v_mfma_f32_16x16x32_bf16 v[36:39], v[244:247], v[108:111], v[36:39]
  s_waitcnt vmcnt(14)
  v_mfma_f32_16x16x32_bf16 v[56:59], v[248:251], v[108:111], v[56:59]
  s_waitcnt lgkmcnt(3)
  v_mfma_f32_16x16x32_bf16 v[20:23], v[240:243], v[112:115], v[20:23]
  v_mfma_f32_16x16x32_bf16 v[40:43], v[244:247], v[112:115], v[40:43]
  v_mfma_f32_16x16x32_bf16 v[60:63], v[248:251], v[112:115], v[60:63]
  s_waitcnt lgkmcnt(2)
  v_mfma_f32_16x16x32_bf16 v[24:27], v[240:243], v[116:119], v[24:27]
  s_add_u32 m0, s44, 8192
  s_nop 0
  buffer_load_dwordx4 v222, s[48:51], s57 offen offset:0  lds
  s_add_u32 s57, s57, s63
  v_mfma_f32_16x16x32_bf16 v[44:47], v[244:247], v[116:119], v[44:47]
  v_mfma_f32_16x16x32_bf16 v[64:67], v[248:251], v[116:119], v[64:67]
  buffer_load_dwordx4 v223, s[48:51], s57 offen offset:1024  lds
  s_add_u32 s57, s57, s63
  s_waitcnt lgkmcnt(1)
  v_mfma_f32_16x16x32_bf16 v[28:31], v[240:243], v[120:123], v[28:31]
  v_mfma_f32_16x16x32_bf16 v[48:51], v[244:247], v[120:123], v[48:51]
  v_mfma_f32_16x16x32_bf16 v[68:71], v[248:251], v[120:123], v[68:71]
  buffer_load_dwordx4 v222, s[48:51], s57 offen offset:2048  lds
  s_add_u32 s57, s57, s63
  s_waitcnt vmcnt(16)
  v_mfma_f32_16x16x32_bf16 v[76:79], v[252:255], v[120:123], v[76:79]
  s_waitcnt lgkmcnt(0)
  v_mfma_f32_16x16x32_bf16 v[32:35], v[240:243], v[124:127], v[32:35]
  v_mfma_f32_16x16x32_bf16 v[52:55], v[244:247], v[124:127], v[52:55]
  buffer_load_dwordx4 v223, s[48:51], s57 offen offset:3072  lds
  s_add_u32 s57, s57, s62
  v_mfma_f32_16x16x32_bf16 v[72:75], v[248:251], v[124:127], v[72:75]
  v_mfma_f32_16x16x32_bf16 v[80:83], v[252:255], v[124:127], v[80:83]
  s_barrier
  v_cvt_pk_bf16_f32 v16, v16, v17
  v_cvt_pk_bf16_f32 v17, v18, v19
  ds_write_b64 v12, v[16:17] offset:0
  v_cvt_pk_bf16_f32 v20, v20, v21
  v_cvt_pk_bf16_f32 v21, v22, v23
  ds_write_b64 v12, v[20:21] offset:768
  v_cvt_pk_bf16_f32 v24, v24, v25
  v_cvt_pk_bf16_f32 v25, v26, v27
  ds_write_b64 v12, v[24:25] offset:1536
  v_cvt_pk_bf16_f32 v28, v28, v29
  v_cvt_pk_bf16_f32 v29, v30, v31
  ds_write_b64 v12, v[28:29] offset:2304
  v_cvt_pk_bf16_f32 v32, v32, v33
  v_cvt_pk_bf16_f32 v33, v34, v35
  ds_write_b64 v12, v[32:33] offset:3072
  ds_write_b128 v13, v[36:39] offset:0
  ds_write_b128 v13, v[40:43] offset:1280
  ds_write_b128 v13, v[44:47] offset:2560
  ds_write_b128 v13, v[48:51] offset:3840
  ds_write_b128 v13, v[52:55] offset:5120
  ds_write_b128 v14, v[56:59] offset:0
  ds_write_b128 v14, v[60:63] offset:1280
  ds_write_b128 v14, v[64:67] offset:2560
  ds_write_b128 v14, v[68:71] offset:3840
  ds_write_b128 v14, v[72:75] offset:5120
  v_cvt_pk_bf16_f32 v76, v76, v77
  v_cvt_pk_bf16_f32 v77, v78, v79
  ds_write_b64 v15, v[76:77] offset:2304
  v_cvt_pk_bf16_f32 v80, v80, v81
  v_cvt_pk_bf16_f32 v81, v82, v83
  ds_write_b64 v15, v[80:81] offset:3072
  s_waitcnt lgkmcnt(0)
  s_branch L_a_join
L_c_h1:
  v_lshlrev_b32 v36, 2, v3
  v_lshlrev_b32 v5, 8, v4
  v_lshl_add_u32 v5, v3, 3, v5
  v_add_u32 v7, 18432, v2
  s_lshl_b32 s23, s18, 2
  s_add_u32 s23, s23, s20
  s_lshl_b32 s22, s23, 7
  s_add_u32 s22, s22, 114688
  s_lshl_b32 s32, s23, 11
  s_add_u32 s32, s32, 52363264
  s_mul_i32 s23, s23, 36864
  s_add_u32 s23, s23, 50003968
  s_waitcnt lgkmcnt(0)
  s_barrier
  ds_read_b64_tr_b16 a[144:145], v12 offset:32768
  ds_read_b64_tr_b16 a[146:147], v12 offset:33280
  ds_read_b64_tr_b16 a[148:149], v13 offset:32768
  ds_read_b64_tr_b16 a[150:151], v13 offset:33280
  ds_read_b64_tr_b16 a[152:153], v14 offset:32768
  ds_read_b64_tr_b16 a[154:155], v14 offset:33280
  ds_read_b64_tr_b16 a[156:157], v15 offset:32768
  ds_read_b64_tr_b16 a[158:159], v15 offset:33280
  ds_read_b64_tr_b16 a[160:161], v12 offset:36864
  ds_read_b64_tr_b16 a[162:163], v12 offset:37376
  ds_read_b64_tr_b16 a[164:165], v13 offset:36864
  ds_read_b64_tr_b16 a[166:167], v13 offset:37376
  ds_read_b64_tr_b16 a[168:169], v14 offset:36864
  ds_read_b64_tr_b16 a[170:171], v14 offset:37376
  ds_read_b64_tr_b16 a[172:173], v15 offset:36864
  ds_read_b64_tr_b16 a[174:175], v15 offset:37376
  buffer_load_dword v37, v36, s[12:15], s22 offen sc0 sc1
  s_waitcnt vmcnt(0)
  v_cmp_ne_u32 s[40:41], 1, v37
  s_nop 0
  s_cmp_eq_u64 s[40:41], 0
  s_cbranch_scc1 L_vk_z1
  s_mov_b32 s42, 0
L_vs_z1:
  buffer_load_dword v37, v36, s[12:15], s22 offen sc0 sc1
  s_add_u32 s42, s42, 1
  s_waitcnt vmcnt(0)
  v_cmp_ne_u32 s[40:41], 1, v37
  s_cmp_gt_u32 s42, 0x40000
  s_cbranch_scc1 L_vk_z1
  s_cmp_lg_u64 s[40:41], 0
  s_cbranch_scc1 L_vs_z1
L_vk_z1:
  buffer_load_dwordx4 a[0:3], v2, s[12:15], s23 offen offset:0 sc1
  buffer_load_dwordx4 a[72:75], v7, s[12:15], s23 offen offset:0 sc1
  buffer_load_dwordx4 a[4:7], v2, s[12:15], s23 offen offset:1024 sc1
  buffer_load_dwordx4 a[76:79], v7, s[12:15], s23 offen offset:1024 sc1
  buffer_load_dwordx4 a[8:11], v2, s[12:15], s23 offen offset:2048 sc1
  buffer_load_dwordx4 a[80:83], v7, s[12:15], s23 offen offset:2048 sc1
  buffer_load_dwordx4 a[12:15], v2, s[12:15], s23 offen offset:3072 sc1
  buffer_load_dwordx4 a[84:87], v7, s[12:15], s23 offen offset:3072 sc1
  s_add_u32 s23, s23, 4096
  buffer_load_dwordx4 a[16:19], v2, s[12:15], s23 offen offset:0 sc1
  buffer_load_dwordx4 a[88:91], v7, s[12:15], s23 offen offset:0 sc1
  buffer_load_dwordx4 a[20:23], v2, s[12:15], s23 offen offset:1024 sc1
  buffer_load_dwordx4 a[92:95], v7, s[12:15], s23 offen offset:1024 sc1
  buffer_load_dwordx2 v[32:33], v5, s[12:15], s32 offen offset:0 sc1
  buffer_load_dwordx2 v[34:35], v5, s[12:15], s32 offen offset:128 sc1
  buffer_load_dwordx2 v[36:37], v5, s[12:15], s32 offen offset:1024 sc1
  buffer_load_dwordx2 v[38:39], v5, s[12:15], s32 offen offset:1152 sc1
  s_add_u32 s40, s29, 0
  s_sub_u32 s21, s40, 4
  s_cmp_ge_u32 s40, 4
  s_cselect_b32 s40, s21, s40
  s_add_u32 s41, s29, 1
  s_sub_u32 s21, s41, 4
  s_cmp_ge_u32 s41, 4
  s_cselect_b32 s41, s21, s41
  s_add_u32 s42, s29, 2
  s_sub_u32 s21, s42, 4
  s_cmp_ge_u32 s42, 4
  s_cselect_b32 s42, s21, s42
  s_add_u32 s43, s29, 3
  s_sub_u32 s21, s43, 4
  s_cmp_ge_u32 s43, 4
  s_cselect_b32 s43, s21, s43
  s_add_u32 s50, s28, 4
  s_sub_u32 s21, s50, 5
  s_cmp_ge_u32 s50, 9
  s_cselect_b32 s50, s21, s50
  s_add_u32 s51, s28, 5
  s_sub_u32 s21, s51, 5
  s_cmp_ge_u32 s51, 9
  s_cselect_b32 s51, s21, s51
  s_add_u32 s53, s28, 6
  s_sub_u32 s21, s53, 5
  s_cmp_ge_u32 s53, 9
  s_cselect_b32 s53, s21, s53
  s_add_u32 s54, s28, 7
  s_sub_u32 s21, s54, 5
  s_cmp_ge_u32 s54, 9
  s_cselect_b32 s54, s21, s54
  s_add_u32 s55, s28, 8
  s_sub_u32 s21, s55, 5
  s_cmp_ge_u32 s55, 9
  s_cselect_b32 s55, s21, s55
  s_lshr_b32 s47, s26, 2
  s_lshl_b32 s47, s47, 8
  s_add_u32 s47, s47, 49152
  s_add_u32 s48, s47, 64
  s_add_u32 s49, s47, 128
  s_mul_i32 s46, s26, 9216
  s_mul_i32 s45, s26, 73728
  s_add_u32 s45, s45, 10158080
  s_lshr_b32 s44, s26, 1
  s_mul_i32 s44, s44, 18432
  s_and_b32 s21, s26, 1
  s_lshl_b32 s21, s21, 7
  s_add_u32 s44, s44, s21
  s_add_u32 s44, s44, 7798784
  v_lshlrev_b32 v60, 3, v4
  v_and_b32 v61, 7, v0
  v_bfe_u32 v62, v0, 3, 1
  s_lshl_b32 s21, s20, 1
  v_add_u32 v62, s21, v62
  v_mul_u32_u24 v63, 1152, v61
  s_and_b32 s21, s26, 15
  s_lshl_b32 s21, s21, 5
  s_add_u32 s21, s21, 161792
  v_lshl_add_u32 v64, v61, 2, s21
  v_accvgpr_write_b32 a228, v64
  s_mov_b32 s21, s40
  s_lshl_b32 s22, s41, 8
  s_or_b32 s21, s21, s22
  s_lshl_b32 s22, s50, 16
  s_or_b32 s21, s21, s22
  s_lshl_b32 s22, s51, 24
  s_or_b32 s21, s21, s22
  v_bfe_u32 v64, s21, v60, 8
  v_lshl_add_u32 v64, v64, 3, v62
  v_lshlrev_b32 v65, 7, v64
  v_lshl_add_u32 v65, v61, 4, v65
  v_lshl_add_u32 v66, v64, 7, v65
  v_lshl_add_u32 v67, v64, 4, v63
  v_lshlrev_b32 v64, 5, v64
  v_add_u32 v64, 158976, v64
  v_accvgpr_write_b32 a216, v65
  v_accvgpr_write_b32 a219, v66
  v_accvgpr_write_b32 a222, v67
  v_accvgpr_write_b32 a225, v64
  s_mov_b32 s21, s42
  s_lshl_b32 s22, s53, 8
  s_or_b32 s21, s21, s22
  s_lshl_b32 s22, s54, 16
  s_or_b32 s21, s21, s22
  v_bfe_u32 v64, s21, v60, 8
  v_lshl_add_u32 v64, v64, 3, v62
  v_lshlrev_b32 v65, 7, v64
  v_lshl_add_u32 v65, v61, 4, v65
  v_lshl_add_u32 v66, v64, 7, v65
  v_lshl_add_u32 v67, v64, 4, v63
  v_lshlrev_b32 v64, 5, v64
  v_add_u32 v64, 158976, v64
  v_accvgpr_write_b32 a217, v65
  v_accvgpr_write_b32 a220, v66
  v_accvgpr_write_b32 a223, v67
  v_accvgpr_write_b32 a226, v64
  s_mov_b32 s21, s43
  s_lshl_b32 s22, s55, 8
  s_or_b32 s21, s21, s22
  v_bfe_u32 v64, s21, v60, 8
  v_lshl_add_u32 v64, v64, 3, v62
  v_lshlrev_b32 v65, 7, v64
  v_lshl_add_u32 v65, v61, 4, v65
  v_lshl_add_u32 v66, v64, 7, v65
  v_lshl_add_u32 v67, v64, 4, v63
  v_lshlrev_b32 v64, 5, v64
  v_add_u32 v64, 158976, v64
  v_accvgpr_write_b32 a218, v65
  v_accvgpr_write_b32 a221, v66
  v_accvgpr_write_b32 a224, v67
  v_accvgpr_write_b32 a227, v64
  s_waitcnt lgkmcnt(8)
  s_waitcnt vmcnt(15)
  v_mfma_f32_16x16x32_bf16 v[64:67], a[144:147], a[0:3], 0
  ds_read_b64_tr_b16 a[176:177], v12 offset:40960
  s_waitcnt vmcnt(14)
  v_mfma_f32_16x16x32_bf16 v[68:71], a[144:147], a[72:75], 0
  ds_read_b64_tr_b16 a[178:179], v12 offset:41472
  buffer_load_dwordx4 a[24:27], v2, s[12:15], s23 offen offset:2048 sc1
  v_mfma_f32_16x16x32_bf16 v[72:75], a[148:151], a[0:3], 0
  ds_read_b64_tr_b16 a[180:181], v13 offset:40960
  v_mfma_f32_16x16x32_bf16 v[76:79], a[148:151], a[72:75], 0
  ds_read_b64_tr_b16 a[182:183], v13 offset:41472
  v_mfma_f32_16x16x32_bf16 v[80:83], a[152:155], a[0:3], 0
  ds_read_b64_tr_b16 a[184:185], v14 offset:40960
  v_mfma_f32_16x16x32_bf16 v[84:87], a[152:155], a[72:75], 0
  ds_read_b64_tr_b16 a[186:187], v14 offset:41472
  buffer_load_dwordx4 a[96:99], v7, s[12:15], s23 offen offset:2048 sc1
  v_mfma_f32_16x16x32_bf16 v[88:91], a[156:159], a[0:3], 0
  ds_read_b64_tr_b16 a[188:189], v15 offset:40960
  v_mfma_f32_16x16x32_bf16 v[92:95], a[156:159], a[72:75], 0
  ds_read_b64_tr_b16 a[190:191], v15 offset:41472
  s_waitcnt lgkmcnt(8)
  s_waitcnt vmcnt(15)
  v_mfma_f32_16x16x32_bf16 v[64:67], a[160:163], a[4:7], v[64:67]
  ds_read_b64_tr_b16 a[192:193], v12 offset:45056
  s_waitcnt vmcnt(14)
  v_mfma_f32_16x16x32_bf16 v[68:71], a[160:163], a[76:79], v[68:71]
  ds_read_b64_tr_b16 a[194:195], v12 offset:45568
  buffer_load_dwordx4 a[28:31], v2, s[12:15], s23 offen offset:3072 sc1
  v_mfma_f32_16x16x32_bf16 v[72:75], a[164:167], a[4:7], v[72:75]
  ds_read_b64_tr_b16 a[196:197], v13 offset:45056
  v_mfma_f32_16x16x32_bf16 v[76:79], a[164:167], a[76:79], v[76:79]
  ds_read_b64_tr_b16 a[198:199], v13 offset:45568
  buffer_load_dwordx4 a[100:103], v7, s[12:15], s23 offen offset:3072 sc1
  v_mfma_f32_16x16x32_bf16 v[80:83], a[168:171], a[4:7], v[80:83]
  ds_read_b64_tr_b16 a[144:145], v14 offset:45056
  v_mfma_f32_16x16x32_bf16 v[84:87], a[168:171], a[76:79], v[84:87]
  ds_read_b64_tr_b16 a[146:147], v14 offset:45568
  s_add_u32 s23, s23, 4096
  v_mfma_f32_16x16x32_bf16 v[88:91], a[172:175], a[4:7], v[88:91]
  ds_read_b64_tr_b16 a[148:149], v15 offset:45056
  v_mfma_f32_16x16x32_bf16 v[92:95], a[172:175], a[76:79], v[92:95]
  ds_read_b64_tr_b16 a[150:151], v15 offset:45568
  s_waitcnt lgkmcnt(8)
  s_waitcnt vmcnt(15)
  v_mfma_f32_16x16x32_bf16 v[64:67], a[176:179], a[8:11], v[64:67]
  ds_read_b64_tr_b16 a[152:153], v12 offset:49152
  s_waitcnt vmcnt(14)
  v_mfma_f32_16x16x32_bf16 v[68:71], a[176:179], a[80:83], v[68:71]
  ds_read_b64_tr_b16 a[154:155], v12 offset:49664
  buffer_load_dwordx4 a[32:35], v2, s[12:15], s23 offen offset:0 sc1
  v_mfma_f32_16x16x32_bf16 v[72:75], a[180:183], a[8:11], v[72:75]
  ds_read_b64_tr_b16 a[156:157], v13 offset:49152
  v_mfma_f32_16x16x32_bf16 v[76:79], a[180:183], a[80:83], v[76:79]
  ds_read_b64_tr_b16 a[158:159], v13 offset:49664
  v_mfma_f32_16x16x32_bf16 v[80:83], a[184:187], a[8:11], v[80:83]
  ds_read_b64_tr_b16 a[160:161], v14 offset:49152
  v_mfma_f32_16x16x32_bf16 v[84:87], a[184:187], a[80:83], v[84:87]
  ds_read_b64_tr_b16 a[162:163], v14 offset:49664
  buffer_load_dwordx4 a[104:107], v7, s[12:15], s23 offen offset:0 sc1
  v_mfma_f32_16x16x32_bf16 v[88:91], a[188:191], a[8:11], v[88:91]
  ds_read_b64_tr_b16 a[164:165], v15 offset:49152
  v_mfma_f32_16x16x32_bf16 v[92:95], a[188:191], a[80:83], v[92:95]
  ds_read_b64_tr_b16 a[166:167], v15 offset:49664
  s_waitcnt lgkmcnt(8)
  s_waitcnt vmcnt(15)
  v_mfma_f32_16x16x32_bf16 v[64:67], a[192:195], a[12:15], v[64:67]
  ds_read_b64_tr_b16 a[168:169], v12 offset:53248
  buffer_load_dwordx4 a[36:39], v2, s[12:15], s23 offen offset:1024 sc1
  s_waitcnt vmcnt(15)
  v_mfma_f32_16x16x32_bf16 v[68:71], a[192:195], a[84:87], v[68:71]
  ds_read_b64_tr_b16 a[170:171], v12 offset:53760
  buffer_load_dwordx4 a[108:111], v7, s[12:15], s23 offen offset:1024 sc1
  v_cmp_eq_u32 vcc, 0, v4
  v_mfma_f32_16x16x32_bf16 v[72:75], a[196:199], a[12:15], v[72:75]
  ds_read_b64_tr_b16 a[172:173], v13 offset:53248
  s_lshl_b32 s22, s20, 7
  v_mfma_f32_16x16x32_bf16 v[76:79], a[196:199], a[84:87], v[76:79]
  ds_read_b64_tr_b16 a[174:175], v13 offset:53760
  s_add_u32 s22, s22, 161792
  v_lshl_add_u32 v6, v3, 2, s22
  v_mfma_f32_16x16x32_bf16 v[80:83], a[144:147], a[12:15], v[80:83]
  ds_read_b64_tr_b16 a[176:177], v14 offset:53248
  s_waitcnt vmcnt(10)
  v_add_f32 v32, v32, v34
  v_mfma_f32_16x16x32_bf16 v[84:87], a[144:147], a[84:87], v[84:87]
  ds_read_b64_tr_b16 a[178:179], v14 offset:53760
  v_add_f32 v33, v33, v35
  v_mov_b32 v34, v32
  v_mfma_f32_16x16x32_bf16 v[88:91], a[148:151], a[12:15], v[88:91]
  ds_read_b64_tr_b16 a[180:181], v15 offset:53248
  v_mov_b32 v35, v33
  v_mfma_f32_16x16x32_bf16 v[92:95], a[148:151], a[84:87], v[92:95]
  ds_read_b64_tr_b16 a[182:183], v15 offset:53760
  v_permlane16_swap_b32 v32, v34
  s_barrier
  s_waitcnt lgkmcnt(8)
  v_mfma_f32_16x16x32_bf16 v[64:67], a[152:155], a[16:19], v[64:67]
  ds_read_b64_tr_b16 a[184:185], v12 offset:57344
  buffer_load_dwordx4 a[40:43], v2, s[12:15], s23 offen offset:2048 sc1
  v_mfma_f32_16x16x32_bf16 v[68:71], a[152:155], a[88:91], v[68:71]
  ds_read_b64_tr_b16 a[186:187], v12 offset:57856
  buffer_load_dwordx4 a[112:115], v7, s[12:15], s23 offen offset:2048 sc1
  v_permlane16_swap_b32 v33, v35
  v_mfma_f32_16x16x32_bf16 v[72:75], a[156:159], a[16:19], v[72:75]
  ds_read_b64_tr_b16 a[188:189], v13 offset:57344
  v_add_f32 v32, v32, v34
  v_mfma_f32_16x16x32_bf16 v[76:79], a[156:159], a[88:91], v[76:79]
  ds_read_b64_tr_b16 a[190:191], v13 offset:57856
  v_add_f32 v33, v33, v35
  v_mov_b32 v34, v32
  v_mfma_f32_16x16x32_bf16 v[80:83], a[160:163], a[16:19], v[80:83]
  ds_read_b64_tr_b16 a[192:193], v14 offset:57344
  v_mov_b32 v35, v33
  v_mfma_f32_16x16x32_bf16 v[84:87], a[160:163], a[88:91], v[84:87]
  ds_read_b64_tr_b16 a[194:195], v14 offset:57856
  v_permlane32_swap_b32 v32, v34
  v_permlane32_swap_b32 v33, v35
  v_mfma_f32_16x16x32_bf16 v[88:91], a[164:167], a[16:19], v[88:91]
  ds_read_b64_tr_b16 a[196:197], v15 offset:57344
  v_add_f32 v32, v32, v34
  v_mfma_f32_16x16x32_bf16 v[92:95], a[164:167], a[88:91], v[92:95]
  ds_read_b64_tr_b16 a[198:199], v15 offset:57856
  v_add_f32 v33, v33, v35
  s_waitcnt lgkmcnt(8)
  v_mfma_f32_16x16x32_bf16 v[64:67], a[168:171], a[20:23], v[64:67]
  ds_read_b64_tr_b16 a[144:145], v12 offset:61440
  buffer_load_dwordx4 a[44:47], v2, s[12:15], s23 offen offset:3072 sc1
  buffer_load_dwordx4 a[116:119], v7, s[12:15], s23 offen offset:3072 sc1
  v_mfma_f32_16x16x32_bf16 v[68:71], a[168:171], a[92:95], v[68:71]
  ds_read_b64_tr_b16 a[146:147], v12 offset:61952
  s_add_u32 s23, s23, 4096
  v_mul_f32 v32, 0xbae38e39, v32
  v_mfma_f32_16x16x32_bf16 v[72:75], a[172:175], a[20:23], v[72:75]
  ds_read_b64_tr_b16 a[148:149], v13 offset:61440
  v_mul_f32 v33, 0x3ae38e39, v33
  v_mfma_f32_16x16x32_bf16 v[76:79], a[172:175], a[92:95], v[76:79]
  ds_read_b64_tr_b16 a[150:151], v13 offset:61952
  v_fma_f32 v33, -v32, v32, v33
  v_max_f32 v33, 0, v33
  v_mfma_f32_16x16x32_bf16 v[80:83], a[176:179], a[20:23], v[80:83]
  ds_read_b64_tr_b16 a[152:153], v14 offset:61440
  v_add_f32 v33, 0x3727c5ac, v33
  v_mfma_f32_16x16x32_bf16 v[84:87], a[176:179], a[92:95], v[84:87]
  ds_read_b64_tr_b16 a[154:155], v14 offset:61952
  v_rsq_f32 v34, v33
  s_nop 0
  v_mul_f32 v33, v33, v34
  v_mfma_f32_16x16x32_bf16 v[88:91], a[180:183], a[20:23], v[88:91]
  ds_read_b64_tr_b16 a[156:157], v15 offset:61440
  ds_write_b32 v6, v34 offset:0
  v_mfma_f32_16x16x32_bf16 v[92:95], a[180:183], a[92:95], v[92:95]
  ds_read_b64_tr_b16 a[158:159], v15 offset:61952
  v_cndmask_b32 v32, 0, v32, vcc
  s_waitcnt lgkmcnt(9)
  s_waitcnt vmcnt(11)
  v_mfma_f32_16x16x32_bf16 v[64:67], a[184:187], a[24:27], v[64:67]
  ds_read_b64_tr_b16 a[160:161], v16 offset:0
  buffer_load_dwordx4 a[48:51], v2, s[12:15], s23 offen offset:0 sc1
  s_waitcnt vmcnt(11)
  v_mfma_f32_16x16x32_bf16 v[68:71], a[184:187], a[96:99], v[68:71]
  ds_read_b64_tr_b16 a[162:163], v16 offset:512
  buffer_load_dwordx4 a[120:123], v7, s[12:15], s23 offen offset:0 sc1
  v_cndmask_b32 v33, 0, v33, vcc
  v_mfma_f32_16x16x32_bf16 v[72:75], a[188:191], a[24:27], v[72:75]
  ds_read_b64_tr_b16 a[164:165], v17 offset:0
  v_cvt_pk_bf16_f32 v27, v32, v33
  v_mfma_f32_16x16x32_bf16 v[76:79], a[188:191], a[96:99], v[76:79]
  ds_read_b64_tr_b16 a[166:167], v17 offset:512
  v_lshlrev_b32 v40, 16, v27
  v_and_b32 v41, 0xffff0000, v27
  v_mfma_f32_16x16x32_bf16 v[80:83], a[192:195], a[24:27], v[80:83]
  ds_read_b64_tr_b16 a[168:169], v18 offset:0
  v_sub_f32 v40, v32, v40
  v_mfma_f32_16x16x32_bf16 v[84:87], a[192:195], a[96:99], v[84:87]
  ds_read_b64_tr_b16 a[170:171], v18 offset:512
  v_sub_f32 v41, v33, v41
  v_cvt_pk_bf16_f32 v24, v32, v32
  v_mfma_f32_16x16x32_bf16 v[88:91], a[196:199], a[24:27], v[88:91]
  ds_read_b64_tr_b16 a[172:173], v19 offset:0
  v_cvt_pk_bf16_f32 v25, v40, v33
  v_mfma_f32_16x16x32_bf16 v[92:95], a[196:199], a[96:99], v[92:95]
  ds_read_b64_tr_b16 a[174:175], v19 offset:512
  v_cvt_pk_bf16_f32 v26, v33, v41
  s_waitcnt lgkmcnt(8)
  s_waitcnt vmcnt(11)
  v_mfma_f32_16x16x32_bf16 v[64:67], a[144:147], a[28:31], v[64:67]
  ds_read_b64_tr_b16 a[176:177], v16 offset:4096
  buffer_load_dwordx4 a[52:55], v2, s[12:15], s23 offen offset:1024 sc1
  s_waitcnt vmcnt(11)
  v_mfma_f32_16x16x32_bf16 v[68:71], a[144:147], a[100:103], v[68:71]
  ds_read_b64_tr_b16 a[178:179], v16 offset:4608
  buffer_load_dwordx4 a[124:127], v7, s[12:15], s23 offen offset:1024 sc1
  v_mov_b32 v27, 0
  v_mfma_f32_16x16x32_bf16 v[72:75], a[148:151], a[28:31], v[72:75]
  ds_read_b64_tr_b16 a[180:181], v17 offset:4096
  v_add_f32 v36, v36, v38
  v_mfma_f32_16x16x32_bf16 v[76:79], a[148:151], a[100:103], v[76:79]
  ds_read_b64_tr_b16 a[182:183], v17 offset:4608
  v_add_f32 v37, v37, v39
  v_mov_b32 v38, v36
  v_mfma_f32_16x16x32_bf16 v[80:83], a[152:155], a[28:31], v[80:83]
  ds_read_b64_tr_b16 a[184:185], v18 offset:4096
  v_mov_b32 v39, v37
  v_mfma_f32_16x16x32_bf16 v[84:87], a[152:155], a[100:103], v[84:87]
  ds_read_b64_tr_b16 a[186:187], v18 offset:4608
  v_permlane16_swap_b32 v36, v38
  v_permlane16_swap_b32 v37, v39
  v_mfma_f32_16x16x32_bf16 v[88:91], a[156:159], a[28:31], v[88:91]
  ds_read_b64_tr_b16 a[188:189], v19 offset:4096
  v_add_f32 v36, v36, v38
  v_mfma_f32_16x16x32_bf16 v[92:95], a[156:159], a[100:103], v[92:95]
  ds_read_b64_tr_b16 a[190:191], v19 offset:4608
  v_add_f32 v37, v37, v39
  s_waitcnt lgkmcnt(8)
  s_waitcnt vmcnt(11)
  v_mfma_f32_16x16x32_bf16 v[64:67], a[160:163], a[32:35], v[64:67]
  ds_read_b64_tr_b16 a[192:193], v16 offset:8192
  buffer_load_dwordx4 a[56:59], v2, s[12:15], s23 offen offset:2048 sc1
  s_waitcnt vmcnt(11)
  v_mfma_f32_16x16x32_bf16 v[68:71], a[160:163], a[104:107], v[68:71]
  ds_read_b64_tr_b16 a[194:195], v16 offset:8704
  buffer_load_dwordx4 a[128:131], v7, s[12:15], s23 offen offset:2048 sc1
  v_mov_b32 v38, v36
  v_mfma_f32_16x16x32_bf16 v[72:75], a[164:167], a[32:35], v[72:75]
  ds_read_b64_tr_b16 a[196:197], v17 offset:8192
  v_mov_b32 v39, v37
  v_mfma_f32_16x16x32_bf16 v[76:79], a[164:167], a[104:107], v[76:79]
  ds_read_b64_tr_b16 a[198:199], v17 offset:8704
  v_permlane32_swap_b32 v36, v38
  v_permlane32_swap_b32 v37, v39
  v_mfma_f32_16x16x32_bf16 v[80:83], a[168:171], a[32:35], v[80:83]
  ds_read_b64_tr_b16 a[144:145], v18 offset:8192
  v_add_f32 v36, v36, v38
  v_mfma_f32_16x16x32_bf16 v[84:87], a[168:171], a[104:107], v[84:87]
  ds_read_b64_tr_b16 a[146:147], v18 offset:8704
  v_add_f32 v37, v37, v39
  v_mul_f32 v36, 0xbae38e39, v36
  v_mfma_f32_16x16x32_bf16 v[88:91], a[172:175], a[32:35], v[88:91]
  ds_read_b64_tr_b16 a[148:149], v19 offset:8192
  v_mul_f32 v37, 0x3ae38e39, v37
  v_mfma_f32_16x16x32_bf16 v[92:95], a[172:175], a[104:107], v[92:95]
  ds_read_b64_tr_b16 a[150:151], v19 offset:8704
  v_fma_f32 v37, -v36, v36, v37
  s_waitcnt lgkmcnt(8)
  s_waitcnt vmcnt(11)
  v_mfma_f32_16x16x32_bf16 v[64:67], a[176:179], a[36:39], v[64:67]
  ds_read_b64_tr_b16 a[152:153], v16 offset:12288
  buffer_load_dwordx4 a[60:63], v2, s[12:15], s23 offen offset:3072 sc1
  buffer_load_dwordx4 a[132:135], v7, s[12:15], s23 offen offset:3072 sc1
  s_waitcnt vmcnt(12)
  v_mfma_f32_16x16x32_bf16 v[68:71], a[176:179], a[108:111], v[68:71]
  ds_read_b64_tr_b16 a[154:155], v16 offset:12800
  s_add_u32 s23, s23, 4096
  v_max_f32 v37, 0, v37
  v_mfma_f32_16x16x32_bf16 v[72:75], a[180:183], a[36:39], v[72:75]
  ds_read_b64_tr_b16 a[156:157], v17 offset:12288
  v_add_f32 v37, 0x3727c5ac, v37
  v_mfma_f32_16x16x32_bf16 v[76:79], a[180:183], a[108:111], v[76:79]
  ds_read_b64_tr_b16 a[158:159], v17 offset:12800
  v_rsq_f32 v38, v37
  s_nop 0
  v_mul_f32 v37, v37, v38
  v_mfma_f32_16x16x32_bf16 v[80:83], a[184:187], a[36:39], v[80:83]
  ds_read_b64_tr_b16 a[160:161], v18 offset:12288
  ds_write_b32 v6, v38 offset:64
  v_mfma_f32_16x16x32_bf16 v[84:87], a[184:187], a[108:111], v[84:87]
  ds_read_b64_tr_b16 a[162:163], v18 offset:12800
  v_cndmask_b32 v36, 0, v36, vcc
  v_cndmask_b32 v37, 0, v37, vcc
  v_mfma_f32_16x16x32_bf16 v[88:91], a[188:191], a[36:39], v[88:91]
  ds_read_b64_tr_b16 a[164:165], v19 offset:12288
  v_cvt_pk_bf16_f32 v31, v36, v37
  v_mfma_f32_16x16x32_bf16 v[92:95], a[188:191], a[108:111], v[92:95]
  ds_read_b64_tr_b16 a[166:167], v19 offset:12800
  v_lshlrev_b32 v40, 16, v31
  s_barrier
  s_waitcnt lgkmcnt(9)
  s_waitcnt vmcnt(11)
  v_mfma_f32_16x16x32_bf16 v[64:67], a[192:195], a[40:43], v[64:67]
  ds_read_b64_tr_b16 a[168:169], v8 offset:0
  buffer_load_dwordx4 a[64:67], v2, s[12:15], s23 offen offset:0 sc1
  s_waitcnt vmcnt(11)
  v_mfma_f32_16x16x32_bf16 v[68:71], a[192:195], a[112:115], v[68:71]
  ds_read_b64_tr_b16 a[170:171], v8 offset:512
  buffer_load_dwordx4 a[136:139], v7, s[12:15], s23 offen offset:0 sc1
  v_and_b32 v41, 0xffff0000, v31
  v_mfma_f32_16x16x32_bf16 v[72:75], a[196:199], a[40:43], v[72:75]
  ds_read_b64_tr_b16 a[172:173], v9 offset:0
  v_sub_f32 v40, v36, v40
  v_mfma_f32_16x16x32_bf16 v[76:79], a[196:199], a[112:115], v[76:79]
  ds_read_b64_tr_b16 a[174:175], v9 offset:512
  v_sub_f32 v41, v37, v41
  v_cvt_pk_bf16_f32 v28, v36, v36
  v_mfma_f32_16x16x32_bf16 v[80:83], a[144:147], a[40:43], v[80:83]
  ds_read_b64_tr_b16 a[176:177], v10 offset:0
  v_cvt_pk_bf16_f32 v29, v40, v37
  v_mfma_f32_16x16x32_bf16 v[84:87], a[144:147], a[112:115], v[84:87]
  ds_read_b64_tr_b16 a[178:179], v10 offset:512
  v_cvt_pk_bf16_f32 v30, v37, v41
  v_mov_b32 v31, 0
  v_mfma_f32_16x16x32_bf16 v[88:91], a[148:151], a[40:43], v[88:91]
  ds_read_b64_tr_b16 a[180:181], v11 offset:0
  v_lshlrev_b32 v3, 4, v3
  v_mfma_f32_16x16x32_bf16 v[92:95], a[148:151], a[112:115], v[92:95]
  ds_read_b64_tr_b16 a[182:183], v11 offset:512
  v_add_u32 v3, 142336, v3
  s_waitcnt lgkmcnt(8)
  s_waitcnt vmcnt(11)
  v_mfma_f32_16x16x32_bf16 v[64:67], a[152:155], a[44:47], v[64:67]
  ds_read_b64_tr_b16 a[184:185], v8 offset:4096
  buffer_load_dwordx4 a[68:71], v2, s[12:15], s23 offen offset:1024 sc1
  s_waitcnt vmcnt(11)
  v_mfma_f32_16x16x32_bf16 v[68:71], a[152:155], a[116:119], v[68:71]
  ds_read_b64_tr_b16 a[186:187], v8 offset:4608
  buffer_load_dwordx4 a[140:143], v7, s[12:15], s23 offen offset:1024 sc1
  s_add_u32 m0, s27, 32768
  v_mfma_f32_16x16x32_bf16 v[72:75], a[156:159], a[44:47], v[72:75]
  ds_read_b64_tr_b16 a[188:189], v9 offset:4096
  s_add_u32 s52, s52, 589824
  v_mfma_f32_16x16x32_bf16 v[76:79], a[156:159], a[116:119], v[76:79]
  ds_read_b64_tr_b16 a[190:191], v9 offset:4608
  buffer_load_dwordx4 v20, s[4:7], s52 offen lds
  v_mfma_f32_16x16x32_bf16 v[80:83], a[160:163], a[44:47], v[80:83]
  ds_read_b64_tr_b16 a[192:193], v10 offset:4096
  s_add_u32 m0, s27, 36864
  v_mfma_f32_16x16x32_bf16 v[84:87], a[160:163], a[116:119], v[84:87]
  ds_read_b64_tr_b16 a[194:195], v10 offset:4608
  buffer_load_dwordx4 v21, s[4:7], s52 offen lds
  v_mfma_f32_16x16x32_bf16 v[88:91], a[164:167], a[44:47], v[88:91]
  ds_read_b64_tr_b16 a[196:197], v11 offset:4096
  v_mov_b32 v5, 1
  v_mfma_f32_16x16x32_bf16 v[92:95], a[164:167], a[116:119], v[92:95]
  ds_read_b64_tr_b16 a[198:199], v11 offset:4608
  v_mov_b32 v6, 0
  s_waitcnt lgkmcnt(8)
  s_waitcnt vmcnt(13)
  v_mfma_f32_16x16x32_bf16 v[64:67], a[168:171], a[48:51], v[64:67]
  ds_read_b64_tr_b16 a[144:145], v8 offset:8192
  v_lshl_add_u32 v4, s34, 10, v3
  s_waitcnt vmcnt(12)
  v_mfma_f32_16x16x32_bf16 v[68:71], a[168:171], a[120:123], v[68:71]
  ds_read_b64_tr_b16 a[146:147], v8 offset:8704
  s_add_u32 m0, s27, 40960
  v_mfma_f32_16x16x32_bf16 v[72:75], a[172:175], a[48:51], v[72:75]
  ds_read_b64_tr_b16 a[148:149], v9 offset:8192
  s_add_u32 s52, s52, 589824
  v_mfma_f32_16x16x32_bf16 v[76:79], a[172:175], a[120:123], v[76:79]
  ds_read_b64_tr_b16 a[150:151], v9 offset:8704
  buffer_load_dwordx4 v20, s[4:7], s52 offen lds
  v_mfma_f32_16x16x32_bf16 v[80:83], a[176:179], a[48:51], v[80:83]
  ds_read_b64_tr_b16 a[152:153], v10 offset:8192
  s_add_u32 m0, s27, 45056
  v_mfma_f32_16x16x32_bf16 v[84:87], a[176:179], a[120:123], v[84:87]
  ds_read_b64_tr_b16 a[154:155], v10 offset:8704
  buffer_load_dwordx4 v21, s[4:7], s52 offen lds
  v_mfma_f32_16x16x32_bf16 v[88:91], a[180:183], a[48:51], v[88:91]
  ds_read_b64_tr_b16 a[156:157], v11 offset:8192
  v_mfma_f32_16x16x32_bf16 v[92:95], a[180:183], a[120:123], v[92:95]
  ds_read_b64_tr_b16 a[158:159], v11 offset:8704
  s_waitcnt lgkmcnt(8)
  s_waitcnt vmcnt(13)
  v_mfma_f32_16x16x32_bf16 v[64:67], a[184:187], a[52:55], v[64:67]
  ds_read_b64_tr_b16 a[160:161], v8 offset:12288
  ds_read_b128 a[232:235], v4 offset:0
  s_waitcnt vmcnt(12)
  v_mfma_f32_16x16x32_bf16 v[68:71], a[184:187], a[124:127], v[68:71]
  ds_read_b64_tr_b16 a[162:163], v8 offset:12800
  s_add_u32 m0, s27, 49152
  v_mfma_f32_16x16x32_bf16 v[72:75], a[188:191], a[52:55], v[72:75]
  ds_read_b64_tr_b16 a[164:165], v9 offset:12288
  s_add_u32 s52, s52, 589824
  v_mfma_f32_16x16x32_bf16 v[76:79], a[188:191], a[124:127], v[76:79]
  ds_read_b64_tr_b16 a[166:167], v9 offset:12800
  buffer_load_dwordx4 v20, s[4:7], s52 offen lds
  v_mfma_f32_16x16x32_bf16 v[80:83], a[192:195], a[52:55], v[80:83]
  ds_read_b64_tr_b16 a[168:169], v10 offset:12288
  s_add_u32 m0, s27, 53248
  v_mfma_f32_16x16x32_bf16 v[84:87], a[192:195], a[124:127], v[84:87]
  ds_read_b64_tr_b16 a[170:171], v10 offset:12800
  buffer_load_dwordx4 v21, s[4:7], s52 offen lds
  v_mfma_f32_16x16x32_bf16 v[88:91], a[196:199], a[52:55], v[88:91]
  ds_read_b64_tr_b16 a[172:173], v11 offset:12288
  v_mfma_f32_16x16x32_bf16 v[92:95], a[196:199], a[124:127], v[92:95]
  ds_read_b64_tr_b16 a[174:175], v11 offset:12800
  s_waitcnt lgkmcnt(9)
  s_waitcnt vmcnt(13)
  v_mfma_f32_16x16x32_bf16 v[64:67], a[144:147], a[56:59], v[64:67]
  ds_read_b64_tr_b16 a[176:177], v8 offset:16384
  ds_read_b128 a[236:239], v4 offset:256
  s_waitcnt vmcnt(12)
  v_mfma_f32_16x16x32_bf16 v[68:71], a[144:147], a[128:131], v[68:71]
  ds_read_b64_tr_b16 a[178:179], v8 offset:16896
  s_add_u32 m0, s27, 57344
  v_mfma_f32_16x16x32_bf16 v[72:75], a[148:151], a[56:59], v[72:75]
  ds_read_b64_tr_b16 a[180:181], v9 offset:16384
  s_add_u32 s52, s52, 589824
  v_mfma_f32_16x16x32_bf16 v[76:79], a[148:151], a[128:131], v[76:79]
  ds_read_b64_tr_b16 a[182:183], v9 offset:16896
  buffer_load_dwordx4 v20, s[4:7], s52 offen lds
  v_mfma_f32_16x16x32_bf16 v[80:83], a[152:155], a[56:59], v[80:83]
  ds_read_b64_tr_b16 a[184:185], v10 offset:16384
  s_add_u32 m0, s27, 61440
  v_mfma_f32_16x16x32_bf16 v[84:87], a[152:155], a[128:131], v[84:87]
  ds_read_b64_tr_b16 a[186:187], v10 offset:16896
  buffer_load_dwordx4 v21, s[4:7], s52 offen lds
  v_mfma_f32_16x16x32_bf16 v[88:91], a[156:159], a[56:59], v[88:91]
  ds_read_b64_tr_b16 a[188:189], v11 offset:16384
  v_mfma_f32_16x16x32_bf16 v[92:95], a[156:159], a[128:131], v[92:95]
  ds_read_b64_tr_b16 a[190:191], v11 offset:16896
  s_waitcnt lgkmcnt(9)
  s_waitcnt vmcnt(13)
  v_mfma_f32_16x16x32_bf16 v[64:67], a[160:163], a[60:63], v[64:67]
  ds_read_b64_tr_b16 a[192:193], v8 offset:20480
  ds_read_b128 a[240:243], v4 offset:512
  s_waitcnt vmcnt(12)
  v_mfma_f32_16x16x32_bf16 v[68:71], a[160:163], a[132:135], v[68:71]
  ds_read_b64_tr_b16 a[194:195], v8 offset:20992
  s_add_u32 m0, s27, 65536
  v_mfma_f32_16x16x32_bf16 v[72:75], a[164:167], a[60:63], v[72:75]
  ds_read_b64_tr_b16 a[196:197], v9 offset:20480
  s_add_u32 s52, s52, 589824
  v_mfma_f32_16x16x32_bf16 v[76:79], a[164:167], a[132:135], v[76:79]
  ds_read_b64_tr_b16 a[198:199], v9 offset:20992
  buffer_load_dwordx4 v20, s[4:7], s52 offen lds
  v_mfma_f32_16x16x32_bf16 v[80:83], a[168:171], a[60:63], v[80:83]
  ds_read_b64_tr_b16 a[144:145], v10 offset:20480
  s_add_u32 m0, s27, 69632
  v_mfma_f32_16x16x32_bf16 v[84:87], a[168:171], a[132:135], v[84:87]
  ds_read_b64_tr_b16 a[146:147], v10 offset:20992
  buffer_load_dwordx4 v21, s[4:7], s52 offen lds
  v_mfma_f32_16x16x32_bf16 v[88:91], a[172:175], a[60:63], v[88:91]
  ds_read_b64_tr_b16 a[148:149], v11 offset:20480
  v_mfma_f32_16x16x32_bf16 v[92:95], a[172:175], a[132:135], v[92:95]
  ds_read_b64_tr_b16 a[150:151], v11 offset:20992
  s_waitcnt vmcnt(6)
  s_barrier
  s_waitcnt lgkmcnt(9)
  v_mfma_f32_16x16x32_bf16 v[64:67], a[176:179], a[64:67], v[64:67]
  ds_read_b64_tr_b16 a[152:153], v8 offset:24576
  ds_read_b128 a[244:247], v4 offset:768
  v_mfma_f32_16x16x32_bf16 v[68:71], a[176:179], a[136:139], v[68:71]
  ds_read_b64_tr_b16 a[154:155], v8 offset:25088
  s_add_u32 m0, s27, 73728
  v_mfma_f32_16x16x32_bf16 v[72:75], a[180:183], a[64:67], v[72:75]
  ds_read_b64_tr_b16 a[156:157], v9 offset:24576
  s_add_u32 s52, s52, 589824
  v_mfma_f32_16x16x32_bf16 v[76:79], a[180:183], a[136:139], v[76:79]
  ds_read_b64_tr_b16 a[158:159], v9 offset:25088
  buffer_load_dwordx4 v20, s[4:7], s52 offen lds
  v_mfma_f32_16x16x32_bf16 v[80:83], a[184:187], a[64:67], v[80:83]
  ds_read_b64_tr_b16 a[160:161], v10 offset:24576
  s_add_u32 m0, s27, 77824
  v_mfma_f32_16x16x32_bf16 v[84:87], a[184:187], a[136:139], v[84:87]
  ds_read_b64_tr_b16 a[162:163], v10 offset:25088
  buffer_load_dwordx4 v21, s[4:7], s52 offen lds
  v_mfma_f32_16x16x32_bf16 v[88:91], a[188:191], a[64:67], v[88:91]
  ds_read_b64_tr_b16 a[164:165], v11 offset:24576
  v_mfma_f32_16x16x32_bf16 v[92:95], a[188:191], a[136:139], v[92:95]
  ds_read_b64_tr_b16 a[166:167], v11 offset:25088
  s_waitcnt lgkmcnt(9)
  v_mfma_f32_16x16x32_bf16 v[64:67], a[192:195], a[68:71], v[64:67]
  ds_read_b64_tr_b16 a[168:169], v8 offset:28672
  s_add_u32 m0, s27, 81920
  v_mfma_f32_16x16x32_bf16 v[68:71], a[192:195], a[140:143], v[68:71]
  ds_read_b64_tr_b16 a[170:171], v8 offset:29184
  s_add_u32 s52, s52, 589824
  v_mfma_f32_16x16x32_bf16 v[72:75], a[196:199], a[68:71], v[72:75]
  ds_read_b64_tr_b16 a[172:173], v9 offset:28672
  v_mfma_f32_16x16x32_bf16 v[76:79], a[196:199], a[140:143], v[76:79]
  ds_read_b64_tr_b16 a[174:175], v9 offset:29184
  buffer_load_dwordx4 v20, s[4:7], s52 offen lds
  v_mfma_f32_16x16x32_bf16 v[80:83], a[144:147], a[68:71], v[80:83]
  ds_read_b64_tr_b16 a[176:177], v10 offset:28672
  s_add_u32 m0, s27, 86016
  v_mfma_f32_16x16x32_bf16 v[84:87], a[144:147], a[140:143], v[84:87]
  ds_read_b64_tr_b16 a[178:179], v10 offset:29184
  buffer_load_dwordx4 v21, s[4:7], s52 offen lds
  v_mfma_f32_16x16x32_bf16 v[88:91], a[148:151], a[68:71], v[88:91]
  ds_read_b64_tr_b16 a[180:181], v11 offset:28672
  v_mfma_f32_16x16x32_bf16 v[92:95], a[148:151], a[140:143], v[92:95]
  ds_read_b64_tr_b16 a[182:183], v11 offset:29184
  v_mfma_f32_16x16x32_bf16 v[64:67], a[232:235], v[24:27], v[64:67]
  v_mfma_f32_16x16x32_bf16 v[68:71], a[232:235], v[28:31], v[68:71]
  v_mfma_f32_16x16x32_bf16 v[72:75], a[236:239], v[24:27], v[72:75]
  v_mfma_f32_16x16x32_bf16 v[76:79], a[236:239], v[28:31], v[76:79]
  v_mfma_f32_16x16x32_bf16 v[80:83], a[240:243], v[24:27], v[80:83]
  v_mfma_f32_16x16x32_bf16 v[84:87], a[240:243], v[28:31], v[84:87]
  s_waitcnt lgkmcnt(14)
  v_mfma_f32_16x16x32_bf16 v[88:91], a[244:247], v[24:27], v[88:91]
  v_mfma_f32_16x16x32_bf16 v[92:95], a[244:247], v[28:31], v[92:95]
  s_waitcnt lgkmcnt(8)
  v_mfma_f32_16x16x32_bf16 v[160:163], a[152:155], a[0:3], 0
  ds_read_b64_tr_b16 a[184:185], v8 offset:32768
  s_add_u32 m0, s27, 90112
  v_mfma_f32_16x16x32_bf16 v[164:167], a[152:155], a[72:75], 0
  ds_read_b64_tr_b16 a[186:187], v8 offset:33280
  s_add_u32 s52, s52, 589824
  v_mfma_f32_16x16x32_bf16 v[168:171], a[156:159], a[0:3], 0
  ds_read_b64_tr_b16 a[188:189], v9 offset:32768
  buffer_load_dwordx4 v20, s[4:7], s52 offen lds
  v_mfma_f32_16x16x32_bf16 v[172:175], a[156:159], a[72:75], 0
  ds_read_b64_tr_b16 a[190:191], v9 offset:33280
  s_add_u32 m0, s27, 94208
  v_mfma_f32_16x16x32_bf16 v[176:179], a[160:163], a[0:3], 0
  ds_read_b64_tr_b16 a[192:193], v10 offset:32768
  buffer_load_dwordx4 v21, s[4:7], s52 offen lds
  v_mfma_f32_16x16x32_bf16 v[180:183], a[160:163], a[72:75], 0
  ds_read_b64_tr_b16 a[194:195], v10 offset:33280
  v_cvt_pk_bf16_f32 v192, v64, v65
  v_mfma_f32_16x16x32_bf16 v[184:187], a[164:167], a[0:3], 0
  ds_read_b64_tr_b16 a[196:197], v11 offset:32768
  v_cvt_pk_bf16_f32 v193, v66, v67
  v_mfma_f32_16x16x32_bf16 v[188:191], a[164:167], a[72:75], 0
  ds_read_b64_tr_b16 a[198:199], v11 offset:33280
  v_cvt_pk_bf16_f32 v194, v72, v73
  s_waitcnt lgkmcnt(8)
  v_mfma_f32_16x16x32_bf16 v[160:163], a[168:171], a[4:7], v[160:163]
  ds_read_b64_tr_b16 a[144:145], v8 offset:36864
  s_add_u32 m0, s27, 98304
  v_mfma_f32_16x16x32_bf16 v[164:167], a[168:171], a[76:79], v[164:167]
  ds_read_b64_tr_b16 a[146:147], v8 offset:37376
  s_lshl_b32 s24, s36, 7
  v_mfma_f32_16x16x32_bf16 v[168:171], a[172:175], a[4:7], v[168:171]
  ds_read_b64_tr_b16 a[148:149], v9 offset:36864
  buffer_load_dwordx4 v20, s[4:7], s24 offen lds
  v_mfma_f32_16x16x32_bf16 v[172:175], a[172:175], a[76:79], v[172:175]
  ds_read_b64_tr_b16 a[150:151], v9 offset:37376
  s_add_u32 m0, s27, 102400
  v_mfma_f32_16x16x32_bf16 v[176:179], a[176:179], a[4:7], v[176:179]
  ds_read_b64_tr_b16 a[152:153], v10 offset:36864
  buffer_load_dwordx4 v21, s[4:7], s24 offen lds
  v_mfma_f32_16x16x32_bf16 v[180:183], a[176:179], a[76:79], v[180:183]
  ds_read_b64_tr_b16 a[154:155], v10 offset:37376
  v_cvt_pk_bf16_f32 v195, v74, v75
  v_mfma_f32_16x16x32_bf16 v[184:187], a[180:183], a[4:7], v[184:187]
  ds_read_b64_tr_b16 a[156:157], v11 offset:36864
  v_pk_max_i16 v192, v192, 0
  v_mfma_f32_16x16x32_bf16 v[188:191], a[180:183], a[76:79], v[188:191]
  ds_read_b64_tr_b16 a[158:159], v11 offset:37376
  v_pk_max_i16 v193, v193, 0
  s_waitcnt lgkmcnt(8)
  v_mfma_f32_16x16x32_bf16 v[160:163], a[184:187], a[8:11], v[160:163]
  ds_read_b64_tr_b16 a[160:161], v8 offset:40960
  s_add_u32 m0, s27, 106496
  v_mfma_f32_16x16x32_bf16 v[164:167], a[184:187], a[80:83], v[164:167]
  ds_read_b64_tr_b16 a[162:163], v8 offset:41472
  s_add_u32 s24, s24, 589824
  v_mfma_f32_16x16x32_bf16 v[168:171], a[188:191], a[8:11], v[168:171]
  ds_read_b64_tr_b16 a[164:165], v9 offset:40960
  buffer_load_dwordx4 v20, s[4:7], s24 offen lds
  v_mfma_f32_16x16x32_bf16 v[172:175], a[188:191], a[80:83], v[172:175]
  ds_read_b64_tr_b16 a[166:167], v9 offset:41472
  s_add_u32 m0, s27, 110592
  v_mfma_f32_16x16x32_bf16 v[176:179], a[192:195], a[8:11], v[176:179]
  ds_read_b64_tr_b16 a[168:169], v10 offset:40960
  buffer_load_dwordx4 v21, s[4:7], s24 offen lds
  v_mfma_f32_16x16x32_bf16 v[180:183], a[192:195], a[80:83], v[180:183]
  ds_read_b64_tr_b16 a[170:171], v10 offset:41472
  v_pk_max_i16 v194, v194, 0
  v_mfma_f32_16x16x32_bf16 v[184:187], a[196:199], a[8:11], v[184:187]
  ds_read_b64_tr_b16 a[172:173], v11 offset:40960
  v_pk_max_i16 v195, v195, 0
  v_mfma_f32_16x16x32_bf16 v[188:191], a[196:199], a[80:83], v[188:191]
  ds_read_b64_tr_b16 a[174:175], v11 offset:41472
  buffer_store_dwordx4 v[192:195], v2, s[12:15], s30 offen offset:0 sc0 sc1
  s_waitcnt lgkmcnt(8)
  v_mfma_f32_16x16x32_bf16 v[160:163], a[144:147], a[12:15], v[160:163]
  ds_read_b64_tr_b16 a[176:177], v8 offset:45056
  s_add_u32 m0, s27, 114688
  v_mfma_f32_16x16x32_bf16 v[164:167], a[144:147], a[84:87], v[164:167]
  ds_read_b64_tr_b16 a[178:179], v8 offset:45568
  s_add_u32 s24, s24, 589824
  v_mfma_f32_16x16x32_bf16 v[168:171], a[148:151], a[12:15], v[168:171]
  ds_read_b64_tr_b16 a[180:181], v9 offset:45056
  buffer_load_dwordx4 v20, s[4:7], s24 offen lds
  v_mfma_f32_16x16x32_bf16 v[172:175], a[148:151], a[84:87], v[172:175]
  ds_read_b64_tr_b16 a[182:183], v9 offset:45568
  s_add_u32 m0, s27, 118784
  v_mfma_f32_16x16x32_bf16 v[176:179], a[152:155], a[12:15], v[176:179]
  ds_read_b64_tr_b16 a[184:185], v10 offset:45056
  buffer_load_dwordx4 v21, s[4:7], s24 offen lds
  v_mfma_f32_16x16x32_bf16 v[180:183], a[152:155], a[84:87], v[180:183]
  ds_read_b64_tr_b16 a[186:187], v10 offset:45568
  v_cvt_pk_bf16_f32 v196, v68, v69
  v_mfma_f32_16x16x32_bf16 v[184:187], a[156:159], a[12:15], v[184:187]
  ds_read_b64_tr_b16 a[188:189], v11 offset:45056
  v_cvt_pk_bf16_f32 v197, v70, v71
  v_mfma_f32_16x16x32_bf16 v[188:191], a[156:159], a[84:87], v[188:191]
  ds_read_b64_tr_b16 a[190:191], v11 offset:45568
  v_cvt_pk_bf16_f32 v198, v76, v77
  s_waitcnt vmcnt(13)
  s_barrier
  s_waitcnt lgkmcnt(8)
  v_mfma_f32_16x16x32_bf16 v[160:163], a[160:163], a[16:19], v[160:163]
  ds_read_b64_tr_b16 a[192:193], v8 offset:49152
  s_add_u32 m0, s27, 122880
  v_mfma_f32_16x16x32_bf16 v[164:167], a[160:163], a[88:91], v[164:167]
  ds_read_b64_tr_b16 a[194:195], v8 offset:49664
  s_add_u32 s24, s24, 589824
  v_mfma_f32_16x16x32_bf16 v[168:171], a[164:167], a[16:19], v[168:171]
  ds_read_b64_tr_b16 a[196:197], v9 offset:49152
  buffer_load_dwordx4 v20, s[4:7], s24 offen lds
  v_mfma_f32_16x16x32_bf16 v[172:175], a[164:167], a[88:91], v[172:175]
  ds_read_b64_tr_b16 a[198:199], v9 offset:49664
  s_add_u32 m0, s27, 126976
  v_mfma_f32_16x16x32_bf16 v[176:179], a[168:171], a[16:19], v[176:179]
  ds_read_b64_tr_b16 a[144:145], v10 offset:49152
  buffer_load_dwordx4 v21, s[4:7], s24 offen lds
  v_mfma_f32_16x16x32_bf16 v[180:183], a[168:171], a[88:91], v[180:183]
  ds_read_b64_tr_b16 a[146:147], v10 offset:49664
  v_cvt_pk_bf16_f32 v199, v78, v79
  v_mfma_f32_16x16x32_bf16 v[184:187], a[172:175], a[16:19], v[184:187]
  ds_read_b64_tr_b16 a[148:149], v11 offset:49152
  v_pk_max_i16 v196, v196, 0
  v_mfma_f32_16x16x32_bf16 v[188:191], a[172:175], a[88:91], v[188:191]
  ds_read_b64_tr_b16 a[150:151], v11 offset:49664
  v_pk_max_i16 v197, v197, 0
  s_waitcnt lgkmcnt(8)
  v_mfma_f32_16x16x32_bf16 v[160:163], a[176:179], a[20:23], v[160:163]
  ds_read_b64_tr_b16 a[152:153], v8 offset:53248
  s_add_u32 m0, s27, 131072
  v_mfma_f32_16x16x32_bf16 v[164:167], a[176:179], a[92:95], v[164:167]
  ds_read_b64_tr_b16 a[154:155], v8 offset:53760
  s_add_u32 s24, s24, 589824
  v_mfma_f32_16x16x32_bf16 v[168:171], a[180:183], a[20:23], v[168:171]
  ds_read_b64_tr_b16 a[156:157], v9 offset:53248
  buffer_load_dwordx4 v20, s[4:7], s24 offen lds
  v_mfma_f32_16x16x32_bf16 v[172:175], a[180:183], a[92:95], v[172:175]
  ds_read_b64_tr_b16 a[158:159], v9 offset:53760
  s_add_u32 m0, s27, 135168
  v_mfma_f32_16x16x32_bf16 v[176:179], a[184:187], a[20:23], v[176:179]
  ds_read_b64_tr_b16 a[160:161], v10 offset:53248
  buffer_load_dwordx4 v21, s[4:7], s24 offen lds
  v_mfma_f32_16x16x32_bf16 v[180:183], a[184:187], a[92:95], v[180:183]
  ds_read_b64_tr_b16 a[162:163], v10 offset:53760
  v_pk_max_i16 v198, v198, 0
  v_mfma_f32_16x16x32_bf16 v[184:187], a[188:191], a[20:23], v[184:187]
  ds_read_b64_tr_b16 a[164:165], v11 offset:53248
  v_pk_max_i16 v199, v199, 0
  v_mfma_f32_16x16x32_bf16 v[188:191], a[188:191], a[92:95], v[188:191]
  ds_read_b64_tr_b16 a[166:167], v11 offset:53760
  buffer_store_dwordx4 v[196:199], v2, s[12:15], s30 offen offset:1024 sc0 sc1
  s_waitcnt lgkmcnt(8)
  v_mfma_f32_16x16x32_bf16 v[160:163], a[192:195], a[24:27], v[160:163]
  ds_read_b64_tr_b16 a[168:169], v8 offset:57344
  s_add_u32 m0, s27, 139264
  v_mfma_f32_16x16x32_bf16 v[164:167], a[192:195], a[96:99], v[164:167]
  ds_read_b64_tr_b16 a[170:171], v8 offset:57856
  s_add_u32 s24, s24, 589824
  v_mfma_f32_16x16x32_bf16 v[168:171], a[196:199], a[24:27], v[168:171]
  ds_read_b64_tr_b16 a[172:173], v9 offset:57344
  buffer_load_dwordx4 v20, s[4:7], s24 offen lds
  v_mfma_f32_16x16x32_bf16 v[172:175], a[196:199], a[96:99], v[172:175]
  ds_read_b64_tr_b16 a[174:175], v9 offset:57856
  v_cvt_pk_bf16_f32 v200, v80, v81
  v_mfma_f32_16x16x32_bf16 v[176:179], a[144:147], a[24:27], v[176:179]
  ds_read_b64_tr_b16 a[176:177], v10 offset:57344
  v_cvt_pk_bf16_f32 v201, v82, v83
  v_mfma_f32_16x16x32_bf16 v[180:183], a[144:147], a[96:99], v[180:183]
  ds_read_b64_tr_b16 a[178:179], v10 offset:57856
  v_cvt_pk_bf16_f32 v202, v88, v89
  v_mfma_f32_16x16x32_bf16 v[184:187], a[148:151], a[24:27], v[184:187]
  ds_read_b64_tr_b16 a[180:181], v11 offset:57344
  v_mfma_f32_16x16x32_bf16 v[188:191], a[148:151], a[96:99], v[188:191]
  ds_read_b64_tr_b16 a[182:183], v11 offset:57856
  s_waitcnt lgkmcnt(8)
  v_mfma_f32_16x16x32_bf16 v[160:163], a[152:155], a[28:31], v[160:163]
  ds_read_b64_tr_b16 a[184:185], v8 offset:61440
  s_add_u32 m0, s27, 143360
  v_mfma_f32_16x16x32_bf16 v[164:167], a[152:155], a[100:103], v[164:167]
  ds_read_b64_tr_b16 a[186:187], v8 offset:61952
  buffer_load_dwordx4 v21, s[4:7], s24 offen lds
  v_mfma_f32_16x16x32_bf16 v[168:171], a[156:159], a[28:31], v[168:171]
  ds_read_b64_tr_b16 a[188:189], v9 offset:61440
  v_mfma_f32_16x16x32_bf16 v[172:175], a[156:159], a[100:103], v[172:175]
  ds_read_b64_tr_b16 a[190:191], v9 offset:61952
  v_cvt_pk_bf16_f32 v203, v90, v91
  v_mfma_f32_16x16x32_bf16 v[176:179], a[160:163], a[28:31], v[176:179]
  ds_read_b64_tr_b16 a[192:193], v10 offset:61440
  v_pk_max_i16 v200, v200, 0
  v_mfma_f32_16x16x32_bf16 v[180:183], a[160:163], a[100:103], v[180:183]
  ds_read_b64_tr_b16 a[194:195], v10 offset:61952
  v_pk_max_i16 v201, v201, 0
  v_mfma_f32_16x16x32_bf16 v[184:187], a[164:167], a[28:31], v[184:187]
  ds_read_b64_tr_b16 a[196:197], v11 offset:61440
  v_mfma_f32_16x16x32_bf16 v[188:191], a[164:167], a[100:103], v[188:191]
  ds_read_b64_tr_b16 a[198:199], v11 offset:61952
  s_waitcnt lgkmcnt(8)
  v_mfma_f32_16x16x32_bf16 v[160:163], a[168:171], a[32:35], v[160:163]
  ds_read_b64_tr_b16 a[144:145], v12 offset:0
  s_add_u32 m0, s27, 0
  v_mfma_f32_16x16x32_bf16 v[164:167], a[168:171], a[104:107], v[164:167]
  ds_read_b64_tr_b16 a[146:147], v12 offset:512
  s_add_u32 s24, s24, 589824
  v_mfma_f32_16x16x32_bf16 v[168:171], a[172:175], a[32:35], v[168:171]
  ds_read_b64_tr_b16 a[148:149], v13 offset:0
  buffer_load_dwordx4 v20, s[4:7], s24 offen lds
  v_mfma_f32_16x16x32_bf16 v[172:175], a[172:175], a[104:107], v[172:175]
  ds_read_b64_tr_b16 a[150:151], v13 offset:512
  v_pk_max_i16 v202, v202, 0
  v_mfma_f32_16x16x32_bf16 v[176:179], a[176:179], a[32:35], v[176:179]
  ds_read_b64_tr_b16 a[152:153], v14 offset:0
  v_pk_max_i16 v203, v203, 0
  v_mfma_f32_16x16x32_bf16 v[180:183], a[176:179], a[104:107], v[180:183]
  ds_read_b64_tr_b16 a[154:155], v14 offset:512
  buffer_store_dwordx4 v[200:203], v2, s[12:15], s30 offen offset:2048 sc0 sc1
  v_mfma_f32_16x16x32_bf16 v[184:187], a[180:183], a[32:35], v[184:187]
  ds_read_b64_tr_b16 a[156:157], v15 offset:0
  v_mfma_f32_16x16x32_bf16 v[188:191], a[180:183], a[104:107], v[188:191]
  ds_read_b64_tr_b16 a[158:159], v15 offset:512
  s_waitcnt lgkmcnt(8)
  v_mfma_f32_16x16x32_bf16 v[160:163], a[184:187], a[36:39], v[160:163]
  ds_read_b64_tr_b16 a[160:161], v12 offset:4096
  s_add_u32 m0, s27, 4096
  v_mfma_f32_16x16x32_bf16 v[164:167], a[184:187], a[108:111], v[164:167]
  ds_read_b64_tr_b16 a[162:163], v12 offset:4608
  buffer_load_dwordx4 v21, s[4:7], s24 offen lds
  v_mfma_f32_16x16x32_bf16 v[168:171], a[188:191], a[36:39], v[168:171]
  ds_read_b64_tr_b16 a[164:165], v13 offset:4096
  v_mfma_f32_16x16x32_bf16 v[172:175], a[188:191], a[108:111], v[172:175]
  ds_read_b64_tr_b16 a[166:167], v13 offset:4608
  v_cvt_pk_bf16_f32 v204, v84, v85
  v_mfma_f32_16x16x32_bf16 v[176:179], a[192:195], a[36:39], v[176:179]
  ds_read_b64_tr_b16 a[168:169], v14 offset:4096
  v_cvt_pk_bf16_f32 v205, v86, v87
  v_mfma_f32_16x16x32_bf16 v[180:183], a[192:195], a[108:111], v[180:183]
  ds_read_b64_tr_b16 a[170:171], v14 offset:4608
  v_cvt_pk_bf16_f32 v206, v92, v93
  v_mfma_f32_16x16x32_bf16 v[184:187], a[196:199], a[36:39], v[184:187]
  ds_read_b64_tr_b16 a[172:173], v15 offset:4096
  v_mfma_f32_16x16x32_bf16 v[188:191], a[196:199], a[108:111], v[188:191]
  ds_read_b64_tr_b16 a[174:175], v15 offset:4608
  s_waitcnt vmcnt(17)
  s_barrier
  s_waitcnt lgkmcnt(8)
  v_mfma_f32_16x16x32_bf16 v[160:163], a[144:147], a[40:43], v[160:163]
  ds_read_b64_tr_b16 a[176:177], v12 offset:8192
  s_add_u32 m0, s27, 8192
  v_mfma_f32_16x16x32_bf16 v[164:167], a[144:147], a[112:115], v[164:167]
  ds_read_b64_tr_b16 a[178:179], v12 offset:8704
  s_add_u32 s24, s24, 589824
  v_mfma_f32_16x16x32_bf16 v[168:171], a[148:151], a[40:43], v[168:171]
  ds_read_b64_tr_b16 a[180:181], v13 offset:8192
  buffer_load_dwordx4 v20, s[4:7], s24 offen lds
  v_mfma_f32_16x16x32_bf16 v[172:175], a[148:151], a[112:115], v[172:175]
  ds_read_b64_tr_b16 a[182:183], v13 offset:8704
  v_cvt_pk_bf16_f32 v207, v94, v95
  v_mfma_f32_16x16x32_bf16 v[176:179], a[152:155], a[40:43], v[176:179]
  ds_read_b64_tr_b16 a[184:185], v14 offset:8192
  v_pk_max_i16 v204, v204, 0
  v_mfma_f32_16x16x32_bf16 v[180:183], a[152:155], a[112:115], v[180:183]
  ds_read_b64_tr_b16 a[186:187], v14 offset:8704
  v_pk_max_i16 v205, v205, 0
  v_mfma_f32_16x16x32_bf16 v[184:187], a[156:159], a[40:43], v[184:187]
  ds_read_b64_tr_b16 a[188:189], v15 offset:8192
  v_mfma_f32_16x16x32_bf16 v[188:191], a[156:159], a[112:115], v[188:191]
  ds_read_b64_tr_b16 a[190:191], v15 offset:8704
  s_waitcnt lgkmcnt(8)
  v_mfma_f32_16x16x32_bf16 v[160:163], a[160:163], a[44:47], v[160:163]
  ds_read_b64_tr_b16 a[192:193], v12 offset:12288
  s_add_u32 m0, s27, 12288
  v_mfma_f32_16x16x32_bf16 v[164:167], a[160:163], a[116:119], v[164:167]
  ds_read_b64_tr_b16 a[194:195], v12 offset:12800
  buffer_load_dwordx4 v21, s[4:7], s24 offen lds
  v_mfma_f32_16x16x32_bf16 v[168:171], a[164:167], a[44:47], v[168:171]
  ds_read_b64_tr_b16 a[196:197], v13 offset:12288
  v_pk_max_i16 v206, v206, 0
  v_mfma_f32_16x16x32_bf16 v[172:175], a[164:167], a[116:119], v[172:175]
  ds_read_b64_tr_b16 a[198:199], v13 offset:12800
  v_pk_max_i16 v207, v207, 0
  v_mfma_f32_16x16x32_bf16 v[176:179], a[168:171], a[44:47], v[176:179]
  ds_read_b64_tr_b16 a[144:145], v14 offset:12288
  buffer_store_dwordx4 v[204:207], v2, s[12:15], s30 offen offset:3072 sc0 sc1
  v_mfma_f32_16x16x32_bf16 v[180:183], a[168:171], a[116:119], v[180:183]
  ds_read_b64_tr_b16 a[146:147], v14 offset:12800
  s_add_u32 s30, s30, 4096
  v_mfma_f32_16x16x32_bf16 v[184:187], a[172:175], a[44:47], v[184:187]
  ds_read_b64_tr_b16 a[148:149], v15 offset:12288
  v_mfma_f32_16x16x32_bf16 v[188:191], a[172:175], a[116:119], v[188:191]
  ds_read_b64_tr_b16 a[150:151], v15 offset:12800
  s_waitcnt lgkmcnt(8)
  v_mfma_f32_16x16x32_bf16 v[160:163], a[176:179], a[48:51], v[160:163]
  ds_read_b64_tr_b16 a[152:153], v12 offset:16384
  v_lshl_add_u32 v4, s35, 10, v3
  v_mfma_f32_16x16x32_bf16 v[164:167], a[176:179], a[120:123], v[164:167]
  ds_read_b64_tr_b16 a[154:155], v12 offset:16896
  s_add_u32 m0, s27, 16384
  v_mfma_f32_16x16x32_bf16 v[168:171], a[180:183], a[48:51], v[168:171]
  ds_read_b64_tr_b16 a[156:157], v13 offset:16384
  v_mfma_f32_16x16x32_bf16 v[172:175], a[180:183], a[120:123], v[172:175]
  ds_read_b64_tr_b16 a[158:159], v13 offset:16896
  s_add_u32 s24, s24, 589824
  v_mfma_f32_16x16x32_bf16 v[176:179], a[184:187], a[48:51], v[176:179]
  ds_read_b64_tr_b16 a[160:161], v14 offset:16384
  v_mfma_f32_16x16x32_bf16 v[180:183], a[184:187], a[120:123], v[180:183]
  ds_read_b64_tr_b16 a[162:163], v14 offset:16896
  buffer_load_dwordx4 v20, s[4:7], s24 offen lds
  v_mfma_f32_16x16x32_bf16 v[184:187], a[188:191], a[48:51], v[184:187]
  ds_read_b64_tr_b16 a[164:165], v15 offset:16384
  v_mfma_f32_16x16x32_bf16 v[188:191], a[188:191], a[120:123], v[188:191]
  ds_read_b64_tr_b16 a[166:167], v15 offset:16896
  s_waitcnt lgkmcnt(8)
  v_mfma_f32_16x16x32_bf16 v[160:163], a[192:195], a[52:55], v[160:163]
  ds_read_b64_tr_b16 a[168:169], v12 offset:20480
  v_mfma_f32_16x16x32_bf16 v[164:167], a[192:195], a[124:127], v[164:167]
  ds_read_b64_tr_b16 a[170:171], v12 offset:20992
  ds_read_b128 a[200:203], v4 offset:0
  v_mfma_f32_16x16x32_bf16 v[168:171], a[196:199], a[52:55], v[168:171]
  ds_read_b64_tr_b16 a[172:173], v13 offset:20480
  v_mfma_f32_16x16x32_bf16 v[172:175], a[196:199], a[124:127], v[172:175]
  ds_read_b64_tr_b16 a[174:175], v13 offset:20992
  s_add_u32 m0, s27, 20480
  v_mfma_f32_16x16x32_bf16 v[176:179], a[144:147], a[52:55], v[176:179]
  ds_read_b64_tr_b16 a[176:177], v14 offset:20480
  v_mfma_f32_16x16x32_bf16 v[180:183], a[144:147], a[124:127], v[180:183]
  ds_read_b64_tr_b16 a[178:179], v14 offset:20992
  buffer_load_dwordx4 v21, s[4:7], s24 offen lds
  v_mfma_f32_16x16x32_bf16 v[184:187], a[148:151], a[52:55], v[184:187]
  ds_read_b64_tr_b16 a[180:181], v15 offset:20480
  v_mfma_f32_16x16x32_bf16 v[188:191], a[148:151], a[124:127], v[188:191]
  ds_read_b64_tr_b16 a[182:183], v15 offset:20992
  s_waitcnt lgkmcnt(9)
  v_mfma_f32_16x16x32_bf16 v[160:163], a[152:155], a[56:59], v[160:163]
  ds_read_b64_tr_b16 a[184:185], v12 offset:24576
  ds_read_b128 a[204:207], v4 offset:256
  v_mfma_f32_16x16x32_bf16 v[164:167], a[152:155], a[128:131], v[164:167]
  ds_read_b64_tr_b16 a[186:187], v12 offset:25088
  s_add_u32 m0, s27, 24576
  v_mfma_f32_16x16x32_bf16 v[168:171], a[156:159], a[56:59], v[168:171]
  ds_read_b64_tr_b16 a[188:189], v13 offset:24576
  v_mfma_f32_16x16x32_bf16 v[172:175], a[156:159], a[128:131], v[172:175]
  ds_read_b64_tr_b16 a[190:191], v13 offset:25088
  s_lshl_b32 s24, s37, 7
  v_mfma_f32_16x16x32_bf16 v[176:179], a[160:163], a[56:59], v[176:179]
  ds_read_b64_tr_b16 a[192:193], v14 offset:24576
  v_mfma_f32_16x16x32_bf16 v[180:183], a[160:163], a[128:131], v[180:183]
  ds_read_b64_tr_b16 a[194:195], v14 offset:25088
  buffer_load_dwordx4 v20, s[4:7], s24 offen lds
  v_mfma_f32_16x16x32_bf16 v[184:187], a[164:167], a[56:59], v[184:187]
  ds_read_b64_tr_b16 a[196:197], v15 offset:24576
  v_mfma_f32_16x16x32_bf16 v[188:191], a[164:167], a[128:131], v[188:191]
  ds_read_b64_tr_b16 a[198:199], v15 offset:25088
  s_waitcnt lgkmcnt(9)
  v_mfma_f32_16x16x32_bf16 v[160:163], a[168:171], a[60:63], v[160:163]
  ds_read_b64_tr_b16 a[144:145], v12 offset:28672
  v_mfma_f32_16x16x32_bf16 v[164:167], a[168:171], a[132:135], v[164:167]
  ds_read_b64_tr_b16 a[146:147], v12 offset:29184
  ds_read_b128 a[208:211], v4 offset:512
  v_mfma_f32_16x16x32_bf16 v[168:171], a[172:175], a[60:63], v[168:171]
  ds_read_b64_tr_b16 a[148:149], v13 offset:28672
  v_mfma_f32_16x16x32_bf16 v[172:175], a[172:175], a[132:135], v[172:175]
  ds_read_b64_tr_b16 a[150:151], v13 offset:29184
  s_add_u32 m0, s27, 28672
  v_mfma_f32_16x16x32_bf16 v[176:179], a[176:179], a[60:63], v[176:179]
  ds_read_b64_tr_b16 a[152:153], v14 offset:28672
  v_mfma_f32_16x16x32_bf16 v[180:183], a[176:179], a[132:135], v[180:183]
  ds_read_b64_tr_b16 a[154:155], v14 offset:29184
  buffer_load_dwordx4 v21, s[4:7], s24 offen lds
  v_mfma_f32_16x16x32_bf16 v[184:187], a[180:183], a[60:63], v[184:187]
  ds_read_b64_tr_b16 a[156:157], v15 offset:28672
  v_mfma_f32_16x16x32_bf16 v[188:191], a[180:183], a[132:135], v[188:191]
  ds_read_b64_tr_b16 a[158:159], v15 offset:29184
  s_waitcnt vmcnt(17)
  s_barrier
  s_waitcnt lgkmcnt(9)
  v_mfma_f32_16x16x32_bf16 v[160:163], a[184:187], a[64:67], v[160:163]
  ds_read_b64_tr_b16 a[160:161], v12 offset:32768
  ds_read_b128 a[212:215], v4 offset:768
  v_mfma_f32_16x16x32_bf16 v[164:167], a[184:187], a[136:139], v[164:167]
  ds_read_b64_tr_b16 a[162:163], v12 offset:33280
  s_add_u32 m0, s27, 32768
  v_mfma_f32_16x16x32_bf16 v[168:171], a[188:191], a[64:67], v[168:171]
  ds_read_b64_tr_b16 a[164:165], v13 offset:32768
  v_mfma_f32_16x16x32_bf16 v[172:175], a[188:191], a[136:139], v[172:175]
  ds_read_b64_tr_b16 a[166:167], v13 offset:33280
  s_add_u32 s24, s24, 589824
  v_mfma_f32_16x16x32_bf16 v[176:179], a[192:195], a[64:67], v[176:179]
  ds_read_b64_tr_b16 a[168:169], v14 offset:32768
  v_mfma_f32_16x16x32_bf16 v[180:183], a[192:195], a[136:139], v[180:183]
  ds_read_b64_tr_b16 a[170:171], v14 offset:33280
  buffer_load_dwordx4 v20, s[4:7], s24 offen lds
  v_mfma_f32_16x16x32_bf16 v[184:187], a[196:199], a[64:67], v[184:187]
  ds_read_b64_tr_b16 a[172:173], v15 offset:32768
  v_mfma_f32_16x16x32_bf16 v[188:191], a[196:199], a[136:139], v[188:191]
  ds_read_b64_tr_b16 a[174:175], v15 offset:33280
  s_waitcnt lgkmcnt(9)
  v_mfma_f32_16x16x32_bf16 v[160:163], a[144:147], a[68:71], v[160:163]
  ds_read_b64_tr_b16 a[176:177], v12 offset:36864
  v_mfma_f32_16x16x32_bf16 v[164:167], a[144:147], a[140:143], v[164:167]
  ds_read_b64_tr_b16 a[178:179], v12 offset:37376
  s_add_u32 m0, s27, 36864
  v_mfma_f32_16x16x32_bf16 v[168:171], a[148:151], a[68:71], v[168:171]
  ds_read_b64_tr_b16 a[180:181], v13 offset:36864
  v_mfma_f32_16x16x32_bf16 v[172:175], a[148:151], a[140:143], v[172:175]
  ds_read_b64_tr_b16 a[182:183], v13 offset:37376
  v_mfma_f32_16x16x32_bf16 v[176:179], a[152:155], a[68:71], v[176:179]
  ds_read_b64_tr_b16 a[184:185], v14 offset:36864
  v_mfma_f32_16x16x32_bf16 v[180:183], a[152:155], a[140:143], v[180:183]
  ds_read_b64_tr_b16 a[186:187], v14 offset:37376
  buffer_load_dwordx4 v21, s[4:7], s24 offen lds
  v_mfma_f32_16x16x32_bf16 v[184:187], a[156:159], a[68:71], v[184:187]
  ds_read_b64_tr_b16 a[188:189], v15 offset:36864
  v_mfma_f32_16x16x32_bf16 v[188:191], a[156:159], a[140:143], v[188:191]
  ds_read_b64_tr_b16 a[190:191], v15 offset:37376
  v_mfma_f32_16x16x32_bf16 v[160:163], a[200:203], v[24:27], v[160:163]
  v_mfma_f32_16x16x32_bf16 v[164:167], a[200:203], v[28:31], v[164:167]
  v_mfma_f32_16x16x32_bf16 v[168:171], a[204:207], v[24:27], v[168:171]
  v_mfma_f32_16x16x32_bf16 v[172:175], a[204:207], v[28:31], v[172:175]
  v_mfma_f32_16x16x32_bf16 v[176:179], a[208:211], v[24:27], v[176:179]
  v_mfma_f32_16x16x32_bf16 v[180:183], a[208:211], v[28:31], v[180:183]
  s_waitcnt lgkmcnt(14)
  v_mfma_f32_16x16x32_bf16 v[184:187], a[212:215], v[24:27], v[184:187]
  v_mfma_f32_16x16x32_bf16 v[188:191], a[212:215], v[28:31], v[188:191]
  s_waitcnt lgkmcnt(8)
  v_mfma_f32_16x16x32_bf16 v[128:131], a[160:163], a[0:3], 0
  ds_read_b64_tr_b16 a[192:193], v12 offset:40960
  s_add_u32 m0, s27, 40960
  v_mfma_f32_16x16x32_bf16 v[132:135], a[160:163], a[72:75], 0
  ds_read_b64_tr_b16 a[194:195], v12 offset:41472
  s_add_u32 s24, s24, 589824
  v_mfma_f32_16x16x32_bf16 v[136:139], a[164:167], a[0:3], 0
  ds_read_b64_tr_b16 a[196:197], v13 offset:40960
  buffer_load_dwordx4 v20, s[4:7], s24 offen lds
  v_mfma_f32_16x16x32_bf16 v[140:143], a[164:167], a[72:75], 0
  ds_read_b64_tr_b16 a[198:199], v13 offset:41472
  v_cvt_pk_bf16_f32 v208, v160, v161
  v_mfma_f32_16x16x32_bf16 v[144:147], a[168:171], a[0:3], 0
  ds_read_b64_tr_b16 a[144:145], v14 offset:40960
  v_cvt_pk_bf16_f32 v209, v162, v163
  v_mfma_f32_16x16x32_bf16 v[148:151], a[168:171], a[72:75], 0
  ds_read_b64_tr_b16 a[146:147], v14 offset:41472
  v_cvt_pk_bf16_f32 v210, v168, v169
  v_mfma_f32_16x16x32_bf16 v[152:155], a[172:175], a[0:3], 0
  ds_read_b64_tr_b16 a[148:149], v15 offset:40960
  v_mfma_f32_16x16x32_bf16 v[156:159], a[172:175], a[72:75], 0
  ds_read_b64_tr_b16 a[150:151], v15 offset:41472
  s_waitcnt lgkmcnt(8)
  v_mfma_f32_16x16x32_bf16 v[128:131], a[176:179], a[4:7], v[128:131]
  ds_read_b64_tr_b16 a[152:153], v12 offset:45056
  s_add_u32 m0, s27, 45056
  v_mfma_f32_16x16x32_bf16 v[132:135], a[176:179], a[76:79], v[132:135]
  ds_read_b64_tr_b16 a[154:155], v12 offset:45568
  buffer_load_dwordx4 v21, s[4:7], s24 offen lds
  v_mfma_f32_16x16x32_bf16 v[136:139], a[180:183], a[4:7], v[136:139]
  ds_read_b64_tr_b16 a[156:157], v13 offset:45056
  v_mfma_f32_16x16x32_bf16 v[140:143], a[180:183], a[76:79], v[140:143]
  ds_read_b64_tr_b16 a[158:159], v13 offset:45568
  v_cvt_pk_bf16_f32 v211, v170, v171
  v_mfma_f32_16x16x32_bf16 v[144:147], a[184:187], a[4:7], v[144:147]
  ds_read_b64_tr_b16 a[160:161], v14 offset:45056
  v_pk_max_i16 v208, v208, 0
  v_mfma_f32_16x16x32_bf16 v[148:151], a[184:187], a[76:79], v[148:151]
  ds_read_b64_tr_b16 a[162:163], v14 offset:45568
  v_pk_max_i16 v209, v209, 0
  v_mfma_f32_16x16x32_bf16 v[152:155], a[188:191], a[4:7], v[152:155]
  ds_read_b64_tr_b16 a[164:165], v15 offset:45056
  v_mfma_f32_16x16x32_bf16 v[156:159], a[188:191], a[76:79], v[156:159]
  ds_read_b64_tr_b16 a[166:167], v15 offset:45568
  s_waitcnt lgkmcnt(8)
  v_mfma_f32_16x16x32_bf16 v[128:131], a[192:195], a[8:11], v[128:131]
  ds_read_b64_tr_b16 a[168:169], v12 offset:49152
  s_add_u32 m0, s27, 49152
  v_mfma_f32_16x16x32_bf16 v[132:135], a[192:195], a[80:83], v[132:135]
  ds_read_b64_tr_b16 a[170:171], v12 offset:49664
  s_add_u32 s24, s24, 589824
  v_mfma_f32_16x16x32_bf16 v[136:139], a[196:199], a[8:11], v[136:139]
  ds_read_b64_tr_b16 a[172:173], v13 offset:49152
  buffer_load_dwordx4 v20, s[4:7], s24 offen lds
  v_mfma_f32_16x16x32_bf16 v[140:143], a[196:199], a[80:83], v[140:143]
  ds_read_b64_tr_b16 a[174:175], v13 offset:49664
  v_pk_max_i16 v210, v210, 0
  v_mfma_f32_16x16x32_bf16 v[144:147], a[144:147], a[8:11], v[144:147]
  ds_read_b64_tr_b16 a[176:177], v14 offset:49152
  v_pk_max_i16 v211, v211, 0
  v_mfma_f32_16x16x32_bf16 v[148:151], a[144:147], a[80:83], v[148:151]
  ds_read_b64_tr_b16 a[178:179], v14 offset:49664
  buffer_store_dwordx4 v[208:211], v2, s[12:15], s30 offen offset:0 sc0 sc1
  v_mfma_f32_16x16x32_bf16 v[152:155], a[148:151], a[8:11], v[152:155]
  ds_read_b64_tr_b16 a[180:181], v15 offset:49152
  v_mfma_f32_16x16x32_bf16 v[156:159], a[148:151], a[80:83], v[156:159]
  ds_read_b64_tr_b16 a[182:183], v15 offset:49664
  s_waitcnt lgkmcnt(8)
  v_mfma_f32_16x16x32_bf16 v[128:131], a[152:155], a[12:15], v[128:131]
  ds_read_b64_tr_b16 a[184:185], v12 offset:53248
  s_add_u32 m0, s27, 53248
  v_mfma_f32_16x16x32_bf16 v[132:135], a[152:155], a[84:87], v[132:135]
  ds_read_b64_tr_b16 a[186:187], v12 offset:53760
  buffer_load_dwordx4 v21, s[4:7], s24 offen lds
  v_mfma_f32_16x16x32_bf16 v[136:139], a[156:159], a[12:15], v[136:139]
  ds_read_b64_tr_b16 a[188:189], v13 offset:53248
  v_mfma_f32_16x16x32_bf16 v[140:143], a[156:159], a[84:87], v[140:143]
  ds_read_b64_tr_b16 a[190:191], v13 offset:53760
  v_cvt_pk_bf16_f32 v212, v164, v165
  v_mfma_f32_16x16x32_bf16 v[144:147], a[160:163], a[12:15], v[144:147]
  ds_read_b64_tr_b16 a[192:193], v14 offset:53248
  v_cvt_pk_bf16_f32 v213, v166, v167
  v_mfma_f32_16x16x32_bf16 v[148:151], a[160:163], a[84:87], v[148:151]
  ds_read_b64_tr_b16 a[194:195], v14 offset:53760
  v_cvt_pk_bf16_f32 v214, v172, v173
  v_mfma_f32_16x16x32_bf16 v[152:155], a[164:167], a[12:15], v[152:155]
  ds_read_b64_tr_b16 a[196:197], v15 offset:53248
  v_mfma_f32_16x16x32_bf16 v[156:159], a[164:167], a[84:87], v[156:159]
  ds_read_b64_tr_b16 a[198:199], v15 offset:53760
  s_waitcnt vmcnt(17)
  s_barrier
  s_waitcnt lgkmcnt(8)
  v_mfma_f32_16x16x32_bf16 v[128:131], a[168:171], a[16:19], v[128:131]
  ds_read_b64_tr_b16 a[144:145], v12 offset:57344
  s_add_u32 m0, s27, 57344
  v_mfma_f32_16x16x32_bf16 v[132:135], a[168:171], a[88:91], v[132:135]
  ds_read_b64_tr_b16 a[146:147], v12 offset:57856
  s_add_u32 s24, s24, 589824
  v_mfma_f32_16x16x32_bf16 v[136:139], a[172:175], a[16:19], v[136:139]
  ds_read_b64_tr_b16 a[148:149], v13 offset:57344
  buffer_load_dwordx4 v20, s[4:7], s24 offen lds
  v_mfma_f32_16x16x32_bf16 v[140:143], a[172:175], a[88:91], v[140:143]
  ds_read_b64_tr_b16 a[150:151], v13 offset:57856
  v_cvt_pk_bf16_f32 v215, v174, v175
  v_mfma_f32_16x16x32_bf16 v[144:147], a[176:179], a[16:19], v[144:147]
  ds_read_b64_tr_b16 a[152:153], v14 offset:57344
  v_pk_max_i16 v212, v212, 0
  v_mfma_f32_16x16x32_bf16 v[148:151], a[176:179], a[88:91], v[148:151]
  ds_read_b64_tr_b16 a[154:155], v14 offset:57856
  v_pk_max_i16 v213, v213, 0
  v_mfma_f32_16x16x32_bf16 v[152:155], a[180:183], a[16:19], v[152:155]
  ds_read_b64_tr_b16 a[156:157], v15 offset:57344
  v_mfma_f32_16x16x32_bf16 v[156:159], a[180:183], a[88:91], v[156:159]
  ds_read_b64_tr_b16 a[158:159], v15 offset:57856
  s_waitcnt lgkmcnt(8)
  v_mfma_f32_16x16x32_bf16 v[128:131], a[184:187], a[20:23], v[128:131]
  ds_read_b64_tr_b16 a[160:161], v12 offset:61440
  s_add_u32 m0, s27, 61440
  v_mfma_f32_16x16x32_bf16 v[132:135], a[184:187], a[92:95], v[132:135]
  ds_read_b64_tr_b16 a[162:163], v12 offset:61952
  buffer_load_dwordx4 v21, s[4:7], s24 offen lds
  v_mfma_f32_16x16x32_bf16 v[136:139], a[188:191], a[20:23], v[136:139]
  ds_read_b64_tr_b16 a[164:165], v13 offset:61440
  v_mfma_f32_16x16x32_bf16 v[140:143], a[188:191], a[92:95], v[140:143]
  ds_read_b64_tr_b16 a[166:167], v13 offset:61952
  v_pk_max_i16 v214, v214, 0
  v_mfma_f32_16x16x32_bf16 v[144:147], a[192:195], a[20:23], v[144:147]
  ds_read_b64_tr_b16 a[168:169], v14 offset:61440
  v_pk_max_i16 v215, v215, 0
  v_mfma_f32_16x16x32_bf16 v[148:151], a[192:195], a[92:95], v[148:151]
  ds_read_b64_tr_b16 a[170:171], v14 offset:61952
  buffer_store_dwordx4 v[212:215], v2, s[12:15], s30 offen offset:1024 sc0 sc1
  v_mfma_f32_16x16x32_bf16 v[152:155], a[196:199], a[20:23], v[152:155]
  ds_read_b64_tr_b16 a[172:173], v15 offset:61440
  v_mfma_f32_16x16x32_bf16 v[156:159], a[196:199], a[92:95], v[156:159]
  ds_read_b64_tr_b16 a[174:175], v15 offset:61952
  s_waitcnt lgkmcnt(8)
  v_mfma_f32_16x16x32_bf16 v[128:131], a[144:147], a[24:27], v[128:131]
  ds_read_b64_tr_b16 a[176:177], v16 offset:0
  s_add_u32 m0, s27, 65536
  v_mfma_f32_16x16x32_bf16 v[132:135], a[144:147], a[96:99], v[132:135]
  ds_read_b64_tr_b16 a[178:179], v16 offset:512
  s_add_u32 s24, s24, 589824
  v_mfma_f32_16x16x32_bf16 v[136:139], a[148:151], a[24:27], v[136:139]
  ds_read_b64_tr_b16 a[180:181], v17 offset:0
  buffer_load_dwordx4 v20, s[4:7], s24 offen lds
  v_mfma_f32_16x16x32_bf16 v[140:143], a[148:151], a[96:99], v[140:143]
  ds_read_b64_tr_b16 a[182:183], v17 offset:512
  v_cvt_pk_bf16_f32 v216, v176, v177
  v_mfma_f32_16x16x32_bf16 v[144:147], a[152:155], a[24:27], v[144:147]
  ds_read_b64_tr_b16 a[184:185], v18 offset:0
  v_cvt_pk_bf16_f32 v217, v178, v179
  v_mfma_f32_16x16x32_bf16 v[148:151], a[152:155], a[96:99], v[148:151]
  ds_read_b64_tr_b16 a[186:187], v18 offset:512
  v_cvt_pk_bf16_f32 v218, v184, v185
  v_mfma_f32_16x16x32_bf16 v[152:155], a[156:159], a[24:27], v[152:155]
  ds_read_b64_tr_b16 a[188:189], v19 offset:0
  v_mfma_f32_16x16x32_bf16 v[156:159], a[156:159], a[96:99], v[156:159]
  ds_read_b64_tr_b16 a[190:191], v19 offset:512
  s_waitcnt lgkmcnt(8)
  v_mfma_f32_16x16x32_bf16 v[128:131], a[160:163], a[28:31], v[128:131]
  ds_read_b64_tr_b16 a[192:193], v16 offset:4096
  s_add_u32 m0, s27, 69632
  v_mfma_f32_16x16x32_bf16 v[132:135], a[160:163], a[100:103], v[132:135]
  ds_read_b64_tr_b16 a[194:195], v16 offset:4608
  buffer_load_dwordx4 v21, s[4:7], s24 offen lds
  v_mfma_f32_16x16x32_bf16 v[136:139], a[164:167], a[28:31], v[136:139]
  ds_read_b64_tr_b16 a[196:197], v17 offset:4096
  v_mfma_f32_16x16x32_bf16 v[140:143], a[164:167], a[100:103], v[140:143]
  ds_read_b64_tr_b16 a[198:199], v17 offset:4608
  v_cvt_pk_bf16_f32 v219, v186, v187
  v_mfma_f32_16x16x32_bf16 v[144:147], a[168:171], a[28:31], v[144:147]
  ds_read_b64_tr_b16 a[144:145], v18 offset:4096
  v_pk_max_i16 v216, v216, 0
  v_mfma_f32_16x16x32_bf16 v[148:151], a[168:171], a[100:103], v[148:151]
  ds_read_b64_tr_b16 a[146:147], v18 offset:4608
  v_pk_max_i16 v217, v217, 0
  v_mfma_f32_16x16x32_bf16 v[152:155], a[172:175], a[28:31], v[152:155]
  ds_read_b64_tr_b16 a[148:149], v19 offset:4096
  v_mfma_f32_16x16x32_bf16 v[156:159], a[172:175], a[100:103], v[156:159]
  ds_read_b64_tr_b16 a[150:151], v19 offset:4608
  s_waitcnt lgkmcnt(8)
  v_mfma_f32_16x16x32_bf16 v[128:131], a[176:179], a[32:35], v[128:131]
  ds_read_b64_tr_b16 a[152:153], v16 offset:8192
  s_add_u32 m0, s27, 73728
  v_mfma_f32_16x16x32_bf16 v[132:135], a[176:179], a[104:107], v[132:135]
  ds_read_b64_tr_b16 a[154:155], v16 offset:8704
  s_add_u32 s24, s24, 589824
  v_mfma_f32_16x16x32_bf16 v[136:139], a[180:183], a[32:35], v[136:139]
  ds_read_b64_tr_b16 a[156:157], v17 offset:8192
  buffer_load_dwordx4 v20, s[4:7], s24 offen lds
  v_mfma_f32_16x16x32_bf16 v[140:143], a[180:183], a[104:107], v[140:143]
  ds_read_b64_tr_b16 a[158:159], v17 offset:8704
  v_pk_max_i16 v218, v218, 0
  v_mfma_f32_16x16x32_bf16 v[144:147], a[184:187], a[32:35], v[144:147]
  ds_read_b64_tr_b16 a[160:161], v18 offset:8192
  v_pk_max_i16 v219, v219, 0
  v_mfma_f32_16x16x32_bf16 v[148:151], a[184:187], a[104:107], v[148:151]
  ds_read_b64_tr_b16 a[162:163], v18 offset:8704
  buffer_store_dwordx4 v[216:219], v2, s[12:15], s30 offen offset:2048 sc0 sc1
  v_mfma_f32_16x16x32_bf16 v[152:155], a[188:191], a[32:35], v[152:155]
  ds_read_b64_tr_b16 a[164:165], v19 offset:8192
  v_mfma_f32_16x16x32_bf16 v[156:159], a[188:191], a[104:107], v[156:159]
  ds_read_b64_tr_b16 a[166:167], v19 offset:8704
  s_waitcnt lgkmcnt(8)
  v_mfma_f32_16x16x32_bf16 v[128:131], a[192:195], a[36:39], v[128:131]
  ds_read_b64_tr_b16 a[168:169], v16 offset:12288
  s_add_u32 m0, s27, 77824
  v_mfma_f32_16x16x32_bf16 v[132:135], a[192:195], a[108:111], v[132:135]
  ds_read_b64_tr_b16 a[170:171], v16 offset:12800
  buffer_load_dwordx4 v21, s[4:7], s24 offen lds
  v_mfma_f32_16x16x32_bf16 v[136:139], a[196:199], a[36:39], v[136:139]
  ds_read_b64_tr_b16 a[172:173], v17 offset:12288
  v_mfma_f32_16x16x32_bf16 v[140:143], a[196:199], a[108:111], v[140:143]
  ds_read_b64_tr_b16 a[174:175], v17 offset:12800
  v_cvt_pk_bf16_f32 v220, v180, v181
  v_mfma_f32_16x16x32_bf16 v[144:147], a[144:147], a[36:39], v[144:147]
  ds_read_b64_tr_b16 a[176:177], v18 offset:12288
  v_cvt_pk_bf16_f32 v221, v182, v183
  v_mfma_f32_16x16x32_bf16 v[148:151], a[144:147], a[108:111], v[148:151]
  ds_read_b64_tr_b16 a[178:179], v18 offset:12800
  v_cvt_pk_bf16_f32 v222, v188, v189
  v_mfma_f32_16x16x32_bf16 v[152:155], a[148:151], a[36:39], v[152:155]
  ds_read_b64_tr_b16 a[180:181], v19 offset:12288
  v_mfma_f32_16x16x32_bf16 v[156:159], a[148:151], a[108:111], v[156:159]
  ds_read_b64_tr_b16 a[182:183], v19 offset:12800
  s_waitcnt vmcnt(17)
  s_barrier
  s_waitcnt lgkmcnt(8)
  v_mfma_f32_16x16x32_bf16 v[128:131], a[152:155], a[40:43], v[128:131]
  ds_read_b64_tr_b16 a[184:185], v8 offset:0
  s_add_u32 m0, s27, 81920
  v_mfma_f32_16x16x32_bf16 v[132:135], a[152:155], a[112:115], v[132:135]
  ds_read_b64_tr_b16 a[186:187], v8 offset:512
  s_add_u32 s24, s24, 589824
  v_mfma_f32_16x16x32_bf16 v[136:139], a[156:159], a[40:43], v[136:139]
  ds_read_b64_tr_b16 a[188:189], v9 offset:0
  buffer_load_dwordx4 v20, s[4:7], s24 offen lds
  v_mfma_f32_16x16x32_bf16 v[140:143], a[156:159], a[112:115], v[140:143]
  ds_read_b64_tr_b16 a[190:191], v9 offset:512
  v_cvt_pk_bf16_f32 v223, v190, v191
  v_mfma_f32_16x16x32_bf16 v[144:147], a[160:163], a[40:43], v[144:147]
  ds_read_b64_tr_b16 a[192:193], v10 offset:0
  v_pk_max_i16 v220, v220, 0
  v_mfma_f32_16x16x32_bf16 v[148:151], a[160:163], a[112:115], v[148:151]
  ds_read_b64_tr_b16 a[194:195], v10 offset:512
  v_pk_max_i16 v221, v221, 0
  v_mfma_f32_16x16x32_bf16 v[152:155], a[164:167], a[40:43], v[152:155]
  ds_read_b64_tr_b16 a[196:197], v11 offset:0
  v_mfma_f32_16x16x32_bf16 v[156:159], a[164:167], a[112:115], v[156:159]
  ds_read_b64_tr_b16 a[198:199], v11 offset:512
  s_waitcnt lgkmcnt(8)
  v_mfma_f32_16x16x32_bf16 v[128:131], a[168:171], a[44:47], v[128:131]
  ds_read_b64_tr_b16 a[144:145], v8 offset:4096
  s_add_u32 m0, s27, 86016
  v_mfma_f32_16x16x32_bf16 v[132:135], a[168:171], a[116:119], v[132:135]
  ds_read_b64_tr_b16 a[146:147], v8 offset:4608
  buffer_load_dwordx4 v21, s[4:7], s24 offen lds
  v_mfma_f32_16x16x32_bf16 v[136:139], a[172:175], a[44:47], v[136:139]
  ds_read_b64_tr_b16 a[148:149], v9 offset:4096
  v_pk_max_i16 v222, v222, 0
  v_mfma_f32_16x16x32_bf16 v[140:143], a[172:175], a[116:119], v[140:143]
  ds_read_b64_tr_b16 a[150:151], v9 offset:4608
  v_pk_max_i16 v223, v223, 0
  v_mfma_f32_16x16x32_bf16 v[144:147], a[176:179], a[44:47], v[144:147]
  ds_read_b64_tr_b16 a[152:153], v10 offset:4096
  buffer_store_dwordx4 v[220:223], v2, s[12:15], s30 offen offset:3072 sc0 sc1
  v_mfma_f32_16x16x32_bf16 v[148:151], a[176:179], a[116:119], v[148:151]
  ds_read_b64_tr_b16 a[154:155], v10 offset:4608
  s_add_u32 s30, s30, 4096
  v_mfma_f32_16x16x32_bf16 v[152:155], a[180:183], a[44:47], v[152:155]
  ds_read_b64_tr_b16 a[156:157], v11 offset:4096
  v_mfma_f32_16x16x32_bf16 v[156:159], a[180:183], a[116:119], v[156:159]
  ds_read_b64_tr_b16 a[158:159], v11 offset:4608
  s_waitcnt lgkmcnt(8)
  v_mfma_f32_16x16x32_bf16 v[128:131], a[184:187], a[48:51], v[128:131]
  ds_read_b64_tr_b16 a[160:161], v8 offset:8192
  v_lshl_add_u32 v4, s36, 10, v3
  v_mfma_f32_16x16x32_bf16 v[132:135], a[184:187], a[120:123], v[132:135]
  ds_read_b64_tr_b16 a[162:163], v8 offset:8704
  s_add_u32 m0, s27, 90112
  v_mfma_f32_16x16x32_bf16 v[136:139], a[188:191], a[48:51], v[136:139]
  ds_read_b64_tr_b16 a[164:165], v9 offset:8192
  v_mfma_f32_16x16x32_bf16 v[140:143], a[188:191], a[120:123], v[140:143]
  ds_read_b64_tr_b16 a[166:167], v9 offset:8704
  s_add_u32 s24, s24, 589824
  v_mfma_f32_16x16x32_bf16 v[144:147], a[192:195], a[48:51], v[144:147]
  ds_read_b64_tr_b16 a[168:169], v10 offset:8192
  v_mfma_f32_16x16x32_bf16 v[148:151], a[192:195], a[120:123], v[148:151]
  ds_read_b64_tr_b16 a[170:171], v10 offset:8704
  buffer_load_dwordx4 v20, s[4:7], s24 offen lds
  v_mfma_f32_16x16x32_bf16 v[152:155], a[196:199], a[48:51], v[152:155]
  ds_read_b64_tr_b16 a[172:173], v11 offset:8192
  v_mfma_f32_16x16x32_bf16 v[156:159], a[196:199], a[120:123], v[156:159]
  ds_read_b64_tr_b16 a[174:175], v11 offset:8704
  s_waitcnt lgkmcnt(8)
  v_mfma_f32_16x16x32_bf16 v[128:131], a[144:147], a[52:55], v[128:131]
  ds_read_b64_tr_b16 a[176:177], v8 offset:12288
  v_mfma_f32_16x16x32_bf16 v[132:135], a[144:147], a[124:127], v[132:135]
  ds_read_b64_tr_b16 a[178:179], v8 offset:12800
  ds_read_b128 a[200:203], v4 offset:0
  v_mfma_f32_16x16x32_bf16 v[136:139], a[148:151], a[52:55], v[136:139]
  ds_read_b64_tr_b16 a[180:181], v9 offset:12288
  v_mfma_f32_16x16x32_bf16 v[140:143], a[148:151], a[124:127], v[140:143]
  ds_read_b64_tr_b16 a[182:183], v9 offset:12800
  s_add_u32 m0, s27, 94208
  v_mfma_f32_16x16x32_bf16 v[144:147], a[152:155], a[52:55], v[144:147]
  ds_read_b64_tr_b16 a[184:185], v10 offset:12288
  v_mfma_f32_16x16x32_bf16 v[148:151], a[152:155], a[124:127], v[148:151]
  ds_read_b64_tr_b16 a[186:187], v10 offset:12800
  buffer_load_dwordx4 v21, s[4:7], s24 offen lds
  v_mfma_f32_16x16x32_bf16 v[152:155], a[156:159], a[52:55], v[152:155]
  ds_read_b64_tr_b16 a[188:189], v11 offset:12288
  v_mfma_f32_16x16x32_bf16 v[156:159], a[156:159], a[124:127], v[156:159]
  ds_read_b64_tr_b16 a[190:191], v11 offset:12800
  s_waitcnt lgkmcnt(9)
  v_mfma_f32_16x16x32_bf16 v[128:131], a[160:163], a[56:59], v[128:131]
  ds_read_b64_tr_b16 a[192:193], v8 offset:16384
  ds_read_b128 a[204:207], v4 offset:256
  v_mfma_f32_16x16x32_bf16 v[132:135], a[160:163], a[128:131], v[132:135]
  ds_read_b64_tr_b16 a[194:195], v8 offset:16896
  s_add_u32 m0, s27, 98304
  v_mfma_f32_16x16x32_bf16 v[136:139], a[164:167], a[56:59], v[136:139]
  ds_read_b64_tr_b16 a[196:197], v9 offset:16384
  v_mfma_f32_16x16x32_bf16 v[140:143], a[164:167], a[128:131], v[140:143]
  ds_read_b64_tr_b16 a[198:199], v9 offset:16896
  s_add_u32 s24, s56, s65
  v_mfma_f32_16x16x32_bf16 v[144:147], a[168:171], a[56:59], v[144:147]
  ds_read_b64_tr_b16 a[144:145], v10 offset:16384
  v_mfma_f32_16x16x32_bf16 v[148:151], a[168:171], a[128:131], v[148:151]
  ds_read_b64_tr_b16 a[146:147], v10 offset:16896
  buffer_load_dwordx4 v22, s[8:11], s24 offen lds
  v_mfma_f32_16x16x32_bf16 v[152:155], a[172:175], a[56:59], v[152:155]
  ds_read_b64_tr_b16 a[148:149], v11 offset:16384
  v_mfma_f32_16x16x32_bf16 v[156:159], a[172:175], a[128:131], v[156:159]
  ds_read_b64_tr_b16 a[150:151], v11 offset:16896
  s_waitcnt lgkmcnt(9)
  v_mfma_f32_16x16x32_bf16 v[128:131], a[176:179], a[60:63], v[128:131]
  ds_read_b64_tr_b16 a[152:153], v8 offset:20480
  v_mfma_f32_16x16x32_bf16 v[132:135], a[176:179], a[132:135], v[132:135]
  ds_read_b64_tr_b16 a[154:155], v8 offset:20992
  ds_read_b128 a[208:211], v4 offset:512
  v_mfma_f32_16x16x32_bf16 v[136:139], a[180:183], a[60:63], v[136:139]
  ds_read_b64_tr_b16 a[156:157], v9 offset:20480
  v_mfma_f32_16x16x32_bf16 v[140:143], a[180:183], a[132:135], v[140:143]
  ds_read_b64_tr_b16 a[158:159], v9 offset:20992
  s_add_u32 m0, s27, 102400
  v_mfma_f32_16x16x32_bf16 v[144:147], a[184:187], a[60:63], v[144:147]
  ds_read_b64_tr_b16 a[160:161], v10 offset:20480
  v_mfma_f32_16x16x32_bf16 v[148:151], a[184:187], a[132:135], v[148:151]
  ds_read_b64_tr_b16 a[162:163], v10 offset:20992
  buffer_load_dwordx4 v23, s[8:11], s24 offen lds
  v_mfma_f32_16x16x32_bf16 v[152:155], a[188:191], a[60:63], v[152:155]
  ds_read_b64_tr_b16 a[164:165], v11 offset:20480
  v_mfma_f32_16x16x32_bf16 v[156:159], a[188:191], a[132:135], v[156:159]
  ds_read_b64_tr_b16 a[166:167], v11 offset:20992
  s_waitcnt vmcnt(18)
  s_barrier
  s_waitcnt lgkmcnt(9)
  v_mfma_f32_16x16x32_bf16 v[128:131], a[192:195], a[64:67], v[128:131]
  ds_read_b64_tr_b16 a[168:169], v8 offset:24576
  ds_read_b128 a[212:215], v4 offset:768
  v_mfma_f32_16x16x32_bf16 v[132:135], a[192:195], a[136:139], v[132:135]
  ds_read_b64_tr_b16 a[170:171], v8 offset:25088
  s_add_u32 m0, s27, 106496
  v_mfma_f32_16x16x32_bf16 v[136:139], a[196:199], a[64:67], v[136:139]
  ds_read_b64_tr_b16 a[172:173], v9 offset:24576
  v_mfma_f32_16x16x32_bf16 v[140:143], a[196:199], a[136:139], v[140:143]
  ds_read_b64_tr_b16 a[174:175], v9 offset:25088
  s_add_u32 s24, s57, s65
  v_mfma_f32_16x16x32_bf16 v[144:147], a[144:147], a[64:67], v[144:147]
  ds_read_b64_tr_b16 a[176:177], v10 offset:24576
  v_mfma_f32_16x16x32_bf16 v[148:151], a[144:147], a[136:139], v[148:151]
  ds_read_b64_tr_b16 a[178:179], v10 offset:25088
  buffer_load_dwordx4 v22, s[8:11], s24 offen lds
  v_mfma_f32_16x16x32_bf16 v[152:155], a[148:151], a[64:67], v[152:155]
  ds_read_b64_tr_b16 a[180:181], v11 offset:24576
  v_mfma_f32_16x16x32_bf16 v[156:159], a[148:151], a[136:139], v[156:159]
  ds_read_b64_tr_b16 a[182:183], v11 offset:25088
  s_waitcnt lgkmcnt(9)
  v_mfma_f32_16x16x32_bf16 v[128:131], a[152:155], a[68:71], v[128:131]
  ds_read_b64_tr_b16 a[184:185], v8 offset:28672
  v_mfma_f32_16x16x32_bf16 v[132:135], a[152:155], a[140:143], v[132:135]
  ds_read_b64_tr_b16 a[186:187], v8 offset:29184
  s_add_u32 m0, s27, 110592
  v_mfma_f32_16x16x32_bf16 v[136:139], a[156:159], a[68:71], v[136:139]
  ds_read_b64_tr_b16 a[188:189], v9 offset:28672
  v_mfma_f32_16x16x32_bf16 v[140:143], a[156:159], a[140:143], v[140:143]
  ds_read_b64_tr_b16 a[190:191], v9 offset:29184
  v_mfma_f32_16x16x32_bf16 v[144:147], a[160:163], a[68:71], v[144:147]
  ds_read_b64_tr_b16 a[192:193], v10 offset:28672
  v_mfma_f32_16x16x32_bf16 v[148:151], a[160:163], a[140:143], v[148:151]
  ds_read_b64_tr_b16 a[194:195], v10 offset:29184
  buffer_load_dwordx4 v23, s[8:11], s24 offen lds
  v_mfma_f32_16x16x32_bf16 v[152:155], a[164:167], a[68:71], v[152:155]
  ds_read_b64_tr_b16 a[196:197], v11 offset:28672
  v_mfma_f32_16x16x32_bf16 v[156:159], a[164:167], a[140:143], v[156:159]
  ds_read_b64_tr_b16 a[198:199], v11 offset:29184
  v_mfma_f32_16x16x32_bf16 v[128:131], a[200:203], v[24:27], v[128:131]
  v_mfma_f32_16x16x32_bf16 v[132:135], a[200:203], v[28:31], v[132:135]
  v_mfma_f32_16x16x32_bf16 v[136:139], a[204:207], v[24:27], v[136:139]
  v_mfma_f32_16x16x32_bf16 v[140:143], a[204:207], v[28:31], v[140:143]
  v_mfma_f32_16x16x32_bf16 v[144:147], a[208:211], v[24:27], v[144:147]
  v_mfma_f32_16x16x32_bf16 v[148:151], a[208:211], v[28:31], v[148:151]
  s_waitcnt lgkmcnt(14)
  v_mfma_f32_16x16x32_bf16 v[152:155], a[212:215], v[24:27], v[152:155]
  v_mfma_f32_16x16x32_bf16 v[156:159], a[212:215], v[28:31], v[156:159]
  s_waitcnt lgkmcnt(8)
  v_mfma_f32_16x16x32_bf16 v[160:163], a[168:171], a[0:3], 0
  ds_read_b64_tr_b16 a[144:145], v8 offset:32768
  s_add_u32 m0, s27, 114688
  v_mfma_f32_16x16x32_bf16 v[164:167], a[168:171], a[72:75], 0
  ds_read_b64_tr_b16 a[146:147], v8 offset:33280
  s_add_u32 s24, s58, s65
  v_mfma_f32_16x16x32_bf16 v[168:171], a[172:175], a[0:3], 0
  ds_read_b64_tr_b16 a[148:149], v9 offset:32768
  buffer_load_dwordx4 v22, s[8:11], s24 offen lds
  v_mfma_f32_16x16x32_bf16 v[172:175], a[172:175], a[72:75], 0
  ds_read_b64_tr_b16 a[150:151], v9 offset:33280
  v_cvt_pk_bf16_f32 v224, v128, v129
  v_mfma_f32_16x16x32_bf16 v[176:179], a[176:179], a[0:3], 0
  ds_read_b64_tr_b16 a[152:153], v10 offset:32768
  v_cvt_pk_bf16_f32 v225, v130, v131
  v_mfma_f32_16x16x32_bf16 v[180:183], a[176:179], a[72:75], 0
  ds_read_b64_tr_b16 a[154:155], v10 offset:33280
  v_cvt_pk_bf16_f32 v226, v136, v137
  v_mfma_f32_16x16x32_bf16 v[184:187], a[180:183], a[0:3], 0
  ds_read_b64_tr_b16 a[156:157], v11 offset:32768
  v_mfma_f32_16x16x32_bf16 v[188:191], a[180:183], a[72:75], 0
  ds_read_b64_tr_b16 a[158:159], v11 offset:33280
  s_waitcnt lgkmcnt(8)
  v_mfma_f32_16x16x32_bf16 v[160:163], a[184:187], a[4:7], v[160:163]
  ds_read_b64_tr_b16 a[160:161], v8 offset:36864
  s_add_u32 m0, s27, 118784
  v_mfma_f32_16x16x32_bf16 v[164:167], a[184:187], a[76:79], v[164:167]
  ds_read_b64_tr_b16 a[162:163], v8 offset:37376
  buffer_load_dwordx4 v23, s[8:11], s24 offen lds
  v_mfma_f32_16x16x32_bf16 v[168:171], a[188:191], a[4:7], v[168:171]
  ds_read_b64_tr_b16 a[164:165], v9 offset:36864
  v_mfma_f32_16x16x32_bf16 v[172:175], a[188:191], a[76:79], v[172:175]
  ds_read_b64_tr_b16 a[166:167], v9 offset:37376
  v_cvt_pk_bf16_f32 v227, v138, v139
  v_mfma_f32_16x16x32_bf16 v[176:179], a[192:195], a[4:7], v[176:179]
  ds_read_b64_tr_b16 a[168:169], v10 offset:36864
  v_pk_max_i16 v224, v224, 0
  v_mfma_f32_16x16x32_bf16 v[180:183], a[192:195], a[76:79], v[180:183]
  ds_read_b64_tr_b16 a[170:171], v10 offset:37376
  v_pk_max_i16 v225, v225, 0
  v_mfma_f32_16x16x32_bf16 v[184:187], a[196:199], a[4:7], v[184:187]
  ds_read_b64_tr_b16 a[172:173], v11 offset:36864
  v_mfma_f32_16x16x32_bf16 v[188:191], a[196:199], a[76:79], v[188:191]
  ds_read_b64_tr_b16 a[174:175], v11 offset:37376
  s_waitcnt lgkmcnt(8)
  v_mfma_f32_16x16x32_bf16 v[160:163], a[144:147], a[8:11], v[160:163]
  ds_read_b64_tr_b16 a[176:177], v8 offset:40960
  s_add_u32 m0, s27, 122880
  v_mfma_f32_16x16x32_bf16 v[164:167], a[144:147], a[80:83], v[164:167]
  ds_read_b64_tr_b16 a[178:179], v8 offset:41472
  s_add_u32 s24, s59, s65
  v_mfma_f32_16x16x32_bf16 v[168:171], a[148:151], a[8:11], v[168:171]
  ds_read_b64_tr_b16 a[180:181], v9 offset:40960
  buffer_load_dwordx4 v22, s[8:11], s24 offen lds
  v_mfma_f32_16x16x32_bf16 v[172:175], a[148:151], a[80:83], v[172:175]
  ds_read_b64_tr_b16 a[182:183], v9 offset:41472
  v_pk_max_i16 v226, v226, 0
  v_mfma_f32_16x16x32_bf16 v[176:179], a[152:155], a[8:11], v[176:179]
  ds_read_b64_tr_b16 a[184:185], v10 offset:40960
  v_pk_max_i16 v227, v227, 0
  v_mfma_f32_16x16x32_bf16 v[180:183], a[152:155], a[80:83], v[180:183]
  ds_read_b64_tr_b16 a[186:187], v10 offset:41472
  buffer_store_dwordx4 v[224:227], v2, s[12:15], s30 offen offset:0 sc0 sc1
  v_mfma_f32_16x16x32_bf16 v[184:187], a[156:159], a[8:11], v[184:187]
  ds_read_b64_tr_b16 a[188:189], v11 offset:40960
  v_mfma_f32_16x16x32_bf16 v[188:191], a[156:159], a[80:83], v[188:191]
  ds_read_b64_tr_b16 a[190:191], v11 offset:41472
  s_waitcnt lgkmcnt(8)
  v_mfma_f32_16x16x32_bf16 v[160:163], a[160:163], a[12:15], v[160:163]
  ds_read_b64_tr_b16 a[192:193], v8 offset:45056
  s_add_u32 m0, s27, 126976
  v_mfma_f32_16x16x32_bf16 v[164:167], a[160:163], a[84:87], v[164:167]
  ds_read_b64_tr_b16 a[194:195], v8 offset:45568
  buffer_load_dwordx4 v23, s[8:11], s24 offen lds
  v_mfma_f32_16x16x32_bf16 v[168:171], a[164:167], a[12:15], v[168:171]
  ds_read_b64_tr_b16 a[196:197], v9 offset:45056
  v_mfma_f32_16x16x32_bf16 v[172:175], a[164:167], a[84:87], v[172:175]
  ds_read_b64_tr_b16 a[198:199], v9 offset:45568
  v_cvt_pk_bf16_f32 v228, v132, v133
  v_mfma_f32_16x16x32_bf16 v[176:179], a[168:171], a[12:15], v[176:179]
  ds_read_b64_tr_b16 a[144:145], v10 offset:45056
  v_cvt_pk_bf16_f32 v229, v134, v135
  v_mfma_f32_16x16x32_bf16 v[180:183], a[168:171], a[84:87], v[180:183]
  ds_read_b64_tr_b16 a[146:147], v10 offset:45568
  v_cvt_pk_bf16_f32 v230, v140, v141
  v_mfma_f32_16x16x32_bf16 v[184:187], a[172:175], a[12:15], v[184:187]
  ds_read_b64_tr_b16 a[148:149], v11 offset:45056
  v_mfma_f32_16x16x32_bf16 v[188:191], a[172:175], a[84:87], v[188:191]
  ds_read_b64_tr_b16 a[150:151], v11 offset:45568
  s_waitcnt vmcnt(17)
  s_barrier
  s_waitcnt lgkmcnt(8)
  v_mfma_f32_16x16x32_bf16 v[160:163], a[176:179], a[16:19], v[160:163]
  ds_read_b64_tr_b16 a[152:153], v8 offset:49152
  s_add_u32 m0, s27, 131072
  v_mfma_f32_16x16x32_bf16 v[164:167], a[176:179], a[88:91], v[164:167]
  ds_read_b64_tr_b16 a[154:155], v8 offset:49664
  s_add_u32 s24, s56, s66
  v_mfma_f32_16x16x32_bf16 v[168:171], a[180:183], a[16:19], v[168:171]
  ds_read_b64_tr_b16 a[156:157], v9 offset:49152
  buffer_load_dwordx4 v22, s[8:11], s24 offen lds
  v_mfma_f32_16x16x32_bf16 v[172:175], a[180:183], a[88:91], v[172:175]
  ds_read_b64_tr_b16 a[158:159], v9 offset:49664
  v_cvt_pk_bf16_f32 v231, v142, v143
  v_mfma_f32_16x16x32_bf16 v[176:179], a[184:187], a[16:19], v[176:179]
  ds_read_b64_tr_b16 a[160:161], v10 offset:49152
  v_pk_max_i16 v228, v228, 0
  v_mfma_f32_16x16x32_bf16 v[180:183], a[184:187], a[88:91], v[180:183]
  ds_read_b64_tr_b16 a[162:163], v10 offset:49664
  v_pk_max_i16 v229, v229, 0
  v_mfma_f32_16x16x32_bf16 v[184:187], a[188:191], a[16:19], v[184:187]
  ds_read_b64_tr_b16 a[164:165], v11 offset:49152
  v_mfma_f32_16x16x32_bf16 v[188:191], a[188:191], a[88:91], v[188:191]
  ds_read_b64_tr_b16 a[166:167], v11 offset:49664
  s_waitcnt lgkmcnt(8)
  v_mfma_f32_16x16x32_bf16 v[160:163], a[192:195], a[20:23], v[160:163]
  ds_read_b64_tr_b16 a[168:169], v8 offset:53248
  s_add_u32 m0, s27, 135168
  v_mfma_f32_16x16x32_bf16 v[164:167], a[192:195], a[92:95], v[164:167]
  ds_read_b64_tr_b16 a[170:171], v8 offset:53760
  buffer_load_dwordx4 v23, s[8:11], s24 offen lds
  v_mfma_f32_16x16x32_bf16 v[168:171], a[196:199], a[20:23], v[168:171]
  ds_read_b64_tr_b16 a[172:173], v9 offset:53248
  v_mfma_f32_16x16x32_bf16 v[172:175], a[196:199], a[92:95], v[172:175]
  ds_read_b64_tr_b16 a[174:175], v9 offset:53760
  v_pk_max_i16 v230, v230, 0
  v_mfma_f32_16x16x32_bf16 v[176:179], a[144:147], a[20:23], v[176:179]
  ds_read_b64_tr_b16 a[176:177], v10 offset:53248
  v_pk_max_i16 v231, v231, 0
  v_mfma_f32_16x16x32_bf16 v[180:183], a[144:147], a[92:95], v[180:183]
  ds_read_b64_tr_b16 a[178:179], v10 offset:53760
  buffer_store_dwordx4 v[228:231], v2, s[12:15], s30 offen offset:1024 sc0 sc1
  v_mfma_f32_16x16x32_bf16 v[184:187], a[148:151], a[20:23], v[184:187]
  ds_read_b64_tr_b16 a[180:181], v11 offset:53248
  v_mfma_f32_16x16x32_bf16 v[188:191], a[148:151], a[92:95], v[188:191]
  ds_read_b64_tr_b16 a[182:183], v11 offset:53760
  s_waitcnt lgkmcnt(8)
  v_mfma_f32_16x16x32_bf16 v[160:163], a[152:155], a[24:27], v[160:163]
  ds_read_b64_tr_b16 a[184:185], v8 offset:57344
  s_add_u32 m0, s27, 139264
  v_mfma_f32_16x16x32_bf16 v[164:167], a[152:155], a[96:99], v[164:167]
  ds_read_b64_tr_b16 a[186:187], v8 offset:57856
  s_add_u32 s24, s57, s66
  v_mfma_f32_16x16x32_bf16 v[168:171], a[156:159], a[24:27], v[168:171]
  ds_read_b64_tr_b16 a[188:189], v9 offset:57344
  buffer_load_dwordx4 v22, s[8:11], s24 offen lds
  v_mfma_f32_16x16x32_bf16 v[172:175], a[156:159], a[96:99], v[172:175]
  ds_read_b64_tr_b16 a[190:191], v9 offset:57856
  v_cvt_pk_bf16_f32 v232, v144, v145
  v_mfma_f32_16x16x32_bf16 v[176:179], a[160:163], a[24:27], v[176:179]
  ds_read_b64_tr_b16 a[192:193], v10 offset:57344
  v_cvt_pk_bf16_f32 v233, v146, v147
  v_mfma_f32_16x16x32_bf16 v[180:183], a[160:163], a[96:99], v[180:183]
  ds_read_b64_tr_b16 a[194:195], v10 offset:57856
  v_cvt_pk_bf16_f32 v234, v152, v153
  v_mfma_f32_16x16x32_bf16 v[184:187], a[164:167], a[24:27], v[184:187]
  ds_read_b64_tr_b16 a[196:197], v11 offset:57344
  v_mfma_f32_16x16x32_bf16 v[188:191], a[164:167], a[96:99], v[188:191]
  ds_read_b64_tr_b16 a[198:199], v11 offset:57856
  s_waitcnt lgkmcnt(8)
  v_mfma_f32_16x16x32_bf16 v[160:163], a[168:171], a[28:31], v[160:163]
  ds_read_b64_tr_b16 a[144:145], v8 offset:61440
  s_add_u32 m0, s27, 143360
  v_mfma_f32_16x16x32_bf16 v[164:167], a[168:171], a[100:103], v[164:167]
  ds_read_b64_tr_b16 a[146:147], v8 offset:61952
  buffer_load_dwordx4 v23, s[8:11], s24 offen lds
  v_mfma_f32_16x16x32_bf16 v[168:171], a[172:175], a[28:31], v[168:171]
  ds_read_b64_tr_b16 a[148:149], v9 offset:61440
  v_mfma_f32_16x16x32_bf16 v[172:175], a[172:175], a[100:103], v[172:175]
  ds_read_b64_tr_b16 a[150:151], v9 offset:61952
  v_cvt_pk_bf16_f32 v235, v154, v155
  v_mfma_f32_16x16x32_bf16 v[176:179], a[176:179], a[28:31], v[176:179]
  ds_read_b64_tr_b16 a[152:153], v10 offset:61440
  v_pk_max_i16 v232, v232, 0
  v_mfma_f32_16x16x32_bf16 v[180:183], a[176:179], a[100:103], v[180:183]
  ds_read_b64_tr_b16 a[154:155], v10 offset:61952
  v_pk_max_i16 v233, v233, 0
  v_mfma_f32_16x16x32_bf16 v[184:187], a[180:183], a[28:31], v[184:187]
  ds_read_b64_tr_b16 a[156:157], v11 offset:61440
  v_mfma_f32_16x16x32_bf16 v[188:191], a[180:183], a[100:103], v[188:191]
  ds_read_b64_tr_b16 a[158:159], v11 offset:61952
  s_waitcnt lgkmcnt(8)
  v_mfma_f32_16x16x32_bf16 v[160:163], a[184:187], a[32:35], v[160:163]
  ds_read_b64_tr_b16 a[160:161], v12 offset:0
  s_add_u32 m0, s27, 0
  v_mfma_f32_16x16x32_bf16 v[164:167], a[184:187], a[104:107], v[164:167]
  ds_read_b64_tr_b16 a[162:163], v12 offset:512
  s_add_u32 s24, s58, s66
  v_mfma_f32_16x16x32_bf16 v[168:171], a[188:191], a[32:35], v[168:171]
  ds_read_b64_tr_b16 a[164:165], v13 offset:0
  buffer_load_dwordx4 v22, s[8:11], s24 offen lds
  v_mfma_f32_16x16x32_bf16 v[172:175], a[188:191], a[104:107], v[172:175]
  ds_read_b64_tr_b16 a[166:167], v13 offset:512
  v_pk_max_i16 v234, v234, 0
  v_mfma_f32_16x16x32_bf16 v[176:179], a[192:195], a[32:35], v[176:179]
  ds_read_b64_tr_b16 a[168:169], v14 offset:0
  v_pk_max_i16 v235, v235, 0
  v_mfma_f32_16x16x32_bf16 v[180:183], a[192:195], a[104:107], v[180:183]
  ds_read_b64_tr_b16 a[170:171], v14 offset:512
  buffer_store_dwordx4 v[232:235], v2, s[12:15], s30 offen offset:2048 sc0 sc1
  v_mfma_f32_16x16x32_bf16 v[184:187], a[196:199], a[32:35], v[184:187]
  ds_read_b64_tr_b16 a[172:173], v15 offset:0
  v_mfma_f32_16x16x32_bf16 v[188:191], a[196:199], a[104:107], v[188:191]
  ds_read_b64_tr_b16 a[174:175], v15 offset:512
  s_waitcnt lgkmcnt(8)
  v_mfma_f32_16x16x32_bf16 v[160:163], a[144:147], a[36:39], v[160:163]
  ds_read_b64_tr_b16 a[176:177], v12 offset:4096
  s_add_u32 m0, s27, 4096
  v_mfma_f32_16x16x32_bf16 v[164:167], a[144:147], a[108:111], v[164:167]
  ds_read_b64_tr_b16 a[178:179], v12 offset:4608
  buffer_load_dwordx4 v23, s[8:11], s24 offen lds
  v_mfma_f32_16x16x32_bf16 v[168:171], a[148:151], a[36:39], v[168:171]
  ds_read_b64_tr_b16 a[180:181], v13 offset:4096
  v_mfma_f32_16x16x32_bf16 v[172:175], a[148:151], a[108:111], v[172:175]
  ds_read_b64_tr_b16 a[182:183], v13 offset:4608
  v_cvt_pk_bf16_f32 v236, v148, v149
  v_mfma_f32_16x16x32_bf16 v[176:179], a[152:155], a[36:39], v[176:179]
  ds_read_b64_tr_b16 a[184:185], v14 offset:4096
  v_cvt_pk_bf16_f32 v237, v150, v151
  v_mfma_f32_16x16x32_bf16 v[180:183], a[152:155], a[108:111], v[180:183]
  ds_read_b64_tr_b16 a[186:187], v14 offset:4608
  v_cvt_pk_bf16_f32 v238, v156, v157
  v_mfma_f32_16x16x32_bf16 v[184:187], a[156:159], a[36:39], v[184:187]
  ds_read_b64_tr_b16 a[188:189], v15 offset:4096
  v_mfma_f32_16x16x32_bf16 v[188:191], a[156:159], a[108:111], v[188:191]
  ds_read_b64_tr_b16 a[190:191], v15 offset:4608
  s_waitcnt vmcnt(17)
  s_barrier
  s_waitcnt lgkmcnt(8)
  v_mfma_f32_16x16x32_bf16 v[160:163], a[160:163], a[40:43], v[160:163]
  ds_read_b64_tr_b16 a[192:193], v12 offset:8192
  s_add_u32 m0, s27, 8192
  v_mfma_f32_16x16x32_bf16 v[164:167], a[160:163], a[112:115], v[164:167]
  ds_read_b64_tr_b16 a[194:195], v12 offset:8704
  s_add_u32 s24, s59, s66
  v_mfma_f32_16x16x32_bf16 v[168:171], a[164:167], a[40:43], v[168:171]
  ds_read_b64_tr_b16 a[196:197], v13 offset:8192
  buffer_load_dwordx4 v22, s[8:11], s24 offen lds
  v_mfma_f32_16x16x32_bf16 v[172:175], a[164:167], a[112:115], v[172:175]
  ds_read_b64_tr_b16 a[198:199], v13 offset:8704
  v_cvt_pk_bf16_f32 v239, v158, v159
  v_mfma_f32_16x16x32_bf16 v[176:179], a[168:171], a[40:43], v[176:179]
  ds_read_b64_tr_b16 a[144:145], v14 offset:8192
  v_pk_max_i16 v236, v236, 0
  v_mfma_f32_16x16x32_bf16 v[180:183], a[168:171], a[112:115], v[180:183]
  ds_read_b64_tr_b16 a[146:147], v14 offset:8704
  v_pk_max_i16 v237, v237, 0
  v_mfma_f32_16x16x32_bf16 v[184:187], a[172:175], a[40:43], v[184:187]
  ds_read_b64_tr_b16 a[148:149], v15 offset:8192
  v_mfma_f32_16x16x32_bf16 v[188:191], a[172:175], a[112:115], v[188:191]
  ds_read_b64_tr_b16 a[150:151], v15 offset:8704
  s_waitcnt lgkmcnt(8)
  v_mfma_f32_16x16x32_bf16 v[160:163], a[176:179], a[44:47], v[160:163]
  ds_read_b64_tr_b16 a[152:153], v12 offset:12288
  s_add_u32 m0, s27, 12288
  v_mfma_f32_16x16x32_bf16 v[164:167], a[176:179], a[116:119], v[164:167]
  ds_read_b64_tr_b16 a[154:155], v12 offset:12800
  buffer_load_dwordx4 v23, s[8:11], s24 offen lds
  v_mfma_f32_16x16x32_bf16 v[168:171], a[180:183], a[44:47], v[168:171]
  ds_read_b64_tr_b16 a[156:157], v13 offset:12288
  v_pk_max_i16 v238, v238, 0
  v_mfma_f32_16x16x32_bf16 v[172:175], a[180:183], a[116:119], v[172:175]
  ds_read_b64_tr_b16 a[158:159], v13 offset:12800
  v_pk_max_i16 v239, v239, 0
  v_mfma_f32_16x16x32_bf16 v[176:179], a[184:187], a[44:47], v[176:179]
  ds_read_b64_tr_b16 a[160:161], v14 offset:12288
  buffer_store_dwordx4 v[236:239], v2, s[12:15], s30 offen offset:3072 sc0 sc1
  v_mfma_f32_16x16x32_bf16 v[180:183], a[184:187], a[116:119], v[180:183]
  ds_read_b64_tr_b16 a[162:163], v14 offset:12800
  s_add_u32 s30, s30, 4096
  v_mfma_f32_16x16x32_bf16 v[184:187], a[188:191], a[44:47], v[184:187]
  ds_read_b64_tr_b16 a[164:165], v15 offset:12288
  v_mfma_f32_16x16x32_bf16 v[188:191], a[188:191], a[116:119], v[188:191]
  ds_read_b64_tr_b16 a[166:167], v15 offset:12800
  s_waitcnt lgkmcnt(8)
  v_mfma_f32_16x16x32_bf16 v[160:163], a[192:195], a[48:51], v[160:163]
  ds_read_b64_tr_b16 a[168:169], v12 offset:16384
  v_lshl_add_u32 v4, s37, 10, v3
  v_mfma_f32_16x16x32_bf16 v[164:167], a[192:195], a[120:123], v[164:167]
  ds_read_b64_tr_b16 a[170:171], v12 offset:16896
  s_add_u32 m0, s27, 16384
  v_mfma_f32_16x16x32_bf16 v[168:171], a[196:199], a[48:51], v[168:171]
  ds_read_b64_tr_b16 a[172:173], v13 offset:16384
  v_mfma_f32_16x16x32_bf16 v[172:175], a[196:199], a[120:123], v[172:175]
  ds_read_b64_tr_b16 a[174:175], v13 offset:16896
  s_add_u32 s24, s56, s67
  v_mfma_f32_16x16x32_bf16 v[176:179], a[144:147], a[48:51], v[176:179]
  ds_read_b64_tr_b16 a[176:177], v14 offset:16384
  v_mfma_f32_16x16x32_bf16 v[180:183], a[144:147], a[120:123], v[180:183]
  ds_read_b64_tr_b16 a[178:179], v14 offset:16896
  buffer_load_dwordx4 v22, s[8:11], s24 offen lds
  v_mfma_f32_16x16x32_bf16 v[184:187], a[148:151], a[48:51], v[184:187]
  ds_read_b64_tr_b16 a[180:181], v15 offset:16384
  v_mfma_f32_16x16x32_bf16 v[188:191], a[148:151], a[120:123], v[188:191]
  ds_read_b64_tr_b16 a[182:183], v15 offset:16896
  s_waitcnt lgkmcnt(8)
  v_mfma_f32_16x16x32_bf16 v[160:163], a[152:155], a[52:55], v[160:163]
  ds_read_b64_tr_b16 a[184:185], v12 offset:20480
  v_mfma_f32_16x16x32_bf16 v[164:167], a[152:155], a[124:127], v[164:167]
  ds_read_b64_tr_b16 a[186:187], v12 offset:20992
  ds_read_b128 a[200:203], v4 offset:0
  v_mfma_f32_16x16x32_bf16 v[168:171], a[156:159], a[52:55], v[168:171]
  ds_read_b64_tr_b16 a[188:189], v13 offset:20480
  v_mfma_f32_16x16x32_bf16 v[172:175], a[156:159], a[124:127], v[172:175]
  ds_read_b64_tr_b16 a[190:191], v13 offset:20992
  s_add_u32 m0, s27, 20480
  v_mfma_f32_16x16x32_bf16 v[176:179], a[160:163], a[52:55], v[176:179]
  ds_read_b64_tr_b16 a[192:193], v14 offset:20480
  v_mfma_f32_16x16x32_bf16 v[180:183], a[160:163], a[124:127], v[180:183]
  ds_read_b64_tr_b16 a[194:195], v14 offset:20992
  buffer_load_dwordx4 v23, s[8:11], s24 offen lds
  v_mfma_f32_16x16x32_bf16 v[184:187], a[164:167], a[52:55], v[184:187]
  ds_read_b64_tr_b16 a[196:197], v15 offset:20480
  v_mfma_f32_16x16x32_bf16 v[188:191], a[164:167], a[124:127], v[188:191]
  ds_read_b64_tr_b16 a[198:199], v15 offset:20992
  s_waitcnt lgkmcnt(9)
  v_mfma_f32_16x16x32_bf16 v[160:163], a[168:171], a[56:59], v[160:163]
  ds_read_b64_tr_b16 a[144:145], v12 offset:24576
  ds_read_b128 a[204:207], v4 offset:256
  v_mfma_f32_16x16x32_bf16 v[164:167], a[168:171], a[128:131], v[164:167]
  ds_read_b64_tr_b16 a[146:147], v12 offset:25088
  s_add_u32 m0, s27, 24576
  v_mfma_f32_16x16x32_bf16 v[168:171], a[172:175], a[56:59], v[168:171]
  ds_read_b64_tr_b16 a[148:149], v13 offset:24576
  v_mfma_f32_16x16x32_bf16 v[172:175], a[172:175], a[128:131], v[172:175]
  ds_read_b64_tr_b16 a[150:151], v13 offset:25088
  s_add_u32 s24, s57, s67
  v_mfma_f32_16x16x32_bf16 v[176:179], a[176:179], a[56:59], v[176:179]
  ds_read_b64_tr_b16 a[152:153], v14 offset:24576
  v_mfma_f32_16x16x32_bf16 v[180:183], a[176:179], a[128:131], v[180:183]
  ds_read_b64_tr_b16 a[154:155], v14 offset:25088
  buffer_load_dwordx4 v22, s[8:11], s24 offen lds
  v_mfma_f32_16x16x32_bf16 v[184:187], a[180:183], a[56:59], v[184:187]
  ds_read_b64_tr_b16 a[156:157], v15 offset:24576
  v_mfma_f32_16x16x32_bf16 v[188:191], a[180:183], a[128:131], v[188:191]
  ds_read_b64_tr_b16 a[158:159], v15 offset:25088
  s_waitcnt lgkmcnt(9)
  v_mfma_f32_16x16x32_bf16 v[160:163], a[184:187], a[60:63], v[160:163]
  ds_read_b64_tr_b16 a[160:161], v12 offset:28672
  v_mfma_f32_16x16x32_bf16 v[164:167], a[184:187], a[132:135], v[164:167]
  ds_read_b64_tr_b16 a[162:163], v12 offset:29184
  ds_read_b128 a[208:211], v4 offset:512
  v_mfma_f32_16x16x32_bf16 v[168:171], a[188:191], a[60:63], v[168:171]
  ds_read_b64_tr_b16 a[164:165], v13 offset:28672
  v_mfma_f32_16x16x32_bf16 v[172:175], a[188:191], a[132:135], v[172:175]
  ds_read_b64_tr_b16 a[166:167], v13 offset:29184
  s_add_u32 m0, s27, 28672
  v_mfma_f32_16x16x32_bf16 v[176:179], a[192:195], a[60:63], v[176:179]
  ds_read_b64_tr_b16 a[168:169], v14 offset:28672
  v_mfma_f32_16x16x32_bf16 v[180:183], a[192:195], a[132:135], v[180:183]
  ds_read_b64_tr_b16 a[170:171], v14 offset:29184
  buffer_load_dwordx4 v23, s[8:11], s24 offen lds
  v_mfma_f32_16x16x32_bf16 v[184:187], a[196:199], a[60:63], v[184:187]
  ds_read_b64_tr_b16 a[172:173], v15 offset:28672
  v_mfma_f32_16x16x32_bf16 v[188:191], a[196:199], a[132:135], v[188:191]
  ds_read_b64_tr_b16 a[174:175], v15 offset:29184
  s_waitcnt vmcnt(18)
  s_barrier
  s_waitcnt lgkmcnt(9)
  v_mfma_f32_16x16x32_bf16 v[160:163], a[144:147], a[64:67], v[160:163]
  ds_read_b64_tr_b16 a[176:177], v12 offset:32768
  ds_read_b128 a[212:215], v4 offset:768
  v_mfma_f32_16x16x32_bf16 v[164:167], a[144:147], a[136:139], v[164:167]
  ds_read_b64_tr_b16 a[178:179], v12 offset:33280
  s_add_u32 m0, s27, 32768
  v_mfma_f32_16x16x32_bf16 v[168:171], a[148:151], a[64:67], v[168:171]
  ds_read_b64_tr_b16 a[180:181], v13 offset:32768
  v_mfma_f32_16x16x32_bf16 v[172:175], a[148:151], a[136:139], v[172:175]
  ds_read_b64_tr_b16 a[182:183], v13 offset:33280
  s_add_u32 s24, s58, s67
  v_mfma_f32_16x16x32_bf16 v[176:179], a[152:155], a[64:67], v[176:179]
  ds_read_b64_tr_b16 a[184:185], v14 offset:32768
  v_mfma_f32_16x16x32_bf16 v[180:183], a[152:155], a[136:139], v[180:183]
  ds_read_b64_tr_b16 a[186:187], v14 offset:33280
  buffer_load_dwordx4 v22, s[8:11], s24 offen lds
  v_mfma_f32_16x16x32_bf16 v[184:187], a[156:159], a[64:67], v[184:187]
  ds_read_b64_tr_b16 a[188:189], v15 offset:32768
  v_mfma_f32_16x16x32_bf16 v[188:191], a[156:159], a[136:139], v[188:191]
  ds_read_b64_tr_b16 a[190:191], v15 offset:33280
  s_waitcnt lgkmcnt(9)
  v_mfma_f32_16x16x32_bf16 v[160:163], a[160:163], a[68:71], v[160:163]
  ds_read_b64_tr_b16 a[192:193], v12 offset:36864
  v_mfma_f32_16x16x32_bf16 v[164:167], a[160:163], a[140:143], v[164:167]
  ds_read_b64_tr_b16 a[194:195], v12 offset:37376
  s_add_u32 m0, s27, 36864
  v_mfma_f32_16x16x32_bf16 v[168:171], a[164:167], a[68:71], v[168:171]
  ds_read_b64_tr_b16 a[196:197], v13 offset:36864
  v_mfma_f32_16x16x32_bf16 v[172:175], a[164:167], a[140:143], v[172:175]
  ds_read_b64_tr_b16 a[198:199], v13 offset:37376
  v_mfma_f32_16x16x32_bf16 v[176:179], a[168:171], a[68:71], v[176:179]
  ds_read_b64_tr_b16 a[144:145], v14 offset:36864
  v_mfma_f32_16x16x32_bf16 v[180:183], a[168:171], a[140:143], v[180:183]
  ds_read_b64_tr_b16 a[146:147], v14 offset:37376
  buffer_load_dwordx4 v23, s[8:11], s24 offen lds
  v_mfma_f32_16x16x32_bf16 v[184:187], a[172:175], a[68:71], v[184:187]
  ds_read_b64_tr_b16 a[148:149], v15 offset:36864
  v_mfma_f32_16x16x32_bf16 v[188:191], a[172:175], a[140:143], v[188:191]
  ds_read_b64_tr_b16 a[150:151], v15 offset:37376
  v_mfma_f32_16x16x32_bf16 v[160:163], a[200:203], v[24:27], v[160:163]
  v_mfma_f32_16x16x32_bf16 v[164:167], a[200:203], v[28:31], v[164:167]
  v_mfma_f32_16x16x32_bf16 v[168:171], a[204:207], v[24:27], v[168:171]
  v_mfma_f32_16x16x32_bf16 v[172:175], a[204:207], v[28:31], v[172:175]
  v_mfma_f32_16x16x32_bf16 v[176:179], a[208:211], v[24:27], v[176:179]
  v_mfma_f32_16x16x32_bf16 v[180:183], a[208:211], v[28:31], v[180:183]
  s_waitcnt lgkmcnt(14)
  v_mfma_f32_16x16x32_bf16 v[184:187], a[212:215], v[24:27], v[184:187]
  v_mfma_f32_16x16x32_bf16 v[188:191], a[212:215], v[28:31], v[188:191]
  s_waitcnt lgkmcnt(8)
  v_mfma_f32_16x16x32_bf16 v[32:35], a[176:179], v[192:195], 0
  ds_read_b64_tr_b16 a[152:153], v12 offset:40960
  s_add_u32 m0, s27, 40960
  v_mfma_f32_16x16x32_bf16 v[36:39], a[176:179], v[196:199], 0
  ds_read_b64_tr_b16 a[154:155], v12 offset:41472
  s_add_u32 s24, s59, s67
  buffer_load_dwordx4 v22, s[8:11], s24 offen lds
  v_mfma_f32_16x16x32_bf16 v[40:43], a[180:183], v[192:195], 0
  ds_read_b64_tr_b16 a[156:157], v13 offset:40960
  v_cvt_pk_bf16_f32 v240, v160, v161
  v_mfma_f32_16x16x32_bf16 v[44:47], a[180:183], v[196:199], 0
  ds_read_b64_tr_b16 a[158:159], v13 offset:41472
  v_cvt_pk_bf16_f32 v241, v162, v163
  v_mfma_f32_16x16x32_bf16 v[48:51], a[184:187], v[192:195], 0
  ds_read_b64_tr_b16 a[160:161], v14 offset:40960
  v_cvt_pk_bf16_f32 v242, v168, v169
  v_mfma_f32_16x16x32_bf16 v[52:55], a[184:187], v[196:199], 0
  ds_read_b64_tr_b16 a[162:163], v14 offset:41472
  v_cvt_pk_bf16_f32 v243, v170, v171
  v_pk_max_i16 v240, v240, 0
  v_mfma_f32_16x16x32_bf16 v[56:59], a[188:191], v[192:195], 0
  ds_read_b64_tr_b16 a[164:165], v15 offset:40960
  v_pk_max_i16 v241, v241, 0
  v_mfma_f32_16x16x32_bf16 v[60:63], a[188:191], v[196:199], 0
  ds_read_b64_tr_b16 a[166:167], v15 offset:41472
  v_pk_max_i16 v242, v242, 0
  s_waitcnt lgkmcnt(8)
  v_mfma_f32_16x16x32_bf16 v[32:35], a[192:195], v[200:203], v[32:35]
  ds_read_b64_tr_b16 a[168:169], v12 offset:45056
  s_add_u32 m0, s27, 45056
  v_mfma_f32_16x16x32_bf16 v[36:39], a[192:195], v[204:207], v[36:39]
  ds_read_b64_tr_b16 a[170:171], v12 offset:45568
  buffer_load_dwordx4 v23, s[8:11], s24 offen lds
  v_pk_max_i16 v243, v243, 0
  v_mfma_f32_16x16x32_bf16 v[40:43], a[196:199], v[200:203], v[40:43]
  ds_read_b64_tr_b16 a[172:173], v13 offset:45056
  buffer_store_dwordx4 v[240:243], v2, s[12:15], s30 offen offset:0 sc0 sc1
  v_mfma_f32_16x16x32_bf16 v[44:47], a[196:199], v[204:207], v[44:47]
  ds_read_b64_tr_b16 a[174:175], v13 offset:45568
  v_cvt_pk_bf16_f32 v244, v164, v165
  v_mfma_f32_16x16x32_bf16 v[48:51], a[144:147], v[200:203], v[48:51]
  ds_read_b64_tr_b16 a[176:177], v14 offset:45056
  v_cvt_pk_bf16_f32 v245, v166, v167
  v_mfma_f32_16x16x32_bf16 v[52:55], a[144:147], v[204:207], v[52:55]
  ds_read_b64_tr_b16 a[178:179], v14 offset:45568
  v_cvt_pk_bf16_f32 v246, v172, v173
  v_mfma_f32_16x16x32_bf16 v[56:59], a[148:151], v[200:203], v[56:59]
  ds_read_b64_tr_b16 a[180:181], v15 offset:45056
  v_cvt_pk_bf16_f32 v247, v174, v175
  v_mfma_f32_16x16x32_bf16 v[60:63], a[148:151], v[204:207], v[60:63]
  ds_read_b64_tr_b16 a[182:183], v15 offset:45568
  v_pk_max_i16 v244, v244, 0
  s_waitcnt lgkmcnt(8)
  v_mfma_f32_16x16x32_bf16 v[32:35], a[152:155], v[208:211], v[32:35]
  ds_read_b64_tr_b16 a[184:185], v12 offset:49152
  s_add_u32 m0, s27, 49152
  v_mfma_f32_16x16x32_bf16 v[36:39], a[152:155], v[212:215], v[36:39]
  ds_read_b64_tr_b16 a[186:187], v12 offset:49664
  s_add_u32 s24, s60, s65
  buffer_load_dwordx4 v22, s[8:11], s24 offen lds
  v_mfma_f32_16x16x32_bf16 v[40:43], a[156:159], v[208:211], v[40:43]
  ds_read_b64_tr_b16 a[188:189], v13 offset:49152
  v_pk_max_i16 v245, v245, 0
  v_mfma_f32_16x16x32_bf16 v[44:47], a[156:159], v[212:215], v[44:47]
  ds_read_b64_tr_b16 a[190:191], v13 offset:49664
  v_pk_max_i16 v246, v246, 0
  v_mfma_f32_16x16x32_bf16 v[48:51], a[160:163], v[208:211], v[48:51]
  ds_read_b64_tr_b16 a[192:193], v14 offset:49152
  v_pk_max_i16 v247, v247, 0
  v_mfma_f32_16x16x32_bf16 v[52:55], a[160:163], v[212:215], v[52:55]
  ds_read_b64_tr_b16 a[194:195], v14 offset:49664
  buffer_store_dwordx4 v[244:247], v2, s[12:15], s30 offen offset:1024 sc0 sc1
  v_cvt_pk_bf16_f32 v248, v176, v177
  v_mfma_f32_16x16x32_bf16 v[56:59], a[164:167], v[208:211], v[56:59]
  ds_read_b64_tr_b16 a[196:197], v15 offset:49152
  v_cvt_pk_bf16_f32 v249, v178, v179
  v_mfma_f32_16x16x32_bf16 v[60:63], a[164:167], v[212:215], v[60:63]
  ds_read_b64_tr_b16 a[198:199], v15 offset:49664
  v_cvt_pk_bf16_f32 v250, v184, v185
  s_waitcnt lgkmcnt(8)
  v_mfma_f32_16x16x32_bf16 v[32:35], a[168:171], v[216:219], v[32:35]
  ds_read_b64_tr_b16 a[144:145], v12 offset:53248
  s_add_u32 m0, s27, 53248
  v_mfma_f32_16x16x32_bf16 v[36:39], a[168:171], v[220:223], v[36:39]
  ds_read_b64_tr_b16 a[146:147], v12 offset:53760
  buffer_load_dwordx4 v23, s[8:11], s24 offen lds
  v_cvt_pk_bf16_f32 v251, v186, v187
  v_mfma_f32_16x16x32_bf16 v[40:43], a[172:175], v[216:219], v[40:43]
  ds_read_b64_tr_b16 a[148:149], v13 offset:53248
  v_pk_max_i16 v248, v248, 0
  v_mfma_f32_16x16x32_bf16 v[44:47], a[172:175], v[220:223], v[44:47]
  ds_read_b64_tr_b16 a[150:151], v13 offset:53760
  v_pk_max_i16 v249, v249, 0
  v_mfma_f32_16x16x32_bf16 v[48:51], a[176:179], v[216:219], v[48:51]
  ds_read_b64_tr_b16 a[152:153], v14 offset:53248
  v_pk_max_i16 v250, v250, 0
  v_mfma_f32_16x16x32_bf16 v[52:55], a[176:179], v[220:223], v[52:55]
  ds_read_b64_tr_b16 a[154:155], v14 offset:53760
  v_pk_max_i16 v251, v251, 0
  v_mfma_f32_16x16x32_bf16 v[56:59], a[180:183], v[216:219], v[56:59]
  ds_read_b64_tr_b16 a[156:157], v15 offset:53248
  buffer_store_dwordx4 v[248:251], v2, s[12:15], s30 offen offset:2048 sc0 sc1
  v_mfma_f32_16x16x32_bf16 v[60:63], a[180:183], v[220:223], v[60:63]
  ds_read_b64_tr_b16 a[158:159], v15 offset:53760
  v_cvt_pk_bf16_f32 v252, v180, v181
  s_waitcnt vmcnt(19)
  s_barrier
  s_waitcnt lgkmcnt(8)
  v_mfma_f32_16x16x32_bf16 v[32:35], a[184:187], v[224:227], v[32:35]
  ds_read_b64_tr_b16 a[160:161], v12 offset:57344
  s_add_u32 m0, s27, 57344
  v_mfma_f32_16x16x32_bf16 v[36:39], a[184:187], v[228:231], v[36:39]
  ds_read_b64_tr_b16 a[162:163], v12 offset:57856
  s_add_u32 s24, s61, s65
  buffer_load_dwordx4 v22, s[8:11], s24 offen lds
  v_mfma_f32_16x16x32_bf16 v[40:43], a[188:191], v[224:227], v[40:43]
  ds_read_b64_tr_b16 a[164:165], v13 offset:57344
  v_cvt_pk_bf16_f32 v253, v182, v183
  v_mfma_f32_16x16x32_bf16 v[44:47], a[188:191], v[228:231], v[44:47]
  ds_read_b64_tr_b16 a[166:167], v13 offset:57856
  v_cvt_pk_bf16_f32 v254, v188, v189
  v_mfma_f32_16x16x32_bf16 v[48:51], a[192:195], v[224:227], v[48:51]
  ds_read_b64_tr_b16 a[168:169], v14 offset:57344
  v_cvt_pk_bf16_f32 v255, v190, v191
  v_mfma_f32_16x16x32_bf16 v[52:55], a[192:195], v[228:231], v[52:55]
  ds_read_b64_tr_b16 a[170:171], v14 offset:57856
  v_pk_max_i16 v252, v252, 0
  v_pk_max_i16 v253, v253, 0
  v_mfma_f32_16x16x32_bf16 v[56:59], a[196:199], v[224:227], v[56:59]
  ds_read_b64_tr_b16 a[172:173], v15 offset:57344
  v_pk_max_i16 v254, v254, 0
  v_mfma_f32_16x16x32_bf16 v[60:63], a[196:199], v[228:231], v[60:63]
  ds_read_b64_tr_b16 a[174:175], v15 offset:57856
  v_pk_max_i16 v255, v255, 0
  s_waitcnt lgkmcnt(8)
  v_mfma_f32_16x16x32_bf16 v[32:35], a[144:147], v[232:235], v[32:35]
  ds_read_b64_tr_b16 a[176:177], v12 offset:61440
  s_add_u32 m0, s27, 61440
  v_mfma_f32_16x16x32_bf16 v[36:39], a[144:147], v[236:239], v[36:39]
  ds_read_b64_tr_b16 a[178:179], v12 offset:61952
  buffer_load_dwordx4 v23, s[8:11], s24 offen lds
  v_mfma_f32_16x16x32_bf16 v[40:43], a[148:151], v[232:235], v[40:43]
  ds_read_b64_tr_b16 a[180:181], v13 offset:61440
  v_mfma_f32_16x16x32_bf16 v[44:47], a[148:151], v[236:239], v[44:47]
  ds_read_b64_tr_b16 a[182:183], v13 offset:61952
  buffer_store_dwordx4 v[252:255], v2, s[12:15], s30 offen offset:3072 sc0 sc1
  v_mfma_f32_16x16x32_bf16 v[48:51], a[152:155], v[232:235], v[48:51]
  ds_read_b64_tr_b16 a[184:185], v14 offset:61440
  v_mfma_f32_16x16x32_bf16 v[52:55], a[152:155], v[236:239], v[52:55]
  ds_read_b64_tr_b16 a[186:187], v14 offset:61952
  s_add_u32 s30, s30, 4096
  v_mfma_f32_16x16x32_bf16 v[56:59], a[156:159], v[232:235], v[56:59]
  ds_read_b64_tr_b16 a[188:189], v15 offset:61440
  v_mfma_f32_16x16x32_bf16 v[60:63], a[156:159], v[236:239], v[60:63]
  ds_read_b64_tr_b16 a[190:191], v15 offset:61952
  s_waitcnt lgkmcnt(8)
  v_mfma_f32_16x16x32_bf16 v[32:35], a[160:163], v[240:243], v[32:35]
  ds_read_b64_tr_b16 a[192:193], v16 offset:0
  v_mfma_f32_16x16x32_bf16 v[36:39], a[160:163], v[244:247], v[36:39]
  ds_read_b64_tr_b16 a[194:195], v16 offset:512
  s_add_u32 m0, s27, 65536
  v_mfma_f32_16x16x32_bf16 v[40:43], a[164:167], v[240:243], v[40:43]
  ds_read_b64_tr_b16 a[196:197], v17 offset:0
  v_mfma_f32_16x16x32_bf16 v[44:47], a[164:167], v[244:247], v[44:47]
  ds_read_b64_tr_b16 a[198:199], v17 offset:512
  s_add_u32 s24, s62, s65
  v_mfma_f32_16x16x32_bf16 v[48:51], a[168:171], v[240:243], v[48:51]
  ds_read_b64_tr_b16 a[144:145], v18 offset:0
  v_mfma_f32_16x16x32_bf16 v[52:55], a[168:171], v[244:247], v[52:55]
  ds_read_b64_tr_b16 a[146:147], v18 offset:512
  buffer_load_dwordx4 v22, s[8:11], s24 offen lds
  v_mfma_f32_16x16x32_bf16 v[56:59], a[172:175], v[240:243], v[56:59]
  ds_read_b64_tr_b16 a[148:149], v19 offset:0
  v_mfma_f32_16x16x32_bf16 v[60:63], a[172:175], v[244:247], v[60:63]
  ds_read_b64_tr_b16 a[150:151], v19 offset:512
  s_waitcnt lgkmcnt(8)
  v_mfma_f32_16x16x32_bf16 v[32:35], a[176:179], v[248:251], v[32:35]
  ds_read_b64_tr_b16 a[152:153], v16 offset:4096
  v_mfma_f32_16x16x32_bf16 v[36:39], a[176:179], v[252:255], v[36:39]
  ds_read_b64_tr_b16 a[154:155], v16 offset:4608
  s_add_u32 m0, s27, 69632
  v_mfma_f32_16x16x32_bf16 v[40:43], a[180:183], v[248:251], v[40:43]
  ds_read_b64_tr_b16 a[156:157], v17 offset:4096
  v_mfma_f32_16x16x32_bf16 v[44:47], a[180:183], v[252:255], v[44:47]
  ds_read_b64_tr_b16 a[158:159], v17 offset:4608
  v_mfma_f32_16x16x32_bf16 v[48:51], a[184:187], v[248:251], v[48:51]
  ds_read_b64_tr_b16 a[160:161], v18 offset:4096
  v_mfma_f32_16x16x32_bf16 v[52:55], a[184:187], v[252:255], v[52:55]
  ds_read_b64_tr_b16 a[162:163], v18 offset:4608
  buffer_load_dwordx4 v23, s[8:11], s24 offen lds
  v_mfma_f32_16x16x32_bf16 v[56:59], a[188:191], v[248:251], v[56:59]
  ds_read_b64_tr_b16 a[164:165], v19 offset:4096
  v_mfma_f32_16x16x32_bf16 v[60:63], a[188:191], v[252:255], v[60:63]
  ds_read_b64_tr_b16 a[166:167], v19 offset:4608
  s_waitcnt lgkmcnt(8)
  v_mfma_f32_16x16x32_bf16 v[64:67], a[192:195], v[192:195], 0
  ds_read_b64_tr_b16 a[168:169], v16 offset:8192
  v_mfma_f32_16x16x32_bf16 v[68:71], a[192:195], v[196:199], 0
  ds_read_b64_tr_b16 a[170:171], v16 offset:8704
  s_add_u32 m0, s27, 73728
  v_mfma_f32_16x16x32_bf16 v[72:75], a[196:199], v[192:195], 0
  ds_read_b64_tr_b16 a[172:173], v17 offset:8192
  v_mfma_f32_16x16x32_bf16 v[76:79], a[196:199], v[196:199], 0
  ds_read_b64_tr_b16 a[174:175], v17 offset:8704
  s_add_u32 s24, s60, s66
  v_mfma_f32_16x16x32_bf16 v[80:83], a[144:147], v[192:195], 0
  ds_read_b64_tr_b16 a[176:177], v18 offset:8192
  v_mfma_f32_16x16x32_bf16 v[84:87], a[144:147], v[196:199], 0
  ds_read_b64_tr_b16 a[178:179], v18 offset:8704
  buffer_load_dwordx4 v22, s[8:11], s24 offen lds
  v_mfma_f32_16x16x32_bf16 v[88:91], a[148:151], v[192:195], 0
  ds_read_b64_tr_b16 a[180:181], v19 offset:8192
  v_mfma_f32_16x16x32_bf16 v[92:95], a[148:151], v[196:199], 0
  ds_read_b64_tr_b16 a[182:183], v19 offset:8704
  s_waitcnt lgkmcnt(8)
  v_mfma_f32_16x16x32_bf16 v[64:67], a[152:155], v[200:203], v[64:67]
  ds_read_b64_tr_b16 a[184:185], v16 offset:12288
  v_mfma_f32_16x16x32_bf16 v[68:71], a[152:155], v[204:207], v[68:71]
  ds_read_b64_tr_b16 a[186:187], v16 offset:12800
  buffer_load_dword v4, v6, s[12:15], s17 offen offset:0 sc0 sc1
  v_mfma_f32_16x16x32_bf16 v[72:75], a[156:159], v[200:203], v[72:75]
  ds_read_b64_tr_b16 a[188:189], v17 offset:12288
  v_mfma_f32_16x16x32_bf16 v[76:79], a[156:159], v[204:207], v[76:79]
  ds_read_b64_tr_b16 a[190:191], v17 offset:12800
  s_add_u32 m0, s27, 77824
  v_mfma_f32_16x16x32_bf16 v[80:83], a[160:163], v[200:203], v[80:83]
  ds_read_b64_tr_b16 a[192:193], v18 offset:12288
  v_mfma_f32_16x16x32_bf16 v[84:87], a[160:163], v[204:207], v[84:87]
  ds_read_b64_tr_b16 a[194:195], v18 offset:12800
  buffer_load_dwordx4 v23, s[8:11], s24 offen lds
  v_mfma_f32_16x16x32_bf16 v[88:91], a[164:167], v[200:203], v[88:91]
  ds_read_b64_tr_b16 a[196:197], v19 offset:12288
  v_mfma_f32_16x16x32_bf16 v[92:95], a[164:167], v[204:207], v[92:95]
  ds_read_b64_tr_b16 a[198:199], v19 offset:12800
  s_waitcnt vmcnt(19)
  s_barrier
  s_waitcnt lgkmcnt(8)
  v_mfma_f32_16x16x32_bf16 v[64:67], a[168:171], v[208:211], v[64:67]
  ds_read_b64_tr_b16 a[144:145], v8 offset:0
  v_mfma_f32_16x16x32_bf16 v[68:71], a[168:171], v[212:215], v[68:71]
  ds_read_b64_tr_b16 a[146:147], v8 offset:512
  s_add_u32 m0, s27, 81920
  v_mfma_f32_16x16x32_bf16 v[72:75], a[172:175], v[208:211], v[72:75]
  ds_read_b64_tr_b16 a[148:149], v9 offset:0
  v_mfma_f32_16x16x32_bf16 v[76:79], a[172:175], v[212:215], v[76:79]
  ds_read_b64_tr_b16 a[150:151], v9 offset:512
  s_add_u32 s24, s61, s66
  v_mfma_f32_16x16x32_bf16 v[80:83], a[176:179], v[208:211], v[80:83]
  ds_read_b64_tr_b16 a[152:153], v10 offset:0
  v_mfma_f32_16x16x32_bf16 v[84:87], a[176:179], v[212:215], v[84:87]
  ds_read_b64_tr_b16 a[154:155], v10 offset:512
  buffer_load_dwordx4 v22, s[8:11], s24 offen lds
  v_mfma_f32_16x16x32_bf16 v[88:91], a[180:183], v[208:211], v[88:91]
  ds_read_b64_tr_b16 a[156:157], v11 offset:0
  v_mfma_f32_16x16x32_bf16 v[92:95], a[180:183], v[212:215], v[92:95]
  ds_read_b64_tr_b16 a[158:159], v11 offset:512
  s_waitcnt lgkmcnt(8)
  v_mfma_f32_16x16x32_bf16 v[64:67], a[184:187], v[216:219], v[64:67]
  ds_read_b64_tr_b16 a[160:161], v8 offset:4096
  v_mfma_f32_16x16x32_bf16 v[68:71], a[184:187], v[220:223], v[68:71]
  ds_read_b64_tr_b16 a[162:163], v8 offset:4608
  s_add_u32 m0, s27, 86016
  v_mfma_f32_16x16x32_bf16 v[72:75], a[188:191], v[216:219], v[72:75]
  ds_read_b64_tr_b16 a[164:165], v9 offset:4096
  v_mfma_f32_16x16x32_bf16 v[76:79], a[188:191], v[220:223], v[76:79]
  ds_read_b64_tr_b16 a[166:167], v9 offset:4608
  v_mfma_f32_16x16x32_bf16 v[80:83], a[192:195], v[216:219], v[80:83]
  ds_read_b64_tr_b16 a[168:169], v10 offset:4096
  v_mfma_f32_16x16x32_bf16 v[84:87], a[192:195], v[220:223], v[84:87]
  ds_read_b64_tr_b16 a[170:171], v10 offset:4608
  buffer_load_dwordx4 v23, s[8:11], s24 offen lds
  v_mfma_f32_16x16x32_bf16 v[88:91], a[196:199], v[216:219], v[88:91]
  ds_read_b64_tr_b16 a[172:173], v11 offset:4096
  v_mfma_f32_16x16x32_bf16 v[92:95], a[196:199], v[220:223], v[92:95]
  ds_read_b64_tr_b16 a[174:175], v11 offset:4608
  s_waitcnt lgkmcnt(8)
  v_mfma_f32_16x16x32_bf16 v[64:67], a[144:147], v[224:227], v[64:67]
  ds_read_b64_tr_b16 a[176:177], v8 offset:8192
  v_mfma_f32_16x16x32_bf16 v[68:71], a[144:147], v[228:231], v[68:71]
  ds_read_b64_tr_b16 a[178:179], v8 offset:8704
  s_add_u32 m0, s27, 90112
  v_mfma_f32_16x16x32_bf16 v[72:75], a[148:151], v[224:227], v[72:75]
  ds_read_b64_tr_b16 a[180:181], v9 offset:8192
  v_mfma_f32_16x16x32_bf16 v[76:79], a[148:151], v[228:231], v[76:79]
  ds_read_b64_tr_b16 a[182:183], v9 offset:8704
  s_add_u32 s24, s62, s66
  v_mfma_f32_16x16x32_bf16 v[80:83], a[152:155], v[224:227], v[80:83]
  ds_read_b64_tr_b16 a[184:185], v10 offset:8192
  v_mfma_f32_16x16x32_bf16 v[84:87], a[152:155], v[228:231], v[84:87]
  ds_read_b64_tr_b16 a[186:187], v10 offset:8704
  buffer_load_dwordx4 v22, s[8:11], s24 offen lds
  v_mfma_f32_16x16x32_bf16 v[88:91], a[156:159], v[224:227], v[88:91]
  ds_read_b64_tr_b16 a[188:189], v11 offset:8192
  v_mfma_f32_16x16x32_bf16 v[92:95], a[156:159], v[228:231], v[92:95]
  ds_read_b64_tr_b16 a[190:191], v11 offset:8704
  s_waitcnt lgkmcnt(8)
  v_mfma_f32_16x16x32_bf16 v[64:67], a[160:163], v[232:235], v[64:67]
  ds_read_b64_tr_b16 a[192:193], v8 offset:12288
  s_waitcnt vmcnt(8)
  v_mfma_f32_16x16x32_bf16 v[68:71], a[160:163], v[236:239], v[68:71]
  ds_read_b64_tr_b16 a[194:195], v8 offset:12800
  s_mov_b64 exec, 1
  buffer_store_dword v5, v6, s[12:15], s16 offen offset:16 sc0 sc1
  s_mov_b64 exec, -1
  v_mfma_f32_16x16x32_bf16 v[72:75], a[164:167], v[232:235], v[72:75]
  ds_read_b64_tr_b16 a[196:197], v9 offset:12288
  v_mfma_f32_16x16x32_bf16 v[76:79], a[164:167], v[236:239], v[76:79]
  ds_read_b64_tr_b16 a[198:199], v9 offset:12800
  s_add_u32 m0, s27, 94208
  v_mfma_f32_16x16x32_bf16 v[80:83], a[168:171], v[232:235], v[80:83]
  ds_read_b64_tr_b16 a[144:145], v10 offset:12288
  v_mfma_f32_16x16x32_bf16 v[84:87], a[168:171], v[236:239], v[84:87]
  ds_read_b64_tr_b16 a[146:147], v10 offset:12800
  buffer_load_dwordx4 v23, s[8:11], s24 offen lds
  v_mfma_f32_16x16x32_bf16 v[88:91], a[172:175], v[232:235], v[88:91]
  ds_read_b64_tr_b16 a[148:149], v11 offset:12288
  v_mfma_f32_16x16x32_bf16 v[92:95], a[172:175], v[236:239], v[92:95]
  ds_read_b64_tr_b16 a[150:151], v11 offset:12800
  s_waitcnt lgkmcnt(8)
  v_mfma_f32_16x16x32_bf16 v[64:67], a[176:179], v[240:243], v[64:67]
  ds_read_b64_tr_b16 a[152:153], v8 offset:16384
  s_waitcnt vmcnt(6)
  v_readfirstlane_b32 s21, v4
  s_nop 0
  s_cmp_eq_u32 s21, 1
  s_cbranch_scc1 L_ok_1a
  s_mov_b32 s22, 0
L_sp_1a:
  buffer_load_dword v4, v6, s[12:15], s17 offen offset:0 sc0 sc1
  s_add_u32 s22, s22, 1
  s_waitcnt vmcnt(0)
  v_readfirstlane_b32 s21, v4
  s_cmp_gt_u32 s22, 0x40000
  s_cbranch_scc1 L_ok_1a
  s_cmp_lg_u32 s21, 1
  s_cbranch_scc1 L_sp_1a
L_ok_1a:
  v_mfma_f32_16x16x32_bf16 v[68:71], a[176:179], v[244:247], v[68:71]
  ds_read_b64_tr_b16 a[154:155], v8 offset:16896
  buffer_load_dwordx4 a[0:3], v2, s[12:15], s31 offen offset:0 sc1
  v_mfma_f32_16x16x32_bf16 v[72:75], a[180:183], v[240:243], v[72:75]
  ds_read_b64_tr_b16 a[156:157], v9 offset:16384
  buffer_load_dwordx4 a[4:7], v2, s[12:15], s31 offen offset:1024 sc1
  v_mfma_f32_16x16x32_bf16 v[76:79], a[180:183], v[244:247], v[76:79]
  ds_read_b64_tr_b16 a[158:159], v9 offset:16896
  s_add_u32 m0, s27, 98304
  v_mfma_f32_16x16x32_bf16 v[80:83], a[184:187], v[240:243], v[80:83]
  ds_read_b64_tr_b16 a[160:161], v10 offset:16384
  s_add_u32 s24, s60, s67
  v_mfma_f32_16x16x32_bf16 v[84:87], a[184:187], v[244:247], v[84:87]
  ds_read_b64_tr_b16 a[162:163], v10 offset:16896
  buffer_load_dwordx4 v22, s[8:11], s24 offen lds
  v_mfma_f32_16x16x32_bf16 v[88:91], a[188:191], v[240:243], v[88:91]
  ds_read_b64_tr_b16 a[164:165], v11 offset:16384
  v_mfma_f32_16x16x32_bf16 v[92:95], a[188:191], v[244:247], v[92:95]
  ds_read_b64_tr_b16 a[166:167], v11 offset:16896
  s_waitcnt lgkmcnt(8)
  v_mfma_f32_16x16x32_bf16 v[64:67], a[192:195], v[248:251], v[64:67]
  ds_read_b64_tr_b16 a[168:169], v8 offset:20480
  v_mfma_f32_16x16x32_bf16 v[68:71], a[192:195], v[252:255], v[68:71]
  ds_read_b64_tr_b16 a[170:171], v8 offset:20992
  buffer_load_dwordx4 a[8:11], v2, s[12:15], s31 offen offset:2048 sc1
  v_mfma_f32_16x16x32_bf16 v[72:75], a[196:199], v[248:251], v[72:75]
  ds_read_b64_tr_b16 a[172:173], v9 offset:20480
  v_mfma_f32_16x16x32_bf16 v[76:79], a[196:199], v[252:255], v[76:79]
  ds_read_b64_tr_b16 a[174:175], v9 offset:20992
  s_add_u32 m0, s27, 102400
  v_mfma_f32_16x16x32_bf16 v[80:83], a[144:147], v[248:251], v[80:83]
  ds_read_b64_tr_b16 a[176:177], v10 offset:20480
  v_mfma_f32_16x16x32_bf16 v[84:87], a[144:147], v[252:255], v[84:87]
  ds_read_b64_tr_b16 a[178:179], v10 offset:20992
  buffer_load_dwordx4 v23, s[8:11], s24 offen lds
  v_mfma_f32_16x16x32_bf16 v[88:91], a[148:151], v[248:251], v[88:91]
  ds_read_b64_tr_b16 a[180:181], v11 offset:20480
  v_mfma_f32_16x16x32_bf16 v[92:95], a[148:151], v[252:255], v[92:95]
  ds_read_b64_tr_b16 a[182:183], v11 offset:20992
  s_barrier
  s_waitcnt lgkmcnt(8)
  v_mfma_f32_16x16x32_bf16 v[96:99], a[152:155], v[192:195], 0
  ds_read_b64_tr_b16 a[184:185], v8 offset:24576
  buffer_load_dwordx4 a[12:15], v2, s[12:15], s31 offen offset:3072 sc1
  v_mfma_f32_16x16x32_bf16 v[100:103], a[152:155], v[196:199], 0
  ds_read_b64_tr_b16 a[186:187], v8 offset:25088
  s_add_u32 s31, s31, 4096
  v_mfma_f32_16x16x32_bf16 v[104:107], a[156:159], v[192:195], 0
  ds_read_b64_tr_b16 a[188:189], v9 offset:24576
  buffer_load_dwordx4 a[16:19], v2, s[12:15], s31 offen offset:0 sc1
  v_mfma_f32_16x16x32_bf16 v[108:111], a[156:159], v[196:199], 0
  ds_read_b64_tr_b16 a[190:191], v9 offset:25088
  s_add_u32 m0, s27, 106496
  v_mfma_f32_16x16x32_bf16 v[112:115], a[160:163], v[192:195], 0
  ds_read_b64_tr_b16 a[192:193], v10 offset:24576
  s_add_u32 s24, s61, s67
  v_mfma_f32_16x16x32_bf16 v[116:119], a[160:163], v[196:199], 0
  ds_read_b64_tr_b16 a[194:195], v10 offset:25088
  buffer_load_dwordx4 v22, s[8:11], s24 offen lds
  v_mfma_f32_16x16x32_bf16 v[120:123], a[164:167], v[192:195], 0
  ds_read_b64_tr_b16 a[196:197], v11 offset:24576
  v_mfma_f32_16x16x32_bf16 v[124:127], a[164:167], v[196:199], 0
  ds_read_b64_tr_b16 a[198:199], v11 offset:25088
  s_waitcnt lgkmcnt(8)
  v_mfma_f32_16x16x32_bf16 v[96:99], a[168:171], v[200:203], v[96:99]
  ds_read_b64_tr_b16 a[144:145], v8 offset:28672
  v_mfma_f32_16x16x32_bf16 v[100:103], a[168:171], v[204:207], v[100:103]
  ds_read_b64_tr_b16 a[146:147], v8 offset:29184
  buffer_load_dwordx4 a[20:23], v2, s[12:15], s31 offen offset:1024 sc1
  v_mfma_f32_16x16x32_bf16 v[104:107], a[172:175], v[200:203], v[104:107]
  ds_read_b64_tr_b16 a[148:149], v9 offset:28672
  v_mfma_f32_16x16x32_bf16 v[108:111], a[172:175], v[204:207], v[108:111]
  ds_read_b64_tr_b16 a[150:151], v9 offset:29184
  s_add_u32 m0, s27, 110592
  v_mfma_f32_16x16x32_bf16 v[112:115], a[176:179], v[200:203], v[112:115]
  ds_read_b64_tr_b16 a[152:153], v10 offset:28672
  v_mfma_f32_16x16x32_bf16 v[116:119], a[176:179], v[204:207], v[116:119]
  ds_read_b64_tr_b16 a[154:155], v10 offset:29184
  buffer_load_dwordx4 v23, s[8:11], s24 offen lds
  v_mfma_f32_16x16x32_bf16 v[120:123], a[180:183], v[200:203], v[120:123]
  ds_read_b64_tr_b16 a[156:157], v11 offset:28672
  v_mfma_f32_16x16x32_bf16 v[124:127], a[180:183], v[204:207], v[124:127]
  ds_read_b64_tr_b16 a[158:159], v11 offset:29184
  s_waitcnt lgkmcnt(8)
  v_mfma_f32_16x16x32_bf16 v[96:99], a[184:187], v[208:211], v[96:99]
  ds_read_b64_tr_b16 a[160:161], v8 offset:32768
  buffer_load_dwordx4 a[24:27], v2, s[12:15], s31 offen offset:2048 sc1
  v_mfma_f32_16x16x32_bf16 v[100:103], a[184:187], v[212:215], v[100:103]
  ds_read_b64_tr_b16 a[162:163], v8 offset:33280
  buffer_load_dwordx4 a[28:31], v2, s[12:15], s31 offen offset:3072 sc1
  v_mfma_f32_16x16x32_bf16 v[104:107], a[188:191], v[208:211], v[104:107]
  ds_read_b64_tr_b16 a[164:165], v9 offset:32768
  s_add_u32 s31, s31, 4096
  v_mfma_f32_16x16x32_bf16 v[108:111], a[188:191], v[212:215], v[108:111]
  ds_read_b64_tr_b16 a[166:167], v9 offset:33280
  s_add_u32 m0, s27, 114688
  v_mfma_f32_16x16x32_bf16 v[112:115], a[192:195], v[208:211], v[112:115]
  ds_read_b64_tr_b16 a[168:169], v10 offset:32768
  s_add_u32 s24, s62, s67
  v_mfma_f32_16x16x32_bf16 v[116:119], a[192:195], v[212:215], v[116:119]
  ds_read_b64_tr_b16 a[170:171], v10 offset:33280
  buffer_load_dwordx4 v22, s[8:11], s24 offen lds
  v_mfma_f32_16x16x32_bf16 v[120:123], a[196:199], v[208:211], v[120:123]
  ds_read_b64_tr_b16 a[172:173], v11 offset:32768
  v_mfma_f32_16x16x32_bf16 v[124:127], a[196:199], v[212:215], v[124:127]
  ds_read_b64_tr_b16 a[174:175], v11 offset:33280
  s_waitcnt lgkmcnt(8)
  v_mfma_f32_16x16x32_bf16 v[96:99], a[144:147], v[216:219], v[96:99]
  ds_read_b64_tr_b16 a[176:177], v8 offset:36864
  v_mfma_f32_16x16x32_bf16 v[100:103], a[144:147], v[220:223], v[100:103]
  ds_read_b64_tr_b16 a[178:179], v8 offset:37376
  buffer_load_dwordx4 a[32:35], v2, s[12:15], s31 offen offset:0 sc1
  v_mfma_f32_16x16x32_bf16 v[104:107], a[148:151], v[216:219], v[104:107]
  ds_read_b64_tr_b16 a[180:181], v9 offset:36864
  v_mfma_f32_16x16x32_bf16 v[108:111], a[148:151], v[220:223], v[108:111]
  ds_read_b64_tr_b16 a[182:183], v9 offset:37376
  s_add_u32 m0, s27, 118784
  v_mfma_f32_16x16x32_bf16 v[112:115], a[152:155], v[216:219], v[112:115]
  ds_read_b64_tr_b16 a[184:185], v10 offset:36864
  v_mfma_f32_16x16x32_bf16 v[116:119], a[152:155], v[220:223], v[116:119]
  ds_read_b64_tr_b16 a[186:187], v10 offset:37376
  buffer_load_dwordx4 v23, s[8:11], s24 offen lds
  v_mfma_f32_16x16x32_bf16 v[120:123], a[156:159], v[216:219], v[120:123]
  ds_read_b64_tr_b16 a[188:189], v11 offset:36864
  v_mfma_f32_16x16x32_bf16 v[124:127], a[156:159], v[220:223], v[124:127]
  ds_read_b64_tr_b16 a[190:191], v11 offset:37376
  s_waitcnt lgkmcnt(8)
  v_mfma_f32_16x16x32_bf16 v[96:99], a[160:163], v[224:227], v[96:99]
  ds_read_b64_tr_b16 a[192:193], v8 offset:40960
  buffer_load_dwordx4 a[36:39], v2, s[12:15], s31 offen offset:1024 sc1
  v_mfma_f32_16x16x32_bf16 v[100:103], a[160:163], v[228:231], v[100:103]
  ds_read_b64_tr_b16 a[194:195], v8 offset:41472
  buffer_load_dwordx4 a[40:43], v2, s[12:15], s31 offen offset:2048 sc1
  v_mfma_f32_16x16x32_bf16 v[104:107], a[164:167], v[224:227], v[104:107]
  ds_read_b64_tr_b16 a[196:197], v9 offset:40960
  v_mfma_f32_16x16x32_bf16 v[108:111], a[164:167], v[228:231], v[108:111]
  ds_read_b64_tr_b16 a[198:199], v9 offset:41472
  s_add_u32 m0, s27, 122880
  v_mfma_f32_16x16x32_bf16 v[112:115], a[168:171], v[224:227], v[112:115]
  ds_read_b64_tr_b16 a[144:145], v10 offset:40960
  s_add_u32 s24, s56, s39
  v_mfma_f32_16x16x32_bf16 v[116:119], a[168:171], v[228:231], v[116:119]
  ds_read_b64_tr_b16 a[146:147], v10 offset:41472
  buffer_load_dwordx4 v22, s[8:11], s24 offen lds
  v_mfma_f32_16x16x32_bf16 v[120:123], a[172:175], v[224:227], v[120:123]
  ds_read_b64_tr_b16 a[148:149], v11 offset:40960
  v_mfma_f32_16x16x32_bf16 v[124:127], a[172:175], v[228:231], v[124:127]
  ds_read_b64_tr_b16 a[150:151], v11 offset:41472
  s_waitcnt lgkmcnt(8)
  v_mfma_f32_16x16x32_bf16 v[96:99], a[176:179], v[232:235], v[96:99]
  ds_read_b64_tr_b16 a[152:153], v8 offset:45056
  buffer_load_dwordx4 a[44:47], v2, s[12:15], s31 offen offset:3072 sc1
  v_mfma_f32_16x16x32_bf16 v[100:103], a[176:179], v[236:239], v[100:103]
  ds_read_b64_tr_b16 a[154:155], v8 offset:45568
  s_add_u32 s31, s31, 4096
  v_mfma_f32_16x16x32_bf16 v[104:107], a[180:183], v[232:235], v[104:107]
  ds_read_b64_tr_b16 a[156:157], v9 offset:45056
  v_mfma_f32_16x16x32_bf16 v[108:111], a[180:183], v[236:239], v[108:111]
  ds_read_b64_tr_b16 a[158:159], v9 offset:45568
  s_add_u32 m0, s27, 126976
  v_mfma_f32_16x16x32_bf16 v[112:115], a[184:187], v[232:235], v[112:115]
  ds_read_b64_tr_b16 a[160:161], v10 offset:45056
  v_mfma_f32_16x16x32_bf16 v[116:119], a[184:187], v[236:239], v[116:119]
  ds_read_b64_tr_b16 a[162:163], v10 offset:45568
  buffer_load_dwordx4 v23, s[8:11], s24 offen lds
  v_mfma_f32_16x16x32_bf16 v[120:123], a[188:191], v[232:235], v[120:123]
  ds_read_b64_tr_b16 a[164:165], v11 offset:45056
  v_mfma_f32_16x16x32_bf16 v[124:127], a[188:191], v[236:239], v[124:127]
  ds_read_b64_tr_b16 a[166:167], v11 offset:45568
  s_barrier
  s_waitcnt lgkmcnt(8)
  v_mfma_f32_16x16x32_bf16 v[96:99], a[192:195], v[240:243], v[96:99]
  ds_read_b64_tr_b16 a[168:169], v8 offset:49152
  v_mfma_f32_16x16x32_bf16 v[100:103], a[192:195], v[244:247], v[100:103]
  ds_read_b64_tr_b16 a[170:171], v8 offset:49664
  s_add_u32 m0, s27, 131072
  v_mfma_f32_16x16x32_bf16 v[104:107], a[196:199], v[240:243], v[104:107]
  ds_read_b64_tr_b16 a[172:173], v9 offset:49152
  v_mfma_f32_16x16x32_bf16 v[108:111], a[196:199], v[244:247], v[108:111]
  ds_read_b64_tr_b16 a[174:175], v9 offset:49664
  s_add_u32 s24, s57, s39
  v_mfma_f32_16x16x32_bf16 v[112:115], a[144:147], v[240:243], v[112:115]
  ds_read_b64_tr_b16 a[176:177], v10 offset:49152
  v_mfma_f32_16x16x32_bf16 v[116:119], a[144:147], v[244:247], v[116:119]
  ds_read_b64_tr_b16 a[178:179], v10 offset:49664
  buffer_load_dwordx4 v22, s[8:11], s24 offen lds
  v_mfma_f32_16x16x32_bf16 v[120:123], a[148:151], v[240:243], v[120:123]
  ds_read_b64_tr_b16 a[180:181], v11 offset:49152
  v_mfma_f32_16x16x32_bf16 v[124:127], a[148:151], v[244:247], v[124:127]
  ds_read_b64_tr_b16 a[182:183], v11 offset:49664
  s_waitcnt lgkmcnt(8)
  v_mfma_f32_16x16x32_bf16 v[96:99], a[152:155], v[248:251], v[96:99]
  ds_read_b64_tr_b16 a[184:185], v8 offset:53248
  v_mfma_f32_16x16x32_bf16 v[100:103], a[152:155], v[252:255], v[100:103]
  ds_read_b64_tr_b16 a[186:187], v8 offset:53760
  s_add_u32 m0, s27, 135168
  v_mfma_f32_16x16x32_bf16 v[104:107], a[156:159], v[248:251], v[104:107]
  ds_read_b64_tr_b16 a[188:189], v9 offset:53248
  v_mfma_f32_16x16x32_bf16 v[108:111], a[156:159], v[252:255], v[108:111]
  ds_read_b64_tr_b16 a[190:191], v9 offset:53760
  v_mfma_f32_16x16x32_bf16 v[112:115], a[160:163], v[248:251], v[112:115]
  ds_read_b64_tr_b16 a[192:193], v10 offset:53248
  v_mfma_f32_16x16x32_bf16 v[116:119], a[160:163], v[252:255], v[116:119]
  ds_read_b64_tr_b16 a[194:195], v10 offset:53760
  buffer_load_dwordx4 v23, s[8:11], s24 offen lds
  v_mfma_f32_16x16x32_bf16 v[120:123], a[164:167], v[248:251], v[120:123]
  ds_read_b64_tr_b16 a[196:197], v11 offset:53248
  v_mfma_f32_16x16x32_bf16 v[124:127], a[164:167], v[252:255], v[124:127]
  ds_read_b64_tr_b16 a[198:199], v11 offset:53760
  s_waitcnt lgkmcnt(8)
  s_waitcnt vmcnt(21)
  v_mfma_f32_16x16x32_bf16 v[32:35], a[168:171], a[0:3], v[32:35]
  ds_read_b64_tr_b16 a[144:145], v8 offset:57344
  s_waitcnt vmcnt(20)
  v_mfma_f32_16x16x32_bf16 v[36:39], a[168:171], a[4:7], v[36:39]
  ds_read_b64_tr_b16 a[146:147], v8 offset:57856
  s_add_u32 m0, s27, 139264
  v_mfma_f32_16x16x32_bf16 v[40:43], a[172:175], a[0:3], v[40:43]
  ds_read_b64_tr_b16 a[148:149], v9 offset:57344
  v_mfma_f32_16x16x32_bf16 v[44:47], a[172:175], a[4:7], v[44:47]
  ds_read_b64_tr_b16 a[150:151], v9 offset:57856
  s_add_u32 s24, s58, s39
  v_mfma_f32_16x16x32_bf16 v[48:51], a[176:179], a[0:3], v[48:51]
  ds_read_b64_tr_b16 a[152:153], v10 offset:57344
  v_mfma_f32_16x16x32_bf16 v[52:55], a[176:179], a[4:7], v[52:55]
  ds_read_b64_tr_b16 a[154:155], v10 offset:57856
  buffer_load_dwordx4 v22, s[8:11], s24 offen lds
  v_mfma_f32_16x16x32_bf16 v[56:59], a[180:183], a[0:3], v[56:59]
  ds_read_b64_tr_b16 a[156:157], v11 offset:57344
  v_mfma_f32_16x16x32_bf16 v[60:63], a[180:183], a[4:7], v[60:63]
  ds_read_b64_tr_b16 a[158:159], v11 offset:57856
  s_waitcnt lgkmcnt(8)
  s_waitcnt vmcnt(19)
  v_mfma_f32_16x16x32_bf16 v[32:35], a[184:187], a[8:11], v[32:35]
  ds_read_b64_tr_b16 a[160:161], v8 offset:61440
  s_waitcnt vmcnt(17)
  v_mfma_f32_16x16x32_bf16 v[36:39], a[184:187], a[12:15], v[36:39]
  ds_read_b64_tr_b16 a[162:163], v8 offset:61952
  s_add_u32 m0, s27, 143360
  v_mfma_f32_16x16x32_bf16 v[40:43], a[188:191], a[8:11], v[40:43]
  ds_read_b64_tr_b16 a[164:165], v9 offset:61440
  v_mfma_f32_16x16x32_bf16 v[44:47], a[188:191], a[12:15], v[44:47]
  ds_read_b64_tr_b16 a[166:167], v9 offset:61952
  v_mfma_f32_16x16x32_bf16 v[48:51], a[192:195], a[8:11], v[48:51]
  ds_read_b64_tr_b16 a[168:169], v10 offset:61440
  v_mfma_f32_16x16x32_bf16 v[52:55], a[192:195], a[12:15], v[52:55]
  ds_read_b64_tr_b16 a[170:171], v10 offset:61952
  buffer_load_dwordx4 v23, s[8:11], s24 offen lds
  v_mfma_f32_16x16x32_bf16 v[56:59], a[196:199], a[8:11], v[56:59]
  ds_read_b64_tr_b16 a[172:173], v11 offset:61440
  v_mfma_f32_16x16x32_bf16 v[60:63], a[196:199], a[12:15], v[60:63]
  ds_read_b64_tr_b16 a[174:175], v11 offset:61952
  s_waitcnt lgkmcnt(8)
  s_waitcnt vmcnt(17)
  v_mfma_f32_16x16x32_bf16 v[32:35], a[144:147], a[16:19], v[32:35]
  ds_read_b64_tr_b16 a[176:177], v12 offset:0
  s_waitcnt vmcnt(15)
  v_mfma_f32_16x16x32_bf16 v[36:39], a[144:147], a[20:23], v[36:39]
  ds_read_b64_tr_b16 a[178:179], v12 offset:512
  s_add_u32 m0, s27, 0
  v_mfma_f32_16x16x32_bf16 v[40:43], a[148:151], a[16:19], v[40:43]
  ds_read_b64_tr_b16 a[180:181], v13 offset:0
  v_mfma_f32_16x16x32_bf16 v[44:47], a[148:151], a[20:23], v[44:47]
  ds_read_b64_tr_b16 a[182:183], v13 offset:512
  s_add_u32 s24, s63, s65
  v_mfma_f32_16x16x32_bf16 v[48:51], a[152:155], a[16:19], v[48:51]
  ds_read_b64_tr_b16 a[184:185], v14 offset:0
  v_mfma_f32_16x16x32_bf16 v[52:55], a[152:155], a[20:23], v[52:55]
  ds_read_b64_tr_b16 a[186:187], v14 offset:512
  buffer_load_dwordx4 v22, s[8:11], s24 offen lds
  v_mfma_f32_16x16x32_bf16 v[56:59], a[156:159], a[16:19], v[56:59]
  ds_read_b64_tr_b16 a[188:189], v15 offset:0
  v_mfma_f32_16x16x32_bf16 v[60:63], a[156:159], a[20:23], v[60:63]
  ds_read_b64_tr_b16 a[190:191], v15 offset:512
  s_waitcnt lgkmcnt(8)
  s_waitcnt vmcnt(14)
  v_mfma_f32_16x16x32_bf16 v[32:35], a[160:163], a[24:27], v[32:35]
  ds_read_b64_tr_b16 a[192:193], v12 offset:4096
  s_waitcnt vmcnt(13)
  v_mfma_f32_16x16x32_bf16 v[36:39], a[160:163], a[28:31], v[36:39]
  ds_read_b64_tr_b16 a[194:195], v12 offset:4608
  s_add_u32 m0, s27, 4096
  v_mfma_f32_16x16x32_bf16 v[40:43], a[164:167], a[24:27], v[40:43]
  ds_read_b64_tr_b16 a[196:197], v13 offset:4096
  v_mfma_f32_16x16x32_bf16 v[44:47], a[164:167], a[28:31], v[44:47]
  ds_read_b64_tr_b16 a[198:199], v13 offset:4608
  v_mfma_f32_16x16x32_bf16 v[48:51], a[168:171], a[24:27], v[48:51]
  ds_read_b64_tr_b16 a[144:145], v14 offset:4096
  v_mfma_f32_16x16x32_bf16 v[52:55], a[168:171], a[28:31], v[52:55]
  ds_read_b64_tr_b16 a[146:147], v14 offset:4608
  buffer_load_dwordx4 v23, s[8:11], s24 offen lds
  v_mfma_f32_16x16x32_bf16 v[56:59], a[172:175], a[24:27], v[56:59]
  ds_read_b64_tr_b16 a[148:149], v15 offset:4096
  v_mfma_f32_16x16x32_bf16 v[60:63], a[172:175], a[28:31], v[60:63]
  ds_read_b64_tr_b16 a[150:151], v15 offset:4608
  s_barrier
  s_waitcnt lgkmcnt(8)
  s_waitcnt vmcnt(12)
  v_mfma_f32_16x16x32_bf16 v[32:35], a[176:179], a[32:35], v[32:35]
  ds_read_b64_tr_b16 a[152:153], v12 offset:8192
  s_waitcnt vmcnt(10)
  v_mfma_f32_16x16x32_bf16 v[36:39], a[176:179], a[36:39], v[36:39]
  ds_read_b64_tr_b16 a[154:155], v12 offset:8704
  s_add_u32 m0, s27, 8192
  v_mfma_f32_16x16x32_bf16 v[40:43], a[180:183], a[32:35], v[40:43]
  ds_read_b64_tr_b16 a[156:157], v13 offset:8192
  v_mfma_f32_16x16x32_bf16 v[44:47], a[180:183], a[36:39], v[44:47]
  ds_read_b64_tr_b16 a[158:159], v13 offset:8704
  s_add_u32 s24, s64, s65
  v_mfma_f32_16x16x32_bf16 v[48:51], a[184:187], a[32:35], v[48:51]
  ds_read_b64_tr_b16 a[160:161], v14 offset:8192
  v_mfma_f32_16x16x32_bf16 v[52:55], a[184:187], a[36:39], v[52:55]
  ds_read_b64_tr_b16 a[162:163], v14 offset:8704
  buffer_load_dwordx4 v22, s[8:11], s24 offen lds
  v_mfma_f32_16x16x32_bf16 v[56:59], a[188:191], a[32:35], v[56:59]
  ds_read_b64_tr_b16 a[164:165], v15 offset:8192
  v_mfma_f32_16x16x32_bf16 v[60:63], a[188:191], a[36:39], v[60:63]
  ds_read_b64_tr_b16 a[166:167], v15 offset:8704
  s_waitcnt lgkmcnt(8)
  s_waitcnt vmcnt(10)
  v_mfma_f32_16x16x32_bf16 v[32:35], a[192:195], a[40:43], v[32:35]
  ds_read_b64_tr_b16 a[168:169], v12 offset:12288
  s_waitcnt vmcnt(8)
  v_mfma_f32_16x16x32_bf16 v[36:39], a[192:195], a[44:47], v[36:39]
  ds_read_b64_tr_b16 a[170:171], v12 offset:12800
  s_add_u32 m0, s27, 12288
  v_mfma_f32_16x16x32_bf16 v[40:43], a[196:199], a[40:43], v[40:43]
  ds_read_b64_tr_b16 a[172:173], v13 offset:12288
  v_mfma_f32_16x16x32_bf16 v[44:47], a[196:199], a[44:47], v[44:47]
  ds_read_b64_tr_b16 a[174:175], v13 offset:12800
  v_mfma_f32_16x16x32_bf16 v[48:51], a[144:147], a[40:43], v[48:51]
  ds_read_b64_tr_b16 a[176:177], v14 offset:12288
  v_mfma_f32_16x16x32_bf16 v[52:55], a[144:147], a[44:47], v[52:55]
  ds_read_b64_tr_b16 a[178:179], v14 offset:12800
  buffer_load_dwordx4 v23, s[8:11], s24 offen lds
  v_mfma_f32_16x16x32_bf16 v[56:59], a[148:151], a[40:43], v[56:59]
  ds_read_b64_tr_b16 a[180:181], v15 offset:12288
  v_mfma_f32_16x16x32_bf16 v[60:63], a[148:151], a[44:47], v[60:63]
  ds_read_b64_tr_b16 a[182:183], v15 offset:12800
  s_waitcnt lgkmcnt(8)
  v_mfma_f32_16x16x32_bf16 v[64:67], a[152:155], a[0:3], v[64:67]
  ds_read_b64_tr_b16 a[184:185], v12 offset:16384
  v_mfma_f32_16x16x32_bf16 v[68:71], a[152:155], a[4:7], v[68:71]
  ds_read_b64_tr_b16 a[186:187], v12 offset:16896
  s_add_u32 m0, s27, 16384
  v_mfma_f32_16x16x32_bf16 v[72:75], a[156:159], a[0:3], v[72:75]
  ds_read_b64_tr_b16 a[188:189], v13 offset:16384
  v_mfma_f32_16x16x32_bf16 v[76:79], a[156:159], a[4:7], v[76:79]
  ds_read_b64_tr_b16 a[190:191], v13 offset:16896
  s_add_u32 s24, s63, s66
  v_mfma_f32_16x16x32_bf16 v[80:83], a[160:163], a[0:3], v[80:83]
  ds_read_b64_tr_b16 a[192:193], v14 offset:16384
  v_mfma_f32_16x16x32_bf16 v[84:87], a[160:163], a[4:7], v[84:87]
  ds_read_b64_tr_b16 a[194:195], v14 offset:16896
  buffer_load_dwordx4 v22, s[8:11], s24 offen lds
  v_mfma_f32_16x16x32_bf16 v[88:91], a[164:167], a[0:3], v[88:91]
  ds_read_b64_tr_b16 a[196:197], v15 offset:16384
  v_mfma_f32_16x16x32_bf16 v[92:95], a[164:167], a[4:7], v[92:95]
  ds_read_b64_tr_b16 a[198:199], v15 offset:16896
  s_waitcnt lgkmcnt(8)
  v_mfma_f32_16x16x32_bf16 v[64:67], a[168:171], a[8:11], v[64:67]
  ds_read_b64_tr_b16 a[144:145], v12 offset:20480
  v_mfma_f32_16x16x32_bf16 v[68:71], a[168:171], a[12:15], v[68:71]
  ds_read_b64_tr_b16 a[146:147], v12 offset:20992
  s_add_u32 m0, s27, 20480
  v_mfma_f32_16x16x32_bf16 v[72:75], a[172:175], a[8:11], v[72:75]
  ds_read_b64_tr_b16 a[148:149], v13 offset:20480
  v_mfma_f32_16x16x32_bf16 v[76:79], a[172:175], a[12:15], v[76:79]
  ds_read_b64_tr_b16 a[150:151], v13 offset:20992
  v_mfma_f32_16x16x32_bf16 v[80:83], a[176:179], a[8:11], v[80:83]
  ds_read_b64_tr_b16 a[152:153], v14 offset:20480
  v_mfma_f32_16x16x32_bf16 v[84:87], a[176:179], a[12:15], v[84:87]
  ds_read_b64_tr_b16 a[154:155], v14 offset:20992
  buffer_load_dwordx4 v23, s[8:11], s24 offen lds
  v_mfma_f32_16x16x32_bf16 v[88:91], a[180:183], a[8:11], v[88:91]
  ds_read_b64_tr_b16 a[156:157], v15 offset:20480
  v_mfma_f32_16x16x32_bf16 v[92:95], a[180:183], a[12:15], v[92:95]
  ds_read_b64_tr_b16 a[158:159], v15 offset:20992
  s_waitcnt lgkmcnt(8)
  v_mfma_f32_16x16x32_bf16 v[64:67], a[184:187], a[16:19], v[64:67]
  ds_read_b64_tr_b16 a[160:161], v12 offset:24576
  v_mfma_f32_16x16x32_bf16 v[68:71], a[184:187], a[20:23], v[68:71]
  ds_read_b64_tr_b16 a[162:163], v12 offset:25088
  s_add_u32 m0, s27, 24576
  v_mfma_f32_16x16x32_bf16 v[72:75], a[188:191], a[16:19], v[72:75]
  ds_read_b64_tr_b16 a[164:165], v13 offset:24576
  v_mfma_f32_16x16x32_bf16 v[76:79], a[188:191], a[20:23], v[76:79]
  ds_read_b64_tr_b16 a[166:167], v13 offset:25088
  s_add_u32 s24, s64, s66
  v_mfma_f32_16x16x32_bf16 v[80:83], a[192:195], a[16:19], v[80:83]
  ds_read_b64_tr_b16 a[168:169], v14 offset:24576
  v_mfma_f32_16x16x32_bf16 v[84:87], a[192:195], a[20:23], v[84:87]
  ds_read_b64_tr_b16 a[170:171], v14 offset:25088
  buffer_load_dwordx4 v22, s[8:11], s24 offen lds
  v_mfma_f32_16x16x32_bf16 v[88:91], a[196:199], a[16:19], v[88:91]
  ds_read_b64_tr_b16 a[172:173], v15 offset:24576
  v_mfma_f32_16x16x32_bf16 v[92:95], a[196:199], a[20:23], v[92:95]
  ds_read_b64_tr_b16 a[174:175], v15 offset:25088
  s_waitcnt lgkmcnt(8)
  v_mfma_f32_16x16x32_bf16 v[64:67], a[144:147], a[24:27], v[64:67]
  ds_read_b64_tr_b16 a[176:177], v12 offset:28672
  v_mfma_f32_16x16x32_bf16 v[68:71], a[144:147], a[28:31], v[68:71]
  ds_read_b64_tr_b16 a[178:179], v12 offset:29184
  s_add_u32 m0, s27, 28672
  v_mfma_f32_16x16x32_bf16 v[72:75], a[148:151], a[24:27], v[72:75]
  ds_read_b64_tr_b16 a[180:181], v13 offset:28672
  v_mfma_f32_16x16x32_bf16 v[76:79], a[148:151], a[28:31], v[76:79]
  ds_read_b64_tr_b16 a[182:183], v13 offset:29184
  v_mfma_f32_16x16x32_bf16 v[80:83], a[152:155], a[24:27], v[80:83]
  ds_read_b64_tr_b16 a[184:185], v14 offset:28672
  v_mfma_f32_16x16x32_bf16 v[84:87], a[152:155], a[28:31], v[84:87]
  ds_read_b64_tr_b16 a[186:187], v14 offset:29184
  buffer_load_dwordx4 v23, s[8:11], s24 offen lds
  v_mfma_f32_16x16x32_bf16 v[88:91], a[156:159], a[24:27], v[88:91]
  ds_read_b64_tr_b16 a[188:189], v15 offset:28672
  v_mfma_f32_16x16x32_bf16 v[92:95], a[156:159], a[28:31], v[92:95]
  ds_read_b64_tr_b16 a[190:191], v15 offset:29184
  s_barrier
  s_waitcnt lgkmcnt(8)
  v_mfma_f32_16x16x32_bf16 v[64:67], a[160:163], a[32:35], v[64:67]
  ds_read_b64_tr_b16 a[192:193], v12 offset:32768
  v_mfma_f32_16x16x32_bf16 v[68:71], a[160:163], a[36:39], v[68:71]
  ds_read_b64_tr_b16 a[194:195], v12 offset:33280
  s_add_u32 m0, s27, 32768
  v_mfma_f32_16x16x32_bf16 v[72:75], a[164:167], a[32:35], v[72:75]
  ds_read_b64_tr_b16 a[196:197], v13 offset:32768
  v_mfma_f32_16x16x32_bf16 v[76:79], a[164:167], a[36:39], v[76:79]
  ds_read_b64_tr_b16 a[198:199], v13 offset:33280
  s_add_u32 s24, s63, s67
  v_mfma_f32_16x16x32_bf16 v[80:83], a[168:171], a[32:35], v[80:83]
  ds_read_b64_tr_b16 a[144:145], v14 offset:32768
  v_mfma_f32_16x16x32_bf16 v[84:87], a[168:171], a[36:39], v[84:87]
  ds_read_b64_tr_b16 a[146:147], v14 offset:33280
  buffer_load_dwordx4 v22, s[8:11], s24 offen lds
  v_mfma_f32_16x16x32_bf16 v[88:91], a[172:175], a[32:35], v[88:91]
  ds_read_b64_tr_b16 a[148:149], v15 offset:32768
  v_mfma_f32_16x16x32_bf16 v[92:95], a[172:175], a[36:39], v[92:95]
  ds_read_b64_tr_b16 a[150:151], v15 offset:33280
  s_waitcnt lgkmcnt(8)
  v_mfma_f32_16x16x32_bf16 v[64:67], a[176:179], a[40:43], v[64:67]
  ds_read_b64_tr_b16 a[152:153], v12 offset:36864
  v_mfma_f32_16x16x32_bf16 v[68:71], a[176:179], a[44:47], v[68:71]
  ds_read_b64_tr_b16 a[154:155], v12 offset:37376
  s_add_u32 m0, s27, 36864
  v_mfma_f32_16x16x32_bf16 v[72:75], a[180:183], a[40:43], v[72:75]
  ds_read_b64_tr_b16 a[156:157], v13 offset:36864
  v_mfma_f32_16x16x32_bf16 v[76:79], a[180:183], a[44:47], v[76:79]
  ds_read_b64_tr_b16 a[158:159], v13 offset:37376
  v_mfma_f32_16x16x32_bf16 v[80:83], a[184:187], a[40:43], v[80:83]
  ds_read_b64_tr_b16 a[160:161], v14 offset:36864
  v_mfma_f32_16x16x32_bf16 v[84:87], a[184:187], a[44:47], v[84:87]
  ds_read_b64_tr_b16 a[162:163], v14 offset:37376
  buffer_load_dwordx4 v23, s[8:11], s24 offen lds
  v_mfma_f32_16x16x32_bf16 v[88:91], a[188:191], a[40:43], v[88:91]
  ds_read_b64_tr_b16 a[164:165], v15 offset:36864
  v_mfma_f32_16x16x32_bf16 v[92:95], a[188:191], a[44:47], v[92:95]
  ds_read_b64_tr_b16 a[166:167], v15 offset:37376
  s_waitcnt lgkmcnt(8)
  v_mfma_f32_16x16x32_bf16 v[96:99], a[192:195], a[0:3], v[96:99]
  ds_read_b64_tr_b16 a[168:169], v12 offset:40960
  v_mfma_f32_16x16x32_bf16 v[100:103], a[192:195], a[4:7], v[100:103]
  ds_read_b64_tr_b16 a[170:171], v12 offset:41472
  s_add_u32 m0, s27, 40960
  v_mfma_f32_16x16x32_bf16 v[104:107], a[196:199], a[0:3], v[104:107]
  ds_read_b64_tr_b16 a[172:173], v13 offset:40960
  v_mfma_f32_16x16x32_bf16 v[108:111], a[196:199], a[4:7], v[108:111]
  ds_read_b64_tr_b16 a[174:175], v13 offset:41472
  s_add_u32 s24, s64, s67
  v_mfma_f32_16x16x32_bf16 v[112:115], a[144:147], a[0:3], v[112:115]
  ds_read_b64_tr_b16 a[176:177], v14 offset:40960
  v_mfma_f32_16x16x32_bf16 v[116:119], a[144:147], a[4:7], v[116:119]
  ds_read_b64_tr_b16 a[178:179], v14 offset:41472
  buffer_load_dwordx4 v22, s[8:11], s24 offen lds
  v_mfma_f32_16x16x32_bf16 v[120:123], a[148:151], a[0:3], v[120:123]
  ds_read_b64_tr_b16 a[180:181], v15 offset:40960
  v_mfma_f32_16x16x32_bf16 v[124:127], a[148:151], a[4:7], v[124:127]
  ds_read_b64_tr_b16 a[182:183], v15 offset:41472
  s_waitcnt lgkmcnt(8)
  v_mfma_f32_16x16x32_bf16 v[96:99], a[152:155], a[8:11], v[96:99]
  ds_read_b64_tr_b16 a[184:185], v12 offset:45056
  v_mfma_f32_16x16x32_bf16 v[100:103], a[152:155], a[12:15], v[100:103]
  ds_read_b64_tr_b16 a[186:187], v12 offset:45568
  buffer_load_dword v4, v6, s[12:15], s17 offen offset:16 sc0 sc1
  v_mfma_f32_16x16x32_bf16 v[104:107], a[156:159], a[8:11], v[104:107]
  ds_read_b64_tr_b16 a[188:189], v13 offset:45056
  v_mfma_f32_16x16x32_bf16 v[108:111], a[156:159], a[12:15], v[108:111]
  ds_read_b64_tr_b16 a[190:191], v13 offset:45568
  s_add_u32 m0, s27, 45056
  v_mfma_f32_16x16x32_bf16 v[112:115], a[160:163], a[8:11], v[112:115]
  ds_read_b64_tr_b16 a[192:193], v14 offset:45056
  v_mfma_f32_16x16x32_bf16 v[116:119], a[160:163], a[12:15], v[116:119]
  ds_read_b64_tr_b16 a[194:195], v14 offset:45568
  buffer_load_dwordx4 v23, s[8:11], s24 offen lds
  v_mfma_f32_16x16x32_bf16 v[120:123], a[164:167], a[8:11], v[120:123]
  ds_read_b64_tr_b16 a[196:197], v15 offset:45056
  v_mfma_f32_16x16x32_bf16 v[124:127], a[164:167], a[12:15], v[124:127]
  ds_read_b64_tr_b16 a[198:199], v15 offset:45568
  s_waitcnt lgkmcnt(8)
  v_mfma_f32_16x16x32_bf16 v[96:99], a[168:171], a[16:19], v[96:99]
  ds_read_b64_tr_b16 a[144:145], v12 offset:49152
  v_mfma_f32_16x16x32_bf16 v[100:103], a[168:171], a[20:23], v[100:103]
  ds_read_b64_tr_b16 a[146:147], v12 offset:49664
  s_add_u32 m0, s27, 49152
  v_mfma_f32_16x16x32_bf16 v[104:107], a[172:175], a[16:19], v[104:107]
  ds_read_b64_tr_b16 a[148:149], v13 offset:49152
  v_mfma_f32_16x16x32_bf16 v[108:111], a[172:175], a[20:23], v[108:111]
  ds_read_b64_tr_b16 a[150:151], v13 offset:49664
  s_add_u32 s24, s59, s39
  v_mfma_f32_16x16x32_bf16 v[112:115], a[176:179], a[16:19], v[112:115]
  ds_read_b64_tr_b16 a[152:153], v14 offset:49152
  v_mfma_f32_16x16x32_bf16 v[116:119], a[176:179], a[20:23], v[116:119]
  ds_read_b64_tr_b16 a[154:155], v14 offset:49664
  buffer_load_dwordx4 v22, s[8:11], s24 offen lds
  v_mfma_f32_16x16x32_bf16 v[120:123], a[180:183], a[16:19], v[120:123]
  ds_read_b64_tr_b16 a[156:157], v15 offset:49152
  v_mfma_f32_16x16x32_bf16 v[124:127], a[180:183], a[20:23], v[124:127]
  ds_read_b64_tr_b16 a[158:159], v15 offset:49664
  s_waitcnt lgkmcnt(8)
  v_mfma_f32_16x16x32_bf16 v[96:99], a[184:187], a[24:27], v[96:99]
  ds_read_b64_tr_b16 a[160:161], v12 offset:53248
  v_mfma_f32_16x16x32_bf16 v[100:103], a[184:187], a[28:31], v[100:103]
  ds_read_b64_tr_b16 a[162:163], v12 offset:53760
  s_add_u32 m0, s27, 53248
  v_mfma_f32_16x16x32_bf16 v[104:107], a[188:191], a[24:27], v[104:107]
  ds_read_b64_tr_b16 a[164:165], v13 offset:53248
  v_mfma_f32_16x16x32_bf16 v[108:111], a[188:191], a[28:31], v[108:111]
  ds_read_b64_tr_b16 a[166:167], v13 offset:53760
  v_mfma_f32_16x16x32_bf16 v[112:115], a[192:195], a[24:27], v[112:115]
  ds_read_b64_tr_b16 a[168:169], v14 offset:53248
  v_mfma_f32_16x16x32_bf16 v[116:119], a[192:195], a[28:31], v[116:119]
  ds_read_b64_tr_b16 a[170:171], v14 offset:53760
  buffer_load_dwordx4 v23, s[8:11], s24 offen lds
  v_mfma_f32_16x16x32_bf16 v[120:123], a[196:199], a[24:27], v[120:123]
  ds_read_b64_tr_b16 a[172:173], v15 offset:53248
  v_mfma_f32_16x16x32_bf16 v[124:127], a[196:199], a[28:31], v[124:127]
  ds_read_b64_tr_b16 a[174:175], v15 offset:53760
  s_waitcnt vmcnt(15)
  s_barrier
  s_waitcnt lgkmcnt(8)
  v_mfma_f32_16x16x32_bf16 v[96:99], a[144:147], a[32:35], v[96:99]
  ds_read_b64_tr_b16 a[176:177], v12 offset:57344
  v_mfma_f32_16x16x32_bf16 v[100:103], a[144:147], a[36:39], v[100:103]
  ds_read_b64_tr_b16 a[178:179], v12 offset:57856
  s_add_u32 m0, s27, 57344
  v_mfma_f32_16x16x32_bf16 v[104:107], a[148:151], a[32:35], v[104:107]
  ds_read_b64_tr_b16 a[180:181], v13 offset:57344
  v_mfma_f32_16x16x32_bf16 v[108:111], a[148:151], a[36:39], v[108:111]
  ds_read_b64_tr_b16 a[182:183], v13 offset:57856
  s_add_u32 s24, s60, s39
  v_mfma_f32_16x16x32_bf16 v[112:115], a[152:155], a[32:35], v[112:115]
  ds_read_b64_tr_b16 a[184:185], v14 offset:57344
  v_mfma_f32_16x16x32_bf16 v[116:119], a[152:155], a[36:39], v[116:119]
  ds_read_b64_tr_b16 a[186:187], v14 offset:57856
  buffer_load_dwordx4 v22, s[8:11], s24 offen lds
  v_mfma_f32_16x16x32_bf16 v[120:123], a[156:159], a[32:35], v[120:123]
  ds_read_b64_tr_b16 a[188:189], v15 offset:57344
  v_mfma_f32_16x16x32_bf16 v[124:127], a[156:159], a[36:39], v[124:127]
  ds_read_b64_tr_b16 a[190:191], v15 offset:57856
  s_waitcnt lgkmcnt(8)
  v_mfma_f32_16x16x32_bf16 v[96:99], a[160:163], a[40:43], v[96:99]
  ds_read_b64_tr_b16 a[192:193], v12 offset:61440
  v_mfma_f32_16x16x32_bf16 v[100:103], a[160:163], a[44:47], v[100:103]
  ds_read_b64_tr_b16 a[194:195], v12 offset:61952
  s_add_u32 m0, s27, 61440
  v_mfma_f32_16x16x32_bf16 v[104:107], a[164:167], a[40:43], v[104:107]
  ds_read_b64_tr_b16 a[196:197], v13 offset:61440
  v_mfma_f32_16x16x32_bf16 v[108:111], a[164:167], a[44:47], v[108:111]
  ds_read_b64_tr_b16 a[198:199], v13 offset:61952
  v_mfma_f32_16x16x32_bf16 v[112:115], a[168:171], a[40:43], v[112:115]
  ds_read_b64_tr_b16 a[144:145], v14 offset:61440
  v_mfma_f32_16x16x32_bf16 v[116:119], a[168:171], a[44:47], v[116:119]
  ds_read_b64_tr_b16 a[146:147], v14 offset:61952
  buffer_load_dwordx4 v23, s[8:11], s24 offen lds
  v_mfma_f32_16x16x32_bf16 v[120:123], a[172:175], a[40:43], v[120:123]
  ds_read_b64_tr_b16 a[148:149], v15 offset:61440
  v_mfma_f32_16x16x32_bf16 v[124:127], a[172:175], a[44:47], v[124:127]
  ds_read_b64_tr_b16 a[150:151], v15 offset:61952
  s_waitcnt lgkmcnt(8)
  v_mfma_f32_16x16x32_bf16 v[128:131], a[176:179], v[192:195], 0
  ds_read_b64_tr_b16 a[152:153], v16 offset:0
  s_waitcnt vmcnt(5)
  v_readfirstlane_b32 s21, v4
  s_nop 0
  s_cmp_eq_u32 s21, 1
  s_cbranch_scc1 L_ok_1b
  s_mov_b32 s22, 0
L_sp_1b:
  buffer_load_dword v4, v6, s[12:15], s17 offen offset:16 sc0 sc1
  s_add_u32 s22, s22, 1
  s_waitcnt vmcnt(0)
  v_readfirstlane_b32 s21, v4
  s_cmp_gt_u32 s22, 0x40000
  s_cbranch_scc1 L_ok_1b
  s_cmp_lg_u32 s21, 1
  s_cbranch_scc1 L_sp_1b
L_ok_1b:
  v_mfma_f32_16x16x32_bf16 v[132:135], a[176:179], v[196:199], 0
  ds_read_b64_tr_b16 a[154:155], v16 offset:512
  buffer_load_dwordx4 a[48:51], v2, s[12:15], s31 offen offset:0 sc1
  v_mfma_f32_16x16x32_bf16 v[136:139], a[180:183], v[192:195], 0
  ds_read_b64_tr_b16 a[156:157], v17 offset:0
  buffer_load_dwordx4 a[52:55], v2, s[12:15], s31 offen offset:1024 sc1
  v_mfma_f32_16x16x32_bf16 v[140:143], a[180:183], v[196:199], 0
  ds_read_b64_tr_b16 a[158:159], v17 offset:512
  s_add_u32 m0, s27, 65536
  v_mfma_f32_16x16x32_bf16 v[144:147], a[184:187], v[192:195], 0
  ds_read_b64_tr_b16 a[160:161], v18 offset:0
  s_add_u32 s24, s61, s39
  v_mfma_f32_16x16x32_bf16 v[148:151], a[184:187], v[196:199], 0
  ds_read_b64_tr_b16 a[162:163], v18 offset:512
  buffer_load_dwordx4 v22, s[8:11], s24 offen lds
  v_mfma_f32_16x16x32_bf16 v[152:155], a[188:191], v[192:195], 0
  ds_read_b64_tr_b16 a[164:165], v19 offset:0
  v_mfma_f32_16x16x32_bf16 v[156:159], a[188:191], v[196:199], 0
  ds_read_b64_tr_b16 a[166:167], v19 offset:512
  s_waitcnt lgkmcnt(8)
  v_mfma_f32_16x16x32_bf16 v[128:131], a[192:195], v[200:203], v[128:131]
  ds_read_b64_tr_b16 a[168:169], v16 offset:4096
  buffer_load_dwordx4 a[56:59], v2, s[12:15], s31 offen offset:2048 sc1
  v_mfma_f32_16x16x32_bf16 v[132:135], a[192:195], v[204:207], v[132:135]
  ds_read_b64_tr_b16 a[170:171], v16 offset:4608
  buffer_load_dwordx4 a[60:63], v2, s[12:15], s31 offen offset:3072 sc1
  v_mfma_f32_16x16x32_bf16 v[136:139], a[196:199], v[200:203], v[136:139]
  ds_read_b64_tr_b16 a[172:173], v17 offset:4096
  v_mfma_f32_16x16x32_bf16 v[140:143], a[196:199], v[204:207], v[140:143]
  ds_read_b64_tr_b16 a[174:175], v17 offset:4608
  s_add_u32 s31, s31, 4096
  v_mfma_f32_16x16x32_bf16 v[144:147], a[144:147], v[200:203], v[144:147]
  ds_read_b64_tr_b16 a[176:177], v18 offset:4096
  s_add_u32 m0, s27, 69632
  v_mfma_f32_16x16x32_bf16 v[148:151], a[144:147], v[204:207], v[148:151]
  ds_read_b64_tr_b16 a[178:179], v18 offset:4608
  buffer_load_dwordx4 v23, s[8:11], s24 offen lds
  v_mfma_f32_16x16x32_bf16 v[152:155], a[148:151], v[200:203], v[152:155]
  ds_read_b64_tr_b16 a[180:181], v19 offset:4096
  v_mfma_f32_16x16x32_bf16 v[156:159], a[148:151], v[204:207], v[156:159]
  ds_read_b64_tr_b16 a[182:183], v19 offset:4608
  s_waitcnt lgkmcnt(8)
  v_mfma_f32_16x16x32_bf16 v[128:131], a[152:155], v[208:211], v[128:131]
  ds_read_b64_tr_b16 a[184:185], v16 offset:8192
  buffer_load_dwordx4 a[64:67], v2, s[12:15], s31 offen offset:0 sc1
  v_mfma_f32_16x16x32_bf16 v[132:135], a[152:155], v[212:215], v[132:135]
  ds_read_b64_tr_b16 a[186:187], v16 offset:8704
  buffer_load_dwordx4 a[68:71], v2, s[12:15], s31 offen offset:1024 sc1
  v_mfma_f32_16x16x32_bf16 v[136:139], a[156:159], v[208:211], v[136:139]
  ds_read_b64_tr_b16 a[188:189], v17 offset:8192
  v_mfma_f32_16x16x32_bf16 v[140:143], a[156:159], v[212:215], v[140:143]
  ds_read_b64_tr_b16 a[190:191], v17 offset:8704
  s_add_u32 m0, s27, 73728
  v_mfma_f32_16x16x32_bf16 v[144:147], a[160:163], v[208:211], v[144:147]
  ds_read_b64_tr_b16 a[192:193], v18 offset:8192
  s_add_u32 s24, s62, s39
  v_mfma_f32_16x16x32_bf16 v[148:151], a[160:163], v[212:215], v[148:151]
  ds_read_b64_tr_b16 a[194:195], v18 offset:8704
  buffer_load_dwordx4 v22, s[8:11], s24 offen lds
  v_mfma_f32_16x16x32_bf16 v[152:155], a[164:167], v[208:211], v[152:155]
  ds_read_b64_tr_b16 a[196:197], v19 offset:8192
  v_mfma_f32_16x16x32_bf16 v[156:159], a[164:167], v[212:215], v[156:159]
  ds_read_b64_tr_b16 a[198:199], v19 offset:8704
  s_waitcnt lgkmcnt(8)
  v_mfma_f32_16x16x32_bf16 v[128:131], a[168:171], v[216:219], v[128:131]
  ds_read_b64_tr_b16 a[144:145], v16 offset:12288
  buffer_load_dwordx4 a[72:75], v2, s[12:15], s31 offen offset:2048 sc1
  v_mfma_f32_16x16x32_bf16 v[132:135], a[168:171], v[220:223], v[132:135]
  ds_read_b64_tr_b16 a[146:147], v16 offset:12800
  buffer_load_dwordx4 a[76:79], v2, s[12:15], s31 offen offset:3072 sc1
  v_mfma_f32_16x16x32_bf16 v[136:139], a[172:175], v[216:219], v[136:139]
  ds_read_b64_tr_b16 a[148:149], v17 offset:12288
  v_mfma_f32_16x16x32_bf16 v[140:143], a[172:175], v[220:223], v[140:143]
  ds_read_b64_tr_b16 a[150:151], v17 offset:12800
  s_add_u32 s31, s31, 4096
  v_mfma_f32_16x16x32_bf16 v[144:147], a[176:179], v[216:219], v[144:147]
  ds_read_b64_tr_b16 a[152:153], v18 offset:12288
  s_add_u32 m0, s27, 77824
  v_mfma_f32_16x16x32_bf16 v[148:151], a[176:179], v[220:223], v[148:151]
  ds_read_b64_tr_b16 a[154:155], v18 offset:12800
  buffer_load_dwordx4 v23, s[8:11], s24 offen lds
  v_mfma_f32_16x16x32_bf16 v[152:155], a[180:183], v[216:219], v[152:155]
  ds_read_b64_tr_b16 a[156:157], v19 offset:12288
  v_mfma_f32_16x16x32_bf16 v[156:159], a[180:183], v[220:223], v[156:159]
  ds_read_b64_tr_b16 a[158:159], v19 offset:12800
  s_barrier
  s_waitcnt lgkmcnt(8)
  v_mfma_f32_16x16x32_bf16 v[128:131], a[184:187], v[224:227], v[128:131]
  ds_read_b64_tr_b16 a[160:161], v8 offset:0
  v_mfma_f32_16x16x32_bf16 v[132:135], a[184:187], v[228:231], v[132:135]
  ds_read_b64_tr_b16 a[162:163], v8 offset:512
  s_add_u32 m0, s27, 81920
  v_mfma_f32_16x16x32_bf16 v[136:139], a[188:191], v[224:227], v[136:139]
  ds_read_b64_tr_b16 a[164:165], v9 offset:0
  v_mfma_f32_16x16x32_bf16 v[140:143], a[188:191], v[228:231], v[140:143]
  ds_read_b64_tr_b16 a[166:167], v9 offset:512
  s_add_u32 s24, s63, s39
  v_mfma_f32_16x16x32_bf16 v[144:147], a[192:195], v[224:227], v[144:147]
  ds_read_b64_tr_b16 a[168:169], v10 offset:0
  v_mfma_f32_16x16x32_bf16 v[148:151], a[192:195], v[228:231], v[148:151]
  ds_read_b64_tr_b16 a[170:171], v10 offset:512
  buffer_load_dwordx4 v22, s[8:11], s24 offen lds
  v_mfma_f32_16x16x32_bf16 v[152:155], a[196:199], v[224:227], v[152:155]
  ds_read_b64_tr_b16 a[172:173], v11 offset:0
  v_mfma_f32_16x16x32_bf16 v[156:159], a[196:199], v[228:231], v[156:159]
  ds_read_b64_tr_b16 a[174:175], v11 offset:512
  s_waitcnt lgkmcnt(8)
  v_mfma_f32_16x16x32_bf16 v[128:131], a[144:147], v[232:235], v[128:131]
  ds_read_b64_tr_b16 a[176:177], v8 offset:4096
  v_mfma_f32_16x16x32_bf16 v[132:135], a[144:147], v[236:239], v[132:135]
  ds_read_b64_tr_b16 a[178:179], v8 offset:4608
  s_add_u32 m0, s27, 86016
  v_mfma_f32_16x16x32_bf16 v[136:139], a[148:151], v[232:235], v[136:139]
  ds_read_b64_tr_b16 a[180:181], v9 offset:4096
  v_mfma_f32_16x16x32_bf16 v[140:143], a[148:151], v[236:239], v[140:143]
  ds_read_b64_tr_b16 a[182:183], v9 offset:4608
  v_mfma_f32_16x16x32_bf16 v[144:147], a[152:155], v[232:235], v[144:147]
  ds_read_b64_tr_b16 a[184:185], v10 offset:4096
  v_mfma_f32_16x16x32_bf16 v[148:151], a[152:155], v[236:239], v[148:151]
  ds_read_b64_tr_b16 a[186:187], v10 offset:4608
  buffer_load_dwordx4 v23, s[8:11], s24 offen lds
  v_mfma_f32_16x16x32_bf16 v[152:155], a[156:159], v[232:235], v[152:155]
  ds_read_b64_tr_b16 a[188:189], v11 offset:4096
  v_mfma_f32_16x16x32_bf16 v[156:159], a[156:159], v[236:239], v[156:159]
  ds_read_b64_tr_b16 a[190:191], v11 offset:4608
  s_waitcnt lgkmcnt(8)
  s_waitcnt vmcnt(13)
  v_mfma_f32_16x16x32_bf16 v[32:35], a[160:163], a[48:51], v[32:35]
  ds_read_b64_tr_b16 a[192:193], v8 offset:8192
  s_waitcnt vmcnt(12)
  v_mfma_f32_16x16x32_bf16 v[36:39], a[160:163], a[52:55], v[36:39]
  ds_read_b64_tr_b16 a[194:195], v8 offset:8704
  s_add_u32 m0, s27, 90112
  v_mfma_f32_16x16x32_bf16 v[40:43], a[164:167], a[48:51], v[40:43]
  ds_read_b64_tr_b16 a[196:197], v9 offset:8192
  v_mfma_f32_16x16x32_bf16 v[44:47], a[164:167], a[52:55], v[44:47]
  ds_read_b64_tr_b16 a[198:199], v9 offset:8704
  s_add_u32 s24, s64, s39
  v_mfma_f32_16x16x32_bf16 v[48:51], a[168:171], a[48:51], v[48:51]
  ds_read_b64_tr_b16 a[144:145], v10 offset:8192
  v_mfma_f32_16x16x32_bf16 v[52:55], a[168:171], a[52:55], v[52:55]
  ds_read_b64_tr_b16 a[146:147], v10 offset:8704
  buffer_load_dwordx4 v22, s[8:11], s24 offen lds
  v_mfma_f32_16x16x32_bf16 v[56:59], a[172:175], a[48:51], v[56:59]
  ds_read_b64_tr_b16 a[148:149], v11 offset:8192
  v_mfma_f32_16x16x32_bf16 v[60:63], a[172:175], a[52:55], v[60:63]
  ds_read_b64_tr_b16 a[150:151], v11 offset:8704
  s_waitcnt lgkmcnt(8)
  s_waitcnt vmcnt(11)
  v_mfma_f32_16x16x32_bf16 v[32:35], a[176:179], a[56:59], v[32:35]
  ds_read_b64_tr_b16 a[152:153], v8 offset:12288
  s_waitcnt vmcnt(10)
  v_mfma_f32_16x16x32_bf16 v[36:39], a[176:179], a[60:63], v[36:39]
  ds_read_b64_tr_b16 a[154:155], v8 offset:12800
  s_add_u32 m0, s27, 94208
  v_mfma_f32_16x16x32_bf16 v[40:43], a[180:183], a[56:59], v[40:43]
  ds_read_b64_tr_b16 a[156:157], v9 offset:12288
  v_mfma_f32_16x16x32_bf16 v[44:47], a[180:183], a[60:63], v[44:47]
  ds_read_b64_tr_b16 a[158:159], v9 offset:12800
  v_mfma_f32_16x16x32_bf16 v[48:51], a[184:187], a[56:59], v[48:51]
  ds_read_b64_tr_b16 a[160:161], v10 offset:12288
  v_mfma_f32_16x16x32_bf16 v[52:55], a[184:187], a[60:63], v[52:55]
  ds_read_b64_tr_b16 a[162:163], v10 offset:12800
  buffer_load_dwordx4 v23, s[8:11], s24 offen lds
  v_mfma_f32_16x16x32_bf16 v[56:59], a[188:191], a[56:59], v[56:59]
  ds_read_b64_tr_b16 a[164:165], v11 offset:12288
  v_mfma_f32_16x16x32_bf16 v[60:63], a[188:191], a[60:63], v[60:63]
  ds_read_b64_tr_b16 a[166:167], v11 offset:12800
  s_waitcnt lgkmcnt(8)
  s_waitcnt vmcnt(9)
  v_mfma_f32_16x16x32_bf16 v[32:35], a[192:195], a[64:67], v[32:35]
  ds_read_b64_tr_b16 a[168:169], v8 offset:16384
  s_waitcnt vmcnt(8)
  v_mfma_f32_16x16x32_bf16 v[36:39], a[192:195], a[68:71], v[36:39]
  ds_read_b64_tr_b16 a[170:171], v8 offset:16896
  s_add_u32 m0, s27, 98304
  v_mfma_f32_16x16x32_bf16 v[40:43], a[196:199], a[64:67], v[40:43]
  ds_read_b64_tr_b16 a[172:173], v9 offset:16384
  v_mfma_f32_16x16x32_bf16 v[44:47], a[196:199], a[68:71], v[44:47]
  ds_read_b64_tr_b16 a[174:175], v9 offset:16896
  s_add_u32 s24, s56, s100
  v_mfma_f32_16x16x32_bf16 v[48:51], a[144:147], a[64:67], v[48:51]
  ds_read_b64_tr_b16 a[176:177], v10 offset:16384
  v_mfma_f32_16x16x32_bf16 v[52:55], a[144:147], a[68:71], v[52:55]
  ds_read_b64_tr_b16 a[178:179], v10 offset:16896
  buffer_load_dwordx4 v22, s[8:11], s24 offen lds
  v_mfma_f32_16x16x32_bf16 v[56:59], a[148:151], a[64:67], v[56:59]
  ds_read_b64_tr_b16 a[180:181], v11 offset:16384
  v_mfma_f32_16x16x32_bf16 v[60:63], a[148:151], a[68:71], v[60:63]
  ds_read_b64_tr_b16 a[182:183], v11 offset:16896
  s_waitcnt lgkmcnt(8)
  s_waitcnt vmcnt(7)
  v_mfma_f32_16x16x32_bf16 v[32:35], a[152:155], a[72:75], v[32:35]
  ds_read_b64_tr_b16 a[184:185], v8 offset:20480
  s_waitcnt vmcnt(6)
  v_mfma_f32_16x16x32_bf16 v[36:39], a[152:155], a[76:79], v[36:39]
  ds_read_b64_tr_b16 a[186:187], v8 offset:20992
  s_add_u32 m0, s27, 102400
  v_mfma_f32_16x16x32_bf16 v[40:43], a[156:159], a[72:75], v[40:43]
  ds_read_b64_tr_b16 a[188:189], v9 offset:20480
  v_mfma_f32_16x16x32_bf16 v[44:47], a[156:159], a[76:79], v[44:47]
  ds_read_b64_tr_b16 a[190:191], v9 offset:20992
  v_mfma_f32_16x16x32_bf16 v[48:51], a[160:163], a[72:75], v[48:51]
  ds_read_b64_tr_b16 a[192:193], v10 offset:20480
  v_mfma_f32_16x16x32_bf16 v[52:55], a[160:163], a[76:79], v[52:55]
  ds_read_b64_tr_b16 a[194:195], v10 offset:20992
  buffer_load_dwordx4 v23, s[8:11], s24 offen lds
  v_mfma_f32_16x16x32_bf16 v[56:59], a[164:167], a[72:75], v[56:59]
  ds_read_b64_tr_b16 a[196:197], v11 offset:20480
  v_mfma_f32_16x16x32_bf16 v[60:63], a[164:167], a[76:79], v[60:63]
  ds_read_b64_tr_b16 a[198:199], v11 offset:20992
  s_barrier
  s_waitcnt lgkmcnt(8)
  v_mfma_f32_16x16x32_bf16 v[64:67], a[168:171], a[48:51], v[64:67]
  ds_read_b64_tr_b16 a[144:145], v8 offset:24576
  s_add_u32 m0, s27, 106496
  v_mfma_f32_16x16x32_bf16 v[68:71], a[168:171], a[52:55], v[68:71]
  ds_read_b64_tr_b16 a[146:147], v8 offset:25088
  s_add_u32 s24, s57, s100
  buffer_load_dwordx4 v22, s[8:11], s24 offen lds
  v_mfma_f32_16x16x32_bf16 v[72:75], a[172:175], a[48:51], v[72:75]
  ds_read_b64_tr_b16 a[148:149], v9 offset:24576
  s_lshl_b32 s23, s65, 3
  v_mfma_f32_16x16x32_bf16 v[76:79], a[172:175], a[52:55], v[76:79]
  ds_read_b64_tr_b16 a[150:151], v9 offset:25088
  s_add_u32 s23, s23, s25
  v_mfma_f32_16x16x32_bf16 v[80:83], a[176:179], a[48:51], v[80:83]
  ds_read_b64_tr_b16 a[152:153], v10 offset:24576
  v_cvt_pk_bf16_f32 v32, v32, v33
  v_mfma_f32_16x16x32_bf16 v[84:87], a[176:179], a[52:55], v[84:87]
  ds_read_b64_tr_b16 a[154:155], v10 offset:25088
  v_cvt_pk_bf16_f32 v33, v34, v35
  v_mfma_f32_16x16x32_bf16 v[88:91], a[180:183], a[48:51], v[88:91]
  ds_read_b64_tr_b16 a[156:157], v11 offset:24576
  v_cvt_pk_bf16_f32 v34, v36, v37
  v_mfma_f32_16x16x32_bf16 v[92:95], a[180:183], a[52:55], v[92:95]
  ds_read_b64_tr_b16 a[158:159], v11 offset:25088
  v_cvt_pk_bf16_f32 v35, v38, v39
  s_waitcnt lgkmcnt(8)
  v_mfma_f32_16x16x32_bf16 v[64:67], a[184:187], a[56:59], v[64:67]
  ds_read_b64_tr_b16 a[160:161], v8 offset:28672
  s_add_u32 m0, s27, 110592
  v_mfma_f32_16x16x32_bf16 v[68:71], a[184:187], a[60:63], v[68:71]
  ds_read_b64_tr_b16 a[162:163], v8 offset:29184
  buffer_load_dwordx4 v23, s[8:11], s24 offen lds
  v_mfma_f32_16x16x32_bf16 v[72:75], a[188:191], a[56:59], v[72:75]
  ds_read_b64_tr_b16 a[164:165], v9 offset:28672
  v_cvt_pk_bf16_f32 v40, v40, v41
  v_mfma_f32_16x16x32_bf16 v[76:79], a[188:191], a[60:63], v[76:79]
  ds_read_b64_tr_b16 a[166:167], v9 offset:29184
  v_cvt_pk_bf16_f32 v41, v42, v43
  v_mfma_f32_16x16x32_bf16 v[80:83], a[192:195], a[56:59], v[80:83]
  ds_read_b64_tr_b16 a[168:169], v10 offset:28672
  v_cvt_pk_bf16_f32 v42, v44, v45
  v_mfma_f32_16x16x32_bf16 v[84:87], a[192:195], a[60:63], v[84:87]
  ds_read_b64_tr_b16 a[170:171], v10 offset:29184
  v_cvt_pk_bf16_f32 v43, v46, v47
  v_mfma_f32_16x16x32_bf16 v[88:91], a[196:199], a[56:59], v[88:91]
  ds_read_b64_tr_b16 a[172:173], v11 offset:28672
  v_cvt_pk_bf16_f32 v48, v48, v49
  v_mfma_f32_16x16x32_bf16 v[92:95], a[196:199], a[60:63], v[92:95]
  ds_read_b64_tr_b16 a[174:175], v11 offset:29184
  s_waitcnt lgkmcnt(8)
  v_mfma_f32_16x16x32_bf16 v[64:67], a[144:147], a[64:67], v[64:67]
  ds_read_b64_tr_b16 a[176:177], v8 offset:32768
  s_add_u32 m0, s27, 114688
  v_mfma_f32_16x16x32_bf16 v[68:71], a[144:147], a[68:71], v[68:71]
  ds_read_b64_tr_b16 a[178:179], v8 offset:33280
  s_add_u32 s24, s58, s100
  v_mfma_f32_16x16x32_bf16 v[72:75], a[148:151], a[64:67], v[72:75]
  ds_read_b64_tr_b16 a[180:181], v9 offset:32768
  buffer_load_dwordx4 v22, s[8:11], s24 offen lds
  v_mfma_f32_16x16x32_bf16 v[76:79], a[148:151], a[68:71], v[76:79]
  ds_read_b64_tr_b16 a[182:183], v9 offset:33280
  v_cvt_pk_bf16_f32 v49, v50, v51
  v_mfma_f32_16x16x32_bf16 v[80:83], a[152:155], a[64:67], v[80:83]
  ds_read_b64_tr_b16 a[184:185], v10 offset:32768
  v_cvt_pk_bf16_f32 v50, v52, v53
  v_mfma_f32_16x16x32_bf16 v[84:87], a[152:155], a[68:71], v[84:87]
  ds_read_b64_tr_b16 a[186:187], v10 offset:33280
  v_cvt_pk_bf16_f32 v51, v54, v55
  v_mfma_f32_16x16x32_bf16 v[88:91], a[156:159], a[64:67], v[88:91]
  ds_read_b64_tr_b16 a[188:189], v11 offset:32768
  v_cvt_pk_bf16_f32 v56, v56, v57
  v_mfma_f32_16x16x32_bf16 v[92:95], a[156:159], a[68:71], v[92:95]
  ds_read_b64_tr_b16 a[190:191], v11 offset:33280
  v_cvt_pk_bf16_f32 v57, v58, v59
  s_waitcnt lgkmcnt(8)
  v_mfma_f32_16x16x32_bf16 v[64:67], a[160:163], a[72:75], v[64:67]
  ds_read_b64_tr_b16 a[192:193], v8 offset:36864
  s_add_u32 m0, s27, 118784
  v_mfma_f32_16x16x32_bf16 v[68:71], a[160:163], a[76:79], v[68:71]
  ds_read_b64_tr_b16 a[194:195], v8 offset:37376
  buffer_load_dwordx4 v23, s[8:11], s24 offen lds
  v_mfma_f32_16x16x32_bf16 v[72:75], a[164:167], a[72:75], v[72:75]
  ds_read_b64_tr_b16 a[196:197], v9 offset:36864
  v_cvt_pk_bf16_f32 v58, v60, v61
  v_mfma_f32_16x16x32_bf16 v[76:79], a[164:167], a[76:79], v[76:79]
  ds_read_b64_tr_b16 a[198:199], v9 offset:37376
  v_cvt_pk_bf16_f32 v59, v62, v63
  v_mfma_f32_16x16x32_bf16 v[80:83], a[168:171], a[72:75], v[80:83]
  ds_read_b64_tr_b16 a[144:145], v10 offset:36864
  v_permlane16_swap_b32 v32, v34
  v_mfma_f32_16x16x32_bf16 v[84:87], a[168:171], a[76:79], v[84:87]
  ds_read_b64_tr_b16 a[146:147], v10 offset:37376
  v_permlane16_swap_b32 v33, v35
  v_mfma_f32_16x16x32_bf16 v[88:91], a[172:175], a[72:75], v[88:91]
  ds_read_b64_tr_b16 a[148:149], v11 offset:36864
  buffer_store_dwordx4 v[32:35], v1, s[12:15], s23 offen offset:0 sc0 sc1
  v_mfma_f32_16x16x32_bf16 v[92:95], a[172:175], a[76:79], v[92:95]
  ds_read_b64_tr_b16 a[150:151], v11 offset:37376
  s_waitcnt lgkmcnt(8)
  v_mfma_f32_16x16x32_bf16 v[96:99], a[176:179], a[48:51], v[96:99]
  ds_read_b64_tr_b16 a[152:153], v8 offset:40960
  s_add_u32 m0, s27, 122880
  v_mfma_f32_16x16x32_bf16 v[100:103], a[176:179], a[52:55], v[100:103]
  ds_read_b64_tr_b16 a[154:155], v8 offset:41472
  s_add_u32 s24, s59, s100
  v_mfma_f32_16x16x32_bf16 v[104:107], a[180:183], a[48:51], v[104:107]
  ds_read_b64_tr_b16 a[156:157], v9 offset:40960
  buffer_load_dwordx4 v22, s[8:11], s24 offen lds
  v_mfma_f32_16x16x32_bf16 v[108:111], a[180:183], a[52:55], v[108:111]
  ds_read_b64_tr_b16 a[158:159], v9 offset:41472
  v_permlane16_swap_b32 v40, v42
  v_mfma_f32_16x16x32_bf16 v[112:115], a[184:187], a[48:51], v[112:115]
  ds_read_b64_tr_b16 a[160:161], v10 offset:40960
  v_permlane16_swap_b32 v41, v43
  v_mfma_f32_16x16x32_bf16 v[116:119], a[184:187], a[52:55], v[116:119]
  ds_read_b64_tr_b16 a[162:163], v10 offset:41472
  buffer_store_dwordx4 v[40:43], v1, s[12:15], s23 offen offset:256 sc0 sc1
  v_mfma_f32_16x16x32_bf16 v[120:123], a[188:191], a[48:51], v[120:123]
  ds_read_b64_tr_b16 a[164:165], v11 offset:40960
  v_permlane16_swap_b32 v48, v50
  v_mfma_f32_16x16x32_bf16 v[124:127], a[188:191], a[52:55], v[124:127]
  ds_read_b64_tr_b16 a[166:167], v11 offset:41472
  v_permlane16_swap_b32 v49, v51
  s_waitcnt lgkmcnt(8)
  v_mfma_f32_16x16x32_bf16 v[96:99], a[192:195], a[56:59], v[96:99]
  ds_read_b64_tr_b16 a[168:169], v8 offset:45056
  s_add_u32 m0, s27, 126976
  v_mfma_f32_16x16x32_bf16 v[100:103], a[192:195], a[60:63], v[100:103]
  ds_read_b64_tr_b16 a[170:171], v8 offset:45568
  buffer_load_dwordx4 v23, s[8:11], s24 offen lds
  v_mfma_f32_16x16x32_bf16 v[104:107], a[196:199], a[56:59], v[104:107]
  ds_read_b64_tr_b16 a[172:173], v9 offset:45056
  buffer_store_dwordx4 v[48:51], v1, s[12:15], s23 offen offset:512 sc0 sc1
  v_mfma_f32_16x16x32_bf16 v[108:111], a[196:199], a[60:63], v[108:111]
  ds_read_b64_tr_b16 a[174:175], v9 offset:45568
  v_permlane16_swap_b32 v56, v58
  v_mfma_f32_16x16x32_bf16 v[112:115], a[144:147], a[56:59], v[112:115]
  ds_read_b64_tr_b16 a[176:177], v10 offset:45056
  v_permlane16_swap_b32 v57, v59
  v_mfma_f32_16x16x32_bf16 v[116:119], a[144:147], a[60:63], v[116:119]
  ds_read_b64_tr_b16 a[178:179], v10 offset:45568
  buffer_store_dwordx4 v[56:59], v1, s[12:15], s23 offen offset:768 sc0 sc1
  v_mfma_f32_16x16x32_bf16 v[120:123], a[148:151], a[56:59], v[120:123]
  ds_read_b64_tr_b16 a[180:181], v11 offset:45056
  s_lshl_b32 s23, s66, 3
  v_mfma_f32_16x16x32_bf16 v[124:127], a[148:151], a[60:63], v[124:127]
  ds_read_b64_tr_b16 a[182:183], v11 offset:45568
  s_add_u32 s23, s23, s25
  s_barrier
  s_waitcnt lgkmcnt(8)
  v_mfma_f32_16x16x32_bf16 v[96:99], a[152:155], a[64:67], v[96:99]
  ds_read_b64_tr_b16 a[184:185], v8 offset:49152
  s_add_u32 m0, s27, 131072
  v_mfma_f32_16x16x32_bf16 v[100:103], a[152:155], a[68:71], v[100:103]
  ds_read_b64_tr_b16 a[186:187], v8 offset:49664
  s_add_u32 s24, s60, s100
  v_mfma_f32_16x16x32_bf16 v[104:107], a[156:159], a[64:67], v[104:107]
  ds_read_b64_tr_b16 a[188:189], v9 offset:49152
  buffer_load_dwordx4 v22, s[8:11], s24 offen lds
  v_mfma_f32_16x16x32_bf16 v[108:111], a[156:159], a[68:71], v[108:111]
  ds_read_b64_tr_b16 a[190:191], v9 offset:49664
  v_cvt_pk_bf16_f32 v64, v64, v65
  v_mfma_f32_16x16x32_bf16 v[112:115], a[160:163], a[64:67], v[112:115]
  ds_read_b64_tr_b16 a[192:193], v10 offset:49152
  v_cvt_pk_bf16_f32 v65, v66, v67
  v_mfma_f32_16x16x32_bf16 v[116:119], a[160:163], a[68:71], v[116:119]
  ds_read_b64_tr_b16 a[194:195], v10 offset:49664
  v_cvt_pk_bf16_f32 v66, v68, v69
  v_mfma_f32_16x16x32_bf16 v[120:123], a[164:167], a[64:67], v[120:123]
  ds_read_b64_tr_b16 a[196:197], v11 offset:49152
  v_cvt_pk_bf16_f32 v67, v70, v71
  v_mfma_f32_16x16x32_bf16 v[124:127], a[164:167], a[68:71], v[124:127]
  ds_read_b64_tr_b16 a[198:199], v11 offset:49664
  v_cvt_pk_bf16_f32 v72, v72, v73
  s_waitcnt lgkmcnt(8)
  v_mfma_f32_16x16x32_bf16 v[96:99], a[168:171], a[72:75], v[96:99]
  ds_read_b64_tr_b16 a[144:145], v8 offset:53248
  s_add_u32 m0, s27, 135168
  v_mfma_f32_16x16x32_bf16 v[100:103], a[168:171], a[76:79], v[100:103]
  ds_read_b64_tr_b16 a[146:147], v8 offset:53760
  buffer_load_dwordx4 v23, s[8:11], s24 offen lds
  v_mfma_f32_16x16x32_bf16 v[104:107], a[172:175], a[72:75], v[104:107]
  ds_read_b64_tr_b16 a[148:149], v9 offset:53248
  v_cvt_pk_bf16_f32 v73, v74, v75
  v_mfma_f32_16x16x32_bf16 v[108:111], a[172:175], a[76:79], v[108:111]
  ds_read_b64_tr_b16 a[150:151], v9 offset:53760
  v_cvt_pk_bf16_f32 v74, v76, v77
  v_mfma_f32_16x16x32_bf16 v[112:115], a[176:179], a[72:75], v[112:115]
  ds_read_b64_tr_b16 a[152:153], v10 offset:53248
  v_cvt_pk_bf16_f32 v75, v78, v79
  v_mfma_f32_16x16x32_bf16 v[116:119], a[176:179], a[76:79], v[116:119]
  ds_read_b64_tr_b16 a[154:155], v10 offset:53760
  v_cvt_pk_bf16_f32 v80, v80, v81
  v_mfma_f32_16x16x32_bf16 v[120:123], a[180:183], a[72:75], v[120:123]
  ds_read_b64_tr_b16 a[156:157], v11 offset:53248
  v_cvt_pk_bf16_f32 v81, v82, v83
  v_mfma_f32_16x16x32_bf16 v[124:127], a[180:183], a[76:79], v[124:127]
  ds_read_b64_tr_b16 a[158:159], v11 offset:53760
  s_waitcnt lgkmcnt(8)
  v_mfma_f32_16x16x32_bf16 v[128:131], a[184:187], v[240:243], v[128:131]
  ds_read_b64_tr_b16 a[160:161], v8 offset:57344
  s_add_u32 m0, s27, 139264
  v_mfma_f32_16x16x32_bf16 v[132:135], a[184:187], v[244:247], v[132:135]
  ds_read_b64_tr_b16 a[162:163], v8 offset:57856
  s_add_u32 s24, s61, s100
  v_mfma_f32_16x16x32_bf16 v[136:139], a[188:191], v[240:243], v[136:139]
  ds_read_b64_tr_b16 a[164:165], v9 offset:57344
  buffer_load_dwordx4 v22, s[8:11], s24 offen lds
  v_mfma_f32_16x16x32_bf16 v[140:143], a[188:191], v[244:247], v[140:143]
  ds_read_b64_tr_b16 a[166:167], v9 offset:57856
  v_cvt_pk_bf16_f32 v82, v84, v85
  v_mfma_f32_16x16x32_bf16 v[144:147], a[192:195], v[240:243], v[144:147]
  ds_read_b64_tr_b16 a[168:169], v10 offset:57344
  v_cvt_pk_bf16_f32 v83, v86, v87
  v_mfma_f32_16x16x32_bf16 v[148:151], a[192:195], v[244:247], v[148:151]
  ds_read_b64_tr_b16 a[170:171], v10 offset:57856
  v_cvt_pk_bf16_f32 v88, v88, v89
  v_mfma_f32_16x16x32_bf16 v[152:155], a[196:199], v[240:243], v[152:155]
  ds_read_b64_tr_b16 a[172:173], v11 offset:57344
  v_cvt_pk_bf16_f32 v89, v90, v91
  v_mfma_f32_16x16x32_bf16 v[156:159], a[196:199], v[244:247], v[156:159]
  ds_read_b64_tr_b16 a[174:175], v11 offset:57856
  v_cvt_pk_bf16_f32 v90, v92, v93
  s_waitcnt lgkmcnt(8)
  v_mfma_f32_16x16x32_bf16 v[128:131], a[144:147], v[248:251], v[128:131]
  ds_read_b64_tr_b16 a[176:177], v8 offset:61440
  s_add_u32 m0, s27, 143360
  v_mfma_f32_16x16x32_bf16 v[132:135], a[144:147], v[252:255], v[132:135]
  ds_read_b64_tr_b16 a[178:179], v8 offset:61952
  buffer_load_dwordx4 v23, s[8:11], s24 offen lds
  v_mfma_f32_16x16x32_bf16 v[136:139], a[148:151], v[248:251], v[136:139]
  ds_read_b64_tr_b16 a[180:181], v9 offset:61440
  v_cvt_pk_bf16_f32 v91, v94, v95
  v_mfma_f32_16x16x32_bf16 v[140:143], a[148:151], v[252:255], v[140:143]
  ds_read_b64_tr_b16 a[182:183], v9 offset:61952
  v_permlane16_swap_b32 v64, v66
  v_mfma_f32_16x16x32_bf16 v[144:147], a[152:155], v[248:251], v[144:147]
  ds_read_b64_tr_b16 a[184:185], v10 offset:61440
  v_permlane16_swap_b32 v65, v67
  v_mfma_f32_16x16x32_bf16 v[148:151], a[152:155], v[252:255], v[148:151]
  ds_read_b64_tr_b16 a[186:187], v10 offset:61952
  buffer_store_dwordx4 v[64:67], v1, s[12:15], s23 offen offset:0 sc0 sc1
  v_mfma_f32_16x16x32_bf16 v[152:155], a[156:159], v[248:251], v[152:155]
  ds_read_b64_tr_b16 a[188:189], v11 offset:61440
  v_permlane16_swap_b32 v72, v74
  v_mfma_f32_16x16x32_bf16 v[156:159], a[156:159], v[252:255], v[156:159]
  ds_read_b64_tr_b16 a[190:191], v11 offset:61952
  s_waitcnt lgkmcnt(8)
  v_mfma_f32_16x16x32_bf16 v[128:131], a[160:163], a[0:3], v[128:131]
  ds_read_b64_tr_b16 a[192:193], v12 offset:0
  s_add_u32 m0, s27, 0
  v_mfma_f32_16x16x32_bf16 v[132:135], a[160:163], a[4:7], v[132:135]
  ds_read_b64_tr_b16 a[194:195], v12 offset:512
  s_add_u32 s24, s62, s100
  v_mfma_f32_16x16x32_bf16 v[136:139], a[164:167], a[0:3], v[136:139]
  ds_read_b64_tr_b16 a[196:197], v13 offset:0
  buffer_load_dwordx4 v22, s[8:11], s24 offen lds
  v_mfma_f32_16x16x32_bf16 v[140:143], a[164:167], a[4:7], v[140:143]
  ds_read_b64_tr_b16 a[198:199], v13 offset:512
  v_permlane16_swap_b32 v73, v75
  v_mfma_f32_16x16x32_bf16 v[144:147], a[168:171], a[0:3], v[144:147]
  ds_read_b64_tr_b16 a[144:145], v14 offset:0
  buffer_store_dwordx4 v[72:75], v1, s[12:15], s23 offen offset:256 sc0 sc1
  v_mfma_f32_16x16x32_bf16 v[148:151], a[168:171], a[4:7], v[148:151]
  ds_read_b64_tr_b16 a[146:147], v14 offset:512
  v_permlane16_swap_b32 v80, v82
  v_mfma_f32_16x16x32_bf16 v[152:155], a[172:175], a[0:3], v[152:155]
  ds_read_b64_tr_b16 a[148:149], v15 offset:0
  v_permlane16_swap_b32 v81, v83
  v_mfma_f32_16x16x32_bf16 v[156:159], a[172:175], a[4:7], v[156:159]
  ds_read_b64_tr_b16 a[150:151], v15 offset:512
  buffer_store_dwordx4 v[80:83], v1, s[12:15], s23 offen offset:512 sc0 sc1
  s_waitcnt lgkmcnt(8)
  v_mfma_f32_16x16x32_bf16 v[128:131], a[176:179], a[8:11], v[128:131]
  ds_read_b64_tr_b16 a[152:153], v12 offset:4096
  s_add_u32 m0, s27, 4096
  v_mfma_f32_16x16x32_bf16 v[132:135], a[176:179], a[12:15], v[132:135]
  ds_read_b64_tr_b16 a[154:155], v12 offset:4608
  buffer_load_dwordx4 v23, s[8:11], s24 offen lds
  v_mfma_f32_16x16x32_bf16 v[136:139], a[180:183], a[8:11], v[136:139]
  ds_read_b64_tr_b16 a[156:157], v13 offset:4096
  v_permlane16_swap_b32 v88, v90
  v_mfma_f32_16x16x32_bf16 v[140:143], a[180:183], a[12:15], v[140:143]
  ds_read_b64_tr_b16 a[158:159], v13 offset:4608
  v_permlane16_swap_b32 v89, v91
  v_mfma_f32_16x16x32_bf16 v[144:147], a[184:187], a[8:11], v[144:147]
  ds_read_b64_tr_b16 a[160:161], v14 offset:4096
  buffer_store_dwordx4 v[88:91], v1, s[12:15], s23 offen offset:768 sc0 sc1
  v_mfma_f32_16x16x32_bf16 v[148:151], a[184:187], a[12:15], v[148:151]
  ds_read_b64_tr_b16 a[162:163], v14 offset:4608
  s_lshl_b32 s23, s67, 3
  v_mfma_f32_16x16x32_bf16 v[152:155], a[188:191], a[8:11], v[152:155]
  ds_read_b64_tr_b16 a[164:165], v15 offset:4096
  s_add_u32 s23, s23, s25
  v_mfma_f32_16x16x32_bf16 v[156:159], a[188:191], a[12:15], v[156:159]
  ds_read_b64_tr_b16 a[166:167], v15 offset:4608
  v_cvt_pk_bf16_f32 v96, v96, v97
  s_waitcnt vmcnt(22)
  s_barrier
  s_waitcnt lgkmcnt(8)
  v_mfma_f32_16x16x32_bf16 v[128:131], a[192:195], a[16:19], v[128:131]
  ds_read_b64_tr_b16 a[168:169], v12 offset:8192
  s_add_u32 m0, s27, 8192
  v_mfma_f32_16x16x32_bf16 v[132:135], a[192:195], a[20:23], v[132:135]
  ds_read_b64_tr_b16 a[170:171], v12 offset:8704
  s_add_u32 s24, s63, s100
  v_mfma_f32_16x16x32_bf16 v[136:139], a[196:199], a[16:19], v[136:139]
  ds_read_b64_tr_b16 a[172:173], v13 offset:8192
  buffer_load_dwordx4 v22, s[8:11], s24 offen lds
  v_mfma_f32_16x16x32_bf16 v[140:143], a[196:199], a[20:23], v[140:143]
  ds_read_b64_tr_b16 a[174:175], v13 offset:8704
  v_cvt_pk_bf16_f32 v97, v98, v99
  v_mfma_f32_16x16x32_bf16 v[144:147], a[144:147], a[16:19], v[144:147]
  ds_read_b64_tr_b16 a[176:177], v14 offset:8192
  v_cvt_pk_bf16_f32 v98, v100, v101
  v_mfma_f32_16x16x32_bf16 v[148:151], a[144:147], a[20:23], v[148:151]
  ds_read_b64_tr_b16 a[178:179], v14 offset:8704
  v_cvt_pk_bf16_f32 v99, v102, v103
  v_mfma_f32_16x16x32_bf16 v[152:155], a[148:151], a[16:19], v[152:155]
  ds_read_b64_tr_b16 a[180:181], v15 offset:8192
  v_cvt_pk_bf16_f32 v104, v104, v105
  v_mfma_f32_16x16x32_bf16 v[156:159], a[148:151], a[20:23], v[156:159]
  ds_read_b64_tr_b16 a[182:183], v15 offset:8704
  v_cvt_pk_bf16_f32 v105, v106, v107
  s_waitcnt lgkmcnt(8)
  v_mfma_f32_16x16x32_bf16 v[128:131], a[152:155], a[24:27], v[128:131]
  ds_read_b64_tr_b16 a[184:185], v12 offset:12288
  s_add_u32 m0, s27, 12288
  v_mfma_f32_16x16x32_bf16 v[132:135], a[152:155], a[28:31], v[132:135]
  ds_read_b64_tr_b16 a[186:187], v12 offset:12800
  buffer_load_dwordx4 v23, s[8:11], s24 offen lds
  v_mfma_f32_16x16x32_bf16 v[136:139], a[156:159], a[24:27], v[136:139]
  ds_read_b64_tr_b16 a[188:189], v13 offset:12288
  v_cvt_pk_bf16_f32 v106, v108, v109
  v_mfma_f32_16x16x32_bf16 v[140:143], a[156:159], a[28:31], v[140:143]
  ds_read_b64_tr_b16 a[190:191], v13 offset:12800
  v_cvt_pk_bf16_f32 v107, v110, v111
  v_mfma_f32_16x16x32_bf16 v[144:147], a[160:163], a[24:27], v[144:147]
  ds_read_b64_tr_b16 a[192:193], v14 offset:12288
  v_cvt_pk_bf16_f32 v112, v112, v113
  v_mfma_f32_16x16x32_bf16 v[148:151], a[160:163], a[28:31], v[148:151]
  ds_read_b64_tr_b16 a[194:195], v14 offset:12800
  v_cvt_pk_bf16_f32 v113, v114, v115
  v_mfma_f32_16x16x32_bf16 v[152:155], a[164:167], a[24:27], v[152:155]
  ds_read_b64_tr_b16 a[196:197], v15 offset:12288
  v_cvt_pk_bf16_f32 v114, v116, v117
  v_mfma_f32_16x16x32_bf16 v[156:159], a[164:167], a[28:31], v[156:159]
  ds_read_b64_tr_b16 a[198:199], v15 offset:12800
  s_waitcnt lgkmcnt(8)
  v_mfma_f32_16x16x32_bf16 v[128:131], a[168:171], a[32:35], v[128:131]
  ds_read_b64_tr_b16 a[144:145], v12 offset:16384
  s_add_u32 m0, s27, 16384
  v_mfma_f32_16x16x32_bf16 v[132:135], a[168:171], a[36:39], v[132:135]
  ds_read_b64_tr_b16 a[146:147], v12 offset:16896
  s_add_u32 s24, s64, s100
  v_mfma_f32_16x16x32_bf16 v[136:139], a[172:175], a[32:35], v[136:139]
  ds_read_b64_tr_b16 a[148:149], v13 offset:16384
  buffer_load_dwordx4 v22, s[8:11], s24 offen lds
  v_mfma_f32_16x16x32_bf16 v[140:143], a[172:175], a[36:39], v[140:143]
  ds_read_b64_tr_b16 a[150:151], v13 offset:16896
  v_cvt_pk_bf16_f32 v115, v118, v119
  v_mfma_f32_16x16x32_bf16 v[144:147], a[176:179], a[32:35], v[144:147]
  ds_read_b64_tr_b16 a[152:153], v14 offset:16384
  v_cvt_pk_bf16_f32 v120, v120, v121
  v_mfma_f32_16x16x32_bf16 v[148:151], a[176:179], a[36:39], v[148:151]
  ds_read_b64_tr_b16 a[154:155], v14 offset:16896
  v_cvt_pk_bf16_f32 v121, v122, v123
  v_mfma_f32_16x16x32_bf16 v[152:155], a[180:183], a[32:35], v[152:155]
  ds_read_b64_tr_b16 a[156:157], v15 offset:16384
  v_cvt_pk_bf16_f32 v122, v124, v125
  v_mfma_f32_16x16x32_bf16 v[156:159], a[180:183], a[36:39], v[156:159]
  ds_read_b64_tr_b16 a[158:159], v15 offset:16896
  v_cvt_pk_bf16_f32 v123, v126, v127
  s_waitcnt lgkmcnt(8)
  v_mfma_f32_16x16x32_bf16 v[128:131], a[184:187], a[40:43], v[128:131]
  ds_read_b64_tr_b16 a[160:161], v12 offset:20480
  s_add_u32 m0, s27, 20480
  v_mfma_f32_16x16x32_bf16 v[132:135], a[184:187], a[44:47], v[132:135]
  ds_read_b64_tr_b16 a[162:163], v12 offset:20992
  buffer_load_dwordx4 v23, s[8:11], s24 offen lds
  v_mfma_f32_16x16x32_bf16 v[136:139], a[188:191], a[40:43], v[136:139]
  ds_read_b64_tr_b16 a[164:165], v13 offset:20480
  v_permlane16_swap_b32 v96, v98
  v_mfma_f32_16x16x32_bf16 v[140:143], a[188:191], a[44:47], v[140:143]
  ds_read_b64_tr_b16 a[166:167], v13 offset:20992
  v_permlane16_swap_b32 v97, v99
  v_mfma_f32_16x16x32_bf16 v[144:147], a[192:195], a[40:43], v[144:147]
  ds_read_b64_tr_b16 a[168:169], v14 offset:20480
  buffer_store_dwordx4 v[96:99], v1, s[12:15], s23 offen offset:0 sc0 sc1
  v_mfma_f32_16x16x32_bf16 v[148:151], a[192:195], a[44:47], v[148:151]
  ds_read_b64_tr_b16 a[170:171], v14 offset:20992
  v_permlane16_swap_b32 v104, v106
  v_mfma_f32_16x16x32_bf16 v[152:155], a[196:199], a[40:43], v[152:155]
  ds_read_b64_tr_b16 a[172:173], v15 offset:20480
  v_permlane16_swap_b32 v105, v107
  v_mfma_f32_16x16x32_bf16 v[156:159], a[196:199], a[44:47], v[156:159]
  ds_read_b64_tr_b16 a[174:175], v15 offset:20992
  s_waitcnt lgkmcnt(8)
  v_mfma_f32_16x16x32_bf16 v[128:131], a[144:147], a[48:51], v[128:131]
  ds_read_b64_tr_b16 a[176:177], v12 offset:24576
  buffer_store_dwordx4 v[104:107], v1, s[12:15], s23 offen offset:256 sc0 sc1
  v_mfma_f32_16x16x32_bf16 v[132:135], a[144:147], a[52:55], v[132:135]
  ds_read_b64_tr_b16 a[178:179], v12 offset:25088
  v_permlane16_swap_b32 v112, v114
  v_mfma_f32_16x16x32_bf16 v[136:139], a[148:151], a[48:51], v[136:139]
  ds_read_b64_tr_b16 a[180:181], v13 offset:24576
  v_mfma_f32_16x16x32_bf16 v[140:143], a[148:151], a[52:55], v[140:143]
  ds_read_b64_tr_b16 a[182:183], v13 offset:25088
  v_permlane16_swap_b32 v113, v115
  v_mfma_f32_16x16x32_bf16 v[144:147], a[152:155], a[48:51], v[144:147]
  ds_read_b64_tr_b16 a[184:185], v14 offset:24576
  buffer_store_dwordx4 v[112:115], v1, s[12:15], s23 offen offset:512 sc0 sc1
  v_mfma_f32_16x16x32_bf16 v[148:151], a[152:155], a[52:55], v[148:151]
  ds_read_b64_tr_b16 a[186:187], v14 offset:25088
  v_permlane16_swap_b32 v120, v122
  v_mfma_f32_16x16x32_bf16 v[152:155], a[156:159], a[48:51], v[152:155]
  ds_read_b64_tr_b16 a[188:189], v15 offset:24576
  v_mfma_f32_16x16x32_bf16 v[156:159], a[156:159], a[52:55], v[156:159]
  ds_read_b64_tr_b16 a[190:191], v15 offset:25088
  s_waitcnt lgkmcnt(8)
  v_mfma_f32_16x16x32_bf16 v[128:131], a[160:163], a[56:59], v[128:131]
  ds_read_b64_tr_b16 a[192:193], v12 offset:28672
  v_mfma_f32_16x16x32_bf16 v[132:135], a[160:163], a[60:63], v[132:135]
  ds_read_b64_tr_b16 a[194:195], v12 offset:29184
  v_permlane16_swap_b32 v121, v123
  v_mfma_f32_16x16x32_bf16 v[136:139], a[164:167], a[56:59], v[136:139]
  ds_read_b64_tr_b16 a[196:197], v13 offset:28672
  v_mfma_f32_16x16x32_bf16 v[140:143], a[164:167], a[60:63], v[140:143]
  ds_read_b64_tr_b16 a[198:199], v13 offset:29184
  v_mfma_f32_16x16x32_bf16 v[144:147], a[168:171], a[56:59], v[144:147]
  ds_read_b64_tr_b16 a[144:145], v14 offset:28672
  v_mfma_f32_16x16x32_bf16 v[148:151], a[168:171], a[60:63], v[148:151]
  ds_read_b64_tr_b16 a[146:147], v14 offset:29184
  buffer_store_dwordx4 v[120:123], v1, s[12:15], s23 offen offset:768 sc0 sc1
  v_mfma_f32_16x16x32_bf16 v[152:155], a[172:175], a[56:59], v[152:155]
  ds_read_b64_tr_b16 a[148:149], v15 offset:28672
  v_mfma_f32_16x16x32_bf16 v[156:159], a[172:175], a[60:63], v[156:159]
  ds_read_b64_tr_b16 a[150:151], v15 offset:29184
  s_waitcnt vmcnt(24)
  s_barrier
  s_waitcnt lgkmcnt(8)
  v_mfma_f32_16x16x32_bf16 v[128:131], a[176:179], a[64:67], v[128:131]
  ds_read_b64_tr_b16 a[152:153], v12 offset:32768
  v_mfma_f32_16x16x32_bf16 v[132:135], a[176:179], a[68:71], v[132:135]
  ds_read_b64_tr_b16 a[154:155], v12 offset:33280
  v_mfma_f32_16x16x32_bf16 v[136:139], a[180:183], a[64:67], v[136:139]
  ds_read_b64_tr_b16 a[156:157], v13 offset:32768
  v_mfma_f32_16x16x32_bf16 v[140:143], a[180:183], a[68:71], v[140:143]
  ds_read_b64_tr_b16 a[158:159], v13 offset:33280
  v_mfma_f32_16x16x32_bf16 v[144:147], a[184:187], a[64:67], v[144:147]
  ds_read_b64_tr_b16 a[160:161], v14 offset:32768
  v_mfma_f32_16x16x32_bf16 v[148:151], a[184:187], a[68:71], v[148:151]
  ds_read_b64_tr_b16 a[162:163], v14 offset:33280
  v_mfma_f32_16x16x32_bf16 v[152:155], a[188:191], a[64:67], v[152:155]
  ds_read_b64_tr_b16 a[164:165], v15 offset:32768
  v_mfma_f32_16x16x32_bf16 v[156:159], a[188:191], a[68:71], v[156:159]
  ds_read_b64_tr_b16 a[166:167], v15 offset:33280
  s_waitcnt lgkmcnt(8)
  v_mfma_f32_16x16x32_bf16 v[128:131], a[192:195], a[72:75], v[128:131]
  ds_read_b64_tr_b16 a[168:169], v12 offset:36864
  v_mfma_f32_16x16x32_bf16 v[132:135], a[192:195], a[76:79], v[132:135]
  ds_read_b64_tr_b16 a[170:171], v12 offset:37376
  v_mfma_f32_16x16x32_bf16 v[136:139], a[196:199], a[72:75], v[136:139]
  ds_read_b64_tr_b16 a[172:173], v13 offset:36864
  v_mfma_f32_16x16x32_bf16 v[140:143], a[196:199], a[76:79], v[140:143]
  ds_read_b64_tr_b16 a[174:175], v13 offset:37376
  v_mfma_f32_16x16x32_bf16 v[144:147], a[144:147], a[72:75], v[144:147]
  ds_read_b64_tr_b16 a[176:177], v14 offset:36864
  v_mfma_f32_16x16x32_bf16 v[148:151], a[144:147], a[76:79], v[148:151]
  ds_read_b64_tr_b16 a[178:179], v14 offset:37376
  v_mfma_f32_16x16x32_bf16 v[152:155], a[148:151], a[72:75], v[152:155]
  ds_read_b64_tr_b16 a[180:181], v15 offset:36864
  v_mfma_f32_16x16x32_bf16 v[156:159], a[148:151], a[76:79], v[156:159]
  ds_read_b64_tr_b16 a[182:183], v15 offset:37376
  s_waitcnt lgkmcnt(8)
  v_mfma_f32_16x16x32_bf16 v[160:163], a[152:155], v[192:195], 0
  ds_read_b64_tr_b16 a[184:185], v12 offset:40960
  s_lshl_b32 s23, s39, 3
  v_mfma_f32_16x16x32_bf16 v[164:167], a[152:155], v[196:199], 0
  ds_read_b64_tr_b16 a[186:187], v12 offset:41472
  s_add_u32 s23, s23, s25
  v_cvt_pk_bf16_f32 v128, v128, v129
  v_mfma_f32_16x16x32_bf16 v[168:171], a[156:159], v[192:195], 0
  ds_read_b64_tr_b16 a[188:189], v13 offset:40960
  v_cvt_pk_bf16_f32 v129, v130, v131
  v_mfma_f32_16x16x32_bf16 v[172:175], a[156:159], v[196:199], 0
  ds_read_b64_tr_b16 a[190:191], v13 offset:41472
  v_cvt_pk_bf16_f32 v130, v132, v133
  v_cvt_pk_bf16_f32 v131, v134, v135
  v_mfma_f32_16x16x32_bf16 v[176:179], a[160:163], v[192:195], 0
  ds_read_b64_tr_b16 a[192:193], v14 offset:40960
  v_cvt_pk_bf16_f32 v136, v136, v137
  v_mfma_f32_16x16x32_bf16 v[180:183], a[160:163], v[196:199], 0
  ds_read_b64_tr_b16 a[194:195], v14 offset:41472
  v_cvt_pk_bf16_f32 v137, v138, v139
  v_cvt_pk_bf16_f32 v138, v140, v141
  v_mfma_f32_16x16x32_bf16 v[184:187], a[164:167], v[192:195], 0
  ds_read_b64_tr_b16 a[196:197], v15 offset:40960
  v_cvt_pk_bf16_f32 v139, v142, v143
  v_mfma_f32_16x16x32_bf16 v[188:191], a[164:167], v[196:199], 0
  ds_read_b64_tr_b16 a[198:199], v15 offset:41472
  v_cvt_pk_bf16_f32 v144, v144, v145
  s_waitcnt lgkmcnt(8)
  v_mfma_f32_16x16x32_bf16 v[160:163], a[168:171], v[200:203], v[160:163]
  ds_read_b64_tr_b16 a[144:145], v12 offset:45056
  v_cvt_pk_bf16_f32 v145, v146, v147
  v_mfma_f32_16x16x32_bf16 v[164:167], a[168:171], v[204:207], v[164:167]
  ds_read_b64_tr_b16 a[146:147], v12 offset:45568
  v_cvt_pk_bf16_f32 v146, v148, v149
  v_cvt_pk_bf16_f32 v147, v150, v151
  v_mfma_f32_16x16x32_bf16 v[168:171], a[172:175], v[200:203], v[168:171]
  ds_read_b64_tr_b16 a[148:149], v13 offset:45056
  v_cvt_pk_bf16_f32 v152, v152, v153
  v_mfma_f32_16x16x32_bf16 v[172:175], a[172:175], v[204:207], v[172:175]
  ds_read_b64_tr_b16 a[150:151], v13 offset:45568
  v_cvt_pk_bf16_f32 v153, v154, v155
  v_mfma_f32_16x16x32_bf16 v[176:179], a[176:179], v[200:203], v[176:179]
  ds_read_b64_tr_b16 a[152:153], v14 offset:45056
  v_cvt_pk_bf16_f32 v154, v156, v157
  v_mfma_f32_16x16x32_bf16 v[180:183], a[176:179], v[204:207], v[180:183]
  ds_read_b64_tr_b16 a[154:155], v14 offset:45568
  v_cvt_pk_bf16_f32 v155, v158, v159
  v_permlane16_swap_b32 v128, v130
  v_mfma_f32_16x16x32_bf16 v[184:187], a[180:183], v[200:203], v[184:187]
  ds_read_b64_tr_b16 a[156:157], v15 offset:45056
  v_permlane16_swap_b32 v129, v131
  v_mfma_f32_16x16x32_bf16 v[188:191], a[180:183], v[204:207], v[188:191]
  ds_read_b64_tr_b16 a[158:159], v15 offset:45568
  buffer_store_dwordx4 v[128:131], v1, s[12:15], s23 offen offset:0 sc0 sc1
  s_waitcnt lgkmcnt(8)
  v_mfma_f32_16x16x32_bf16 v[160:163], a[184:187], v[208:211], v[160:163]
  ds_read_b64_tr_b16 a[160:161], v12 offset:49152
  v_permlane16_swap_b32 v136, v138
  v_mfma_f32_16x16x32_bf16 v[164:167], a[184:187], v[212:215], v[164:167]
  ds_read_b64_tr_b16 a[162:163], v12 offset:49664
  v_permlane16_swap_b32 v137, v139
  buffer_store_dwordx4 v[136:139], v1, s[12:15], s23 offen offset:256 sc0 sc1
  v_mfma_f32_16x16x32_bf16 v[168:171], a[188:191], v[208:211], v[168:171]
  ds_read_b64_tr_b16 a[164:165], v13 offset:49152
  v_permlane16_swap_b32 v144, v146
  v_mfma_f32_16x16x32_bf16 v[172:175], a[188:191], v[212:215], v[172:175]
  ds_read_b64_tr_b16 a[166:167], v13 offset:49664
  v_permlane16_swap_b32 v145, v147
  v_mfma_f32_16x16x32_bf16 v[176:179], a[192:195], v[208:211], v[176:179]
  ds_read_b64_tr_b16 a[168:169], v14 offset:49152
  buffer_store_dwordx4 v[144:147], v1, s[12:15], s23 offen offset:512 sc0 sc1
  v_mfma_f32_16x16x32_bf16 v[180:183], a[192:195], v[212:215], v[180:183]
  ds_read_b64_tr_b16 a[170:171], v14 offset:49664
  v_permlane16_swap_b32 v152, v154
  v_mfma_f32_16x16x32_bf16 v[184:187], a[196:199], v[208:211], v[184:187]
  ds_read_b64_tr_b16 a[172:173], v15 offset:49152
  v_permlane16_swap_b32 v153, v155
  v_mfma_f32_16x16x32_bf16 v[188:191], a[196:199], v[212:215], v[188:191]
  ds_read_b64_tr_b16 a[174:175], v15 offset:49664
  buffer_store_dwordx4 v[152:155], v1, s[12:15], s23 offen offset:768 sc0 sc1
  s_waitcnt lgkmcnt(8)
  v_mfma_f32_16x16x32_bf16 v[160:163], a[144:147], v[216:219], v[160:163]
  ds_read_b64_tr_b16 a[176:177], v12 offset:53248
  v_mfma_f32_16x16x32_bf16 v[164:167], a[144:147], v[220:223], v[164:167]
  ds_read_b64_tr_b16 a[178:179], v12 offset:53760
  v_mfma_f32_16x16x32_bf16 v[168:171], a[148:151], v[216:219], v[168:171]
  ds_read_b64_tr_b16 a[180:181], v13 offset:53248
  v_mfma_f32_16x16x32_bf16 v[172:175], a[148:151], v[220:223], v[172:175]
  ds_read_b64_tr_b16 a[182:183], v13 offset:53760
  v_mfma_f32_16x16x32_bf16 v[176:179], a[152:155], v[216:219], v[176:179]
  ds_read_b64_tr_b16 a[184:185], v14 offset:53248
  v_mfma_f32_16x16x32_bf16 v[180:183], a[152:155], v[220:223], v[180:183]
  ds_read_b64_tr_b16 a[186:187], v14 offset:53760
  v_mfma_f32_16x16x32_bf16 v[184:187], a[156:159], v[216:219], v[184:187]
  ds_read_b64_tr_b16 a[188:189], v15 offset:53248
  v_mfma_f32_16x16x32_bf16 v[188:191], a[156:159], v[220:223], v[188:191]
  ds_read_b64_tr_b16 a[190:191], v15 offset:53760
  s_waitcnt vmcnt(8)
  s_barrier
  s_waitcnt lgkmcnt(8)
  v_mfma_f32_16x16x32_bf16 v[160:163], a[160:163], v[224:227], v[160:163]
  ds_read_b64_tr_b16 a[192:193], v12 offset:57344
  v_mfma_f32_16x16x32_bf16 v[164:167], a[160:163], v[228:231], v[164:167]
  ds_read_b64_tr_b16 a[194:195], v12 offset:57856
  v_mfma_f32_16x16x32_bf16 v[168:171], a[164:167], v[224:227], v[168:171]
  ds_read_b64_tr_b16 a[196:197], v13 offset:57344
  v_mfma_f32_16x16x32_bf16 v[172:175], a[164:167], v[228:231], v[172:175]
  ds_read_b64_tr_b16 a[198:199], v13 offset:57856
  v_mfma_f32_16x16x32_bf16 v[176:179], a[168:171], v[224:227], v[176:179]
  ds_read_b64_tr_b16 a[144:145], v14 offset:57344
  v_mfma_f32_16x16x32_bf16 v[180:183], a[168:171], v[228:231], v[180:183]
  ds_read_b64_tr_b16 a[146:147], v14 offset:57856
  v_mfma_f32_16x16x32_bf16 v[184:187], a[172:175], v[224:227], v[184:187]
  ds_read_b64_tr_b16 a[148:149], v15 offset:57344
  v_mfma_f32_16x16x32_bf16 v[188:191], a[172:175], v[228:231], v[188:191]
  ds_read_b64_tr_b16 a[150:151], v15 offset:57856
  s_waitcnt lgkmcnt(8)
  v_mfma_f32_16x16x32_bf16 v[160:163], a[176:179], v[232:235], v[160:163]
  ds_read_b64_tr_b16 a[152:153], v12 offset:61440
  v_and_b32 v29, 15, v0
  v_mfma_f32_16x16x32_bf16 v[164:167], a[176:179], v[236:239], v[164:167]
  ds_read_b64_tr_b16 a[154:155], v12 offset:61952
  v_lshlrev_b32 v29, 2, v29
  v_mfma_f32_16x16x32_bf16 v[168:171], a[180:183], v[232:235], v[168:171]
  ds_read_b64_tr_b16 a[156:157], v13 offset:61440
  v_accvgpr_read_b32 v28, a216
  v_mfma_f32_16x16x32_bf16 v[172:175], a[180:183], v[236:239], v[172:175]
  ds_read_b64_tr_b16 a[158:159], v13 offset:61952
  s_mov_b32 s43, s45
  v_mfma_f32_16x16x32_bf16 v[176:179], a[184:187], v[232:235], v[176:179]
  ds_read_b64_tr_b16 a[160:161], v14 offset:61440
  v_accvgpr_read_b32 v24, a219
  v_mfma_f32_16x16x32_bf16 v[180:183], a[184:187], v[236:239], v[180:183]
  ds_read_b64_tr_b16 a[162:163], v14 offset:61952
  v_accvgpr_read_b32 v25, a220
  v_mfma_f32_16x16x32_bf16 v[184:187], a[188:191], v[232:235], v[184:187]
  ds_read_b64_tr_b16 a[164:165], v15 offset:61440
  v_accvgpr_read_b32 v26, a221
  v_mfma_f32_16x16x32_bf16 v[188:191], a[188:191], v[236:239], v[188:191]
  ds_read_b64_tr_b16 a[166:167], v15 offset:61952
  s_waitcnt lgkmcnt(8)
  v_mfma_f32_16x16x32_bf16 v[160:163], a[192:195], v[240:243], v[160:163]
  ds_read_b64_tr_b16 a[168:169], v16 offset:0
  v_mfma_f32_16x16x32_bf16 v[164:167], a[192:195], v[244:247], v[164:167]
  ds_read_b64_tr_b16 a[170:171], v16 offset:512
  v_mfma_f32_16x16x32_bf16 v[168:171], a[196:199], v[240:243], v[168:171]
  ds_read_b64_tr_b16 a[172:173], v17 offset:0
  v_mfma_f32_16x16x32_bf16 v[172:175], a[196:199], v[244:247], v[172:175]
  ds_read_b64_tr_b16 a[174:175], v17 offset:512
  v_mfma_f32_16x16x32_bf16 v[176:179], a[144:147], v[240:243], v[176:179]
  ds_read_b64_tr_b16 a[176:177], v18 offset:0
  v_mfma_f32_16x16x32_bf16 v[180:183], a[144:147], v[244:247], v[180:183]
  ds_read_b64_tr_b16 a[178:179], v18 offset:512
  v_mfma_f32_16x16x32_bf16 v[184:187], a[148:151], v[240:243], v[184:187]
  ds_read_b64_tr_b16 a[180:181], v19 offset:0
  v_mfma_f32_16x16x32_bf16 v[188:191], a[148:151], v[244:247], v[188:191]
  ds_read_b64_tr_b16 a[182:183], v19 offset:512
  s_waitcnt lgkmcnt(8)
  v_mfma_f32_16x16x32_bf16 v[160:163], a[152:155], v[248:251], v[160:163]
  ds_read_b64_tr_b16 a[184:185], v16 offset:4096
  v_mfma_f32_16x16x32_bf16 v[164:167], a[152:155], v[252:255], v[164:167]
  ds_read_b64_tr_b16 a[186:187], v16 offset:4608
  s_waitcnt vmcnt(0)
  v_mfma_f32_16x16x32_bf16 v[168:171], a[156:159], v[248:251], v[168:171]
  ds_read_b64_tr_b16 a[188:189], v17 offset:4096
  v_mfma_f32_16x16x32_bf16 v[172:175], a[156:159], v[252:255], v[172:175]
  ds_read_b64_tr_b16 a[190:191], v17 offset:4608
  s_mov_b64 exec, 1
  buffer_store_dword v5, v6, s[12:15], s33 offen offset:64 sc0 sc1
  s_mov_b64 exec, -1
  v_mfma_f32_16x16x32_bf16 v[176:179], a[160:163], v[248:251], v[176:179]
  ds_read_b64_tr_b16 a[192:193], v18 offset:4096
  v_mfma_f32_16x16x32_bf16 v[180:183], a[160:163], v[252:255], v[180:183]
  ds_read_b64_tr_b16 a[194:195], v18 offset:4608
  buffer_load_dwordx4 v[64:67], v24, s[12:15], s44 offen sc1
  v_mfma_f32_16x16x32_bf16 v[184:187], a[164:167], v[248:251], v[184:187]
  ds_read_b64_tr_b16 a[196:197], v19 offset:4096
  v_mfma_f32_16x16x32_bf16 v[188:191], a[164:167], v[252:255], v[188:191]
  ds_read_b64_tr_b16 a[198:199], v19 offset:4608
  s_waitcnt lgkmcnt(8)
  v_mfma_f32_16x16x32_bf16 v[160:163], a[168:171], a[0:3], v[160:163]
  ds_read_b64_tr_b16 a[144:145], v16 offset:8192
  v_mfma_f32_16x16x32_bf16 v[164:167], a[168:171], a[4:7], v[164:167]
  ds_read_b64_tr_b16 a[146:147], v16 offset:8704
  buffer_load_dwordx4 v[68:71], v25, s[12:15], s44 offen sc1
  v_mfma_f32_16x16x32_bf16 v[168:171], a[172:175], a[0:3], v[168:171]
  ds_read_b64_tr_b16 a[148:149], v17 offset:8192
  v_mfma_f32_16x16x32_bf16 v[172:175], a[172:175], a[4:7], v[172:175]
  ds_read_b64_tr_b16 a[150:151], v17 offset:8704
  v_mfma_f32_16x16x32_bf16 v[176:179], a[176:179], a[0:3], v[176:179]
  ds_read_b64_tr_b16 a[152:153], v18 offset:8192
  v_mfma_f32_16x16x32_bf16 v[180:183], a[176:179], a[4:7], v[180:183]
  ds_read_b64_tr_b16 a[154:155], v18 offset:8704
  v_mfma_f32_16x16x32_bf16 v[184:187], a[180:183], a[0:3], v[184:187]
  ds_read_b64_tr_b16 a[156:157], v19 offset:8192
  v_mfma_f32_16x16x32_bf16 v[188:191], a[180:183], a[4:7], v[188:191]
  ds_read_b64_tr_b16 a[158:159], v19 offset:8704
  s_waitcnt lgkmcnt(8)
  v_mfma_f32_16x16x32_bf16 v[160:163], a[184:187], a[8:11], v[160:163]
  ds_read_b64_tr_b16 a[160:161], v16 offset:12288
  v_mfma_f32_16x16x32_bf16 v[164:167], a[184:187], a[12:15], v[164:167]
  ds_read_b64_tr_b16 a[162:163], v16 offset:12800
  buffer_load_dwordx4 v[72:75], v26, s[12:15], s44 offen sc1
  v_mfma_f32_16x16x32_bf16 v[168:171], a[188:191], a[8:11], v[168:171]
  ds_read_b64_tr_b16 a[164:165], v17 offset:12288
  v_mfma_f32_16x16x32_bf16 v[172:175], a[188:191], a[12:15], v[172:175]
  ds_read_b64_tr_b16 a[166:167], v17 offset:12800
  v_mfma_f32_16x16x32_bf16 v[176:179], a[192:195], a[8:11], v[176:179]
  ds_read_b64_tr_b16 a[168:169], v18 offset:12288
  v_mfma_f32_16x16x32_bf16 v[180:183], a[192:195], a[12:15], v[180:183]
  ds_read_b64_tr_b16 a[170:171], v18 offset:12800
  v_mfma_f32_16x16x32_bf16 v[184:187], a[196:199], a[8:11], v[184:187]
  ds_read_b64_tr_b16 a[172:173], v19 offset:12288
  v_mfma_f32_16x16x32_bf16 v[188:191], a[196:199], a[12:15], v[188:191]
  ds_read_b64_tr_b16 a[174:175], v19 offset:12800
  s_waitcnt lgkmcnt(8)
  v_mfma_f32_16x16x32_bf16 v[160:163], a[144:147], a[16:19], v[160:163]
  ds_read_b64_tr_b16 a[176:177], v8 offset:0
  v_mfma_f32_16x16x32_bf16 v[164:167], a[144:147], a[20:23], v[164:167]
  ds_read_b64_tr_b16 a[178:179], v8 offset:512
  v_mfma_f32_16x16x32_bf16 v[168:171], a[148:151], a[16:19], v[168:171]
  ds_read_b64_tr_b16 a[180:181], v9 offset:0
  v_mfma_f32_16x16x32_bf16 v[172:175], a[148:151], a[20:23], v[172:175]
  ds_read_b64_tr_b16 a[182:183], v9 offset:512
  v_mfma_f32_16x16x32_bf16 v[176:179], a[152:155], a[16:19], v[176:179]
  ds_read_b64_tr_b16 a[184:185], v10 offset:0
  v_mfma_f32_16x16x32_bf16 v[180:183], a[152:155], a[20:23], v[180:183]
  ds_read_b64_tr_b16 a[186:187], v10 offset:512
  v_mfma_f32_16x16x32_bf16 v[184:187], a[156:159], a[16:19], v[184:187]
  ds_read_b64_tr_b16 a[188:189], v11 offset:0
  v_mfma_f32_16x16x32_bf16 v[188:191], a[156:159], a[20:23], v[188:191]
  ds_read_b64_tr_b16 a[190:191], v11 offset:512
  s_waitcnt lgkmcnt(8)
  v_mfma_f32_16x16x32_bf16 v[160:163], a[160:163], a[24:27], v[160:163]
  ds_read_b64_tr_b16 a[192:193], v8 offset:4096
  v_mfma_f32_16x16x32_bf16 v[164:167], a[160:163], a[28:31], v[164:167]
  ds_read_b64_tr_b16 a[194:195], v8 offset:4608
  v_mfma_f32_16x16x32_bf16 v[168:171], a[164:167], a[24:27], v[168:171]
  ds_read_b64_tr_b16 a[196:197], v9 offset:4096
  v_mfma_f32_16x16x32_bf16 v[172:175], a[164:167], a[28:31], v[172:175]
  ds_read_b64_tr_b16 a[198:199], v9 offset:4608
  v_mfma_f32_16x16x32_bf16 v[176:179], a[168:171], a[24:27], v[176:179]
  ds_read_b64_tr_b16 a[144:145], v10 offset:4096
  v_mfma_f32_16x16x32_bf16 v[180:183], a[168:171], a[28:31], v[180:183]
  ds_read_b64_tr_b16 a[146:147], v10 offset:4608
  v_mfma_f32_16x16x32_bf16 v[184:187], a[172:175], a[24:27], v[184:187]
  ds_read_b64_tr_b16 a[148:149], v11 offset:4096
  v_mfma_f32_16x16x32_bf16 v[188:191], a[172:175], a[28:31], v[188:191]
  ds_read_b64_tr_b16 a[150:151], v11 offset:4608
  s_waitcnt lgkmcnt(8)
  v_mfma_f32_16x16x32_bf16 v[160:163], a[176:179], a[32:35], v[160:163]
  ds_read_b64_tr_b16 a[152:153], v8 offset:8192
  v_mfma_f32_16x16x32_bf16 v[164:167], a[176:179], a[36:39], v[164:167]
  ds_read_b64_tr_b16 a[154:155], v8 offset:8704
  v_mfma_f32_16x16x32_bf16 v[168:171], a[180:183], a[32:35], v[168:171]
  ds_read_b64_tr_b16 a[156:157], v9 offset:8192
  v_mfma_f32_16x16x32_bf16 v[172:175], a[180:183], a[36:39], v[172:175]
  ds_read_b64_tr_b16 a[158:159], v9 offset:8704
  v_mfma_f32_16x16x32_bf16 v[176:179], a[184:187], a[32:35], v[176:179]
  ds_read_b64_tr_b16 a[160:161], v10 offset:8192
  v_mfma_f32_16x16x32_bf16 v[180:183], a[184:187], a[36:39], v[180:183]
  ds_read_b64_tr_b16 a[162:163], v10 offset:8704
  v_mfma_f32_16x16x32_bf16 v[184:187], a[188:191], a[32:35], v[184:187]
  ds_read_b64_tr_b16 a[164:165], v11 offset:8192
  v_mfma_f32_16x16x32_bf16 v[188:191], a[188:191], a[36:39], v[188:191]
  ds_read_b64_tr_b16 a[166:167], v11 offset:8704
  s_waitcnt lgkmcnt(8)
  v_mfma_f32_16x16x32_bf16 v[160:163], a[192:195], a[40:43], v[160:163]
  ds_read_b64_tr_b16 a[168:169], v8 offset:12288
  v_mfma_f32_16x16x32_bf16 v[164:167], a[192:195], a[44:47], v[164:167]
  ds_read_b64_tr_b16 a[170:171], v8 offset:12800
  v_mfma_f32_16x16x32_bf16 v[168:171], a[196:199], a[40:43], v[168:171]
  ds_read_b64_tr_b16 a[172:173], v9 offset:12288
  v_mfma_f32_16x16x32_bf16 v[172:175], a[196:199], a[44:47], v[172:175]
  ds_read_b64_tr_b16 a[174:175], v9 offset:12800
  v_mfma_f32_16x16x32_bf16 v[176:179], a[144:147], a[40:43], v[176:179]
  ds_read_b64_tr_b16 a[176:177], v10 offset:12288
  v_mfma_f32_16x16x32_bf16 v[180:183], a[144:147], a[44:47], v[180:183]
  ds_read_b64_tr_b16 a[178:179], v10 offset:12800
  v_mfma_f32_16x16x32_bf16 v[184:187], a[148:151], a[40:43], v[184:187]
  ds_read_b64_tr_b16 a[180:181], v11 offset:12288
  v_mfma_f32_16x16x32_bf16 v[188:191], a[148:151], a[44:47], v[188:191]
  ds_read_b64_tr_b16 a[182:183], v11 offset:12800
  s_waitcnt lgkmcnt(8)
  v_mfma_f32_16x16x32_bf16 v[160:163], a[152:155], a[48:51], v[160:163]
  ds_read_b64_tr_b16 a[184:185], v8 offset:16384
  v_mfma_f32_16x16x32_bf16 v[164:167], a[152:155], a[52:55], v[164:167]
  ds_read_b64_tr_b16 a[186:187], v8 offset:16896
  v_mfma_f32_16x16x32_bf16 v[168:171], a[156:159], a[48:51], v[168:171]
  ds_read_b64_tr_b16 a[188:189], v9 offset:16384
  v_mfma_f32_16x16x32_bf16 v[172:175], a[156:159], a[52:55], v[172:175]
  ds_read_b64_tr_b16 a[190:191], v9 offset:16896
  v_mfma_f32_16x16x32_bf16 v[176:179], a[160:163], a[48:51], v[176:179]
  ds_read_b64_tr_b16 a[192:193], v10 offset:16384
  v_mfma_f32_16x16x32_bf16 v[180:183], a[160:163], a[52:55], v[180:183]
  ds_read_b64_tr_b16 a[194:195], v10 offset:16896
  v_mfma_f32_16x16x32_bf16 v[184:187], a[164:167], a[48:51], v[184:187]
  ds_read_b64_tr_b16 a[196:197], v11 offset:16384
  v_mfma_f32_16x16x32_bf16 v[188:191], a[164:167], a[52:55], v[188:191]
  ds_read_b64_tr_b16 a[198:199], v11 offset:16896
  s_waitcnt lgkmcnt(8)
  v_mfma_f32_16x16x32_bf16 v[160:163], a[168:171], a[56:59], v[160:163]
  ds_read_b64_tr_b16 a[144:145], v8 offset:20480
  v_mfma_f32_16x16x32_bf16 v[164:167], a[168:171], a[60:63], v[164:167]
  ds_read_b64_tr_b16 a[146:147], v8 offset:20992
  v_mfma_f32_16x16x32_bf16 v[168:171], a[172:175], a[56:59], v[168:171]
  ds_read_b64_tr_b16 a[148:149], v9 offset:20480
  v_mfma_f32_16x16x32_bf16 v[172:175], a[172:175], a[60:63], v[172:175]
  ds_read_b64_tr_b16 a[150:151], v9 offset:20992
  v_mfma_f32_16x16x32_bf16 v[176:179], a[176:179], a[56:59], v[176:179]
  ds_read_b64_tr_b16 a[152:153], v10 offset:20480
  v_mfma_f32_16x16x32_bf16 v[180:183], a[176:179], a[60:63], v[180:183]
  ds_read_b64_tr_b16 a[154:155], v10 offset:20992
  v_mfma_f32_16x16x32_bf16 v[184:187], a[180:183], a[56:59], v[184:187]
  ds_read_b64_tr_b16 a[156:157], v11 offset:20480
  v_mfma_f32_16x16x32_bf16 v[188:191], a[180:183], a[60:63], v[188:191]
  ds_read_b64_tr_b16 a[158:159], v11 offset:20992
  s_waitcnt lgkmcnt(8)
  v_mfma_f32_16x16x32_bf16 v[160:163], a[184:187], a[64:67], v[160:163]
  v_mfma_f32_16x16x32_bf16 v[164:167], a[184:187], a[68:71], v[164:167]
  v_mfma_f32_16x16x32_bf16 v[168:171], a[188:191], a[64:67], v[168:171]
  v_mfma_f32_16x16x32_bf16 v[172:175], a[188:191], a[68:71], v[172:175]
  v_mfma_f32_16x16x32_bf16 v[176:179], a[192:195], a[64:67], v[176:179]
  v_mfma_f32_16x16x32_bf16 v[180:183], a[192:195], a[68:71], v[180:183]
  v_mfma_f32_16x16x32_bf16 v[184:187], a[196:199], a[64:67], v[184:187]
  v_mfma_f32_16x16x32_bf16 v[188:191], a[196:199], a[68:71], v[188:191]
  s_waitcnt lgkmcnt(0)
  v_mfma_f32_16x16x32_bf16 v[160:163], a[144:147], a[72:75], v[160:163]
  v_mfma_f32_16x16x32_bf16 v[164:167], a[144:147], a[76:79], v[164:167]
  buffer_load_dword v7, v29, s[12:15], s48 offen sc0 sc1
  v_mfma_f32_16x16x32_bf16 v[168:171], a[148:151], a[72:75], v[168:171]
  v_mfma_f32_16x16x32_bf16 v[172:175], a[148:151], a[76:79], v[172:175]
  v_mfma_f32_16x16x32_bf16 v[176:179], a[152:155], a[72:75], v[176:179]
  v_mfma_f32_16x16x32_bf16 v[180:183], a[152:155], a[76:79], v[180:183]
  v_mfma_f32_16x16x32_bf16 v[184:187], a[156:159], a[72:75], v[184:187]
  v_mfma_f32_16x16x32_bf16 v[188:191], a[156:159], a[76:79], v[188:191]
  s_lshl_b32 s23, s100, 3
  s_add_u32 s23, s23, s25
  v_cvt_pk_bf16_f32 v160, v160, v161
  v_cvt_pk_bf16_f32 v161, v162, v163
  v_cvt_pk_bf16_f32 v162, v164, v165
  v_cvt_pk_bf16_f32 v163, v166, v167
  v_cvt_pk_bf16_f32 v168, v168, v169
  v_cvt_pk_bf16_f32 v169, v170, v171
  v_cvt_pk_bf16_f32 v170, v172, v173
  v_cvt_pk_bf16_f32 v171, v174, v175
  v_cvt_pk_bf16_f32 v176, v176, v177
  v_cvt_pk_bf16_f32 v177, v178, v179
  v_cvt_pk_bf16_f32 v178, v180, v181
  v_cvt_pk_bf16_f32 v179, v182, v183
  v_cvt_pk_bf16_f32 v184, v184, v185
  v_cvt_pk_bf16_f32 v185, v186, v187
  v_cvt_pk_bf16_f32 v186, v188, v189
  v_cvt_pk_bf16_f32 v187, v190, v191
  v_permlane16_swap_b32 v160, v162
  v_permlane16_swap_b32 v161, v163
  buffer_store_dwordx4 v[160:163], v1, s[12:15], s23 offen offset:0 sc0 sc1
  v_permlane16_swap_b32 v168, v170
  v_permlane16_swap_b32 v169, v171
  buffer_store_dwordx4 v[168:171], v1, s[12:15], s23 offen offset:256 sc0 sc1
  v_permlane16_swap_b32 v176, v178
  v_permlane16_swap_b32 v177, v179
  buffer_store_dwordx4 v[176:179], v1, s[12:15], s23 offen offset:512 sc0 sc1
  v_permlane16_swap_b32 v184, v186
  v_permlane16_swap_b32 v185, v187
  buffer_store_dwordx4 v[184:187], v1, s[12:15], s23 offen offset:768 sc0 sc1
  s_waitcnt vmcnt(4)
  v_cmp_ne_u32 s[40:41], 1, v7
  s_nop 0
  s_cmp_eq_u64 s[40:41], 0
  s_cbranch_scc1 L_vk_p21
  s_mov_b32 s42, 0
L_vs_p21:
  buffer_load_dword v7, v29, s[12:15], s48 offen sc0 sc1
  s_add_u32 s42, s42, 1
  s_waitcnt vmcnt(0)
  v_cmp_ne_u32 s[40:41], 1, v7
  s_cmp_gt_u32 s42, 0x40000
  s_cbranch_scc1 L_vk_p21
  s_cmp_lg_u64 s[40:41], 0
  s_cbranch_scc1 L_vs_p21
L_vk_p21:
  buffer_load_dwordx4 v[32:35], v28, s[12:15], s43 offen sc1
  s_add_u32 s43, s43, 9216
  buffer_load_dwordx4 v[36:39], v28, s[12:15], s43 offen sc1
  s_add_u32 s43, s43, 9216
  s_waitcnt vmcnt(2)
  s_mov_b64 exec, 1
  buffer_store_dword v5, v6, s[12:15], s33 offen offset:128 sc0 sc1
  s_mov_b64 exec, -1
  buffer_load_dwordx4 v[40:43], v28, s[12:15], s43 offen sc1
  s_add_u32 s43, s43, 9216
  buffer_load_dwordx4 v[44:47], v28, s[12:15], s43 offen sc1
  s_add_u32 s43, s43, 9216
  buffer_load_dwordx4 v[48:51], v28, s[12:15], s43 offen sc1
  s_add_u32 s43, s43, 9216
  buffer_load_dwordx4 v[52:55], v28, s[12:15], s43 offen sc1
  s_add_u32 s43, s43, 9216
  buffer_load_dwordx4 v[56:59], v28, s[12:15], s43 offen sc1
  s_add_u32 s43, s43, 9216
  buffer_load_dwordx4 v[60:63], v28, s[12:15], s43 offen sc1
  s_add_u32 s43, s43, 9216
  s_branch L_c_join
L_kf_last:
.section .rodata,"a"
.p2align 6
.amdhsa_kernel k0_kernel
  .amdhsa_next_free_vgpr 96
  .amdhsa_next_free_sgpr 102
  .amdhsa_accum_offset 96
  .amdhsa_group_segment_fixed_size 0
  .amdhsa_kernarg_size 88
  .amdhsa_user_sgpr_count 2
  .amdhsa_user_sgpr_kernarg_segment_ptr 1
  .amdhsa_system_sgpr_workgroup_id_x 1
.end_amdhsa_kernel
.p2align 6
.amdhsa_kernel kf_kernel
  .amdhsa_next_free_vgpr 512
  .amdhsa_next_free_sgpr 102
  .amdhsa_accum_offset 256
  .amdhsa_group_segment_fixed_size 0
  .amdhsa_kernarg_size 88
  .amdhsa_user_sgpr_count 2
  .amdhsa_user_sgpr_kernarg_segment_ptr 1
  .amdhsa_system_sgpr_workgroup_id_x 1
.end_amdhsa_kernel
```
